```python
import torch

def _softmax(x, axis=-1):
    return torch.softmax(x, dim=axis)
def _gelu(x):
    return torch.nn.functional.gelu(x, approximate="tanh")
def _silu(x):
    return torch.nn.functional.silu(x)
def _sigmoid(x):
    return torch.sigmoid(x)
def _layernorm(x, axis=-1, eps=1e-5):
    m = x.mean(dim=axis, keepdim=True)
    v = x.var(dim=axis, keepdim=True, unbiased=False)
    return (x - m) / torch.sqrt(v + eps)
def _scatter_add(tgt, idx, src, axis=0):
    return tgt.clone().index_add_(axis, idx, src)
def _segment_sum(src, seg, n):
    out = torch.zeros((n,) + src.shape[1:], dtype=src.dtype)
    return out.index_add_(0, seg, src)
def _pad(x, pw):
    flat = tuple(v for pair in reversed(pw) for v in pair)
    return torch.nn.functional.pad(x, flat)

kernel_name = 'gated_mix__grouped_kv_mqa__mixer_channel_mlp__prompt'

def setup_inputs():

    _w = (lambda a: (lambda t: t.to(torch.bfloat16) if t.is_floating_point() else t)(torch.as_tensor(a)))
    def _A_setup():
        B, S, D, H = 1, 2048, 576, 32
        Dh = D // H
        return {
            "x": _w((lambda *s: torch.randn(*s, dtype=torch.bfloat16) * 0.05)(B, S, D)),
            "wq": _w((lambda *s: torch.randn(*s, dtype=torch.bfloat16) * 0.8)(D, H * Dh)),
            "wk": _w((lambda *s: torch.randn(*s, dtype=torch.bfloat16) * 0.8)(D, Dh)),
            "wv": _w((lambda *s: torch.randn(*s, dtype=torch.bfloat16) * 0.2)(D, Dh)),
            "wo": _w((lambda *s: torch.randn(*s, dtype=torch.bfloat16) * 0.2)(H * Dh, D)),
        }
    _A_in = _A_setup()

    def _B_setup():
        B, S, D, F = 1, 2048, 576, 4608
        return {
            "x": _w((lambda *s: torch.randn(*s, dtype=torch.bfloat16) * 0.05)(B, S, D)),
            "w1": _w((lambda *s: torch.randn(*s, dtype=torch.bfloat16) * 0.8)(D, F) * (D ** -0.5)),
            "b1": _w((lambda *s: torch.randn(*s, dtype=torch.bfloat16) * 0.8)(F)),
            "w2": _w((lambda *s: torch.randn(*s, dtype=torch.bfloat16) * 0.05)(F, D) * (F ** -0.5)),
            "b2": _w((lambda *s: torch.randn(*s, dtype=torch.bfloat16) * 0.05)(D)),
        }
    _B_in = _B_setup()

    return {
        "A_x": _A_in["x"],
        "A_wq": _A_in["wq"],
        "A_wk": _A_in["wk"],
        "A_wv": _A_in["wv"],
        "A_wo": _A_in["wo"],
        "B_x": _B_in["x"],
        "B_w1": _B_in["w1"],
        "B_b1": _B_in["b1"],
        "B_w2": _B_in["w2"],
        "B_b2": _B_in["b2"],
        "gate_w": _w((lambda *s: torch.randn(*s, dtype=torch.bfloat16) * 0.05)(576) * 16.0),
    }

def reference(A_x, A_wq, A_wk, A_wv, A_wo, B_x, B_w1, B_b1, B_w2, B_b2, gate_w):
    def _A_ref(x, wq, wk, wv, wo):
        B, S, D = x.shape
        H = 32
        Dh = D // H
        q = (lambda x, *d: x.permute(*d))((x @ wq).reshape(B, S, H, Dh), 0, 2, 1, 3)
        k = x @ wk
        v = x @ wv
        scores = torch.einsum("bhqd,bkd->bhqk", q, k) * (Dh ** -0.5)
        p = _softmax(scores, axis=-1)
        o = torch.einsum("bhqk,bkd->bhqd", p, v)
        return (lambda x, *d: x.permute(*d))(o, 0, 2, 1, 3).reshape(B, S, H * Dh) @ wo

    def _B_ref(x, w1, b1, w2, b2):
        y = _layernorm(x, axis=-1)
        h = _gelu(torch.einsum("bsd,df->bsf", y, w1) + b1)
        return torch.einsum("bsf,fd->bsd", h, w2) + b2

    x = A_x
    g = _sigmoid((x * gate_w).sum(-1, keepdims=True))
    a = _A_ref(x, A_wq, A_wk, A_wv, A_wo)
    b = _B_ref(x, B_w1, B_b1, B_w2, B_b2)
    return g * a + (1 - g) * b
```

```asm
; @launch grid=(256,1,1) block=(256,1,1) lds=160768
.amdgcn_target "amdgcn-amd-amdhsa--gfx950"
.text
.globl gated_mix__grouped_kv_mqa__mixer_channel_mlp__prompt_kernel
.p2align 8
.type gated_mix__grouped_kv_mqa__mixer_channel_mlp__prompt_kernel,@function
gated_mix__grouped_kv_mqa__mixer_channel_mlp__prompt_kernel:
    s_cmp_ge_u32 s2, 256
    s_cbranch_scc1 MK_end
    s_getpc_b64 s[68:69]
MK_pc:
    v_lshrrev_b32 v126, 6, v0
    s_lshr_b32 s7, s2, 3
    s_lshl_b32 s7, s7, 2
    v_add_u32 v126, s7, v126
    v_lshlrev_b32 v126, 3, v126
    v_and_b32 v127, 7, v0
    v_add_u32 v126, v126, v127
    v_lshlrev_b32 v126, 7, v126
    v_and_b32 v127, 63, v0
    v_cmp_gt_u32 vcc, 8, v127
    s_nop 3
    s_mov_b64 s[8:9], vcc
    s_mov_b32 s7, MK_codeend-MK_pc
    v_cmp_gt_u32 vcc, s7, v126
    s_nop 3
    s_and_b64 vcc, vcc, s[8:9]
    s_and_saveexec_b64 s[8:9], vcc
    s_cbranch_execz MK_nopf
    global_load_dword v128, v126, s[68:69]
MK_nopf:
    s_mov_b64 exec, s[8:9]
    s_load_dwordx4 s[40:43], s[0:1], 0
    s_load_dwordx4 s[56:59], s[0:1], 96
    s_load_dwordx4 s[44:47], s[0:1], 16
    s_load_dwordx4 s[52:55], s[0:1], 48
    s_load_dwordx2 s[50:51], s[0:1], 64
    s_load_dwordx2 s[48:49], s[0:1], 80
    s_and_b32 s3, s2, 7
    s_lshr_b32 s4, s2, 3
    v_lshrrev_b32 v2, 6, v0
    v_and_b32 v1, 63, v0
    s_nop 0
    v_readfirstlane_b32 s5, v2
    s_cmp_ge_u32 s4, 16
    s_cbranch_scc1 MK_ida
    s_lshr_b32 s6, s3, 1
    s_and_b32 s7, s3, 1
    s_and_b32 s8, s4, 3
    s_lshr_b32 s9, s4, 2
    s_lshl_b32 s6, s6, 2
    s_add_u32 s4, s6, s8
    s_lshl_b32 s7, s7, 2
    s_add_u32 s3, s7, s9
    s_branch MK_idd
MK_ida:
    s_sub_u32 s4, s4, 16
    s_lshl_b32 s6, s3, 1
    s_and_b32 s7, s4, 1
    s_lshr_b32 s3, s4, 1
    s_add_u32 s4, s6, s7
MK_idd:
    s_lshl_b32 s6, s4, 2
    s_add_u32 s6, s6, s5
    s_lshr_b32 s7, s2, 3
    s_cmp_ge_u32 s7, 16
    s_cbranch_scc1 A_start
M_start:
    v_lshlrev_b32 v12, 4, v1
    v_lshlrev_b32 v13, 3, v0
    v_lshlrev_b32 v14, 4, v0
    v_and_b32 v74, 31, v1
    v_lshrrev_b32 v75, 5, v1
    v_and_b32 v15, 3, v1
    v_lshlrev_b32 v15, 4, v15
    v_lshrrev_b32 v16, 5, v1
    v_lshlrev_b32 v16, 6, v16
    v_add_u32 v15, v15, v16
    v_bfe_u32 v16, v1, 2, 3
    v_mul_u32_u24 v2, 9216, v16
    v_add_u32 v2, v2, v15
    v_mul_u32_u24 v6, 1152, v16
    v_add_u32 v6, v6, v15
    v_add_u32 v3, 72704, v2
    v_add_u32 v7, 8192, v6
    v_add_u32 v4, 145408, v2
    v_add_u32 v8, 16384, v6
    v_add_u32 v5, 218112, v2
    v_add_u32 v9, 24576, v6
    v_lshrrev_b32 v15, 5, v1
    v_bfe_u32 v16, v1, 2, 2
    v_lshlrev_b32 v16, 6, v16
    v_bfe_u32 v17, v1, 4, 1
    v_lshlrev_b32 v17, 5, v17
    v_add_u32 v16, v16, v17
    v_and_b32 v17, 3, v1
    v_lshlrev_b32 v17, 3, v17
    v_add_u32 v16, v16, v17
    v_lshlrev_b32 v17, 10, v15
    v_add_u32 v17, v17, v16
    v_lshlrev_b32 v18, 8, v15
    v_add_u32 v18, v18, v16
    v_add_u32 v104, 0, v17
    v_add_u32 v108, 0, v18
    v_add_u32 v105, 36864, v17
    v_add_u32 v109, 36864, v18
    v_add_u32 v106, 73728, v17
    v_add_u32 v110, 73728, v18
    v_add_u32 v107, 110592, v17
    v_add_u32 v111, 110592, v18
    v_lshlrev_b32 v15, 4, v15
    v_add_u32 v10, 147456, v15
    v_mov_b32 v11, 0x409d30fc
    v_and_b32 v72, 31, v1
    v_bfe_u32 v73, v72, 1, 3
    v_mul_u32_u24 v72, 1152, v72
    s_mul_i32 s11, s5, 36864
    v_add_u32 v72, s11, v72
    v_lshrrev_b32 v68, 5, v1
    v_add_u32 v68, 0, v68
    v_xor_b32 v68, v68, v73
    v_lshlrev_b32 v68, 4, v68
    v_add_u32 v68, v72, v68
    v_lshrrev_b32 v69, 5, v1
    v_add_u32 v69, 2, v69
    v_xor_b32 v69, v69, v73
    v_lshlrev_b32 v69, 4, v69
    v_add_u32 v69, v72, v69
    v_lshrrev_b32 v70, 5, v1
    v_add_u32 v70, 4, v70
    v_xor_b32 v70, v70, v73
    v_lshlrev_b32 v70, 4, v70
    v_add_u32 v70, v72, v70
    v_lshrrev_b32 v71, 5, v1
    v_add_u32 v71, 6, v71
    v_xor_b32 v71, v71, v73
    v_lshlrev_b32 v71, 4, v71
    v_add_u32 v71, v72, v71
    s_waitcnt lgkmcnt(0)
    s_mov_b32 s64, s40
    s_and_b32 s65, s41, 0xffff
    s_mov_b32 s66, 2359296
    s_mov_b32 s67, 0x20000
    s_lshr_b32 s7, s2, 3
    s_lshl_b32 s7, s7, 2
    s_add_u32 s7, s7, s5
    s_and_b32 s8, s2, 7
    s_lshr_b32 s9, s8, 1
    v_lshlrev_b32 v118, 7, v1
    s_mul_i32 s10, s7, 4608
    s_mul_i32 s11, s9, 589824
    s_add_u32 s10, s10, s11
    s_mov_b32 exec_hi, 15
    buffer_load_dword v119, v118, s[64:67], s10 offen
    s_mov_b32 exec_hi, -1
    s_mov_b64 s[94:95], s[42:43]
    s_mov_b32 s24, s58
    s_and_b32 s25, s59, 0xffff
    s_mov_b32 s26, 29372416
    s_mov_b32 s27, 0x20000
    v_mov_b32 v130, 0
    s_mov_b32 s9, 29368320
    s_mov_b64 exec, 1
    buffer_load_dword v130, v130, s[24:27], s9 offen sc1
    s_mov_b64 exec, -1
    s_mov_b32 s42, 911
    s_mul_i32 s44, s6, 36864
    s_add_u32 s99, s44, 18432
    s_mul_i32 s45, s5, 36864
    v_mov_b32 v115, v1
    s_mov_b32 s43, 18
XD_0:
    v_mul_lo_u32 v113, v115, s42
    v_lshrrev_b32 v113, 16, v113
    v_mul_u32_u24 v114, 72, v113
    v_sub_u32 v112, v115, v114
    v_bfe_u32 v114, v113, 1, 3
    v_xor_b32 v112, v112, v114
    v_lshlrev_b32 v112, 4, v112
    v_mul_u32_u24 v113, 1152, v113
    s_mov_b32 m0, s45
    v_add_u32 v116, v112, v113
    buffer_load_dwordx4 v116, s[64:67], s44 offen lds
    s_add_u32 m0, s45, 18432
    v_add_u32 v115, 64, v115
    buffer_load_dwordx4 v116, s[64:67], s99 offen lds
    s_add_u32 s45, s45, 1024
    s_sub_u32 s43, s43, 1
    s_cmp_lg_u32 s43, 0
    s_cbranch_scc1 XD_0
    s_mov_b32 s28, s52
    s_and_b32 s29, s53, 0xffff
    s_mov_b32 s30, 5308416
    s_mov_b32 s31, 0x20000
    s_mov_b32 s32, s50
    s_and_b32 s33, s51, 0xffff
    s_mov_b32 s34, 5308416
    s_mov_b32 s35, 0x20000
    s_mov_b32 s36, s54
    s_and_b32 s37, s55, 0xffff
    s_mov_b32 s38, 9216
    s_mov_b32 s39, 0x20000
    s_mov_b32 s60, s56
    s_and_b32 s61, s57, 0xffff
    s_mov_b32 s62, 256
    s_mov_b32 s63, 0x20000
    s_mov_b32 s12, s94
    s_and_b32 s13, s95, 0xffff
    s_mov_b32 s14, 663552
    s_mov_b32 s15, 0x20000
    s_mov_b32 s20, s48
    s_and_b32 s21, s49, 0xffff
    s_mov_b32 s22, 1152
    s_mov_b32 s23, 0x20000
    v_cmp_gt_u32 vcc, 144, v0
    s_nop 1
    s_mov_b64 s[46:47], vcc
    s_mul_i32 s40, s5, 663552
    s_mul_i32 s42, s3, 1152
    s_add_u32 s40, s40, s42
    s_mul_i32 s41, s3, 663552
    s_mul_i32 s42, s5, 82944
    s_add_u32 s41, s41, s42
    s_mul_i32 s43, s5, 9216
    s_mul_i32 s42, s3, 1152
    s_mov_b64 s[50:51], exec
    s_mov_b64 exec, s[46:47]
    buffer_load_dwordx2 v[60:61], v13, s[36:39], s42 offen
    s_mov_b64 exec, s[50:51]
    v_cmp_gt_u32 vcc, 72, v0
    s_nop 1
    s_mov_b64 s[54:55], vcc
    s_mov_b64 exec, s[54:55]
    buffer_load_dwordx4 v[64:67], v14, s[20:23], 0 offen
    s_mov_b64 exec, s[50:51]
    s_lshr_b32 s44, s2, 3
    s_lshl_b32 s44, s44, 2
    s_add_u32 s44, s44, s5
    s_and_b32 s45, s2, 1
    v_lshlrev_b32 v48, 7, v1
    s_mul_i32 s49, s44, 5248
    buffer_load_dword v49, v48, s[12:15], s49 offen
    s_mul_i32 s49, s44, 36
    v_add_u32 v50, s49, v1
    v_lshrrev_b32 v51, 3, v50
    v_mul_u32_u24 v51, 9216, v51
    v_bfe_u32 v48, v50, 1, 2
    v_mul_u32_u24 v48, 1152, v48
    v_add_u32 v51, v51, v48
    v_and_b32 v48, 1, v50
    v_lshlrev_b32 v48, 7, v48
    v_add_u32 v51, v51, v48
    s_mul_i32 s49, s45, 4608
    buffer_load_dword v52, v51, s[28:31], s49 offen
    s_waitcnt vmcnt(4)
    v_readfirstlane_b32 s98, v130
    s_nop 3
    s_add_u32 s98, s98, 1
    ds_read_b128 v[112:115], v68 offset:0
    ds_read_b128 v[116:119], v69 offset:0
    ds_read_b128 v[120:123], v70 offset:0
    ds_read_b128 v[124:127], v71 offset:0
    ds_read_b128 v[128:131], v68 offset:128
    ds_read_b128 v[132:135], v69 offset:128
    ds_read_b128 v[136:139], v70 offset:128
    ds_read_b128 v[140:143], v71 offset:128
    ds_read_b128 v[144:147], v68 offset:256
    ds_read_b128 v[148:151], v69 offset:256
    ds_read_b128 v[152:155], v70 offset:256
    ds_read_b128 v[156:159], v71 offset:256
    ds_read_b128 v[160:163], v68 offset:384
    ds_read_b128 v[164:167], v69 offset:384
    ds_read_b128 v[168:171], v70 offset:384
    ds_read_b128 v[172:175], v71 offset:384
    ds_read_b128 v[176:179], v68 offset:512
    ds_read_b128 v[180:183], v69 offset:512
    ds_read_b128 v[184:187], v70 offset:512
    ds_read_b128 v[188:191], v71 offset:512
    ds_read_b128 v[192:195], v68 offset:640
    ds_read_b128 v[196:199], v69 offset:640
    ds_read_b128 v[200:203], v70 offset:640
    ds_read_b128 v[204:207], v71 offset:640
    ds_read_b128 v[208:211], v68 offset:768
    ds_read_b128 v[212:215], v69 offset:768
    ds_read_b128 v[216:219], v70 offset:768
    ds_read_b128 v[220:223], v71 offset:768
    ds_read_b128 v[224:227], v68 offset:896
    ds_read_b128 v[228:231], v69 offset:896
    ds_read_b128 v[232:235], v70 offset:896
    ds_read_b128 v[236:239], v71 offset:896
    ds_read_b128 v[240:243], v68 offset:1024
    ds_read_b128 v[244:247], v69 offset:1024
    ds_read_b128 v[248:251], v70 offset:1024
    ds_read_b128 v[252:255], v71 offset:1024
    s_waitcnt vmcnt(2) lgkmcnt(0)
    s_barrier
    s_mov_b64 exec, s[46:47]
    v_and_b32 v63, 0xffff0000, v61
    v_lshlrev_b32 v62, 16, v61
    v_and_b32 v61, 0xffff0000, v60
    v_lshlrev_b32 v60, 16, v60
    v_mul_f32 v60, 0x3eeff558, v60
    v_mul_f32 v61, 0x3eeff558, v61
    v_mul_f32 v62, 0x3eeff558, v62
    v_mul_f32 v63, 0x3eeff558, v63
    v_add_u32 v76, 147456, v14
    ds_write_b128 v76, v[60:63]
    s_mov_b64 exec, s[54:55]
    v_add_u32 v76, 149760, v14
    ds_write_b128 v76, v[64:67]
    s_mov_b64 exec, s[50:51]
    s_mov_b32 s56, 0x3f803f80
    v_mov_b32 v78, 0
    v_mov_b32 v79, 0
    v_mov_b32 v81, 0
    v_mov_b32 v82, 0
    v_dot2_f32_bf16 v78, v112, s56, v78
    v_dot2_f32_bf16 v79, v112, v112, v79
    s_add_u32 m0, s43, 0
    s_add_u32 s44, s40, 0
    buffer_load_dwordx4 v2, s[28:31], s44 offen offset:0 lds
    v_dot2_f32_bf16 v81, v113, s56, v81
    v_dot2_f32_bf16 v82, v113, v113, v82
    v_dot2_f32_bf16 v78, v114, s56, v78
    v_dot2_f32_bf16 v79, v114, v114, v79
    v_dot2_f32_bf16 v81, v115, s56, v81
    v_dot2_f32_bf16 v82, v115, v115, v82
    v_dot2_f32_bf16 v78, v116, s56, v78
    v_dot2_f32_bf16 v79, v116, v116, v79
    v_dot2_f32_bf16 v81, v117, s56, v81
    v_dot2_f32_bf16 v82, v117, v117, v82
    s_add_u32 m0, s43, 1024
    s_add_u32 s44, s40, 73728
    buffer_load_dwordx4 v2, s[28:31], s44 offen offset:0 lds
    v_dot2_f32_bf16 v78, v118, s56, v78
    v_dot2_f32_bf16 v79, v118, v118, v79
    v_dot2_f32_bf16 v81, v119, s56, v81
    v_dot2_f32_bf16 v82, v119, v119, v82
    v_dot2_f32_bf16 v78, v120, s56, v78
    v_dot2_f32_bf16 v79, v120, v120, v79
    v_dot2_f32_bf16 v81, v121, s56, v81
    v_dot2_f32_bf16 v82, v121, v121, v82
    v_dot2_f32_bf16 v78, v122, s56, v78
    v_dot2_f32_bf16 v79, v122, v122, v79
    s_add_u32 m0, s43, 2048
    s_add_u32 s44, s40, 147456
    buffer_load_dwordx4 v2, s[28:31], s44 offen offset:0 lds
    v_dot2_f32_bf16 v81, v123, s56, v81
    v_dot2_f32_bf16 v82, v123, v123, v82
    v_dot2_f32_bf16 v78, v124, s56, v78
    v_dot2_f32_bf16 v79, v124, v124, v79
    v_dot2_f32_bf16 v81, v125, s56, v81
    v_dot2_f32_bf16 v82, v125, v125, v82
    v_dot2_f32_bf16 v78, v126, s56, v78
    v_dot2_f32_bf16 v79, v126, v126, v79
    v_dot2_f32_bf16 v81, v127, s56, v81
    v_dot2_f32_bf16 v82, v127, v127, v82
    s_add_u32 m0, s43, 3072
    s_add_u32 s44, s40, 221184
    buffer_load_dwordx4 v2, s[28:31], s44 offen offset:0 lds
    v_dot2_f32_bf16 v78, v128, s56, v78
    v_dot2_f32_bf16 v79, v128, v128, v79
    v_dot2_f32_bf16 v81, v129, s56, v81
    v_dot2_f32_bf16 v82, v129, v129, v82
    v_dot2_f32_bf16 v78, v130, s56, v78
    v_dot2_f32_bf16 v79, v130, v130, v79
    v_dot2_f32_bf16 v81, v131, s56, v81
    v_dot2_f32_bf16 v82, v131, v131, v82
    v_dot2_f32_bf16 v78, v132, s56, v78
    v_dot2_f32_bf16 v79, v132, v132, v79
    s_add_u32 m0, s43, 4096
    s_add_u32 s44, s40, 294912
    buffer_load_dwordx4 v2, s[28:31], s44 offen offset:0 lds
    v_dot2_f32_bf16 v81, v133, s56, v81
    v_dot2_f32_bf16 v82, v133, v133, v82
    v_dot2_f32_bf16 v78, v134, s56, v78
    v_dot2_f32_bf16 v79, v134, v134, v79
    v_dot2_f32_bf16 v81, v135, s56, v81
    v_dot2_f32_bf16 v82, v135, v135, v82
    v_dot2_f32_bf16 v78, v136, s56, v78
    v_dot2_f32_bf16 v79, v136, v136, v79
    v_dot2_f32_bf16 v81, v137, s56, v81
    v_dot2_f32_bf16 v82, v137, v137, v82
    s_add_u32 m0, s43, 5120
    s_add_u32 s44, s40, 368640
    buffer_load_dwordx4 v2, s[28:31], s44 offen offset:0 lds
    v_dot2_f32_bf16 v78, v138, s56, v78
    v_dot2_f32_bf16 v79, v138, v138, v79
    v_dot2_f32_bf16 v81, v139, s56, v81
    v_dot2_f32_bf16 v82, v139, v139, v82
    v_dot2_f32_bf16 v78, v140, s56, v78
    v_dot2_f32_bf16 v79, v140, v140, v79
    v_dot2_f32_bf16 v81, v141, s56, v81
    v_dot2_f32_bf16 v82, v141, v141, v82
    v_dot2_f32_bf16 v78, v142, s56, v78
    v_dot2_f32_bf16 v79, v142, v142, v79
    s_add_u32 m0, s43, 6144
    s_add_u32 s44, s40, 442368
    buffer_load_dwordx4 v2, s[28:31], s44 offen offset:0 lds
    v_dot2_f32_bf16 v81, v143, s56, v81
    v_dot2_f32_bf16 v82, v143, v143, v82
    v_dot2_f32_bf16 v78, v144, s56, v78
    v_dot2_f32_bf16 v79, v144, v144, v79
    v_dot2_f32_bf16 v81, v145, s56, v81
    v_dot2_f32_bf16 v82, v145, v145, v82
    v_dot2_f32_bf16 v78, v146, s56, v78
    v_dot2_f32_bf16 v79, v146, v146, v79
    v_dot2_f32_bf16 v81, v147, s56, v81
    v_dot2_f32_bf16 v82, v147, v147, v82
    s_add_u32 m0, s43, 7168
    s_add_u32 s44, s40, 516096
    buffer_load_dwordx4 v2, s[28:31], s44 offen offset:0 lds
    v_dot2_f32_bf16 v78, v148, s56, v78
    v_dot2_f32_bf16 v79, v148, v148, v79
    v_dot2_f32_bf16 v81, v149, s56, v81
    v_dot2_f32_bf16 v82, v149, v149, v82
    v_dot2_f32_bf16 v78, v150, s56, v78
    v_dot2_f32_bf16 v79, v150, v150, v79
    v_dot2_f32_bf16 v81, v151, s56, v81
    v_dot2_f32_bf16 v82, v151, v151, v82
    v_dot2_f32_bf16 v78, v152, s56, v78
    v_dot2_f32_bf16 v79, v152, v152, v79
    s_add_u32 m0, s43, 8192
    s_add_u32 s44, s40, 589824
    buffer_load_dwordx4 v2, s[28:31], s44 offen offset:0 lds
    v_dot2_f32_bf16 v81, v153, s56, v81
    v_dot2_f32_bf16 v82, v153, v153, v82
    v_dot2_f32_bf16 v78, v154, s56, v78
    v_dot2_f32_bf16 v79, v154, v154, v79
    v_dot2_f32_bf16 v81, v155, s56, v81
    v_dot2_f32_bf16 v82, v155, v155, v82
    v_dot2_f32_bf16 v78, v156, s56, v78
    v_dot2_f32_bf16 v79, v156, v156, v79
    v_dot2_f32_bf16 v81, v157, s56, v81
    v_dot2_f32_bf16 v82, v157, v157, v82
    s_add_u32 m0, s43, 36864
    s_add_u32 s44, s40, 2654208
    buffer_load_dwordx4 v2, s[28:31], s44 offen offset:0 lds
    v_dot2_f32_bf16 v78, v158, s56, v78
    v_dot2_f32_bf16 v79, v158, v158, v79
    v_dot2_f32_bf16 v81, v159, s56, v81
    v_dot2_f32_bf16 v82, v159, v159, v82
    v_dot2_f32_bf16 v78, v160, s56, v78
    v_dot2_f32_bf16 v79, v160, v160, v79
    v_dot2_f32_bf16 v81, v161, s56, v81
    v_dot2_f32_bf16 v82, v161, v161, v82
    v_dot2_f32_bf16 v78, v162, s56, v78
    v_dot2_f32_bf16 v79, v162, v162, v79
    s_add_u32 m0, s43, 37888
    s_add_u32 s44, s40, 2727936
    buffer_load_dwordx4 v2, s[28:31], s44 offen offset:0 lds
    v_dot2_f32_bf16 v81, v163, s56, v81
    v_dot2_f32_bf16 v82, v163, v163, v82
    v_dot2_f32_bf16 v78, v164, s56, v78
    v_dot2_f32_bf16 v79, v164, v164, v79
    v_dot2_f32_bf16 v81, v165, s56, v81
    v_dot2_f32_bf16 v82, v165, v165, v82
    v_dot2_f32_bf16 v78, v166, s56, v78
    v_dot2_f32_bf16 v79, v166, v166, v79
    v_dot2_f32_bf16 v81, v167, s56, v81
    v_dot2_f32_bf16 v82, v167, v167, v82
    s_add_u32 m0, s43, 38912
    s_add_u32 s44, s40, 2801664
    buffer_load_dwordx4 v2, s[28:31], s44 offen offset:0 lds
    v_dot2_f32_bf16 v78, v168, s56, v78
    v_dot2_f32_bf16 v79, v168, v168, v79
    v_dot2_f32_bf16 v81, v169, s56, v81
    v_dot2_f32_bf16 v82, v169, v169, v82
    v_dot2_f32_bf16 v78, v170, s56, v78
    v_dot2_f32_bf16 v79, v170, v170, v79
    v_dot2_f32_bf16 v81, v171, s56, v81
    v_dot2_f32_bf16 v82, v171, v171, v82
    v_dot2_f32_bf16 v78, v172, s56, v78
    v_dot2_f32_bf16 v79, v172, v172, v79
    s_add_u32 m0, s43, 39936
    s_add_u32 s44, s40, 2875392
    buffer_load_dwordx4 v2, s[28:31], s44 offen offset:0 lds
    v_dot2_f32_bf16 v81, v173, s56, v81
    v_dot2_f32_bf16 v82, v173, v173, v82
    v_dot2_f32_bf16 v78, v174, s56, v78
    v_dot2_f32_bf16 v79, v174, v174, v79
    v_dot2_f32_bf16 v81, v175, s56, v81
    v_dot2_f32_bf16 v82, v175, v175, v82
    v_dot2_f32_bf16 v78, v176, s56, v78
    v_dot2_f32_bf16 v79, v176, v176, v79
    v_dot2_f32_bf16 v81, v177, s56, v81
    v_dot2_f32_bf16 v82, v177, v177, v82
    s_add_u32 m0, s43, 40960
    s_add_u32 s44, s40, 2949120
    buffer_load_dwordx4 v2, s[28:31], s44 offen offset:0 lds
    v_dot2_f32_bf16 v78, v178, s56, v78
    v_dot2_f32_bf16 v79, v178, v178, v79
    v_dot2_f32_bf16 v81, v179, s56, v81
    v_dot2_f32_bf16 v82, v179, v179, v82
    v_dot2_f32_bf16 v78, v180, s56, v78
    v_dot2_f32_bf16 v79, v180, v180, v79
    v_dot2_f32_bf16 v81, v181, s56, v81
    v_dot2_f32_bf16 v82, v181, v181, v82
    v_dot2_f32_bf16 v78, v182, s56, v78
    v_dot2_f32_bf16 v79, v182, v182, v79
    s_add_u32 m0, s43, 41984
    s_add_u32 s44, s40, 3022848
    buffer_load_dwordx4 v2, s[28:31], s44 offen offset:0 lds
    v_dot2_f32_bf16 v81, v183, s56, v81
    v_dot2_f32_bf16 v82, v183, v183, v82
    v_dot2_f32_bf16 v78, v184, s56, v78
    v_dot2_f32_bf16 v79, v184, v184, v79
    v_dot2_f32_bf16 v81, v185, s56, v81
    v_dot2_f32_bf16 v82, v185, v185, v82
    v_dot2_f32_bf16 v78, v186, s56, v78
    v_dot2_f32_bf16 v79, v186, v186, v79
    v_dot2_f32_bf16 v81, v187, s56, v81
    v_dot2_f32_bf16 v82, v187, v187, v82
    s_add_u32 m0, s43, 43008
    s_add_u32 s44, s40, 3096576
    buffer_load_dwordx4 v2, s[28:31], s44 offen offset:0 lds
    v_dot2_f32_bf16 v78, v188, s56, v78
    v_dot2_f32_bf16 v79, v188, v188, v79
    v_dot2_f32_bf16 v81, v189, s56, v81
    v_dot2_f32_bf16 v82, v189, v189, v82
    v_dot2_f32_bf16 v78, v190, s56, v78
    v_dot2_f32_bf16 v79, v190, v190, v79
    v_dot2_f32_bf16 v81, v191, s56, v81
    v_dot2_f32_bf16 v82, v191, v191, v82
    v_dot2_f32_bf16 v78, v192, s56, v78
    v_dot2_f32_bf16 v79, v192, v192, v79
    s_add_u32 m0, s43, 44032
    s_add_u32 s44, s40, 3170304
    buffer_load_dwordx4 v2, s[28:31], s44 offen offset:0 lds
    v_dot2_f32_bf16 v81, v193, s56, v81
    v_dot2_f32_bf16 v82, v193, v193, v82
    v_dot2_f32_bf16 v78, v194, s56, v78
    v_dot2_f32_bf16 v79, v194, v194, v79
    v_dot2_f32_bf16 v81, v195, s56, v81
    v_dot2_f32_bf16 v82, v195, v195, v82
    v_dot2_f32_bf16 v78, v196, s56, v78
    v_dot2_f32_bf16 v79, v196, v196, v79
    v_dot2_f32_bf16 v81, v197, s56, v81
    v_dot2_f32_bf16 v82, v197, v197, v82
    s_add_u32 m0, s43, 45056
    s_add_u32 s44, s40, 3244032
    buffer_load_dwordx4 v2, s[28:31], s44 offen offset:0 lds
    v_dot2_f32_bf16 v78, v198, s56, v78
    v_dot2_f32_bf16 v79, v198, v198, v79
    v_dot2_f32_bf16 v81, v199, s56, v81
    v_dot2_f32_bf16 v82, v199, v199, v82
    v_dot2_f32_bf16 v78, v200, s56, v78
    v_dot2_f32_bf16 v79, v200, v200, v79
    v_dot2_f32_bf16 v81, v201, s56, v81
    v_dot2_f32_bf16 v82, v201, v201, v82
    v_dot2_f32_bf16 v78, v202, s56, v78
    v_dot2_f32_bf16 v79, v202, v202, v79
    s_add_u32 m0, s43, 73728
    s_add_u32 s44, s40, 128
    buffer_load_dwordx4 v2, s[28:31], s44 offen offset:0 lds
    v_dot2_f32_bf16 v81, v203, s56, v81
    v_dot2_f32_bf16 v82, v203, v203, v82
    v_dot2_f32_bf16 v78, v204, s56, v78
    v_dot2_f32_bf16 v79, v204, v204, v79
    v_dot2_f32_bf16 v81, v205, s56, v81
    v_dot2_f32_bf16 v82, v205, v205, v82
    v_dot2_f32_bf16 v78, v206, s56, v78
    v_dot2_f32_bf16 v79, v206, v206, v79
    v_dot2_f32_bf16 v81, v207, s56, v81
    v_dot2_f32_bf16 v82, v207, v207, v82
    s_add_u32 m0, s43, 74752
    s_add_u32 s44, s40, 73856
    buffer_load_dwordx4 v2, s[28:31], s44 offen offset:0 lds
    v_dot2_f32_bf16 v78, v208, s56, v78
    v_dot2_f32_bf16 v79, v208, v208, v79
    v_dot2_f32_bf16 v81, v209, s56, v81
    v_dot2_f32_bf16 v82, v209, v209, v82
    v_dot2_f32_bf16 v78, v210, s56, v78
    v_dot2_f32_bf16 v79, v210, v210, v79
    v_dot2_f32_bf16 v81, v211, s56, v81
    v_dot2_f32_bf16 v82, v211, v211, v82
    v_dot2_f32_bf16 v78, v212, s56, v78
    v_dot2_f32_bf16 v79, v212, v212, v79
    s_add_u32 m0, s43, 75776
    s_add_u32 s44, s40, 147584
    buffer_load_dwordx4 v2, s[28:31], s44 offen offset:0 lds
    v_dot2_f32_bf16 v81, v213, s56, v81
    v_dot2_f32_bf16 v82, v213, v213, v82
    v_dot2_f32_bf16 v78, v214, s56, v78
    v_dot2_f32_bf16 v79, v214, v214, v79
    v_dot2_f32_bf16 v81, v215, s56, v81
    v_dot2_f32_bf16 v82, v215, v215, v82
    v_dot2_f32_bf16 v78, v216, s56, v78
    v_dot2_f32_bf16 v79, v216, v216, v79
    v_dot2_f32_bf16 v81, v217, s56, v81
    v_dot2_f32_bf16 v82, v217, v217, v82
    s_add_u32 m0, s43, 76800
    s_add_u32 s44, s40, 221312
    buffer_load_dwordx4 v2, s[28:31], s44 offen offset:0 lds
    v_dot2_f32_bf16 v78, v218, s56, v78
    v_dot2_f32_bf16 v79, v218, v218, v79
    v_dot2_f32_bf16 v81, v219, s56, v81
    v_dot2_f32_bf16 v82, v219, v219, v82
    v_dot2_f32_bf16 v78, v220, s56, v78
    v_dot2_f32_bf16 v79, v220, v220, v79
    v_dot2_f32_bf16 v81, v221, s56, v81
    v_dot2_f32_bf16 v82, v221, v221, v82
    v_dot2_f32_bf16 v78, v222, s56, v78
    v_dot2_f32_bf16 v79, v222, v222, v79
    s_add_u32 m0, s43, 77824
    s_add_u32 s44, s40, 295040
    buffer_load_dwordx4 v2, s[28:31], s44 offen offset:0 lds
    v_dot2_f32_bf16 v81, v223, s56, v81
    v_dot2_f32_bf16 v82, v223, v223, v82
    v_dot2_f32_bf16 v78, v224, s56, v78
    v_dot2_f32_bf16 v79, v224, v224, v79
    v_dot2_f32_bf16 v81, v225, s56, v81
    v_dot2_f32_bf16 v82, v225, v225, v82
    v_dot2_f32_bf16 v78, v226, s56, v78
    v_dot2_f32_bf16 v79, v226, v226, v79
    v_dot2_f32_bf16 v81, v227, s56, v81
    v_dot2_f32_bf16 v82, v227, v227, v82
    s_add_u32 m0, s43, 78848
    s_add_u32 s44, s40, 368768
    buffer_load_dwordx4 v2, s[28:31], s44 offen offset:0 lds
    v_dot2_f32_bf16 v78, v228, s56, v78
    v_dot2_f32_bf16 v79, v228, v228, v79
    v_dot2_f32_bf16 v81, v229, s56, v81
    v_dot2_f32_bf16 v82, v229, v229, v82
    v_dot2_f32_bf16 v78, v230, s56, v78
    v_dot2_f32_bf16 v79, v230, v230, v79
    v_dot2_f32_bf16 v81, v231, s56, v81
    v_dot2_f32_bf16 v82, v231, v231, v82
    v_dot2_f32_bf16 v78, v232, s56, v78
    v_dot2_f32_bf16 v79, v232, v232, v79
    s_add_u32 m0, s43, 79872
    s_add_u32 s44, s40, 442496
    buffer_load_dwordx4 v2, s[28:31], s44 offen offset:0 lds
    v_dot2_f32_bf16 v81, v233, s56, v81
    v_dot2_f32_bf16 v82, v233, v233, v82
    v_dot2_f32_bf16 v78, v234, s56, v78
    v_dot2_f32_bf16 v79, v234, v234, v79
    v_dot2_f32_bf16 v81, v235, s56, v81
    v_dot2_f32_bf16 v82, v235, v235, v82
    v_dot2_f32_bf16 v78, v236, s56, v78
    v_dot2_f32_bf16 v79, v236, v236, v79
    v_dot2_f32_bf16 v81, v237, s56, v81
    v_dot2_f32_bf16 v82, v237, v237, v82
    s_add_u32 m0, s43, 80896
    s_add_u32 s44, s40, 516224
    buffer_load_dwordx4 v2, s[28:31], s44 offen offset:0 lds
    v_dot2_f32_bf16 v78, v238, s56, v78
    v_dot2_f32_bf16 v79, v238, v238, v79
    v_dot2_f32_bf16 v81, v239, s56, v81
    v_dot2_f32_bf16 v82, v239, v239, v82
    v_dot2_f32_bf16 v78, v240, s56, v78
    v_dot2_f32_bf16 v79, v240, v240, v79
    v_dot2_f32_bf16 v81, v241, s56, v81
    v_dot2_f32_bf16 v82, v241, v241, v82
    v_dot2_f32_bf16 v78, v242, s56, v78
    v_dot2_f32_bf16 v79, v242, v242, v79
    s_add_u32 m0, s43, 81920
    s_add_u32 s44, s40, 589952
    buffer_load_dwordx4 v2, s[28:31], s44 offen offset:0 lds
    v_dot2_f32_bf16 v81, v243, s56, v81
    v_dot2_f32_bf16 v82, v243, v243, v82
    v_dot2_f32_bf16 v78, v244, s56, v78
    v_dot2_f32_bf16 v79, v244, v244, v79
    v_dot2_f32_bf16 v81, v245, s56, v81
    v_dot2_f32_bf16 v82, v245, v245, v82
    v_dot2_f32_bf16 v78, v246, s56, v78
    v_dot2_f32_bf16 v79, v246, v246, v79
    v_dot2_f32_bf16 v81, v247, s56, v81
    v_dot2_f32_bf16 v82, v247, v247, v82
    v_dot2_f32_bf16 v78, v248, s56, v78
    v_dot2_f32_bf16 v79, v248, v248, v79
    v_dot2_f32_bf16 v81, v249, s56, v81
    v_dot2_f32_bf16 v82, v249, v249, v82
    v_dot2_f32_bf16 v78, v250, s56, v78
    v_dot2_f32_bf16 v79, v250, v250, v79
    v_dot2_f32_bf16 v81, v251, s56, v81
    v_dot2_f32_bf16 v82, v251, v251, v82
    v_dot2_f32_bf16 v78, v252, s56, v78
    v_dot2_f32_bf16 v79, v252, v252, v79
    v_dot2_f32_bf16 v81, v253, s56, v81
    v_dot2_f32_bf16 v82, v253, v253, v82
    v_dot2_f32_bf16 v78, v254, s56, v78
    v_dot2_f32_bf16 v79, v254, v254, v79
    v_dot2_f32_bf16 v81, v255, s56, v81
    v_dot2_f32_bf16 v82, v255, v255, v82
    s_nop 3
    v_add_f32 v78, v78, v81
    v_add_f32 v79, v79, v82
    v_mov_b32 v83, v78
    s_nop 1
    v_permlane32_swap_b32 v78, v83
    s_nop 1
    v_add_f32 v78, v78, v83
    v_mov_b32 v83, v79
    s_nop 1
    v_permlane32_swap_b32 v79, v83
    s_nop 1
    v_add_f32 v79, v79, v83
    v_mul_f32 v78, 0x3ae38e39, v78
    v_mul_f32 v79, 0x3ae38e39, v79
    v_fma_f32 v79, -v78, v78, v79
    v_max_f32 v79, 0, v79
    v_add_f32 v79, 0x3727c5ac, v79
    v_rsq_f32 v79, v79
    s_nop 0
    v_mul_f32 v79, 0x3eeff558, v79
    v_mul_f32 v78, v78, v79
    s_waitcnt lgkmcnt(0)
    s_barrier
    s_cmp_lg_u32 s3, 2
    s_cbranch_scc1 M_nogate
    v_lshlrev_b32 v83, 4, v75
    v_add_u32 v83, 149760, v83
    v_mov_b32 v80, 0
    ds_read_b128 v[84:87], v83 offset:0
    ds_read_b128 v[88:91], v83 offset:32
    ds_read_b128 v[92:95], v83 offset:64
    ds_read_b128 v[96:99], v83 offset:96
    s_waitcnt lgkmcnt(0)
    v_dot2_f32_bf16 v80, v112, v84, v80
    v_dot2_f32_bf16 v80, v113, v85, v80
    v_dot2_f32_bf16 v80, v114, v86, v80
    v_dot2_f32_bf16 v80, v115, v87, v80
    v_dot2_f32_bf16 v80, v116, v88, v80
    v_dot2_f32_bf16 v80, v117, v89, v80
    v_dot2_f32_bf16 v80, v118, v90, v80
    v_dot2_f32_bf16 v80, v119, v91, v80
    v_dot2_f32_bf16 v80, v120, v92, v80
    v_dot2_f32_bf16 v80, v121, v93, v80
    v_dot2_f32_bf16 v80, v122, v94, v80
    v_dot2_f32_bf16 v80, v123, v95, v80
    v_dot2_f32_bf16 v80, v124, v96, v80
    v_dot2_f32_bf16 v80, v125, v97, v80
    v_dot2_f32_bf16 v80, v126, v98, v80
    v_dot2_f32_bf16 v80, v127, v99, v80
    ds_read_b128 v[84:87], v83 offset:128
    ds_read_b128 v[88:91], v83 offset:160
    ds_read_b128 v[92:95], v83 offset:192
    ds_read_b128 v[96:99], v83 offset:224
    s_waitcnt lgkmcnt(0)
    v_dot2_f32_bf16 v80, v128, v84, v80
    v_dot2_f32_bf16 v80, v129, v85, v80
    v_dot2_f32_bf16 v80, v130, v86, v80
    v_dot2_f32_bf16 v80, v131, v87, v80
    v_dot2_f32_bf16 v80, v132, v88, v80
    v_dot2_f32_bf16 v80, v133, v89, v80
    v_dot2_f32_bf16 v80, v134, v90, v80
    v_dot2_f32_bf16 v80, v135, v91, v80
    v_dot2_f32_bf16 v80, v136, v92, v80
    v_dot2_f32_bf16 v80, v137, v93, v80
    v_dot2_f32_bf16 v80, v138, v94, v80
    v_dot2_f32_bf16 v80, v139, v95, v80
    v_dot2_f32_bf16 v80, v140, v96, v80
    v_dot2_f32_bf16 v80, v141, v97, v80
    v_dot2_f32_bf16 v80, v142, v98, v80
    v_dot2_f32_bf16 v80, v143, v99, v80
    ds_read_b128 v[84:87], v83 offset:256
    ds_read_b128 v[88:91], v83 offset:288
    ds_read_b128 v[92:95], v83 offset:320
    ds_read_b128 v[96:99], v83 offset:352
    s_waitcnt lgkmcnt(0)
    v_dot2_f32_bf16 v80, v144, v84, v80
    v_dot2_f32_bf16 v80, v145, v85, v80
    v_dot2_f32_bf16 v80, v146, v86, v80
    v_dot2_f32_bf16 v80, v147, v87, v80
    v_dot2_f32_bf16 v80, v148, v88, v80
    v_dot2_f32_bf16 v80, v149, v89, v80
    v_dot2_f32_bf16 v80, v150, v90, v80
    v_dot2_f32_bf16 v80, v151, v91, v80
    v_dot2_f32_bf16 v80, v152, v92, v80
    v_dot2_f32_bf16 v80, v153, v93, v80
    v_dot2_f32_bf16 v80, v154, v94, v80
    v_dot2_f32_bf16 v80, v155, v95, v80
    v_dot2_f32_bf16 v80, v156, v96, v80
    v_dot2_f32_bf16 v80, v157, v97, v80
    v_dot2_f32_bf16 v80, v158, v98, v80
    v_dot2_f32_bf16 v80, v159, v99, v80
    ds_read_b128 v[84:87], v83 offset:384
    ds_read_b128 v[88:91], v83 offset:416
    ds_read_b128 v[92:95], v83 offset:448
    ds_read_b128 v[96:99], v83 offset:480
    s_waitcnt lgkmcnt(0)
    v_dot2_f32_bf16 v80, v160, v84, v80
    v_dot2_f32_bf16 v80, v161, v85, v80
    v_dot2_f32_bf16 v80, v162, v86, v80
    v_dot2_f32_bf16 v80, v163, v87, v80
    v_dot2_f32_bf16 v80, v164, v88, v80
    v_dot2_f32_bf16 v80, v165, v89, v80
    v_dot2_f32_bf16 v80, v166, v90, v80
    v_dot2_f32_bf16 v80, v167, v91, v80
    v_dot2_f32_bf16 v80, v168, v92, v80
    v_dot2_f32_bf16 v80, v169, v93, v80
    v_dot2_f32_bf16 v80, v170, v94, v80
    v_dot2_f32_bf16 v80, v171, v95, v80
    v_dot2_f32_bf16 v80, v172, v96, v80
    v_dot2_f32_bf16 v80, v173, v97, v80
    v_dot2_f32_bf16 v80, v174, v98, v80
    v_dot2_f32_bf16 v80, v175, v99, v80
    ds_read_b128 v[84:87], v83 offset:512
    ds_read_b128 v[88:91], v83 offset:544
    ds_read_b128 v[92:95], v83 offset:576
    ds_read_b128 v[96:99], v83 offset:608
    s_waitcnt lgkmcnt(0)
    v_dot2_f32_bf16 v80, v176, v84, v80
    v_dot2_f32_bf16 v80, v177, v85, v80
    v_dot2_f32_bf16 v80, v178, v86, v80
    v_dot2_f32_bf16 v80, v179, v87, v80
    v_dot2_f32_bf16 v80, v180, v88, v80
    v_dot2_f32_bf16 v80, v181, v89, v80
    v_dot2_f32_bf16 v80, v182, v90, v80
    v_dot2_f32_bf16 v80, v183, v91, v80
    v_dot2_f32_bf16 v80, v184, v92, v80
    v_dot2_f32_bf16 v80, v185, v93, v80
    v_dot2_f32_bf16 v80, v186, v94, v80
    v_dot2_f32_bf16 v80, v187, v95, v80
    v_dot2_f32_bf16 v80, v188, v96, v80
    v_dot2_f32_bf16 v80, v189, v97, v80
    v_dot2_f32_bf16 v80, v190, v98, v80
    v_dot2_f32_bf16 v80, v191, v99, v80
    ds_read_b128 v[84:87], v83 offset:640
    ds_read_b128 v[88:91], v83 offset:672
    ds_read_b128 v[92:95], v83 offset:704
    ds_read_b128 v[96:99], v83 offset:736
    s_waitcnt lgkmcnt(0)
    v_dot2_f32_bf16 v80, v192, v84, v80
    v_dot2_f32_bf16 v80, v193, v85, v80
    v_dot2_f32_bf16 v80, v194, v86, v80
    v_dot2_f32_bf16 v80, v195, v87, v80
    v_dot2_f32_bf16 v80, v196, v88, v80
    v_dot2_f32_bf16 v80, v197, v89, v80
    v_dot2_f32_bf16 v80, v198, v90, v80
    v_dot2_f32_bf16 v80, v199, v91, v80
    v_dot2_f32_bf16 v80, v200, v92, v80
    v_dot2_f32_bf16 v80, v201, v93, v80
    v_dot2_f32_bf16 v80, v202, v94, v80
    v_dot2_f32_bf16 v80, v203, v95, v80
    v_dot2_f32_bf16 v80, v204, v96, v80
    v_dot2_f32_bf16 v80, v205, v97, v80
    v_dot2_f32_bf16 v80, v206, v98, v80
    v_dot2_f32_bf16 v80, v207, v99, v80
    ds_read_b128 v[84:87], v83 offset:768
    ds_read_b128 v[88:91], v83 offset:800
    ds_read_b128 v[92:95], v83 offset:832
    ds_read_b128 v[96:99], v83 offset:864
    s_waitcnt lgkmcnt(0)
    v_dot2_f32_bf16 v80, v208, v84, v80
    v_dot2_f32_bf16 v80, v209, v85, v80
    v_dot2_f32_bf16 v80, v210, v86, v80
    v_dot2_f32_bf16 v80, v211, v87, v80
    v_dot2_f32_bf16 v80, v212, v88, v80
    v_dot2_f32_bf16 v80, v213, v89, v80
    v_dot2_f32_bf16 v80, v214, v90, v80
    v_dot2_f32_bf16 v80, v215, v91, v80
    v_dot2_f32_bf16 v80, v216, v92, v80
    v_dot2_f32_bf16 v80, v217, v93, v80
    v_dot2_f32_bf16 v80, v218, v94, v80
    v_dot2_f32_bf16 v80, v219, v95, v80
    v_dot2_f32_bf16 v80, v220, v96, v80
    v_dot2_f32_bf16 v80, v221, v97, v80
    v_dot2_f32_bf16 v80, v222, v98, v80
    v_dot2_f32_bf16 v80, v223, v99, v80
    ds_read_b128 v[84:87], v83 offset:896
    ds_read_b128 v[88:91], v83 offset:928
    ds_read_b128 v[92:95], v83 offset:960
    ds_read_b128 v[96:99], v83 offset:992
    s_waitcnt lgkmcnt(0)
    v_dot2_f32_bf16 v80, v224, v84, v80
    v_dot2_f32_bf16 v80, v225, v85, v80
    v_dot2_f32_bf16 v80, v226, v86, v80
    v_dot2_f32_bf16 v80, v227, v87, v80
    v_dot2_f32_bf16 v80, v228, v88, v80
    v_dot2_f32_bf16 v80, v229, v89, v80
    v_dot2_f32_bf16 v80, v230, v90, v80
    v_dot2_f32_bf16 v80, v231, v91, v80
    v_dot2_f32_bf16 v80, v232, v92, v80
    v_dot2_f32_bf16 v80, v233, v93, v80
    v_dot2_f32_bf16 v80, v234, v94, v80
    v_dot2_f32_bf16 v80, v235, v95, v80
    v_dot2_f32_bf16 v80, v236, v96, v80
    v_dot2_f32_bf16 v80, v237, v97, v80
    v_dot2_f32_bf16 v80, v238, v98, v80
    v_dot2_f32_bf16 v80, v239, v99, v80
    ds_read_b128 v[84:87], v83 offset:1024
    ds_read_b128 v[88:91], v83 offset:1056
    ds_read_b128 v[92:95], v83 offset:1088
    ds_read_b128 v[96:99], v83 offset:1120
    s_waitcnt lgkmcnt(0)
    v_dot2_f32_bf16 v80, v240, v84, v80
    v_dot2_f32_bf16 v80, v241, v85, v80
    v_dot2_f32_bf16 v80, v242, v86, v80
    v_dot2_f32_bf16 v80, v243, v87, v80
    v_dot2_f32_bf16 v80, v244, v88, v80
    v_dot2_f32_bf16 v80, v245, v89, v80
    v_dot2_f32_bf16 v80, v246, v90, v80
    v_dot2_f32_bf16 v80, v247, v91, v80
    v_dot2_f32_bf16 v80, v248, v92, v80
    v_dot2_f32_bf16 v80, v249, v93, v80
    v_dot2_f32_bf16 v80, v250, v94, v80
    v_dot2_f32_bf16 v80, v251, v95, v80
    v_dot2_f32_bf16 v80, v252, v96, v80
    v_dot2_f32_bf16 v80, v253, v97, v80
    v_dot2_f32_bf16 v80, v254, v98, v80
    v_dot2_f32_bf16 v80, v255, v99, v80
    s_nop 3
    v_mov_b32 v83, v80
    s_nop 1
    v_permlane32_swap_b32 v80, v83
    s_nop 1
    v_add_f32 v80, v80, v83
    v_mul_f32 v80, 0xbfb8aa3b, v80
    v_exp_f32 v80, v80
    s_nop 0
    v_add_f32 v80, 1.0, v80
    v_rcp_f32 v80, v80
    s_lshl_b32 s53, s6, 7
    s_add_u32 s53, s53, 4886528
    v_lshlrev_b32 v83, 2, v74
    s_mov_b32 exec_hi, 0
    buffer_store_dword v80, v83, s[24:27], s53 offen sc1
    s_mov_b32 exec_hi, -1
    s_waitcnt vmcnt(0)
M_nogate:
    v_mov_b32 v84, v79
    v_mov_b32 v85, v79
    v_sub_f32 v86, 0, v78
    v_sub_f32 v87, 0, v78
    v_lshlrev_b32 v16, 16, v112
    v_and_b32 v17, 0xffff0000, v112
    v_pk_fma_f32 v[16:17], v[16:17], v[84:85], v[86:87]
    v_lshlrev_b32 v18, 16, v113
    v_and_b32 v19, 0xffff0000, v113
    v_pk_fma_f32 v[18:19], v[18:19], v[84:85], v[86:87]
    v_cvt_pk_bf16_f32 v16, v16, v17
    v_accvgpr_write_b32 a0, v16
    v_lshlrev_b32 v20, 16, v114
    v_and_b32 v21, 0xffff0000, v114
    v_pk_fma_f32 v[20:21], v[20:21], v[84:85], v[86:87]
    v_cvt_pk_bf16_f32 v18, v18, v19
    v_accvgpr_write_b32 a1, v18
    v_lshlrev_b32 v22, 16, v115
    v_and_b32 v23, 0xffff0000, v115
    v_pk_fma_f32 v[22:23], v[22:23], v[84:85], v[86:87]
    v_cvt_pk_bf16_f32 v20, v20, v21
    v_accvgpr_write_b32 a2, v20
    v_lshlrev_b32 v16, 16, v116
    v_and_b32 v17, 0xffff0000, v116
    v_pk_fma_f32 v[16:17], v[16:17], v[84:85], v[86:87]
    v_cvt_pk_bf16_f32 v22, v22, v23
    v_accvgpr_write_b32 a3, v22
    v_lshlrev_b32 v18, 16, v117
    v_and_b32 v19, 0xffff0000, v117
    v_pk_fma_f32 v[18:19], v[18:19], v[84:85], v[86:87]
    v_cvt_pk_bf16_f32 v16, v16, v17
    v_accvgpr_write_b32 a4, v16
    v_lshlrev_b32 v20, 16, v118
    v_and_b32 v21, 0xffff0000, v118
    v_pk_fma_f32 v[20:21], v[20:21], v[84:85], v[86:87]
    v_cvt_pk_bf16_f32 v18, v18, v19
    v_accvgpr_write_b32 a5, v18
    v_lshlrev_b32 v22, 16, v119
    v_and_b32 v23, 0xffff0000, v119
    v_pk_fma_f32 v[22:23], v[22:23], v[84:85], v[86:87]
    v_cvt_pk_bf16_f32 v20, v20, v21
    v_accvgpr_write_b32 a6, v20
    v_lshlrev_b32 v16, 16, v120
    v_and_b32 v17, 0xffff0000, v120
    v_pk_fma_f32 v[16:17], v[16:17], v[84:85], v[86:87]
    v_cvt_pk_bf16_f32 v22, v22, v23
    v_accvgpr_write_b32 a7, v22
    v_lshlrev_b32 v18, 16, v121
    v_and_b32 v19, 0xffff0000, v121
    v_pk_fma_f32 v[18:19], v[18:19], v[84:85], v[86:87]
    v_cvt_pk_bf16_f32 v16, v16, v17
    v_accvgpr_write_b32 a8, v16
    v_lshlrev_b32 v20, 16, v122
    v_and_b32 v21, 0xffff0000, v122
    v_pk_fma_f32 v[20:21], v[20:21], v[84:85], v[86:87]
    v_cvt_pk_bf16_f32 v18, v18, v19
    v_accvgpr_write_b32 a9, v18
    v_lshlrev_b32 v22, 16, v123
    v_and_b32 v23, 0xffff0000, v123
    v_pk_fma_f32 v[22:23], v[22:23], v[84:85], v[86:87]
    v_cvt_pk_bf16_f32 v20, v20, v21
    v_accvgpr_write_b32 a10, v20
    v_lshlrev_b32 v16, 16, v124
    v_and_b32 v17, 0xffff0000, v124
    v_pk_fma_f32 v[16:17], v[16:17], v[84:85], v[86:87]
    v_cvt_pk_bf16_f32 v22, v22, v23
    v_accvgpr_write_b32 a11, v22
    v_lshlrev_b32 v18, 16, v125
    v_and_b32 v19, 0xffff0000, v125
    v_pk_fma_f32 v[18:19], v[18:19], v[84:85], v[86:87]
    v_cvt_pk_bf16_f32 v16, v16, v17
    v_accvgpr_write_b32 a12, v16
    v_lshlrev_b32 v20, 16, v126
    v_and_b32 v21, 0xffff0000, v126
    v_pk_fma_f32 v[20:21], v[20:21], v[84:85], v[86:87]
    v_cvt_pk_bf16_f32 v18, v18, v19
    v_accvgpr_write_b32 a13, v18
    v_lshlrev_b32 v22, 16, v127
    v_and_b32 v23, 0xffff0000, v127
    v_pk_fma_f32 v[22:23], v[22:23], v[84:85], v[86:87]
    v_cvt_pk_bf16_f32 v20, v20, v21
    v_accvgpr_write_b32 a14, v20
    v_lshlrev_b32 v16, 16, v128
    v_and_b32 v17, 0xffff0000, v128
    v_pk_fma_f32 v[16:17], v[16:17], v[84:85], v[86:87]
    v_cvt_pk_bf16_f32 v22, v22, v23
    v_accvgpr_write_b32 a15, v22
    v_lshlrev_b32 v18, 16, v129
    v_and_b32 v19, 0xffff0000, v129
    v_pk_fma_f32 v[18:19], v[18:19], v[84:85], v[86:87]
    v_cvt_pk_bf16_f32 v16, v16, v17
    v_accvgpr_write_b32 a16, v16
    v_lshlrev_b32 v20, 16, v130
    v_and_b32 v21, 0xffff0000, v130
    v_pk_fma_f32 v[20:21], v[20:21], v[84:85], v[86:87]
    v_cvt_pk_bf16_f32 v18, v18, v19
    v_accvgpr_write_b32 a17, v18
    v_lshlrev_b32 v22, 16, v131
    v_and_b32 v23, 0xffff0000, v131
    v_pk_fma_f32 v[22:23], v[22:23], v[84:85], v[86:87]
    v_cvt_pk_bf16_f32 v20, v20, v21
    v_accvgpr_write_b32 a18, v20
    v_lshlrev_b32 v16, 16, v132
    v_and_b32 v17, 0xffff0000, v132
    v_pk_fma_f32 v[16:17], v[16:17], v[84:85], v[86:87]
    v_cvt_pk_bf16_f32 v22, v22, v23
    v_accvgpr_write_b32 a19, v22
    v_lshlrev_b32 v18, 16, v133
    v_and_b32 v19, 0xffff0000, v133
    v_pk_fma_f32 v[18:19], v[18:19], v[84:85], v[86:87]
    v_cvt_pk_bf16_f32 v16, v16, v17
    v_accvgpr_write_b32 a20, v16
    v_lshlrev_b32 v20, 16, v134
    v_and_b32 v21, 0xffff0000, v134
    v_pk_fma_f32 v[20:21], v[20:21], v[84:85], v[86:87]
    v_cvt_pk_bf16_f32 v18, v18, v19
    v_accvgpr_write_b32 a21, v18
    v_lshlrev_b32 v22, 16, v135
    v_and_b32 v23, 0xffff0000, v135
    v_pk_fma_f32 v[22:23], v[22:23], v[84:85], v[86:87]
    v_cvt_pk_bf16_f32 v20, v20, v21
    v_accvgpr_write_b32 a22, v20
    v_lshlrev_b32 v16, 16, v136
    v_and_b32 v17, 0xffff0000, v136
    v_pk_fma_f32 v[16:17], v[16:17], v[84:85], v[86:87]
    v_cvt_pk_bf16_f32 v22, v22, v23
    v_accvgpr_write_b32 a23, v22
    v_lshlrev_b32 v18, 16, v137
    v_and_b32 v19, 0xffff0000, v137
    v_pk_fma_f32 v[18:19], v[18:19], v[84:85], v[86:87]
    v_cvt_pk_bf16_f32 v16, v16, v17
    v_accvgpr_write_b32 a24, v16
    v_lshlrev_b32 v20, 16, v138
    v_and_b32 v21, 0xffff0000, v138
    v_pk_fma_f32 v[20:21], v[20:21], v[84:85], v[86:87]
    v_cvt_pk_bf16_f32 v18, v18, v19
    v_accvgpr_write_b32 a25, v18
    v_lshlrev_b32 v22, 16, v139
    v_and_b32 v23, 0xffff0000, v139
    v_pk_fma_f32 v[22:23], v[22:23], v[84:85], v[86:87]
    v_cvt_pk_bf16_f32 v20, v20, v21
    v_accvgpr_write_b32 a26, v20
    v_lshlrev_b32 v16, 16, v140
    v_and_b32 v17, 0xffff0000, v140
    v_pk_fma_f32 v[16:17], v[16:17], v[84:85], v[86:87]
    v_cvt_pk_bf16_f32 v22, v22, v23
    v_accvgpr_write_b32 a27, v22
    v_lshlrev_b32 v18, 16, v141
    v_and_b32 v19, 0xffff0000, v141
    v_pk_fma_f32 v[18:19], v[18:19], v[84:85], v[86:87]
    v_cvt_pk_bf16_f32 v16, v16, v17
    v_accvgpr_write_b32 a28, v16
    v_lshlrev_b32 v20, 16, v142
    v_and_b32 v21, 0xffff0000, v142
    v_pk_fma_f32 v[20:21], v[20:21], v[84:85], v[86:87]
    v_cvt_pk_bf16_f32 v18, v18, v19
    v_accvgpr_write_b32 a29, v18
    v_lshlrev_b32 v22, 16, v143
    v_and_b32 v23, 0xffff0000, v143
    v_pk_fma_f32 v[22:23], v[22:23], v[84:85], v[86:87]
    v_cvt_pk_bf16_f32 v20, v20, v21
    v_accvgpr_write_b32 a30, v20
    v_lshlrev_b32 v16, 16, v144
    v_and_b32 v17, 0xffff0000, v144
    v_pk_fma_f32 v[16:17], v[16:17], v[84:85], v[86:87]
    v_cvt_pk_bf16_f32 v22, v22, v23
    v_accvgpr_write_b32 a31, v22
    v_lshlrev_b32 v18, 16, v145
    v_and_b32 v19, 0xffff0000, v145
    v_pk_fma_f32 v[18:19], v[18:19], v[84:85], v[86:87]
    v_cvt_pk_bf16_f32 v16, v16, v17
    v_accvgpr_write_b32 a32, v16
    v_lshlrev_b32 v20, 16, v146
    v_and_b32 v21, 0xffff0000, v146
    v_pk_fma_f32 v[20:21], v[20:21], v[84:85], v[86:87]
    v_cvt_pk_bf16_f32 v18, v18, v19
    v_accvgpr_write_b32 a33, v18
    v_lshlrev_b32 v22, 16, v147
    v_and_b32 v23, 0xffff0000, v147
    v_pk_fma_f32 v[22:23], v[22:23], v[84:85], v[86:87]
    v_cvt_pk_bf16_f32 v20, v20, v21
    v_accvgpr_write_b32 a34, v20
    v_lshlrev_b32 v16, 16, v148
    v_and_b32 v17, 0xffff0000, v148
    v_pk_fma_f32 v[16:17], v[16:17], v[84:85], v[86:87]
    v_cvt_pk_bf16_f32 v22, v22, v23
    v_accvgpr_write_b32 a35, v22
    v_lshlrev_b32 v18, 16, v149
    v_and_b32 v19, 0xffff0000, v149
    v_pk_fma_f32 v[18:19], v[18:19], v[84:85], v[86:87]
    v_cvt_pk_bf16_f32 v16, v16, v17
    v_accvgpr_write_b32 a36, v16
    v_lshlrev_b32 v20, 16, v150
    v_and_b32 v21, 0xffff0000, v150
    v_pk_fma_f32 v[20:21], v[20:21], v[84:85], v[86:87]
    v_cvt_pk_bf16_f32 v18, v18, v19
    v_accvgpr_write_b32 a37, v18
    v_lshlrev_b32 v22, 16, v151
    v_and_b32 v23, 0xffff0000, v151
    v_pk_fma_f32 v[22:23], v[22:23], v[84:85], v[86:87]
    v_cvt_pk_bf16_f32 v20, v20, v21
    v_accvgpr_write_b32 a38, v20
    v_lshlrev_b32 v16, 16, v152
    v_and_b32 v17, 0xffff0000, v152
    v_pk_fma_f32 v[16:17], v[16:17], v[84:85], v[86:87]
    v_cvt_pk_bf16_f32 v22, v22, v23
    v_accvgpr_write_b32 a39, v22
    v_lshlrev_b32 v18, 16, v153
    v_and_b32 v19, 0xffff0000, v153
    v_pk_fma_f32 v[18:19], v[18:19], v[84:85], v[86:87]
    v_cvt_pk_bf16_f32 v16, v16, v17
    v_accvgpr_write_b32 a40, v16
    v_lshlrev_b32 v20, 16, v154
    v_and_b32 v21, 0xffff0000, v154
    v_pk_fma_f32 v[20:21], v[20:21], v[84:85], v[86:87]
    v_cvt_pk_bf16_f32 v18, v18, v19
    v_accvgpr_write_b32 a41, v18
    v_lshlrev_b32 v22, 16, v155
    v_and_b32 v23, 0xffff0000, v155
    v_pk_fma_f32 v[22:23], v[22:23], v[84:85], v[86:87]
    v_cvt_pk_bf16_f32 v20, v20, v21
    v_accvgpr_write_b32 a42, v20
    v_lshlrev_b32 v16, 16, v156
    v_and_b32 v17, 0xffff0000, v156
    v_pk_fma_f32 v[16:17], v[16:17], v[84:85], v[86:87]
    v_cvt_pk_bf16_f32 v22, v22, v23
    v_accvgpr_write_b32 a43, v22
    v_lshlrev_b32 v18, 16, v157
    v_and_b32 v19, 0xffff0000, v157
    v_pk_fma_f32 v[18:19], v[18:19], v[84:85], v[86:87]
    v_cvt_pk_bf16_f32 v16, v16, v17
    v_accvgpr_write_b32 a44, v16
    v_lshlrev_b32 v20, 16, v158
    v_and_b32 v21, 0xffff0000, v158
    v_pk_fma_f32 v[20:21], v[20:21], v[84:85], v[86:87]
    v_cvt_pk_bf16_f32 v18, v18, v19
    v_accvgpr_write_b32 a45, v18
    v_lshlrev_b32 v22, 16, v159
    v_and_b32 v23, 0xffff0000, v159
    v_pk_fma_f32 v[22:23], v[22:23], v[84:85], v[86:87]
    v_cvt_pk_bf16_f32 v20, v20, v21
    v_accvgpr_write_b32 a46, v20
    v_lshlrev_b32 v16, 16, v160
    v_and_b32 v17, 0xffff0000, v160
    v_pk_fma_f32 v[16:17], v[16:17], v[84:85], v[86:87]
    v_cvt_pk_bf16_f32 v22, v22, v23
    v_accvgpr_write_b32 a47, v22
    v_lshlrev_b32 v18, 16, v161
    v_and_b32 v19, 0xffff0000, v161
    v_pk_fma_f32 v[18:19], v[18:19], v[84:85], v[86:87]
    v_cvt_pk_bf16_f32 v16, v16, v17
    v_accvgpr_write_b32 a48, v16
    v_lshlrev_b32 v20, 16, v162
    v_and_b32 v21, 0xffff0000, v162
    v_pk_fma_f32 v[20:21], v[20:21], v[84:85], v[86:87]
    v_cvt_pk_bf16_f32 v18, v18, v19
    v_accvgpr_write_b32 a49, v18
    v_lshlrev_b32 v22, 16, v163
    v_and_b32 v23, 0xffff0000, v163
    v_pk_fma_f32 v[22:23], v[22:23], v[84:85], v[86:87]
    v_cvt_pk_bf16_f32 v20, v20, v21
    v_accvgpr_write_b32 a50, v20
    v_lshlrev_b32 v16, 16, v164
    v_and_b32 v17, 0xffff0000, v164
    v_pk_fma_f32 v[16:17], v[16:17], v[84:85], v[86:87]
    v_cvt_pk_bf16_f32 v22, v22, v23
    v_accvgpr_write_b32 a51, v22
    v_lshlrev_b32 v18, 16, v165
    v_and_b32 v19, 0xffff0000, v165
    v_pk_fma_f32 v[18:19], v[18:19], v[84:85], v[86:87]
    v_cvt_pk_bf16_f32 v16, v16, v17
    v_accvgpr_write_b32 a52, v16
    v_lshlrev_b32 v20, 16, v166
    v_and_b32 v21, 0xffff0000, v166
    v_pk_fma_f32 v[20:21], v[20:21], v[84:85], v[86:87]
    v_cvt_pk_bf16_f32 v18, v18, v19
    v_accvgpr_write_b32 a53, v18
    v_lshlrev_b32 v22, 16, v167
    v_and_b32 v23, 0xffff0000, v167
    v_pk_fma_f32 v[22:23], v[22:23], v[84:85], v[86:87]
    v_cvt_pk_bf16_f32 v20, v20, v21
    v_accvgpr_write_b32 a54, v20
    v_lshlrev_b32 v16, 16, v168
    v_and_b32 v17, 0xffff0000, v168
    v_pk_fma_f32 v[16:17], v[16:17], v[84:85], v[86:87]
    v_cvt_pk_bf16_f32 v22, v22, v23
    v_accvgpr_write_b32 a55, v22
    v_lshlrev_b32 v18, 16, v169
    v_and_b32 v19, 0xffff0000, v169
    v_pk_fma_f32 v[18:19], v[18:19], v[84:85], v[86:87]
    v_cvt_pk_bf16_f32 v16, v16, v17
    v_accvgpr_write_b32 a56, v16
    v_lshlrev_b32 v20, 16, v170
    v_and_b32 v21, 0xffff0000, v170
    v_pk_fma_f32 v[20:21], v[20:21], v[84:85], v[86:87]
    v_cvt_pk_bf16_f32 v18, v18, v19
    v_accvgpr_write_b32 a57, v18
    v_lshlrev_b32 v22, 16, v171
    v_and_b32 v23, 0xffff0000, v171
    v_pk_fma_f32 v[22:23], v[22:23], v[84:85], v[86:87]
    v_cvt_pk_bf16_f32 v20, v20, v21
    v_accvgpr_write_b32 a58, v20
    v_lshlrev_b32 v16, 16, v172
    v_and_b32 v17, 0xffff0000, v172
    v_pk_fma_f32 v[16:17], v[16:17], v[84:85], v[86:87]
    v_cvt_pk_bf16_f32 v22, v22, v23
    v_accvgpr_write_b32 a59, v22
    v_lshlrev_b32 v18, 16, v173
    v_and_b32 v19, 0xffff0000, v173
    v_pk_fma_f32 v[18:19], v[18:19], v[84:85], v[86:87]
    v_cvt_pk_bf16_f32 v16, v16, v17
    v_accvgpr_write_b32 a60, v16
    v_lshlrev_b32 v20, 16, v174
    v_and_b32 v21, 0xffff0000, v174
    v_pk_fma_f32 v[20:21], v[20:21], v[84:85], v[86:87]
    v_cvt_pk_bf16_f32 v18, v18, v19
    v_accvgpr_write_b32 a61, v18
    v_lshlrev_b32 v22, 16, v175
    v_and_b32 v23, 0xffff0000, v175
    v_pk_fma_f32 v[22:23], v[22:23], v[84:85], v[86:87]
    v_cvt_pk_bf16_f32 v20, v20, v21
    v_accvgpr_write_b32 a62, v20
    v_lshlrev_b32 v16, 16, v176
    v_and_b32 v17, 0xffff0000, v176
    v_pk_fma_f32 v[16:17], v[16:17], v[84:85], v[86:87]
    v_cvt_pk_bf16_f32 v22, v22, v23
    v_accvgpr_write_b32 a63, v22
    v_lshlrev_b32 v18, 16, v177
    v_and_b32 v19, 0xffff0000, v177
    v_pk_fma_f32 v[18:19], v[18:19], v[84:85], v[86:87]
    v_cvt_pk_bf16_f32 v16, v16, v17
    v_accvgpr_write_b32 a64, v16
    v_lshlrev_b32 v20, 16, v178
    v_and_b32 v21, 0xffff0000, v178
    v_pk_fma_f32 v[20:21], v[20:21], v[84:85], v[86:87]
    v_cvt_pk_bf16_f32 v18, v18, v19
    v_accvgpr_write_b32 a65, v18
    v_lshlrev_b32 v22, 16, v179
    v_and_b32 v23, 0xffff0000, v179
    v_pk_fma_f32 v[22:23], v[22:23], v[84:85], v[86:87]
    v_cvt_pk_bf16_f32 v20, v20, v21
    v_accvgpr_write_b32 a66, v20
    v_lshlrev_b32 v16, 16, v180
    v_and_b32 v17, 0xffff0000, v180
    v_pk_fma_f32 v[16:17], v[16:17], v[84:85], v[86:87]
    v_cvt_pk_bf16_f32 v22, v22, v23
    v_accvgpr_write_b32 a67, v22
    v_lshlrev_b32 v18, 16, v181
    v_and_b32 v19, 0xffff0000, v181
    v_pk_fma_f32 v[18:19], v[18:19], v[84:85], v[86:87]
    v_cvt_pk_bf16_f32 v16, v16, v17
    v_accvgpr_write_b32 a68, v16
    v_lshlrev_b32 v20, 16, v182
    v_and_b32 v21, 0xffff0000, v182
    v_pk_fma_f32 v[20:21], v[20:21], v[84:85], v[86:87]
    v_cvt_pk_bf16_f32 v18, v18, v19
    v_accvgpr_write_b32 a69, v18
    v_lshlrev_b32 v22, 16, v183
    v_and_b32 v23, 0xffff0000, v183
    v_pk_fma_f32 v[22:23], v[22:23], v[84:85], v[86:87]
    v_cvt_pk_bf16_f32 v20, v20, v21
    v_accvgpr_write_b32 a70, v20
    v_lshlrev_b32 v16, 16, v184
    v_and_b32 v17, 0xffff0000, v184
    v_pk_fma_f32 v[16:17], v[16:17], v[84:85], v[86:87]
    v_cvt_pk_bf16_f32 v22, v22, v23
    v_accvgpr_write_b32 a71, v22
    v_lshlrev_b32 v18, 16, v185
    v_and_b32 v19, 0xffff0000, v185
    v_pk_fma_f32 v[18:19], v[18:19], v[84:85], v[86:87]
    v_cvt_pk_bf16_f32 v16, v16, v17
    v_accvgpr_write_b32 a72, v16
    v_lshlrev_b32 v20, 16, v186
    v_and_b32 v21, 0xffff0000, v186
    v_pk_fma_f32 v[20:21], v[20:21], v[84:85], v[86:87]
    v_cvt_pk_bf16_f32 v18, v18, v19
    v_accvgpr_write_b32 a73, v18
    v_lshlrev_b32 v22, 16, v187
    v_and_b32 v23, 0xffff0000, v187
    v_pk_fma_f32 v[22:23], v[22:23], v[84:85], v[86:87]
    v_cvt_pk_bf16_f32 v20, v20, v21
    v_accvgpr_write_b32 a74, v20
    v_lshlrev_b32 v16, 16, v188
    v_and_b32 v17, 0xffff0000, v188
    v_pk_fma_f32 v[16:17], v[16:17], v[84:85], v[86:87]
    v_cvt_pk_bf16_f32 v22, v22, v23
    v_accvgpr_write_b32 a75, v22
    v_lshlrev_b32 v18, 16, v189
    v_and_b32 v19, 0xffff0000, v189
    v_pk_fma_f32 v[18:19], v[18:19], v[84:85], v[86:87]
    v_cvt_pk_bf16_f32 v16, v16, v17
    v_accvgpr_write_b32 a76, v16
    v_lshlrev_b32 v20, 16, v190
    v_and_b32 v21, 0xffff0000, v190
    v_pk_fma_f32 v[20:21], v[20:21], v[84:85], v[86:87]
    v_cvt_pk_bf16_f32 v18, v18, v19
    v_accvgpr_write_b32 a77, v18
    v_lshlrev_b32 v22, 16, v191
    v_and_b32 v23, 0xffff0000, v191
    v_pk_fma_f32 v[22:23], v[22:23], v[84:85], v[86:87]
    v_cvt_pk_bf16_f32 v20, v20, v21
    v_accvgpr_write_b32 a78, v20
    v_lshlrev_b32 v16, 16, v192
    v_and_b32 v17, 0xffff0000, v192
    v_pk_fma_f32 v[16:17], v[16:17], v[84:85], v[86:87]
    v_cvt_pk_bf16_f32 v22, v22, v23
    v_accvgpr_write_b32 a79, v22
    v_lshlrev_b32 v18, 16, v193
    v_and_b32 v19, 0xffff0000, v193
    v_pk_fma_f32 v[18:19], v[18:19], v[84:85], v[86:87]
    v_cvt_pk_bf16_f32 v16, v16, v17
    v_accvgpr_write_b32 a80, v16
    v_lshlrev_b32 v20, 16, v194
    v_and_b32 v21, 0xffff0000, v194
    v_pk_fma_f32 v[20:21], v[20:21], v[84:85], v[86:87]
    v_cvt_pk_bf16_f32 v18, v18, v19
    v_accvgpr_write_b32 a81, v18
    v_lshlrev_b32 v22, 16, v195
    v_and_b32 v23, 0xffff0000, v195
    v_pk_fma_f32 v[22:23], v[22:23], v[84:85], v[86:87]
    v_cvt_pk_bf16_f32 v20, v20, v21
    v_accvgpr_write_b32 a82, v20
    v_lshlrev_b32 v16, 16, v196
    v_and_b32 v17, 0xffff0000, v196
    v_pk_fma_f32 v[16:17], v[16:17], v[84:85], v[86:87]
    v_cvt_pk_bf16_f32 v22, v22, v23
    v_accvgpr_write_b32 a83, v22
    v_lshlrev_b32 v18, 16, v197
    v_and_b32 v19, 0xffff0000, v197
    v_pk_fma_f32 v[18:19], v[18:19], v[84:85], v[86:87]
    v_cvt_pk_bf16_f32 v16, v16, v17
    v_accvgpr_write_b32 a84, v16
    v_lshlrev_b32 v20, 16, v198
    v_and_b32 v21, 0xffff0000, v198
    v_pk_fma_f32 v[20:21], v[20:21], v[84:85], v[86:87]
    v_cvt_pk_bf16_f32 v18, v18, v19
    v_accvgpr_write_b32 a85, v18
    v_lshlrev_b32 v22, 16, v199
    v_and_b32 v23, 0xffff0000, v199
    v_pk_fma_f32 v[22:23], v[22:23], v[84:85], v[86:87]
    v_cvt_pk_bf16_f32 v20, v20, v21
    v_accvgpr_write_b32 a86, v20
    v_lshlrev_b32 v16, 16, v200
    v_and_b32 v17, 0xffff0000, v200
    v_pk_fma_f32 v[16:17], v[16:17], v[84:85], v[86:87]
    v_cvt_pk_bf16_f32 v22, v22, v23
    v_accvgpr_write_b32 a87, v22
    v_lshlrev_b32 v18, 16, v201
    v_and_b32 v19, 0xffff0000, v201
    v_pk_fma_f32 v[18:19], v[18:19], v[84:85], v[86:87]
    v_cvt_pk_bf16_f32 v16, v16, v17
    v_accvgpr_write_b32 a88, v16
    v_lshlrev_b32 v20, 16, v202
    v_and_b32 v21, 0xffff0000, v202
    v_pk_fma_f32 v[20:21], v[20:21], v[84:85], v[86:87]
    v_cvt_pk_bf16_f32 v18, v18, v19
    v_accvgpr_write_b32 a89, v18
    v_lshlrev_b32 v22, 16, v203
    v_and_b32 v23, 0xffff0000, v203
    v_pk_fma_f32 v[22:23], v[22:23], v[84:85], v[86:87]
    v_cvt_pk_bf16_f32 v20, v20, v21
    v_accvgpr_write_b32 a90, v20
    v_lshlrev_b32 v16, 16, v204
    v_and_b32 v17, 0xffff0000, v204
    v_pk_fma_f32 v[16:17], v[16:17], v[84:85], v[86:87]
    v_cvt_pk_bf16_f32 v22, v22, v23
    v_accvgpr_write_b32 a91, v22
    v_lshlrev_b32 v18, 16, v205
    v_and_b32 v19, 0xffff0000, v205
    v_pk_fma_f32 v[18:19], v[18:19], v[84:85], v[86:87]
    v_cvt_pk_bf16_f32 v16, v16, v17
    v_accvgpr_write_b32 a92, v16
    v_lshlrev_b32 v20, 16, v206
    v_and_b32 v21, 0xffff0000, v206
    v_pk_fma_f32 v[20:21], v[20:21], v[84:85], v[86:87]
    v_cvt_pk_bf16_f32 v18, v18, v19
    v_accvgpr_write_b32 a93, v18
    v_lshlrev_b32 v22, 16, v207
    v_and_b32 v23, 0xffff0000, v207
    v_pk_fma_f32 v[22:23], v[22:23], v[84:85], v[86:87]
    v_cvt_pk_bf16_f32 v20, v20, v21
    v_accvgpr_write_b32 a94, v20
    v_lshlrev_b32 v16, 16, v208
    v_and_b32 v17, 0xffff0000, v208
    v_pk_fma_f32 v[16:17], v[16:17], v[84:85], v[86:87]
    v_cvt_pk_bf16_f32 v22, v22, v23
    v_accvgpr_write_b32 a95, v22
    v_lshlrev_b32 v18, 16, v209
    v_and_b32 v19, 0xffff0000, v209
    v_pk_fma_f32 v[18:19], v[18:19], v[84:85], v[86:87]
    v_cvt_pk_bf16_f32 v16, v16, v17
    v_accvgpr_write_b32 a96, v16
    v_lshlrev_b32 v20, 16, v210
    v_and_b32 v21, 0xffff0000, v210
    v_pk_fma_f32 v[20:21], v[20:21], v[84:85], v[86:87]
    v_cvt_pk_bf16_f32 v18, v18, v19
    v_accvgpr_write_b32 a97, v18
    v_lshlrev_b32 v22, 16, v211
    v_and_b32 v23, 0xffff0000, v211
    v_pk_fma_f32 v[22:23], v[22:23], v[84:85], v[86:87]
    v_cvt_pk_bf16_f32 v20, v20, v21
    v_accvgpr_write_b32 a98, v20
    v_lshlrev_b32 v16, 16, v212
    v_and_b32 v17, 0xffff0000, v212
    v_pk_fma_f32 v[16:17], v[16:17], v[84:85], v[86:87]
    v_cvt_pk_bf16_f32 v22, v22, v23
    v_accvgpr_write_b32 a99, v22
    v_lshlrev_b32 v18, 16, v213
    v_and_b32 v19, 0xffff0000, v213
    v_pk_fma_f32 v[18:19], v[18:19], v[84:85], v[86:87]
    v_cvt_pk_bf16_f32 v16, v16, v17
    v_accvgpr_write_b32 a100, v16
    v_lshlrev_b32 v20, 16, v214
    v_and_b32 v21, 0xffff0000, v214
    v_pk_fma_f32 v[20:21], v[20:21], v[84:85], v[86:87]
    v_cvt_pk_bf16_f32 v18, v18, v19
    v_accvgpr_write_b32 a101, v18
    v_lshlrev_b32 v22, 16, v215
    v_and_b32 v23, 0xffff0000, v215
    v_pk_fma_f32 v[22:23], v[22:23], v[84:85], v[86:87]
    v_cvt_pk_bf16_f32 v20, v20, v21
    v_accvgpr_write_b32 a102, v20
    v_lshlrev_b32 v16, 16, v216
    v_and_b32 v17, 0xffff0000, v216
    v_pk_fma_f32 v[16:17], v[16:17], v[84:85], v[86:87]
    v_cvt_pk_bf16_f32 v22, v22, v23
    v_accvgpr_write_b32 a103, v22
    v_lshlrev_b32 v18, 16, v217
    v_and_b32 v19, 0xffff0000, v217
    v_pk_fma_f32 v[18:19], v[18:19], v[84:85], v[86:87]
    v_cvt_pk_bf16_f32 v16, v16, v17
    v_accvgpr_write_b32 a104, v16
    v_lshlrev_b32 v20, 16, v218
    v_and_b32 v21, 0xffff0000, v218
    v_pk_fma_f32 v[20:21], v[20:21], v[84:85], v[86:87]
    v_cvt_pk_bf16_f32 v18, v18, v19
    v_accvgpr_write_b32 a105, v18
    v_lshlrev_b32 v22, 16, v219
    v_and_b32 v23, 0xffff0000, v219
    v_pk_fma_f32 v[22:23], v[22:23], v[84:85], v[86:87]
    v_cvt_pk_bf16_f32 v20, v20, v21
    v_accvgpr_write_b32 a106, v20
    v_lshlrev_b32 v16, 16, v220
    v_and_b32 v17, 0xffff0000, v220
    v_pk_fma_f32 v[16:17], v[16:17], v[84:85], v[86:87]
    v_cvt_pk_bf16_f32 v22, v22, v23
    v_accvgpr_write_b32 a107, v22
    v_lshlrev_b32 v18, 16, v221
    v_and_b32 v19, 0xffff0000, v221
    v_pk_fma_f32 v[18:19], v[18:19], v[84:85], v[86:87]
    v_cvt_pk_bf16_f32 v16, v16, v17
    v_accvgpr_write_b32 a108, v16
    v_lshlrev_b32 v20, 16, v222
    v_and_b32 v21, 0xffff0000, v222
    v_pk_fma_f32 v[20:21], v[20:21], v[84:85], v[86:87]
    v_cvt_pk_bf16_f32 v18, v18, v19
    v_accvgpr_write_b32 a109, v18
    v_lshlrev_b32 v22, 16, v223
    v_and_b32 v23, 0xffff0000, v223
    v_pk_fma_f32 v[22:23], v[22:23], v[84:85], v[86:87]
    v_cvt_pk_bf16_f32 v20, v20, v21
    v_accvgpr_write_b32 a110, v20
    v_lshlrev_b32 v16, 16, v224
    v_and_b32 v17, 0xffff0000, v224
    v_pk_fma_f32 v[16:17], v[16:17], v[84:85], v[86:87]
    v_cvt_pk_bf16_f32 v22, v22, v23
    v_accvgpr_write_b32 a111, v22
    v_lshlrev_b32 v18, 16, v225
    v_and_b32 v19, 0xffff0000, v225
    v_pk_fma_f32 v[18:19], v[18:19], v[84:85], v[86:87]
    v_cvt_pk_bf16_f32 v16, v16, v17
    v_accvgpr_write_b32 a112, v16
    v_lshlrev_b32 v20, 16, v226
    v_and_b32 v21, 0xffff0000, v226
    v_pk_fma_f32 v[20:21], v[20:21], v[84:85], v[86:87]
    v_cvt_pk_bf16_f32 v18, v18, v19
    v_accvgpr_write_b32 a113, v18
    v_lshlrev_b32 v22, 16, v227
    v_and_b32 v23, 0xffff0000, v227
    v_pk_fma_f32 v[22:23], v[22:23], v[84:85], v[86:87]
    v_cvt_pk_bf16_f32 v20, v20, v21
    v_accvgpr_write_b32 a114, v20
    v_lshlrev_b32 v16, 16, v228
    v_and_b32 v17, 0xffff0000, v228
    v_pk_fma_f32 v[16:17], v[16:17], v[84:85], v[86:87]
    v_cvt_pk_bf16_f32 v22, v22, v23
    v_accvgpr_write_b32 a115, v22
    v_lshlrev_b32 v18, 16, v229
    v_and_b32 v19, 0xffff0000, v229
    v_pk_fma_f32 v[18:19], v[18:19], v[84:85], v[86:87]
    v_cvt_pk_bf16_f32 v16, v16, v17
    v_accvgpr_write_b32 a116, v16
    v_lshlrev_b32 v20, 16, v230
    v_and_b32 v21, 0xffff0000, v230
    v_pk_fma_f32 v[20:21], v[20:21], v[84:85], v[86:87]
    v_cvt_pk_bf16_f32 v18, v18, v19
    v_accvgpr_write_b32 a117, v18
    v_lshlrev_b32 v22, 16, v231
    v_and_b32 v23, 0xffff0000, v231
    v_pk_fma_f32 v[22:23], v[22:23], v[84:85], v[86:87]
    v_cvt_pk_bf16_f32 v20, v20, v21
    v_accvgpr_write_b32 a118, v20
    v_lshlrev_b32 v16, 16, v232
    v_and_b32 v17, 0xffff0000, v232
    v_pk_fma_f32 v[16:17], v[16:17], v[84:85], v[86:87]
    v_cvt_pk_bf16_f32 v22, v22, v23
    v_accvgpr_write_b32 a119, v22
    v_lshlrev_b32 v18, 16, v233
    v_and_b32 v19, 0xffff0000, v233
    v_pk_fma_f32 v[18:19], v[18:19], v[84:85], v[86:87]
    v_cvt_pk_bf16_f32 v16, v16, v17
    v_accvgpr_write_b32 a120, v16
    v_lshlrev_b32 v20, 16, v234
    v_and_b32 v21, 0xffff0000, v234
    v_pk_fma_f32 v[20:21], v[20:21], v[84:85], v[86:87]
    v_cvt_pk_bf16_f32 v18, v18, v19
    v_accvgpr_write_b32 a121, v18
    v_lshlrev_b32 v22, 16, v235
    v_and_b32 v23, 0xffff0000, v235
    v_pk_fma_f32 v[22:23], v[22:23], v[84:85], v[86:87]
    v_cvt_pk_bf16_f32 v20, v20, v21
    v_accvgpr_write_b32 a122, v20
    v_lshlrev_b32 v16, 16, v236
    v_and_b32 v17, 0xffff0000, v236
    v_pk_fma_f32 v[16:17], v[16:17], v[84:85], v[86:87]
    v_cvt_pk_bf16_f32 v22, v22, v23
    v_accvgpr_write_b32 a123, v22
    v_lshlrev_b32 v18, 16, v237
    v_and_b32 v19, 0xffff0000, v237
    v_pk_fma_f32 v[18:19], v[18:19], v[84:85], v[86:87]
    v_cvt_pk_bf16_f32 v16, v16, v17
    v_accvgpr_write_b32 a124, v16
    v_lshlrev_b32 v20, 16, v238
    v_and_b32 v21, 0xffff0000, v238
    v_pk_fma_f32 v[20:21], v[20:21], v[84:85], v[86:87]
    v_cvt_pk_bf16_f32 v18, v18, v19
    v_accvgpr_write_b32 a125, v18
    v_lshlrev_b32 v22, 16, v239
    v_and_b32 v23, 0xffff0000, v239
    v_pk_fma_f32 v[22:23], v[22:23], v[84:85], v[86:87]
    v_cvt_pk_bf16_f32 v20, v20, v21
    v_accvgpr_write_b32 a126, v20
    v_lshlrev_b32 v16, 16, v240
    v_and_b32 v17, 0xffff0000, v240
    v_pk_fma_f32 v[16:17], v[16:17], v[84:85], v[86:87]
    v_cvt_pk_bf16_f32 v22, v22, v23
    v_accvgpr_write_b32 a127, v22
    v_lshlrev_b32 v18, 16, v241
    v_and_b32 v19, 0xffff0000, v241
    v_pk_fma_f32 v[18:19], v[18:19], v[84:85], v[86:87]
    v_cvt_pk_bf16_f32 v16, v16, v17
    v_accvgpr_write_b32 a128, v16
    v_lshlrev_b32 v20, 16, v242
    v_and_b32 v21, 0xffff0000, v242
    v_pk_fma_f32 v[20:21], v[20:21], v[84:85], v[86:87]
    v_cvt_pk_bf16_f32 v18, v18, v19
    v_accvgpr_write_b32 a129, v18
    v_lshlrev_b32 v22, 16, v243
    v_and_b32 v23, 0xffff0000, v243
    v_pk_fma_f32 v[22:23], v[22:23], v[84:85], v[86:87]
    v_cvt_pk_bf16_f32 v20, v20, v21
    v_accvgpr_write_b32 a130, v20
    v_lshlrev_b32 v16, 16, v244
    v_and_b32 v17, 0xffff0000, v244
    v_pk_fma_f32 v[16:17], v[16:17], v[84:85], v[86:87]
    v_cvt_pk_bf16_f32 v22, v22, v23
    v_accvgpr_write_b32 a131, v22
    v_lshlrev_b32 v18, 16, v245
    v_and_b32 v19, 0xffff0000, v245
    v_pk_fma_f32 v[18:19], v[18:19], v[84:85], v[86:87]
    v_cvt_pk_bf16_f32 v16, v16, v17
    v_accvgpr_write_b32 a132, v16
    v_lshlrev_b32 v20, 16, v246
    v_and_b32 v21, 0xffff0000, v246
    v_pk_fma_f32 v[20:21], v[20:21], v[84:85], v[86:87]
    v_cvt_pk_bf16_f32 v18, v18, v19
    v_accvgpr_write_b32 a133, v18
    v_lshlrev_b32 v22, 16, v247
    v_and_b32 v23, 0xffff0000, v247
    v_pk_fma_f32 v[22:23], v[22:23], v[84:85], v[86:87]
    v_cvt_pk_bf16_f32 v20, v20, v21
    v_accvgpr_write_b32 a134, v20
    v_lshlrev_b32 v16, 16, v248
    v_and_b32 v17, 0xffff0000, v248
    v_pk_fma_f32 v[16:17], v[16:17], v[84:85], v[86:87]
    v_cvt_pk_bf16_f32 v22, v22, v23
    v_accvgpr_write_b32 a135, v22
    v_lshlrev_b32 v18, 16, v249
    v_and_b32 v19, 0xffff0000, v249
    v_pk_fma_f32 v[18:19], v[18:19], v[84:85], v[86:87]
    v_cvt_pk_bf16_f32 v16, v16, v17
    v_accvgpr_write_b32 a136, v16
    v_lshlrev_b32 v20, 16, v250
    v_and_b32 v21, 0xffff0000, v250
    v_pk_fma_f32 v[20:21], v[20:21], v[84:85], v[86:87]
    v_cvt_pk_bf16_f32 v18, v18, v19
    v_accvgpr_write_b32 a137, v18
    v_lshlrev_b32 v22, 16, v251
    v_and_b32 v23, 0xffff0000, v251
    v_pk_fma_f32 v[22:23], v[22:23], v[84:85], v[86:87]
    v_cvt_pk_bf16_f32 v20, v20, v21
    v_accvgpr_write_b32 a138, v20
    v_lshlrev_b32 v16, 16, v252
    v_and_b32 v17, 0xffff0000, v252
    v_pk_fma_f32 v[16:17], v[16:17], v[84:85], v[86:87]
    v_cvt_pk_bf16_f32 v22, v22, v23
    v_accvgpr_write_b32 a139, v22
    v_lshlrev_b32 v18, 16, v253
    v_and_b32 v19, 0xffff0000, v253
    v_pk_fma_f32 v[18:19], v[18:19], v[84:85], v[86:87]
    v_cvt_pk_bf16_f32 v16, v16, v17
    v_accvgpr_write_b32 a140, v16
    v_lshlrev_b32 v20, 16, v254
    v_and_b32 v21, 0xffff0000, v254
    v_pk_fma_f32 v[20:21], v[20:21], v[84:85], v[86:87]
    v_cvt_pk_bf16_f32 v18, v18, v19
    v_accvgpr_write_b32 a141, v18
    v_lshlrev_b32 v22, 16, v255
    v_and_b32 v23, 0xffff0000, v255
    v_pk_fma_f32 v[22:23], v[22:23], v[84:85], v[86:87]
    v_cvt_pk_bf16_f32 v20, v20, v21
    v_accvgpr_write_b32 a142, v20
    v_cvt_pk_bf16_f32 v22, v22, v23
    v_accvgpr_write_b32 a143, v22
    s_waitcnt vmcnt(18)
    s_barrier
    ds_read_b128 v[16:19], v10 offset:0
    ds_read_b128 v[20:23], v10 offset:32
    ds_read_b128 v[24:27], v10 offset:64
    ds_read_b128 v[28:31], v10 offset:96
    ds_read_b128 v[32:35], v10 offset:128
    ds_read_b128 v[36:39], v10 offset:160
    ds_read_b128 v[40:43], v10 offset:192
    ds_read_b128 v[44:47], v10 offset:224
    ds_read_b64_tr_b16 a[144:145], v104 offset:0
    ds_read_b64_tr_b16 a[146:147], v104 offset:256
    ds_read_b64_tr_b16 a[148:149], v104 offset:512
    ds_read_b64_tr_b16 a[150:151], v104 offset:768
    ds_read_b64_tr_b16 a[152:153], v104 offset:2048
    ds_read_b64_tr_b16 a[154:155], v104 offset:2304
    ds_read_b64_tr_b16 a[156:157], v104 offset:2560
    ds_read_b64_tr_b16 a[158:159], v104 offset:2816
    ds_read_b64_tr_b16 a[160:161], v104 offset:4096
    ds_read_b64_tr_b16 a[162:163], v104 offset:4352
    ds_read_b64_tr_b16 a[164:165], v104 offset:4608
    ds_read_b64_tr_b16 a[166:167], v104 offset:4864
    ds_read_b64_tr_b16 a[168:169], v104 offset:6144
    ds_read_b64_tr_b16 a[170:171], v104 offset:6400
    s_waitcnt lgkmcnt(14)
    s_waitcnt lgkmcnt(6)
    v_mfma_f32_32x32x16_bf16 v[16:31], a[144:147], a[0:3], v[16:31]
    ds_read_b64_tr_b16 a[172:173], v104 offset:6656
    ds_read_b64_tr_b16 a[174:175], v104 offset:6912
    v_mfma_f32_32x32x16_bf16 v[32:47], a[148:151], a[0:3], v[32:47]
    ds_read_b64_tr_b16 a[144:145], v104 offset:8192
    ds_read_b64_tr_b16 a[146:147], v104 offset:8448
    s_add_u32 m0, s43, 110592
    s_add_u32 s44, s40, 2654336
    buffer_load_dwordx4 v2, s[28:31], s44 offen offset:0 lds
    v_mfma_f32_32x32x16_bf16 v[16:31], a[152:155], a[4:7], v[16:31]
    ds_read_b64_tr_b16 a[148:149], v104 offset:8704
    ds_read_b64_tr_b16 a[150:151], v104 offset:8960
    v_mfma_f32_32x32x16_bf16 v[32:47], a[156:159], a[4:7], v[32:47]
    ds_read_b64_tr_b16 a[152:153], v104 offset:10240
    ds_read_b64_tr_b16 a[154:155], v104 offset:10496
    s_waitcnt lgkmcnt(6)
    v_mfma_f32_32x32x16_bf16 v[16:31], a[160:163], a[8:11], v[16:31]
    ds_read_b64_tr_b16 a[156:157], v104 offset:10752
    ds_read_b64_tr_b16 a[158:159], v104 offset:11008
    v_mfma_f32_32x32x16_bf16 v[32:47], a[164:167], a[8:11], v[32:47]
    ds_read_b64_tr_b16 a[160:161], v104 offset:12288
    ds_read_b64_tr_b16 a[162:163], v104 offset:12544
    buffer_load_dwordx4 v3, s[28:31], s44 offen offset:1024 lds
    v_mfma_f32_32x32x16_bf16 v[16:31], a[168:171], a[12:15], v[16:31]
    ds_read_b64_tr_b16 a[164:165], v104 offset:12800
    ds_read_b64_tr_b16 a[166:167], v104 offset:13056
    v_mfma_f32_32x32x16_bf16 v[32:47], a[172:175], a[12:15], v[32:47]
    ds_read_b64_tr_b16 a[168:169], v104 offset:14336
    ds_read_b64_tr_b16 a[170:171], v104 offset:14592
    s_waitcnt lgkmcnt(6)
    v_mfma_f32_32x32x16_bf16 v[16:31], a[144:147], a[16:19], v[16:31]
    ds_read_b64_tr_b16 a[172:173], v104 offset:14848
    ds_read_b64_tr_b16 a[174:175], v104 offset:15104
    v_mfma_f32_32x32x16_bf16 v[32:47], a[148:151], a[16:19], v[32:47]
    ds_read_b64_tr_b16 a[144:145], v104 offset:16384
    ds_read_b64_tr_b16 a[146:147], v104 offset:16640
    buffer_load_dwordx4 v4, s[28:31], s44 offen offset:2048 lds
    v_mfma_f32_32x32x16_bf16 v[16:31], a[152:155], a[20:23], v[16:31]
    ds_read_b64_tr_b16 a[148:149], v104 offset:16896
    ds_read_b64_tr_b16 a[150:151], v104 offset:17152
    v_mfma_f32_32x32x16_bf16 v[32:47], a[156:159], a[20:23], v[32:47]
    ds_read_b64_tr_b16 a[152:153], v104 offset:18432
    ds_read_b64_tr_b16 a[154:155], v104 offset:18688
    s_waitcnt lgkmcnt(6)
    v_mfma_f32_32x32x16_bf16 v[16:31], a[160:163], a[24:27], v[16:31]
    ds_read_b64_tr_b16 a[156:157], v104 offset:18944
    ds_read_b64_tr_b16 a[158:159], v104 offset:19200
    v_mfma_f32_32x32x16_bf16 v[32:47], a[164:167], a[24:27], v[32:47]
    ds_read_b64_tr_b16 a[160:161], v104 offset:20480
    ds_read_b64_tr_b16 a[162:163], v104 offset:20736
    buffer_load_dwordx4 v5, s[28:31], s44 offen offset:3072 lds
    v_mfma_f32_32x32x16_bf16 v[16:31], a[168:171], a[28:31], v[16:31]
    ds_read_b64_tr_b16 a[164:165], v104 offset:20992
    ds_read_b64_tr_b16 a[166:167], v104 offset:21248
    v_mfma_f32_32x32x16_bf16 v[32:47], a[172:175], a[28:31], v[32:47]
    ds_read_b64_tr_b16 a[168:169], v104 offset:22528
    ds_read_b64_tr_b16 a[170:171], v104 offset:22784
    s_waitcnt lgkmcnt(6)
    v_mfma_f32_32x32x16_bf16 v[16:31], a[144:147], a[32:35], v[16:31]
    ds_read_b64_tr_b16 a[172:173], v104 offset:23040
    ds_read_b64_tr_b16 a[174:175], v104 offset:23296
    v_mfma_f32_32x32x16_bf16 v[32:47], a[148:151], a[32:35], v[32:47]
    ds_read_b64_tr_b16 a[144:145], v104 offset:24576
    ds_read_b64_tr_b16 a[146:147], v104 offset:24832
    s_add_u32 m0, s43, 114688
    s_add_u32 s44, s40, 2949248
    buffer_load_dwordx4 v2, s[28:31], s44 offen offset:0 lds
    v_mfma_f32_32x32x16_bf16 v[16:31], a[152:155], a[36:39], v[16:31]
    ds_read_b64_tr_b16 a[148:149], v104 offset:25088
    ds_read_b64_tr_b16 a[150:151], v104 offset:25344
    v_mfma_f32_32x32x16_bf16 v[32:47], a[156:159], a[36:39], v[32:47]
    ds_read_b64_tr_b16 a[152:153], v104 offset:26624
    ds_read_b64_tr_b16 a[154:155], v104 offset:26880
    s_waitcnt lgkmcnt(6)
    v_mfma_f32_32x32x16_bf16 v[16:31], a[160:163], a[40:43], v[16:31]
    ds_read_b64_tr_b16 a[156:157], v104 offset:27136
    ds_read_b64_tr_b16 a[158:159], v104 offset:27392
    v_mfma_f32_32x32x16_bf16 v[32:47], a[164:167], a[40:43], v[32:47]
    ds_read_b64_tr_b16 a[160:161], v104 offset:28672
    ds_read_b64_tr_b16 a[162:163], v104 offset:28928
    buffer_load_dwordx4 v3, s[28:31], s44 offen offset:1024 lds
    v_mfma_f32_32x32x16_bf16 v[16:31], a[168:171], a[44:47], v[16:31]
    ds_read_b64_tr_b16 a[164:165], v104 offset:29184
    ds_read_b64_tr_b16 a[166:167], v104 offset:29440
    v_mfma_f32_32x32x16_bf16 v[32:47], a[172:175], a[44:47], v[32:47]
    ds_read_b64_tr_b16 a[168:169], v104 offset:30720
    ds_read_b64_tr_b16 a[170:171], v104 offset:30976
    s_waitcnt lgkmcnt(6)
    v_mfma_f32_32x32x16_bf16 v[16:31], a[144:147], a[48:51], v[16:31]
    ds_read_b64_tr_b16 a[172:173], v104 offset:31232
    ds_read_b64_tr_b16 a[174:175], v104 offset:31488
    v_mfma_f32_32x32x16_bf16 v[32:47], a[148:151], a[48:51], v[32:47]
    ds_read_b64_tr_b16 a[144:145], v104 offset:32768
    ds_read_b64_tr_b16 a[146:147], v104 offset:33024
    buffer_load_dwordx4 v4, s[28:31], s44 offen offset:2048 lds
    v_mfma_f32_32x32x16_bf16 v[16:31], a[152:155], a[52:55], v[16:31]
    ds_read_b64_tr_b16 a[148:149], v104 offset:33280
    ds_read_b64_tr_b16 a[150:151], v104 offset:33536
    v_mfma_f32_32x32x16_bf16 v[32:47], a[156:159], a[52:55], v[32:47]
    ds_read_b64_tr_b16 a[152:153], v104 offset:34816
    ds_read_b64_tr_b16 a[154:155], v104 offset:35072
    s_waitcnt lgkmcnt(6)
    v_mfma_f32_32x32x16_bf16 v[16:31], a[160:163], a[56:59], v[16:31]
    ds_read_b64_tr_b16 a[156:157], v104 offset:35328
    ds_read_b64_tr_b16 a[158:159], v104 offset:35584
    v_mfma_f32_32x32x16_bf16 v[32:47], a[164:167], a[56:59], v[32:47]
    s_waitcnt vmcnt(16)
    s_barrier
    ds_read_b64_tr_b16 a[160:161], v105 offset:0
    ds_read_b64_tr_b16 a[162:163], v105 offset:256
    buffer_load_dwordx4 v5, s[28:31], s44 offen offset:3072 lds
    v_mfma_f32_32x32x16_bf16 v[16:31], a[168:171], a[60:63], v[16:31]
    ds_read_b64_tr_b16 a[164:165], v105 offset:512
    ds_read_b64_tr_b16 a[166:167], v105 offset:768
    v_mfma_f32_32x32x16_bf16 v[32:47], a[172:175], a[60:63], v[32:47]
    ds_read_b64_tr_b16 a[168:169], v105 offset:2048
    ds_read_b64_tr_b16 a[170:171], v105 offset:2304
    s_waitcnt lgkmcnt(6)
    v_mfma_f32_32x32x16_bf16 v[16:31], a[144:147], a[64:67], v[16:31]
    ds_read_b64_tr_b16 a[172:173], v105 offset:2560
    ds_read_b64_tr_b16 a[174:175], v105 offset:2816
    v_mfma_f32_32x32x16_bf16 v[32:47], a[148:151], a[64:67], v[32:47]
    ds_read_b64_tr_b16 a[144:145], v105 offset:4096
    ds_read_b64_tr_b16 a[146:147], v105 offset:4352
    s_add_u32 m0, s43, 118784
    s_add_u32 s44, s40, 3244160
    buffer_load_dwordx4 v2, s[28:31], s44 offen offset:0 lds
    v_mfma_f32_32x32x16_bf16 v[16:31], a[152:155], a[68:71], v[16:31]
    ds_read_b64_tr_b16 a[148:149], v105 offset:4608
    ds_read_b64_tr_b16 a[150:151], v105 offset:4864
    v_mfma_f32_32x32x16_bf16 v[32:47], a[156:159], a[68:71], v[32:47]
    ds_read_b64_tr_b16 a[152:153], v105 offset:6144
    ds_read_b64_tr_b16 a[154:155], v105 offset:6400
    s_waitcnt lgkmcnt(6)
    v_mfma_f32_32x32x16_bf16 v[16:31], a[160:163], a[72:75], v[16:31]
    ds_read_b64_tr_b16 a[156:157], v105 offset:6656
    ds_read_b64_tr_b16 a[158:159], v105 offset:6912
    v_mfma_f32_32x32x16_bf16 v[32:47], a[164:167], a[72:75], v[32:47]
    ds_read_b64_tr_b16 a[160:161], v105 offset:8192
    ds_read_b64_tr_b16 a[162:163], v105 offset:8448
    s_add_u32 m0, s43, 0
    s_add_u32 s44, s40, 256
    buffer_load_dwordx4 v2, s[28:31], s44 offen offset:0 lds
    v_mfma_f32_32x32x16_bf16 v[16:31], a[168:171], a[76:79], v[16:31]
    ds_read_b64_tr_b16 a[164:165], v105 offset:8704
    ds_read_b64_tr_b16 a[166:167], v105 offset:8960
    v_mfma_f32_32x32x16_bf16 v[32:47], a[172:175], a[76:79], v[32:47]
    ds_read_b64_tr_b16 a[168:169], v105 offset:10240
    ds_read_b64_tr_b16 a[170:171], v105 offset:10496
    s_waitcnt lgkmcnt(6)
    v_mfma_f32_32x32x16_bf16 v[16:31], a[144:147], a[80:83], v[16:31]
    ds_read_b64_tr_b16 a[172:173], v105 offset:10752
    ds_read_b64_tr_b16 a[174:175], v105 offset:11008
    v_mfma_f32_32x32x16_bf16 v[32:47], a[148:151], a[80:83], v[32:47]
    ds_read_b64_tr_b16 a[144:145], v105 offset:12288
    ds_read_b64_tr_b16 a[146:147], v105 offset:12544
    buffer_load_dwordx4 v3, s[28:31], s44 offen offset:1024 lds
    v_mfma_f32_32x32x16_bf16 v[16:31], a[152:155], a[84:87], v[16:31]
    ds_read_b64_tr_b16 a[148:149], v105 offset:12800
    ds_read_b64_tr_b16 a[150:151], v105 offset:13056
    v_mfma_f32_32x32x16_bf16 v[32:47], a[156:159], a[84:87], v[32:47]
    ds_read_b64_tr_b16 a[152:153], v105 offset:14336
    ds_read_b64_tr_b16 a[154:155], v105 offset:14592
    s_waitcnt lgkmcnt(6)
    v_mfma_f32_32x32x16_bf16 v[16:31], a[160:163], a[88:91], v[16:31]
    ds_read_b64_tr_b16 a[156:157], v105 offset:14848
    ds_read_b64_tr_b16 a[158:159], v105 offset:15104
    v_mfma_f32_32x32x16_bf16 v[32:47], a[164:167], a[88:91], v[32:47]
    ds_read_b64_tr_b16 a[160:161], v105 offset:16384
    ds_read_b64_tr_b16 a[162:163], v105 offset:16640
    buffer_load_dwordx4 v4, s[28:31], s44 offen offset:2048 lds
    v_mfma_f32_32x32x16_bf16 v[16:31], a[168:171], a[92:95], v[16:31]
    ds_read_b64_tr_b16 a[164:165], v105 offset:16896
    ds_read_b64_tr_b16 a[166:167], v105 offset:17152
    v_mfma_f32_32x32x16_bf16 v[32:47], a[172:175], a[92:95], v[32:47]
    ds_read_b64_tr_b16 a[168:169], v105 offset:18432
    ds_read_b64_tr_b16 a[170:171], v105 offset:18688
    s_waitcnt lgkmcnt(6)
    v_mfma_f32_32x32x16_bf16 v[16:31], a[144:147], a[96:99], v[16:31]
    ds_read_b64_tr_b16 a[172:173], v105 offset:18944
    ds_read_b64_tr_b16 a[174:175], v105 offset:19200
    v_mfma_f32_32x32x16_bf16 v[32:47], a[148:151], a[96:99], v[32:47]
    ds_read_b64_tr_b16 a[144:145], v105 offset:20480
    ds_read_b64_tr_b16 a[146:147], v105 offset:20736
    buffer_load_dwordx4 v5, s[28:31], s44 offen offset:3072 lds
    v_mfma_f32_32x32x16_bf16 v[16:31], a[152:155], a[100:103], v[16:31]
    ds_read_b64_tr_b16 a[148:149], v105 offset:20992
    ds_read_b64_tr_b16 a[150:151], v105 offset:21248
    v_mfma_f32_32x32x16_bf16 v[32:47], a[156:159], a[100:103], v[32:47]
    ds_read_b64_tr_b16 a[152:153], v105 offset:22528
    ds_read_b64_tr_b16 a[154:155], v105 offset:22784
    s_waitcnt lgkmcnt(6)
    v_mfma_f32_32x32x16_bf16 v[16:31], a[160:163], a[104:107], v[16:31]
    ds_read_b64_tr_b16 a[156:157], v105 offset:23040
    ds_read_b64_tr_b16 a[158:159], v105 offset:23296
    v_mfma_f32_32x32x16_bf16 v[32:47], a[164:167], a[104:107], v[32:47]
    ds_read_b64_tr_b16 a[160:161], v105 offset:24576
    ds_read_b64_tr_b16 a[162:163], v105 offset:24832
    s_add_u32 m0, s43, 4096
    s_add_u32 s44, s40, 295168
    buffer_load_dwordx4 v2, s[28:31], s44 offen offset:0 lds
    v_mfma_f32_32x32x16_bf16 v[16:31], a[168:171], a[108:111], v[16:31]
    ds_read_b64_tr_b16 a[164:165], v105 offset:25088
    ds_read_b64_tr_b16 a[166:167], v105 offset:25344
    v_mfma_f32_32x32x16_bf16 v[32:47], a[172:175], a[108:111], v[32:47]
    ds_read_b64_tr_b16 a[168:169], v105 offset:26624
    ds_read_b64_tr_b16 a[170:171], v105 offset:26880
    s_waitcnt lgkmcnt(6)
    v_mfma_f32_32x32x16_bf16 v[16:31], a[144:147], a[112:115], v[16:31]
    ds_read_b64_tr_b16 a[172:173], v105 offset:27136
    ds_read_b64_tr_b16 a[174:175], v105 offset:27392
    v_mfma_f32_32x32x16_bf16 v[32:47], a[148:151], a[112:115], v[32:47]
    ds_read_b64_tr_b16 a[144:145], v105 offset:28672
    ds_read_b64_tr_b16 a[146:147], v105 offset:28928
    buffer_load_dwordx4 v3, s[28:31], s44 offen offset:1024 lds
    v_mfma_f32_32x32x16_bf16 v[16:31], a[152:155], a[116:119], v[16:31]
    ds_read_b64_tr_b16 a[148:149], v105 offset:29184
    ds_read_b64_tr_b16 a[150:151], v105 offset:29440
    v_mfma_f32_32x32x16_bf16 v[32:47], a[156:159], a[116:119], v[32:47]
    ds_read_b64_tr_b16 a[152:153], v105 offset:30720
    ds_read_b64_tr_b16 a[154:155], v105 offset:30976
    s_waitcnt lgkmcnt(6)
    v_mfma_f32_32x32x16_bf16 v[16:31], a[160:163], a[120:123], v[16:31]
    ds_read_b64_tr_b16 a[156:157], v105 offset:31232
    ds_read_b64_tr_b16 a[158:159], v105 offset:31488
    v_mfma_f32_32x32x16_bf16 v[32:47], a[164:167], a[120:123], v[32:47]
    ds_read_b64_tr_b16 a[160:161], v105 offset:32768
    ds_read_b64_tr_b16 a[162:163], v105 offset:33024
    buffer_load_dwordx4 v4, s[28:31], s44 offen offset:2048 lds
    v_mfma_f32_32x32x16_bf16 v[16:31], a[168:171], a[124:127], v[16:31]
    ds_read_b64_tr_b16 a[164:165], v105 offset:33280
    ds_read_b64_tr_b16 a[166:167], v105 offset:33536
    v_mfma_f32_32x32x16_bf16 v[32:47], a[172:175], a[124:127], v[32:47]
    ds_read_b64_tr_b16 a[168:169], v105 offset:34816
    ds_read_b64_tr_b16 a[170:171], v105 offset:35072
    s_waitcnt lgkmcnt(6)
    v_mfma_f32_32x32x16_bf16 v[16:31], a[144:147], a[128:131], v[16:31]
    ds_read_b64_tr_b16 a[172:173], v105 offset:35328
    ds_read_b64_tr_b16 a[174:175], v105 offset:35584
    v_mfma_f32_32x32x16_bf16 v[32:47], a[148:151], a[128:131], v[32:47]
    s_waitcnt vmcnt(16)
    s_barrier
    ds_read_b64_tr_b16 a[144:145], v106 offset:0
    ds_read_b64_tr_b16 a[146:147], v106 offset:256
    buffer_load_dwordx4 v5, s[28:31], s44 offen offset:3072 lds
    v_mfma_f32_32x32x16_bf16 v[16:31], a[152:155], a[132:135], v[16:31]
    ds_read_b64_tr_b16 a[148:149], v106 offset:512
    ds_read_b64_tr_b16 a[150:151], v106 offset:768
    ds_read_b128 v[48:51], v10 offset:256
    ds_read_b128 v[52:55], v10 offset:288
    ds_read_b128 v[56:59], v10 offset:320
    ds_read_b128 v[60:63], v10 offset:352
    ds_read_b128 v[64:67], v10 offset:384
    ds_read_b128 v[68:71], v10 offset:416
    ds_read_b128 v[72:75], v10 offset:448
    ds_read_b128 v[76:79], v10 offset:480
    v_mfma_f32_32x32x16_bf16 v[32:47], a[156:159], a[132:135], v[32:47]
    ds_read_b64_tr_b16 a[152:153], v106 offset:2048
    ds_read_b64_tr_b16 a[154:155], v106 offset:2304
    s_waitcnt lgkmcnt(14)
    v_mfma_f32_32x32x16_bf16 v[16:31], a[160:163], a[136:139], v[16:31]
    ds_read_b64_tr_b16 a[156:157], v106 offset:2560
    ds_read_b64_tr_b16 a[158:159], v106 offset:2816
    v_mfma_f32_32x32x16_bf16 v[32:47], a[164:167], a[136:139], v[32:47]
    ds_read_b64_tr_b16 a[160:161], v106 offset:4096
    ds_read_b64_tr_b16 a[162:163], v106 offset:4352
    s_add_u32 m0, s43, 8192
    s_add_u32 s44, s40, 590080
    buffer_load_dwordx4 v2, s[28:31], s44 offen offset:0 lds
    v_mfma_f32_32x32x16_bf16 v[16:31], a[168:171], a[140:143], v[16:31]
    ds_read_b64_tr_b16 a[164:165], v106 offset:4608
    ds_read_b64_tr_b16 a[166:167], v106 offset:4864
    v_mfma_f32_32x32x16_bf16 v[32:47], a[172:175], a[140:143], v[32:47]
    ds_read_b64_tr_b16 a[168:169], v106 offset:6144
    ds_read_b64_tr_b16 a[170:171], v106 offset:6400
    s_waitcnt lgkmcnt(6)
    v_mfma_f32_32x32x16_bf16 v[48:63], a[144:147], a[0:3], v[48:63]
    ds_read_b64_tr_b16 a[172:173], v106 offset:6656
    ds_read_b64_tr_b16 a[174:175], v106 offset:6912
    v_mfma_f32_32x32x16_bf16 v[64:79], a[148:151], a[0:3], v[64:79]
    ds_read_b64_tr_b16 a[144:145], v106 offset:8192
    ds_read_b64_tr_b16 a[146:147], v106 offset:8448
    s_add_u32 m0, s43, 36864
    s_add_u32 s44, s40, 2654464
    buffer_load_dwordx4 v2, s[28:31], s44 offen offset:0 lds
    v_mfma_f32_32x32x16_bf16 v[48:63], a[152:155], a[4:7], v[48:63]
    ds_read_b64_tr_b16 a[148:149], v106 offset:8704
    ds_read_b64_tr_b16 a[150:151], v106 offset:8960
    v_mfma_f32_32x32x16_bf16 v[64:79], a[156:159], a[4:7], v[64:79]
    ds_read_b64_tr_b16 a[152:153], v106 offset:10240
    ds_read_b64_tr_b16 a[154:155], v106 offset:10496
    v_fma_f32 v96, v16, v16, v11
    v_fma_f32 v97, v17, v17, v11
    v_fma_f32 v98, v18, v18, v11
    v_mul_f32 v96, v16, v96
    v_mul_f32 v97, v17, v97
    s_waitcnt lgkmcnt(6)
    v_mfma_f32_32x32x16_bf16 v[48:63], a[160:163], a[8:11], v[48:63]
    ds_read_b64_tr_b16 a[156:157], v106 offset:10752
    ds_read_b64_tr_b16 a[158:159], v106 offset:11008
    v_mul_f32 v98, v18, v98
    v_exp_f32 v96, -v96
    v_exp_f32 v97, -v97
    v_mfma_f32_32x32x16_bf16 v[64:79], a[164:167], a[8:11], v[64:79]
    ds_read_b64_tr_b16 a[160:161], v106 offset:12288
    ds_read_b64_tr_b16 a[162:163], v106 offset:12544
    buffer_load_dwordx4 v3, s[28:31], s44 offen offset:1024 lds
    v_exp_f32 v98, -v98
    v_add_f32 v96, 1.0, v96
    v_add_f32 v97, 1.0, v97
    v_mfma_f32_32x32x16_bf16 v[48:63], a[168:171], a[12:15], v[48:63]
    ds_read_b64_tr_b16 a[164:165], v106 offset:12800
    ds_read_b64_tr_b16 a[166:167], v106 offset:13056
    v_add_f32 v98, 1.0, v98
    v_rcp_f32 v96, v96
    v_rcp_f32 v97, v97
    v_mfma_f32_32x32x16_bf16 v[64:79], a[172:175], a[12:15], v[64:79]
    ds_read_b64_tr_b16 a[168:169], v106 offset:14336
    ds_read_b64_tr_b16 a[170:171], v106 offset:14592
    v_rcp_f32 v98, v98
    v_mul_f32 v16, v16, v96
    s_waitcnt lgkmcnt(6)
    v_mfma_f32_32x32x16_bf16 v[48:63], a[144:147], a[16:19], v[48:63]
    ds_read_b64_tr_b16 a[172:173], v106 offset:14848
    ds_read_b64_tr_b16 a[174:175], v106 offset:15104
    v_mul_f32 v17, v17, v97
    v_mul_f32 v18, v18, v98
    v_fma_f32 v99, v19, v19, v11
    v_fma_f32 v100, v20, v20, v11
    v_fma_f32 v101, v21, v21, v11
    v_mfma_f32_32x32x16_bf16 v[64:79], a[148:151], a[16:19], v[64:79]
    ds_read_b64_tr_b16 a[144:145], v106 offset:16384
    ds_read_b64_tr_b16 a[146:147], v106 offset:16640
    buffer_load_dwordx4 v4, s[28:31], s44 offen offset:2048 lds
    v_mul_f32 v99, v19, v99
    v_mul_f32 v100, v20, v100
    v_mul_f32 v101, v21, v101
    v_exp_f32 v99, -v99
    v_mfma_f32_32x32x16_bf16 v[48:63], a[152:155], a[20:23], v[48:63]
    ds_read_b64_tr_b16 a[148:149], v106 offset:16896
    ds_read_b64_tr_b16 a[150:151], v106 offset:17152
    v_exp_f32 v100, -v100
    v_exp_f32 v101, -v101
    v_mfma_f32_32x32x16_bf16 v[64:79], a[156:159], a[20:23], v[64:79]
    ds_read_b64_tr_b16 a[152:153], v106 offset:18432
    ds_read_b64_tr_b16 a[154:155], v106 offset:18688
    v_add_f32 v99, 1.0, v99
    v_add_f32 v100, 1.0, v100
    v_add_f32 v101, 1.0, v101
    v_rcp_f32 v99, v99
    s_waitcnt lgkmcnt(6)
    v_mfma_f32_32x32x16_bf16 v[48:63], a[160:163], a[24:27], v[48:63]
    ds_read_b64_tr_b16 a[156:157], v106 offset:18944
    ds_read_b64_tr_b16 a[158:159], v106 offset:19200
    v_rcp_f32 v100, v100
    v_rcp_f32 v101, v101
    v_mfma_f32_32x32x16_bf16 v[64:79], a[164:167], a[24:27], v[64:79]
    ds_read_b64_tr_b16 a[160:161], v106 offset:20480
    ds_read_b64_tr_b16 a[162:163], v106 offset:20736
    buffer_load_dwordx4 v5, s[28:31], s44 offen offset:3072 lds
    v_mul_f32 v19, v19, v99
    v_mul_f32 v20, v20, v100
    v_mul_f32 v21, v21, v101
    v_fma_f32 v96, v22, v22, v11
    v_mfma_f32_32x32x16_bf16 v[48:63], a[168:171], a[28:31], v[48:63]
    ds_read_b64_tr_b16 a[164:165], v106 offset:20992
    ds_read_b64_tr_b16 a[166:167], v106 offset:21248
    v_fma_f32 v97, v23, v23, v11
    v_fma_f32 v98, v24, v24, v11
    v_mul_f32 v96, v22, v96
    v_mul_f32 v97, v23, v97
    v_mfma_f32_32x32x16_bf16 v[64:79], a[172:175], a[28:31], v[64:79]
    ds_read_b64_tr_b16 a[168:169], v106 offset:22528
    ds_read_b64_tr_b16 a[170:171], v106 offset:22784
    v_mul_f32 v98, v24, v98
    v_exp_f32 v96, -v96
    v_exp_f32 v97, -v97
    s_waitcnt lgkmcnt(6)
    v_mfma_f32_32x32x16_bf16 v[48:63], a[144:147], a[32:35], v[48:63]
    ds_read_b64_tr_b16 a[172:173], v106 offset:23040
    ds_read_b64_tr_b16 a[174:175], v106 offset:23296
    v_exp_f32 v98, -v98
    v_add_f32 v96, 1.0, v96
    v_add_f32 v97, 1.0, v97
    v_mfma_f32_32x32x16_bf16 v[64:79], a[148:151], a[32:35], v[64:79]
    ds_read_b64_tr_b16 a[144:145], v106 offset:24576
    ds_read_b64_tr_b16 a[146:147], v106 offset:24832
    s_add_u32 m0, s43, 40960
    s_add_u32 s44, s40, 2949376
    buffer_load_dwordx4 v2, s[28:31], s44 offen offset:0 lds
    v_add_f32 v98, 1.0, v98
    v_rcp_f32 v96, v96
    v_rcp_f32 v97, v97
    v_mfma_f32_32x32x16_bf16 v[48:63], a[152:155], a[36:39], v[48:63]
    ds_read_b64_tr_b16 a[148:149], v106 offset:25088
    ds_read_b64_tr_b16 a[150:151], v106 offset:25344
    v_rcp_f32 v98, v98
    v_mul_f32 v22, v22, v96
    v_mul_f32 v23, v23, v97
    v_mfma_f32_32x32x16_bf16 v[64:79], a[156:159], a[36:39], v[64:79]
    ds_read_b64_tr_b16 a[152:153], v106 offset:26624
    ds_read_b64_tr_b16 a[154:155], v106 offset:26880
    v_mul_f32 v24, v24, v98
    v_fma_f32 v99, v25, v25, v11
    v_fma_f32 v100, v26, v26, v11
    v_fma_f32 v101, v27, v27, v11
    s_waitcnt lgkmcnt(6)
    v_mfma_f32_32x32x16_bf16 v[48:63], a[160:163], a[40:43], v[48:63]
    ds_read_b64_tr_b16 a[156:157], v106 offset:27136
    ds_read_b64_tr_b16 a[158:159], v106 offset:27392
    v_mul_f32 v99, v25, v99
    v_mul_f32 v100, v26, v100
    v_mul_f32 v101, v27, v101
    v_exp_f32 v99, -v99
    v_mfma_f32_32x32x16_bf16 v[64:79], a[164:167], a[40:43], v[64:79]
    ds_read_b64_tr_b16 a[160:161], v106 offset:28672
    ds_read_b64_tr_b16 a[162:163], v106 offset:28928
    buffer_load_dwordx4 v3, s[28:31], s44 offen offset:1024 lds
    v_exp_f32 v100, -v100
    v_exp_f32 v101, -v101
    v_mfma_f32_32x32x16_bf16 v[48:63], a[168:171], a[44:47], v[48:63]
    ds_read_b64_tr_b16 a[164:165], v106 offset:29184
    ds_read_b64_tr_b16 a[166:167], v106 offset:29440
    v_add_f32 v99, 1.0, v99
    v_add_f32 v100, 1.0, v100
    v_add_f32 v101, 1.0, v101
    v_rcp_f32 v99, v99
    v_mfma_f32_32x32x16_bf16 v[64:79], a[172:175], a[44:47], v[64:79]
    ds_read_b64_tr_b16 a[168:169], v106 offset:30720
    ds_read_b64_tr_b16 a[170:171], v106 offset:30976
    v_rcp_f32 v100, v100
    v_rcp_f32 v101, v101
    s_waitcnt lgkmcnt(6)
    v_mfma_f32_32x32x16_bf16 v[48:63], a[144:147], a[48:51], v[48:63]
    ds_read_b64_tr_b16 a[172:173], v106 offset:31232
    ds_read_b64_tr_b16 a[174:175], v106 offset:31488
    v_mul_f32 v25, v25, v99
    v_mul_f32 v26, v26, v100
    v_mul_f32 v27, v27, v101
    v_fma_f32 v96, v28, v28, v11
    v_mfma_f32_32x32x16_bf16 v[64:79], a[148:151], a[48:51], v[64:79]
    ds_read_b64_tr_b16 a[144:145], v106 offset:32768
    ds_read_b64_tr_b16 a[146:147], v106 offset:33024
    buffer_load_dwordx4 v4, s[28:31], s44 offen offset:2048 lds
    v_fma_f32 v97, v29, v29, v11
    v_mul_f32 v96, v28, v96
    v_mul_f32 v97, v29, v97
    v_exp_f32 v96, -v96
    v_mfma_f32_32x32x16_bf16 v[48:63], a[152:155], a[52:55], v[48:63]
    ds_read_b64_tr_b16 a[148:149], v106 offset:33280
    ds_read_b64_tr_b16 a[150:151], v106 offset:33536
    v_exp_f32 v97, -v97
    v_add_f32 v96, 1.0, v96
    v_add_f32 v97, 1.0, v97
    v_mfma_f32_32x32x16_bf16 v[64:79], a[156:159], a[52:55], v[64:79]
    ds_read_b64_tr_b16 a[152:153], v106 offset:34816
    ds_read_b64_tr_b16 a[154:155], v106 offset:35072
    v_rcp_f32 v96, v96
    v_rcp_f32 v97, v97
    s_waitcnt lgkmcnt(6)
    v_mfma_f32_32x32x16_bf16 v[48:63], a[160:163], a[56:59], v[48:63]
    ds_read_b64_tr_b16 a[156:157], v106 offset:35328
    ds_read_b64_tr_b16 a[158:159], v106 offset:35584
    v_mul_f32 v28, v28, v96
    v_mul_f32 v29, v29, v97
    v_fma_f32 v96, v30, v30, v11
    v_fma_f32 v97, v31, v31, v11
    v_mul_f32 v96, v30, v96
    v_mfma_f32_32x32x16_bf16 v[64:79], a[164:167], a[56:59], v[64:79]
    s_waitcnt vmcnt(16)
    s_barrier
    ds_read_b64_tr_b16 a[160:161], v107 offset:0
    ds_read_b64_tr_b16 a[162:163], v107 offset:256
    buffer_load_dwordx4 v5, s[28:31], s44 offen offset:3072 lds
    v_mul_f32 v97, v31, v97
    v_exp_f32 v96, -v96
    v_exp_f32 v97, -v97
    v_mfma_f32_32x32x16_bf16 v[48:63], a[168:171], a[60:63], v[48:63]
    ds_read_b64_tr_b16 a[164:165], v107 offset:512
    ds_read_b64_tr_b16 a[166:167], v107 offset:768
    v_add_f32 v96, 1.0, v96
    v_add_f32 v97, 1.0, v97
    v_rcp_f32 v96, v96
    v_mfma_f32_32x32x16_bf16 v[64:79], a[172:175], a[60:63], v[64:79]
    ds_read_b64_tr_b16 a[168:169], v107 offset:2048
    ds_read_b64_tr_b16 a[170:171], v107 offset:2304
    v_rcp_f32 v97, v97
    v_mul_f32 v30, v30, v96
    v_mul_f32 v31, v31, v97
    s_waitcnt lgkmcnt(6)
    v_mfma_f32_32x32x16_bf16 v[48:63], a[144:147], a[64:67], v[48:63]
    ds_read_b64_tr_b16 a[172:173], v107 offset:2560
    ds_read_b64_tr_b16 a[174:175], v107 offset:2816
    v_cvt_pk_bf16_f32 v112, v16, v17
    v_cvt_pk_bf16_f32 v113, v18, v19
    v_cvt_pk_bf16_f32 v114, v20, v21
    v_cvt_pk_bf16_f32 v115, v22, v23
    v_mfma_f32_32x32x16_bf16 v[64:79], a[148:151], a[64:67], v[64:79]
    ds_read_b64_tr_b16 a[144:145], v107 offset:4096
    ds_read_b64_tr_b16 a[146:147], v107 offset:4352
    s_add_u32 m0, s43, 45056
    s_add_u32 s44, s40, 3244288
    buffer_load_dwordx4 v2, s[28:31], s44 offen offset:0 lds
    v_cvt_pk_bf16_f32 v116, v24, v25
    v_cvt_pk_bf16_f32 v117, v26, v27
    v_cvt_pk_bf16_f32 v118, v28, v29
    v_cvt_pk_bf16_f32 v119, v30, v31
    v_mfma_f32_32x32x16_bf16 v[48:63], a[152:155], a[68:71], v[48:63]
    ds_read_b64_tr_b16 a[148:149], v107 offset:4608
    ds_read_b64_tr_b16 a[150:151], v107 offset:4864
    v_fma_f32 v96, v32, v32, v11
    v_fma_f32 v97, v33, v33, v11
    v_fma_f32 v98, v34, v34, v11
    v_mul_f32 v96, v32, v96
    v_mul_f32 v97, v33, v97
    v_mfma_f32_32x32x16_bf16 v[64:79], a[156:159], a[68:71], v[64:79]
    ds_read_b64_tr_b16 a[152:153], v107 offset:6144
    ds_read_b64_tr_b16 a[154:155], v107 offset:6400
    v_mul_f32 v98, v34, v98
    v_exp_f32 v96, -v96
    v_exp_f32 v97, -v97
    s_waitcnt lgkmcnt(6)
    v_mfma_f32_32x32x16_bf16 v[48:63], a[160:163], a[72:75], v[48:63]
    ds_read_b64_tr_b16 a[156:157], v107 offset:6656
    ds_read_b64_tr_b16 a[158:159], v107 offset:6912
    v_exp_f32 v98, -v98
    v_add_f32 v96, 1.0, v96
    v_add_f32 v97, 1.0, v97
    v_mfma_f32_32x32x16_bf16 v[64:79], a[164:167], a[72:75], v[64:79]
    ds_read_b64_tr_b16 a[160:161], v107 offset:8192
    ds_read_b64_tr_b16 a[162:163], v107 offset:8448
    s_add_u32 m0, s43, 73728
    s_add_u32 s44, s40, 384
    buffer_load_dwordx4 v2, s[28:31], s44 offen offset:0 lds
    v_add_f32 v98, 1.0, v98
    v_rcp_f32 v96, v96
    v_rcp_f32 v97, v97
    v_mfma_f32_32x32x16_bf16 v[48:63], a[168:171], a[76:79], v[48:63]
    ds_read_b64_tr_b16 a[164:165], v107 offset:8704
    ds_read_b64_tr_b16 a[166:167], v107 offset:8960
    v_rcp_f32 v98, v98
    v_mul_f32 v32, v32, v96
    v_mfma_f32_32x32x16_bf16 v[64:79], a[172:175], a[76:79], v[64:79]
    ds_read_b64_tr_b16 a[168:169], v107 offset:10240
    ds_read_b64_tr_b16 a[170:171], v107 offset:10496
    v_mul_f32 v33, v33, v97
    v_mul_f32 v34, v34, v98
    v_fma_f32 v99, v35, v35, v11
    v_fma_f32 v100, v36, v36, v11
    v_fma_f32 v101, v37, v37, v11
    s_waitcnt lgkmcnt(6)
    v_mfma_f32_32x32x16_bf16 v[48:63], a[144:147], a[80:83], v[48:63]
    ds_read_b64_tr_b16 a[172:173], v107 offset:10752
    ds_read_b64_tr_b16 a[174:175], v107 offset:11008
    v_mul_f32 v99, v35, v99
    v_mul_f32 v100, v36, v100
    v_mul_f32 v101, v37, v101
    v_exp_f32 v99, -v99
    v_mfma_f32_32x32x16_bf16 v[64:79], a[148:151], a[80:83], v[64:79]
    ds_read_b64_tr_b16 a[144:145], v107 offset:12288
    ds_read_b64_tr_b16 a[146:147], v107 offset:12544
    buffer_load_dwordx4 v3, s[28:31], s44 offen offset:1024 lds
    v_exp_f32 v100, -v100
    v_exp_f32 v101, -v101
    v_mfma_f32_32x32x16_bf16 v[48:63], a[152:155], a[84:87], v[48:63]
    ds_read_b64_tr_b16 a[148:149], v107 offset:12800
    ds_read_b64_tr_b16 a[150:151], v107 offset:13056
    v_add_f32 v99, 1.0, v99
    v_add_f32 v100, 1.0, v100
    v_add_f32 v101, 1.0, v101
    v_rcp_f32 v99, v99
    v_mfma_f32_32x32x16_bf16 v[64:79], a[156:159], a[84:87], v[64:79]
    ds_read_b64_tr_b16 a[152:153], v107 offset:14336
    ds_read_b64_tr_b16 a[154:155], v107 offset:14592
    v_rcp_f32 v100, v100
    v_rcp_f32 v101, v101
    s_waitcnt lgkmcnt(6)
    v_mfma_f32_32x32x16_bf16 v[48:63], a[160:163], a[88:91], v[48:63]
    ds_read_b64_tr_b16 a[156:157], v107 offset:14848
    ds_read_b64_tr_b16 a[158:159], v107 offset:15104
    v_mul_f32 v35, v35, v99
    v_mul_f32 v36, v36, v100
    v_mul_f32 v37, v37, v101
    v_fma_f32 v96, v38, v38, v11
    v_mfma_f32_32x32x16_bf16 v[64:79], a[164:167], a[88:91], v[64:79]
    ds_read_b64_tr_b16 a[160:161], v107 offset:16384
    ds_read_b64_tr_b16 a[162:163], v107 offset:16640
    buffer_load_dwordx4 v4, s[28:31], s44 offen offset:2048 lds
    v_fma_f32 v97, v39, v39, v11
    v_fma_f32 v98, v40, v40, v11
    v_mul_f32 v96, v38, v96
    v_mul_f32 v97, v39, v97
    v_mfma_f32_32x32x16_bf16 v[48:63], a[168:171], a[92:95], v[48:63]
    ds_read_b64_tr_b16 a[164:165], v107 offset:16896
    ds_read_b64_tr_b16 a[166:167], v107 offset:17152
    v_mul_f32 v98, v40, v98
    v_exp_f32 v96, -v96
    v_exp_f32 v97, -v97
    v_mfma_f32_32x32x16_bf16 v[64:79], a[172:175], a[92:95], v[64:79]
    ds_read_b64_tr_b16 a[168:169], v107 offset:18432
    ds_read_b64_tr_b16 a[170:171], v107 offset:18688
    v_exp_f32 v98, -v98
    v_add_f32 v96, 1.0, v96
    v_add_f32 v97, 1.0, v97
    s_waitcnt lgkmcnt(6)
    v_mfma_f32_32x32x16_bf16 v[48:63], a[144:147], a[96:99], v[48:63]
    ds_read_b64_tr_b16 a[172:173], v107 offset:18944
    ds_read_b64_tr_b16 a[174:175], v107 offset:19200
    v_add_f32 v98, 1.0, v98
    v_rcp_f32 v96, v96
    v_rcp_f32 v97, v97
    v_mfma_f32_32x32x16_bf16 v[64:79], a[148:151], a[96:99], v[64:79]
    ds_read_b64_tr_b16 a[144:145], v107 offset:20480
    ds_read_b64_tr_b16 a[146:147], v107 offset:20736
    buffer_load_dwordx4 v5, s[28:31], s44 offen offset:3072 lds
    v_rcp_f32 v98, v98
    v_mul_f32 v38, v38, v96
    v_mul_f32 v39, v39, v97
    v_mfma_f32_32x32x16_bf16 v[48:63], a[152:155], a[100:103], v[48:63]
    ds_read_b64_tr_b16 a[148:149], v107 offset:20992
    ds_read_b64_tr_b16 a[150:151], v107 offset:21248
    v_mul_f32 v40, v40, v98
    v_fma_f32 v99, v41, v41, v11
    v_fma_f32 v100, v42, v42, v11
    v_fma_f32 v101, v43, v43, v11
    v_mfma_f32_32x32x16_bf16 v[64:79], a[156:159], a[100:103], v[64:79]
    ds_read_b64_tr_b16 a[152:153], v107 offset:22528
    ds_read_b64_tr_b16 a[154:155], v107 offset:22784
    v_mul_f32 v99, v41, v99
    v_mul_f32 v100, v42, v100
    v_mul_f32 v101, v43, v101
    v_exp_f32 v99, -v99
    s_waitcnt lgkmcnt(6)
    v_mfma_f32_32x32x16_bf16 v[48:63], a[160:163], a[104:107], v[48:63]
    ds_read_b64_tr_b16 a[156:157], v107 offset:23040
    ds_read_b64_tr_b16 a[158:159], v107 offset:23296
    v_exp_f32 v100, -v100
    v_exp_f32 v101, -v101
    v_mfma_f32_32x32x16_bf16 v[64:79], a[164:167], a[104:107], v[64:79]
    ds_read_b64_tr_b16 a[160:161], v107 offset:24576
    ds_read_b64_tr_b16 a[162:163], v107 offset:24832
    s_add_u32 m0, s43, 77824
    s_add_u32 s44, s40, 295296
    buffer_load_dwordx4 v2, s[28:31], s44 offen offset:0 lds
    v_add_f32 v99, 1.0, v99
    v_add_f32 v100, 1.0, v100
    v_add_f32 v101, 1.0, v101
    v_rcp_f32 v99, v99
    v_mfma_f32_32x32x16_bf16 v[48:63], a[168:171], a[108:111], v[48:63]
    ds_read_b64_tr_b16 a[164:165], v107 offset:25088
    ds_read_b64_tr_b16 a[166:167], v107 offset:25344
    v_rcp_f32 v100, v100
    v_rcp_f32 v101, v101
    v_mfma_f32_32x32x16_bf16 v[64:79], a[172:175], a[108:111], v[64:79]
    ds_read_b64_tr_b16 a[168:169], v107 offset:26624
    ds_read_b64_tr_b16 a[170:171], v107 offset:26880
    v_mul_f32 v41, v41, v99
    v_mul_f32 v42, v42, v100
    v_mul_f32 v43, v43, v101
    v_fma_f32 v96, v44, v44, v11
    s_waitcnt lgkmcnt(6)
    v_mfma_f32_32x32x16_bf16 v[48:63], a[144:147], a[112:115], v[48:63]
    ds_read_b64_tr_b16 a[172:173], v107 offset:27136
    ds_read_b64_tr_b16 a[174:175], v107 offset:27392
    v_fma_f32 v97, v45, v45, v11
    v_mul_f32 v96, v44, v96
    v_mul_f32 v97, v45, v97
    v_exp_f32 v96, -v96
    v_mfma_f32_32x32x16_bf16 v[64:79], a[148:151], a[112:115], v[64:79]
    ds_read_b64_tr_b16 a[144:145], v107 offset:28672
    ds_read_b64_tr_b16 a[146:147], v107 offset:28928
    buffer_load_dwordx4 v3, s[28:31], s44 offen offset:1024 lds
    v_exp_f32 v97, -v97
    v_add_f32 v96, 1.0, v96
    v_add_f32 v97, 1.0, v97
    v_mfma_f32_32x32x16_bf16 v[48:63], a[152:155], a[116:119], v[48:63]
    ds_read_b64_tr_b16 a[148:149], v107 offset:29184
    ds_read_b64_tr_b16 a[150:151], v107 offset:29440
    v_rcp_f32 v96, v96
    v_rcp_f32 v97, v97
    v_mfma_f32_32x32x16_bf16 v[64:79], a[156:159], a[116:119], v[64:79]
    ds_read_b64_tr_b16 a[152:153], v107 offset:30720
    ds_read_b64_tr_b16 a[154:155], v107 offset:30976
    v_mul_f32 v44, v44, v96
    v_mul_f32 v45, v45, v97
    v_fma_f32 v96, v46, v46, v11
    v_fma_f32 v97, v47, v47, v11
    v_mul_f32 v96, v46, v96
    s_waitcnt lgkmcnt(6)
    v_mfma_f32_32x32x16_bf16 v[48:63], a[160:163], a[120:123], v[48:63]
    ds_read_b64_tr_b16 a[156:157], v107 offset:31232
    ds_read_b64_tr_b16 a[158:159], v107 offset:31488
    v_mul_f32 v97, v47, v97
    v_exp_f32 v96, -v96
    v_exp_f32 v97, -v97
    v_mfma_f32_32x32x16_bf16 v[64:79], a[164:167], a[120:123], v[64:79]
    ds_read_b64_tr_b16 a[160:161], v107 offset:32768
    ds_read_b64_tr_b16 a[162:163], v107 offset:33024
    buffer_load_dwordx4 v4, s[28:31], s44 offen offset:2048 lds
    v_add_f32 v96, 1.0, v96
    v_add_f32 v97, 1.0, v97
    v_rcp_f32 v96, v96
    v_mfma_f32_32x32x16_bf16 v[48:63], a[168:171], a[124:127], v[48:63]
    ds_read_b64_tr_b16 a[164:165], v107 offset:33280
    ds_read_b64_tr_b16 a[166:167], v107 offset:33536
    v_rcp_f32 v97, v97
    v_mul_f32 v46, v46, v96
    v_mul_f32 v47, v47, v97
    v_mfma_f32_32x32x16_bf16 v[64:79], a[172:175], a[124:127], v[64:79]
    ds_read_b64_tr_b16 a[168:169], v107 offset:34816
    ds_read_b64_tr_b16 a[170:171], v107 offset:35072
    v_cvt_pk_bf16_f32 v120, v32, v33
    v_cvt_pk_bf16_f32 v121, v34, v35
    v_cvt_pk_bf16_f32 v122, v36, v37
    v_cvt_pk_bf16_f32 v123, v38, v39
    s_waitcnt lgkmcnt(6)
    v_mfma_f32_32x32x16_bf16 v[48:63], a[144:147], a[128:131], v[48:63]
    ds_read_b64_tr_b16 a[172:173], v107 offset:35328
    ds_read_b64_tr_b16 a[174:175], v107 offset:35584
    v_cvt_pk_bf16_f32 v124, v40, v41
    v_cvt_pk_bf16_f32 v125, v42, v43
    v_cvt_pk_bf16_f32 v126, v44, v45
    v_cvt_pk_bf16_f32 v127, v46, v47
    v_mfma_f32_32x32x16_bf16 v[64:79], a[148:151], a[128:131], v[64:79]
    s_waitcnt vmcnt(16)
    s_barrier
    ds_read_b64_tr_b16 a[144:145], v104 offset:0
    ds_read_b64_tr_b16 a[146:147], v104 offset:256
    buffer_load_dwordx4 v5, s[28:31], s44 offen offset:3072 lds
    v_mfma_f32_32x32x16_bf16 v[48:63], a[152:155], a[132:135], v[48:63]
    ds_read_b64_tr_b16 a[148:149], v104 offset:512
    ds_read_b64_tr_b16 a[150:151], v104 offset:768
    ds_read_b128 v[16:19], v10 offset:512
    ds_read_b128 v[20:23], v10 offset:544
    ds_read_b128 v[24:27], v10 offset:576
    ds_read_b128 v[28:31], v10 offset:608
    ds_read_b128 v[32:35], v10 offset:640
    ds_read_b128 v[36:39], v10 offset:672
    ds_read_b128 v[40:43], v10 offset:704
    ds_read_b128 v[44:47], v10 offset:736
    v_mfma_f32_32x32x16_bf16 v[64:79], a[156:159], a[132:135], v[64:79]
    ds_read_b64_tr_b16 a[152:153], v104 offset:2048
    ds_read_b64_tr_b16 a[154:155], v104 offset:2304
    s_waitcnt lgkmcnt(14)
    v_mfma_f32_32x32x16_bf16 v[48:63], a[160:163], a[136:139], v[48:63]
    ds_read_b64_tr_b16 a[156:157], v104 offset:2560
    ds_read_b64_tr_b16 a[158:159], v104 offset:2816
    v_mfma_f32_32x32x16_bf16 v[64:79], a[164:167], a[136:139], v[64:79]
    ds_read_b64_tr_b16 a[160:161], v104 offset:4096
    ds_read_b64_tr_b16 a[162:163], v104 offset:4352
    s_add_u32 m0, s43, 81920
    s_add_u32 s44, s40, 590208
    buffer_load_dwordx4 v2, s[28:31], s44 offen offset:0 lds
    v_mfma_f32_32x32x16_bf16 v[48:63], a[168:171], a[140:143], v[48:63]
    ds_read_b64_tr_b16 a[164:165], v104 offset:4608
    ds_read_b64_tr_b16 a[166:167], v104 offset:4864
    v_mfma_f32_32x32x16_bf16 v[64:79], a[172:175], a[140:143], v[64:79]
    ds_read_b64_tr_b16 a[168:169], v104 offset:6144
    ds_read_b64_tr_b16 a[170:171], v104 offset:6400
    s_waitcnt lgkmcnt(6)
    v_mfma_f32_32x32x16_bf16 v[16:31], a[144:147], a[0:3], v[16:31]
    ds_read_b64_tr_b16 a[172:173], v104 offset:6656
    ds_read_b64_tr_b16 a[174:175], v104 offset:6912
    v_mfma_f32_32x32x16_bf16 v[32:47], a[148:151], a[0:3], v[32:47]
    ds_read_b64_tr_b16 a[144:145], v104 offset:8192
    ds_read_b64_tr_b16 a[146:147], v104 offset:8448
    s_add_u32 m0, s43, 110592
    s_add_u32 s44, s40, 2654592
    buffer_load_dwordx4 v2, s[28:31], s44 offen offset:0 lds
    v_mfma_f32_32x32x16_bf16 v[16:31], a[152:155], a[4:7], v[16:31]
    ds_read_b64_tr_b16 a[148:149], v104 offset:8704
    ds_read_b64_tr_b16 a[150:151], v104 offset:8960
    v_mfma_f32_32x32x16_bf16 v[32:47], a[156:159], a[4:7], v[32:47]
    ds_read_b64_tr_b16 a[152:153], v104 offset:10240
    ds_read_b64_tr_b16 a[154:155], v104 offset:10496
    v_fma_f32 v96, v48, v48, v11
    v_fma_f32 v97, v49, v49, v11
    v_fma_f32 v98, v50, v50, v11
    v_mul_f32 v96, v48, v96
    v_mul_f32 v97, v49, v97
    s_waitcnt lgkmcnt(6)
    v_mfma_f32_32x32x16_bf16 v[16:31], a[160:163], a[8:11], v[16:31]
    ds_read_b64_tr_b16 a[156:157], v104 offset:10752
    ds_read_b64_tr_b16 a[158:159], v104 offset:11008
    v_mul_f32 v98, v50, v98
    v_exp_f32 v96, -v96
    v_exp_f32 v97, -v97
    v_mfma_f32_32x32x16_bf16 v[32:47], a[164:167], a[8:11], v[32:47]
    ds_read_b64_tr_b16 a[160:161], v104 offset:12288
    ds_read_b64_tr_b16 a[162:163], v104 offset:12544
    buffer_load_dwordx4 v3, s[28:31], s44 offen offset:1024 lds
    v_exp_f32 v98, -v98
    v_add_f32 v96, 1.0, v96
    v_add_f32 v97, 1.0, v97
    v_mfma_f32_32x32x16_bf16 v[16:31], a[168:171], a[12:15], v[16:31]
    ds_read_b64_tr_b16 a[164:165], v104 offset:12800
    ds_read_b64_tr_b16 a[166:167], v104 offset:13056
    v_add_f32 v98, 1.0, v98
    v_rcp_f32 v96, v96
    v_rcp_f32 v97, v97
    v_mfma_f32_32x32x16_bf16 v[32:47], a[172:175], a[12:15], v[32:47]
    ds_read_b64_tr_b16 a[168:169], v104 offset:14336
    ds_read_b64_tr_b16 a[170:171], v104 offset:14592
    v_rcp_f32 v98, v98
    v_mul_f32 v48, v48, v96
    s_waitcnt lgkmcnt(6)
    v_mfma_f32_32x32x16_bf16 v[16:31], a[144:147], a[16:19], v[16:31]
    ds_read_b64_tr_b16 a[172:173], v104 offset:14848
    ds_read_b64_tr_b16 a[174:175], v104 offset:15104
    v_mul_f32 v49, v49, v97
    v_mul_f32 v50, v50, v98
    v_fma_f32 v99, v51, v51, v11
    v_fma_f32 v100, v52, v52, v11
    v_fma_f32 v101, v53, v53, v11
    v_mfma_f32_32x32x16_bf16 v[32:47], a[148:151], a[16:19], v[32:47]
    ds_read_b64_tr_b16 a[144:145], v104 offset:16384
    ds_read_b64_tr_b16 a[146:147], v104 offset:16640
    buffer_load_dwordx4 v4, s[28:31], s44 offen offset:2048 lds
    v_mul_f32 v99, v51, v99
    v_mul_f32 v100, v52, v100
    v_mul_f32 v101, v53, v101
    v_exp_f32 v99, -v99
    v_mfma_f32_32x32x16_bf16 v[16:31], a[152:155], a[20:23], v[16:31]
    ds_read_b64_tr_b16 a[148:149], v104 offset:16896
    ds_read_b64_tr_b16 a[150:151], v104 offset:17152
    v_exp_f32 v100, -v100
    v_exp_f32 v101, -v101
    v_mfma_f32_32x32x16_bf16 v[32:47], a[156:159], a[20:23], v[32:47]
    ds_read_b64_tr_b16 a[152:153], v104 offset:18432
    ds_read_b64_tr_b16 a[154:155], v104 offset:18688
    v_add_f32 v99, 1.0, v99
    v_add_f32 v100, 1.0, v100
    v_add_f32 v101, 1.0, v101
    v_rcp_f32 v99, v99
    s_waitcnt lgkmcnt(6)
    v_mfma_f32_32x32x16_bf16 v[16:31], a[160:163], a[24:27], v[16:31]
    ds_read_b64_tr_b16 a[156:157], v104 offset:18944
    ds_read_b64_tr_b16 a[158:159], v104 offset:19200
    v_rcp_f32 v100, v100
    v_rcp_f32 v101, v101
    v_mfma_f32_32x32x16_bf16 v[32:47], a[164:167], a[24:27], v[32:47]
    ds_read_b64_tr_b16 a[160:161], v104 offset:20480
    ds_read_b64_tr_b16 a[162:163], v104 offset:20736
    buffer_load_dwordx4 v5, s[28:31], s44 offen offset:3072 lds
    v_mul_f32 v51, v51, v99
    v_mul_f32 v52, v52, v100
    v_mul_f32 v53, v53, v101
    v_fma_f32 v96, v54, v54, v11
    v_mfma_f32_32x32x16_bf16 v[16:31], a[168:171], a[28:31], v[16:31]
    ds_read_b64_tr_b16 a[164:165], v104 offset:20992
    ds_read_b64_tr_b16 a[166:167], v104 offset:21248
    v_fma_f32 v97, v55, v55, v11
    v_fma_f32 v98, v56, v56, v11
    v_mul_f32 v96, v54, v96
    v_mul_f32 v97, v55, v97
    v_mfma_f32_32x32x16_bf16 v[32:47], a[172:175], a[28:31], v[32:47]
    ds_read_b64_tr_b16 a[168:169], v104 offset:22528
    ds_read_b64_tr_b16 a[170:171], v104 offset:22784
    v_mul_f32 v98, v56, v98
    v_exp_f32 v96, -v96
    v_exp_f32 v97, -v97
    s_waitcnt lgkmcnt(6)
    v_mfma_f32_32x32x16_bf16 v[16:31], a[144:147], a[32:35], v[16:31]
    ds_read_b64_tr_b16 a[172:173], v104 offset:23040
    ds_read_b64_tr_b16 a[174:175], v104 offset:23296
    v_exp_f32 v98, -v98
    v_add_f32 v96, 1.0, v96
    v_add_f32 v97, 1.0, v97
    v_mfma_f32_32x32x16_bf16 v[32:47], a[148:151], a[32:35], v[32:47]
    ds_read_b64_tr_b16 a[144:145], v104 offset:24576
    ds_read_b64_tr_b16 a[146:147], v104 offset:24832
    s_add_u32 m0, s43, 114688
    s_add_u32 s44, s40, 2949504
    buffer_load_dwordx4 v2, s[28:31], s44 offen offset:0 lds
    v_add_f32 v98, 1.0, v98
    v_rcp_f32 v96, v96
    v_rcp_f32 v97, v97
    v_mfma_f32_32x32x16_bf16 v[16:31], a[152:155], a[36:39], v[16:31]
    ds_read_b64_tr_b16 a[148:149], v104 offset:25088
    ds_read_b64_tr_b16 a[150:151], v104 offset:25344
    v_rcp_f32 v98, v98
    v_mul_f32 v54, v54, v96
    v_mul_f32 v55, v55, v97
    v_mfma_f32_32x32x16_bf16 v[32:47], a[156:159], a[36:39], v[32:47]
    ds_read_b64_tr_b16 a[152:153], v104 offset:26624
    ds_read_b64_tr_b16 a[154:155], v104 offset:26880
    v_mul_f32 v56, v56, v98
    v_fma_f32 v99, v57, v57, v11
    v_fma_f32 v100, v58, v58, v11
    v_fma_f32 v101, v59, v59, v11
    s_waitcnt lgkmcnt(6)
    v_mfma_f32_32x32x16_bf16 v[16:31], a[160:163], a[40:43], v[16:31]
    ds_read_b64_tr_b16 a[156:157], v104 offset:27136
    ds_read_b64_tr_b16 a[158:159], v104 offset:27392
    v_mul_f32 v99, v57, v99
    v_mul_f32 v100, v58, v100
    v_mul_f32 v101, v59, v101
    v_exp_f32 v99, -v99
    v_mfma_f32_32x32x16_bf16 v[32:47], a[164:167], a[40:43], v[32:47]
    ds_read_b64_tr_b16 a[160:161], v104 offset:28672
    ds_read_b64_tr_b16 a[162:163], v104 offset:28928
    buffer_load_dwordx4 v3, s[28:31], s44 offen offset:1024 lds
    v_exp_f32 v100, -v100
    v_exp_f32 v101, -v101
    v_mfma_f32_32x32x16_bf16 v[16:31], a[168:171], a[44:47], v[16:31]
    ds_read_b64_tr_b16 a[164:165], v104 offset:29184
    ds_read_b64_tr_b16 a[166:167], v104 offset:29440
    v_add_f32 v99, 1.0, v99
    v_add_f32 v100, 1.0, v100
    v_add_f32 v101, 1.0, v101
    v_rcp_f32 v99, v99
    v_mfma_f32_32x32x16_bf16 v[32:47], a[172:175], a[44:47], v[32:47]
    ds_read_b64_tr_b16 a[168:169], v104 offset:30720
    ds_read_b64_tr_b16 a[170:171], v104 offset:30976
    v_rcp_f32 v100, v100
    v_rcp_f32 v101, v101
    s_waitcnt lgkmcnt(6)
    v_mfma_f32_32x32x16_bf16 v[16:31], a[144:147], a[48:51], v[16:31]
    ds_read_b64_tr_b16 a[172:173], v104 offset:31232
    ds_read_b64_tr_b16 a[174:175], v104 offset:31488
    v_mul_f32 v57, v57, v99
    v_mul_f32 v58, v58, v100
    v_mul_f32 v59, v59, v101
    v_fma_f32 v96, v60, v60, v11
    v_mfma_f32_32x32x16_bf16 v[32:47], a[148:151], a[48:51], v[32:47]
    ds_read_b64_tr_b16 a[144:145], v104 offset:32768
    ds_read_b64_tr_b16 a[146:147], v104 offset:33024
    buffer_load_dwordx4 v4, s[28:31], s44 offen offset:2048 lds
    v_fma_f32 v97, v61, v61, v11
    v_mul_f32 v96, v60, v96
    v_mul_f32 v97, v61, v97
    v_exp_f32 v96, -v96
    v_mfma_f32_32x32x16_bf16 v[16:31], a[152:155], a[52:55], v[16:31]
    ds_read_b64_tr_b16 a[148:149], v104 offset:33280
    ds_read_b64_tr_b16 a[150:151], v104 offset:33536
    v_exp_f32 v97, -v97
    v_add_f32 v96, 1.0, v96
    v_add_f32 v97, 1.0, v97
    v_mfma_f32_32x32x16_bf16 v[32:47], a[156:159], a[52:55], v[32:47]
    ds_read_b64_tr_b16 a[152:153], v104 offset:34816
    ds_read_b64_tr_b16 a[154:155], v104 offset:35072
    v_rcp_f32 v96, v96
    v_rcp_f32 v97, v97
    s_waitcnt lgkmcnt(6)
    v_mfma_f32_32x32x16_bf16 v[16:31], a[160:163], a[56:59], v[16:31]
    ds_read_b64_tr_b16 a[156:157], v104 offset:35328
    ds_read_b64_tr_b16 a[158:159], v104 offset:35584
    v_mul_f32 v60, v60, v96
    v_mul_f32 v61, v61, v97
    v_fma_f32 v96, v62, v62, v11
    v_fma_f32 v97, v63, v63, v11
    v_mul_f32 v96, v62, v96
    v_mfma_f32_32x32x16_bf16 v[32:47], a[164:167], a[56:59], v[32:47]
    s_waitcnt vmcnt(16)
    s_barrier
    ds_read_b64_tr_b16 a[160:161], v105 offset:0
    ds_read_b64_tr_b16 a[162:163], v105 offset:256
    buffer_load_dwordx4 v5, s[28:31], s44 offen offset:3072 lds
    v_mul_f32 v97, v63, v97
    v_exp_f32 v96, -v96
    v_exp_f32 v97, -v97
    v_mfma_f32_32x32x16_bf16 v[16:31], a[168:171], a[60:63], v[16:31]
    ds_read_b64_tr_b16 a[164:165], v105 offset:512
    ds_read_b64_tr_b16 a[166:167], v105 offset:768
    v_add_f32 v96, 1.0, v96
    v_add_f32 v97, 1.0, v97
    v_rcp_f32 v96, v96
    v_mfma_f32_32x32x16_bf16 v[32:47], a[172:175], a[60:63], v[32:47]
    ds_read_b64_tr_b16 a[168:169], v105 offset:2048
    ds_read_b64_tr_b16 a[170:171], v105 offset:2304
    v_rcp_f32 v97, v97
    v_mul_f32 v62, v62, v96
    v_mul_f32 v63, v63, v97
    s_waitcnt lgkmcnt(6)
    v_mfma_f32_32x32x16_bf16 v[16:31], a[144:147], a[64:67], v[16:31]
    ds_read_b64_tr_b16 a[172:173], v105 offset:2560
    ds_read_b64_tr_b16 a[174:175], v105 offset:2816
    v_cvt_pk_bf16_f32 v128, v48, v49
    v_cvt_pk_bf16_f32 v129, v50, v51
    v_cvt_pk_bf16_f32 v130, v52, v53
    v_cvt_pk_bf16_f32 v131, v54, v55
    v_mfma_f32_32x32x16_bf16 v[32:47], a[148:151], a[64:67], v[32:47]
    ds_read_b64_tr_b16 a[144:145], v105 offset:4096
    ds_read_b64_tr_b16 a[146:147], v105 offset:4352
    s_add_u32 m0, s43, 118784
    s_add_u32 s44, s40, 3244416
    buffer_load_dwordx4 v2, s[28:31], s44 offen offset:0 lds
    v_cvt_pk_bf16_f32 v132, v56, v57
    v_cvt_pk_bf16_f32 v133, v58, v59
    v_cvt_pk_bf16_f32 v134, v60, v61
    v_cvt_pk_bf16_f32 v135, v62, v63
    v_mfma_f32_32x32x16_bf16 v[16:31], a[152:155], a[68:71], v[16:31]
    ds_read_b64_tr_b16 a[148:149], v105 offset:4608
    ds_read_b64_tr_b16 a[150:151], v105 offset:4864
    v_fma_f32 v96, v64, v64, v11
    v_fma_f32 v97, v65, v65, v11
    v_fma_f32 v98, v66, v66, v11
    v_mul_f32 v96, v64, v96
    v_mul_f32 v97, v65, v97
    v_mfma_f32_32x32x16_bf16 v[32:47], a[156:159], a[68:71], v[32:47]
    ds_read_b64_tr_b16 a[152:153], v105 offset:6144
    ds_read_b64_tr_b16 a[154:155], v105 offset:6400
    v_mul_f32 v98, v66, v98
    v_exp_f32 v96, -v96
    v_exp_f32 v97, -v97
    s_waitcnt lgkmcnt(6)
    v_mfma_f32_32x32x16_bf16 v[16:31], a[160:163], a[72:75], v[16:31]
    ds_read_b64_tr_b16 a[156:157], v105 offset:6656
    ds_read_b64_tr_b16 a[158:159], v105 offset:6912
    v_exp_f32 v98, -v98
    v_add_f32 v96, 1.0, v96
    v_add_f32 v97, 1.0, v97
    v_mfma_f32_32x32x16_bf16 v[32:47], a[164:167], a[72:75], v[32:47]
    ds_read_b64_tr_b16 a[160:161], v105 offset:8192
    ds_read_b64_tr_b16 a[162:163], v105 offset:8448
    s_add_u32 m0, s43, 0
    s_add_u32 s44, s40, 512
    buffer_load_dwordx4 v2, s[28:31], s44 offen offset:0 lds
    v_add_f32 v98, 1.0, v98
    v_rcp_f32 v96, v96
    v_rcp_f32 v97, v97
    v_mfma_f32_32x32x16_bf16 v[16:31], a[168:171], a[76:79], v[16:31]
    ds_read_b64_tr_b16 a[164:165], v105 offset:8704
    ds_read_b64_tr_b16 a[166:167], v105 offset:8960
    v_rcp_f32 v98, v98
    v_mul_f32 v64, v64, v96
    v_mfma_f32_32x32x16_bf16 v[32:47], a[172:175], a[76:79], v[32:47]
    ds_read_b64_tr_b16 a[168:169], v105 offset:10240
    ds_read_b64_tr_b16 a[170:171], v105 offset:10496
    v_mul_f32 v65, v65, v97
    v_mul_f32 v66, v66, v98
    v_fma_f32 v99, v67, v67, v11
    v_fma_f32 v100, v68, v68, v11
    v_fma_f32 v101, v69, v69, v11
    s_waitcnt lgkmcnt(6)
    v_mfma_f32_32x32x16_bf16 v[16:31], a[144:147], a[80:83], v[16:31]
    ds_read_b64_tr_b16 a[172:173], v105 offset:10752
    ds_read_b64_tr_b16 a[174:175], v105 offset:11008
    v_mul_f32 v99, v67, v99
    v_mul_f32 v100, v68, v100
    v_mul_f32 v101, v69, v101
    v_exp_f32 v99, -v99
    v_mfma_f32_32x32x16_bf16 v[32:47], a[148:151], a[80:83], v[32:47]
    ds_read_b64_tr_b16 a[144:145], v105 offset:12288
    ds_read_b64_tr_b16 a[146:147], v105 offset:12544
    buffer_load_dwordx4 v3, s[28:31], s44 offen offset:1024 lds
    v_exp_f32 v100, -v100
    v_exp_f32 v101, -v101
    v_mfma_f32_32x32x16_bf16 v[16:31], a[152:155], a[84:87], v[16:31]
    ds_read_b64_tr_b16 a[148:149], v105 offset:12800
    ds_read_b64_tr_b16 a[150:151], v105 offset:13056
    v_add_f32 v99, 1.0, v99
    v_add_f32 v100, 1.0, v100
    v_add_f32 v101, 1.0, v101
    v_rcp_f32 v99, v99
    v_mfma_f32_32x32x16_bf16 v[32:47], a[156:159], a[84:87], v[32:47]
    ds_read_b64_tr_b16 a[152:153], v105 offset:14336
    ds_read_b64_tr_b16 a[154:155], v105 offset:14592
    v_rcp_f32 v100, v100
    v_rcp_f32 v101, v101
    s_waitcnt lgkmcnt(6)
    v_mfma_f32_32x32x16_bf16 v[16:31], a[160:163], a[88:91], v[16:31]
    ds_read_b64_tr_b16 a[156:157], v105 offset:14848
    ds_read_b64_tr_b16 a[158:159], v105 offset:15104
    v_mul_f32 v67, v67, v99
    v_mul_f32 v68, v68, v100
    v_mul_f32 v69, v69, v101
    v_fma_f32 v96, v70, v70, v11
    v_mfma_f32_32x32x16_bf16 v[32:47], a[164:167], a[88:91], v[32:47]
    ds_read_b64_tr_b16 a[160:161], v105 offset:16384
    ds_read_b64_tr_b16 a[162:163], v105 offset:16640
    buffer_load_dwordx4 v4, s[28:31], s44 offen offset:2048 lds
    v_fma_f32 v97, v71, v71, v11
    v_fma_f32 v98, v72, v72, v11
    v_mul_f32 v96, v70, v96
    v_mul_f32 v97, v71, v97
    v_mfma_f32_32x32x16_bf16 v[16:31], a[168:171], a[92:95], v[16:31]
    ds_read_b64_tr_b16 a[164:165], v105 offset:16896
    ds_read_b64_tr_b16 a[166:167], v105 offset:17152
    v_mul_f32 v98, v72, v98
    v_exp_f32 v96, -v96
    v_exp_f32 v97, -v97
    v_mfma_f32_32x32x16_bf16 v[32:47], a[172:175], a[92:95], v[32:47]
    ds_read_b64_tr_b16 a[168:169], v105 offset:18432
    ds_read_b64_tr_b16 a[170:171], v105 offset:18688
    v_exp_f32 v98, -v98
    v_add_f32 v96, 1.0, v96
    v_add_f32 v97, 1.0, v97
    s_waitcnt lgkmcnt(6)
    v_mfma_f32_32x32x16_bf16 v[16:31], a[144:147], a[96:99], v[16:31]
    ds_read_b64_tr_b16 a[172:173], v105 offset:18944
    ds_read_b64_tr_b16 a[174:175], v105 offset:19200
    v_add_f32 v98, 1.0, v98
    v_rcp_f32 v96, v96
    v_rcp_f32 v97, v97
    v_mfma_f32_32x32x16_bf16 v[32:47], a[148:151], a[96:99], v[32:47]
    ds_read_b64_tr_b16 a[144:145], v105 offset:20480
    ds_read_b64_tr_b16 a[146:147], v105 offset:20736
    buffer_load_dwordx4 v5, s[28:31], s44 offen offset:3072 lds
    v_rcp_f32 v98, v98
    v_mul_f32 v70, v70, v96
    v_mul_f32 v71, v71, v97
    v_mfma_f32_32x32x16_bf16 v[16:31], a[152:155], a[100:103], v[16:31]
    ds_read_b64_tr_b16 a[148:149], v105 offset:20992
    ds_read_b64_tr_b16 a[150:151], v105 offset:21248
    v_mul_f32 v72, v72, v98
    v_fma_f32 v99, v73, v73, v11
    v_fma_f32 v100, v74, v74, v11
    v_fma_f32 v101, v75, v75, v11
    v_mfma_f32_32x32x16_bf16 v[32:47], a[156:159], a[100:103], v[32:47]
    ds_read_b64_tr_b16 a[152:153], v105 offset:22528
    ds_read_b64_tr_b16 a[154:155], v105 offset:22784
    v_mul_f32 v99, v73, v99
    v_mul_f32 v100, v74, v100
    v_mul_f32 v101, v75, v101
    v_exp_f32 v99, -v99
    s_waitcnt lgkmcnt(6)
    v_mfma_f32_32x32x16_bf16 v[16:31], a[160:163], a[104:107], v[16:31]
    ds_read_b64_tr_b16 a[156:157], v105 offset:23040
    ds_read_b64_tr_b16 a[158:159], v105 offset:23296
    v_exp_f32 v100, -v100
    v_exp_f32 v101, -v101
    v_mfma_f32_32x32x16_bf16 v[32:47], a[164:167], a[104:107], v[32:47]
    ds_read_b64_tr_b16 a[160:161], v105 offset:24576
    ds_read_b64_tr_b16 a[162:163], v105 offset:24832
    s_add_u32 m0, s43, 4096
    s_add_u32 s44, s40, 295424
    buffer_load_dwordx4 v2, s[28:31], s44 offen offset:0 lds
    v_add_f32 v99, 1.0, v99
    v_add_f32 v100, 1.0, v100
    v_add_f32 v101, 1.0, v101
    v_rcp_f32 v99, v99
    v_mfma_f32_32x32x16_bf16 v[16:31], a[168:171], a[108:111], v[16:31]
    ds_read_b64_tr_b16 a[164:165], v105 offset:25088
    ds_read_b64_tr_b16 a[166:167], v105 offset:25344
    v_rcp_f32 v100, v100
    v_rcp_f32 v101, v101
    v_mfma_f32_32x32x16_bf16 v[32:47], a[172:175], a[108:111], v[32:47]
    ds_read_b64_tr_b16 a[168:169], v105 offset:26624
    ds_read_b64_tr_b16 a[170:171], v105 offset:26880
    v_mul_f32 v73, v73, v99
    v_mul_f32 v74, v74, v100
    v_mul_f32 v75, v75, v101
    v_fma_f32 v96, v76, v76, v11
    s_waitcnt lgkmcnt(6)
    v_mfma_f32_32x32x16_bf16 v[16:31], a[144:147], a[112:115], v[16:31]
    ds_read_b64_tr_b16 a[172:173], v105 offset:27136
    ds_read_b64_tr_b16 a[174:175], v105 offset:27392
    v_fma_f32 v97, v77, v77, v11
    v_mul_f32 v96, v76, v96
    v_mul_f32 v97, v77, v97
    v_exp_f32 v96, -v96
    v_mfma_f32_32x32x16_bf16 v[32:47], a[148:151], a[112:115], v[32:47]
    ds_read_b64_tr_b16 a[144:145], v105 offset:28672
    ds_read_b64_tr_b16 a[146:147], v105 offset:28928
    buffer_load_dwordx4 v3, s[28:31], s44 offen offset:1024 lds
    v_exp_f32 v97, -v97
    v_add_f32 v96, 1.0, v96
    v_add_f32 v97, 1.0, v97
    v_mfma_f32_32x32x16_bf16 v[16:31], a[152:155], a[116:119], v[16:31]
    ds_read_b64_tr_b16 a[148:149], v105 offset:29184
    ds_read_b64_tr_b16 a[150:151], v105 offset:29440
    v_rcp_f32 v96, v96
    v_rcp_f32 v97, v97
    v_mfma_f32_32x32x16_bf16 v[32:47], a[156:159], a[116:119], v[32:47]
    ds_read_b64_tr_b16 a[152:153], v105 offset:30720
    ds_read_b64_tr_b16 a[154:155], v105 offset:30976
    v_mul_f32 v76, v76, v96
    v_mul_f32 v77, v77, v97
    v_fma_f32 v96, v78, v78, v11
    v_fma_f32 v97, v79, v79, v11
    v_mul_f32 v96, v78, v96
    s_waitcnt lgkmcnt(6)
    v_mfma_f32_32x32x16_bf16 v[16:31], a[160:163], a[120:123], v[16:31]
    ds_read_b64_tr_b16 a[156:157], v105 offset:31232
    ds_read_b64_tr_b16 a[158:159], v105 offset:31488
    v_mul_f32 v97, v79, v97
    v_exp_f32 v96, -v96
    v_exp_f32 v97, -v97
    v_mfma_f32_32x32x16_bf16 v[32:47], a[164:167], a[120:123], v[32:47]
    ds_read_b64_tr_b16 a[160:161], v105 offset:32768
    ds_read_b64_tr_b16 a[162:163], v105 offset:33024
    buffer_load_dwordx4 v4, s[28:31], s44 offen offset:2048 lds
    v_add_f32 v96, 1.0, v96
    v_add_f32 v97, 1.0, v97
    v_rcp_f32 v96, v96
    v_mfma_f32_32x32x16_bf16 v[16:31], a[168:171], a[124:127], v[16:31]
    ds_read_b64_tr_b16 a[164:165], v105 offset:33280
    ds_read_b64_tr_b16 a[166:167], v105 offset:33536
    v_rcp_f32 v97, v97
    v_mul_f32 v78, v78, v96
    v_mul_f32 v79, v79, v97
    v_mfma_f32_32x32x16_bf16 v[32:47], a[172:175], a[124:127], v[32:47]
    ds_read_b64_tr_b16 a[168:169], v105 offset:34816
    ds_read_b64_tr_b16 a[170:171], v105 offset:35072
    v_cvt_pk_bf16_f32 v136, v64, v65
    v_cvt_pk_bf16_f32 v137, v66, v67
    v_cvt_pk_bf16_f32 v138, v68, v69
    v_cvt_pk_bf16_f32 v139, v70, v71
    s_waitcnt lgkmcnt(6)
    v_mfma_f32_32x32x16_bf16 v[16:31], a[144:147], a[128:131], v[16:31]
    ds_read_b64_tr_b16 a[172:173], v105 offset:35328
    ds_read_b64_tr_b16 a[174:175], v105 offset:35584
    v_cvt_pk_bf16_f32 v140, v72, v73
    v_cvt_pk_bf16_f32 v141, v74, v75
    v_cvt_pk_bf16_f32 v142, v76, v77
    v_cvt_pk_bf16_f32 v143, v78, v79
    v_mfma_f32_32x32x16_bf16 v[32:47], a[148:151], a[128:131], v[32:47]
    s_waitcnt vmcnt(16)
    s_barrier
    ds_read_b64_tr_b16 a[144:145], v106 offset:0
    ds_read_b64_tr_b16 a[146:147], v106 offset:256
    buffer_load_dwordx4 v5, s[28:31], s44 offen offset:3072 lds
    v_mfma_f32_32x32x16_bf16 v[16:31], a[152:155], a[132:135], v[16:31]
    ds_read_b64_tr_b16 a[148:149], v106 offset:512
    ds_read_b64_tr_b16 a[150:151], v106 offset:768
    ds_read_b128 v[48:51], v10 offset:768
    ds_read_b128 v[52:55], v10 offset:800
    ds_read_b128 v[56:59], v10 offset:832
    ds_read_b128 v[60:63], v10 offset:864
    ds_read_b128 v[64:67], v10 offset:896
    ds_read_b128 v[68:71], v10 offset:928
    ds_read_b128 v[72:75], v10 offset:960
    ds_read_b128 v[76:79], v10 offset:992
    v_mfma_f32_32x32x16_bf16 v[32:47], a[156:159], a[132:135], v[32:47]
    ds_read_b64_tr_b16 a[152:153], v106 offset:2048
    ds_read_b64_tr_b16 a[154:155], v106 offset:2304
    s_waitcnt lgkmcnt(14)
    v_mfma_f32_32x32x16_bf16 v[16:31], a[160:163], a[136:139], v[16:31]
    ds_read_b64_tr_b16 a[156:157], v106 offset:2560
    ds_read_b64_tr_b16 a[158:159], v106 offset:2816
    v_mfma_f32_32x32x16_bf16 v[32:47], a[164:167], a[136:139], v[32:47]
    ds_read_b64_tr_b16 a[160:161], v106 offset:4096
    ds_read_b64_tr_b16 a[162:163], v106 offset:4352
    s_add_u32 m0, s43, 8192
    s_add_u32 s44, s40, 590336
    buffer_load_dwordx4 v2, s[28:31], s44 offen offset:0 lds
    v_mfma_f32_32x32x16_bf16 v[16:31], a[168:171], a[140:143], v[16:31]
    ds_read_b64_tr_b16 a[164:165], v106 offset:4608
    ds_read_b64_tr_b16 a[166:167], v106 offset:4864
    v_mfma_f32_32x32x16_bf16 v[32:47], a[172:175], a[140:143], v[32:47]
    ds_read_b64_tr_b16 a[168:169], v106 offset:6144
    ds_read_b64_tr_b16 a[170:171], v106 offset:6400
    s_waitcnt lgkmcnt(6)
    v_mfma_f32_32x32x16_bf16 v[48:63], a[144:147], a[0:3], v[48:63]
    ds_read_b64_tr_b16 a[172:173], v106 offset:6656
    ds_read_b64_tr_b16 a[174:175], v106 offset:6912
    v_mfma_f32_32x32x16_bf16 v[64:79], a[148:151], a[0:3], v[64:79]
    ds_read_b64_tr_b16 a[144:145], v106 offset:8192
    ds_read_b64_tr_b16 a[146:147], v106 offset:8448
    s_add_u32 m0, s43, 36864
    s_add_u32 s44, s40, 2654720
    buffer_load_dwordx4 v2, s[28:31], s44 offen offset:0 lds
    v_mfma_f32_32x32x16_bf16 v[48:63], a[152:155], a[4:7], v[48:63]
    ds_read_b64_tr_b16 a[148:149], v106 offset:8704
    ds_read_b64_tr_b16 a[150:151], v106 offset:8960
    v_mfma_f32_32x32x16_bf16 v[64:79], a[156:159], a[4:7], v[64:79]
    ds_read_b64_tr_b16 a[152:153], v106 offset:10240
    ds_read_b64_tr_b16 a[154:155], v106 offset:10496
    v_fma_f32 v96, v16, v16, v11
    v_fma_f32 v97, v17, v17, v11
    v_fma_f32 v98, v18, v18, v11
    v_mul_f32 v96, v16, v96
    v_mul_f32 v97, v17, v97
    s_waitcnt lgkmcnt(6)
    v_mfma_f32_32x32x16_bf16 v[48:63], a[160:163], a[8:11], v[48:63]
    ds_read_b64_tr_b16 a[156:157], v106 offset:10752
    ds_read_b64_tr_b16 a[158:159], v106 offset:11008
    v_mul_f32 v98, v18, v98
    v_exp_f32 v96, -v96
    v_exp_f32 v97, -v97
    v_mfma_f32_32x32x16_bf16 v[64:79], a[164:167], a[8:11], v[64:79]
    ds_read_b64_tr_b16 a[160:161], v106 offset:12288
    ds_read_b64_tr_b16 a[162:163], v106 offset:12544
    buffer_load_dwordx4 v3, s[28:31], s44 offen offset:1024 lds
    v_exp_f32 v98, -v98
    v_add_f32 v96, 1.0, v96
    v_add_f32 v97, 1.0, v97
    v_mfma_f32_32x32x16_bf16 v[48:63], a[168:171], a[12:15], v[48:63]
    ds_read_b64_tr_b16 a[164:165], v106 offset:12800
    ds_read_b64_tr_b16 a[166:167], v106 offset:13056
    v_add_f32 v98, 1.0, v98
    v_rcp_f32 v96, v96
    v_rcp_f32 v97, v97
    v_mfma_f32_32x32x16_bf16 v[64:79], a[172:175], a[12:15], v[64:79]
    ds_read_b64_tr_b16 a[168:169], v106 offset:14336
    ds_read_b64_tr_b16 a[170:171], v106 offset:14592
    v_rcp_f32 v98, v98
    v_mul_f32 v16, v16, v96
    s_waitcnt lgkmcnt(6)
    v_mfma_f32_32x32x16_bf16 v[48:63], a[144:147], a[16:19], v[48:63]
    ds_read_b64_tr_b16 a[172:173], v106 offset:14848
    ds_read_b64_tr_b16 a[174:175], v106 offset:15104
    v_mul_f32 v17, v17, v97
    v_mul_f32 v18, v18, v98
    v_fma_f32 v99, v19, v19, v11
    v_fma_f32 v100, v20, v20, v11
    v_fma_f32 v101, v21, v21, v11
    v_mfma_f32_32x32x16_bf16 v[64:79], a[148:151], a[16:19], v[64:79]
    ds_read_b64_tr_b16 a[144:145], v106 offset:16384
    ds_read_b64_tr_b16 a[146:147], v106 offset:16640
    buffer_load_dwordx4 v4, s[28:31], s44 offen offset:2048 lds
    v_mul_f32 v99, v19, v99
    v_mul_f32 v100, v20, v100
    v_mul_f32 v101, v21, v101
    v_exp_f32 v99, -v99
    v_mfma_f32_32x32x16_bf16 v[48:63], a[152:155], a[20:23], v[48:63]
    ds_read_b64_tr_b16 a[148:149], v106 offset:16896
    ds_read_b64_tr_b16 a[150:151], v106 offset:17152
    v_exp_f32 v100, -v100
    v_exp_f32 v101, -v101
    v_mfma_f32_32x32x16_bf16 v[64:79], a[156:159], a[20:23], v[64:79]
    ds_read_b64_tr_b16 a[152:153], v106 offset:18432
    ds_read_b64_tr_b16 a[154:155], v106 offset:18688
    v_add_f32 v99, 1.0, v99
    v_add_f32 v100, 1.0, v100
    v_add_f32 v101, 1.0, v101
    v_rcp_f32 v99, v99
    s_waitcnt lgkmcnt(6)
    v_mfma_f32_32x32x16_bf16 v[48:63], a[160:163], a[24:27], v[48:63]
    ds_read_b64_tr_b16 a[156:157], v106 offset:18944
    ds_read_b64_tr_b16 a[158:159], v106 offset:19200
    v_rcp_f32 v100, v100
    v_rcp_f32 v101, v101
    v_mfma_f32_32x32x16_bf16 v[64:79], a[164:167], a[24:27], v[64:79]
    ds_read_b64_tr_b16 a[160:161], v106 offset:20480
    ds_read_b64_tr_b16 a[162:163], v106 offset:20736
    buffer_load_dwordx4 v5, s[28:31], s44 offen offset:3072 lds
    v_mul_f32 v19, v19, v99
    v_mul_f32 v20, v20, v100
    v_mul_f32 v21, v21, v101
    v_fma_f32 v96, v22, v22, v11
    v_mfma_f32_32x32x16_bf16 v[48:63], a[168:171], a[28:31], v[48:63]
    ds_read_b64_tr_b16 a[164:165], v106 offset:20992
    ds_read_b64_tr_b16 a[166:167], v106 offset:21248
    v_fma_f32 v97, v23, v23, v11
    v_fma_f32 v98, v24, v24, v11
    v_mul_f32 v96, v22, v96
    v_mul_f32 v97, v23, v97
    v_mfma_f32_32x32x16_bf16 v[64:79], a[172:175], a[28:31], v[64:79]
    ds_read_b64_tr_b16 a[168:169], v106 offset:22528
    ds_read_b64_tr_b16 a[170:171], v106 offset:22784
    v_mul_f32 v98, v24, v98
    v_exp_f32 v96, -v96
    v_exp_f32 v97, -v97
    s_waitcnt lgkmcnt(6)
    v_mfma_f32_32x32x16_bf16 v[48:63], a[144:147], a[32:35], v[48:63]
    ds_read_b64_tr_b16 a[172:173], v106 offset:23040
    ds_read_b64_tr_b16 a[174:175], v106 offset:23296
    v_exp_f32 v98, -v98
    v_add_f32 v96, 1.0, v96
    v_add_f32 v97, 1.0, v97
    v_mfma_f32_32x32x16_bf16 v[64:79], a[148:151], a[32:35], v[64:79]
    ds_read_b64_tr_b16 a[144:145], v106 offset:24576
    ds_read_b64_tr_b16 a[146:147], v106 offset:24832
    s_add_u32 m0, s43, 40960
    s_add_u32 s44, s40, 2949632
    buffer_load_dwordx4 v2, s[28:31], s44 offen offset:0 lds
    v_add_f32 v98, 1.0, v98
    v_rcp_f32 v96, v96
    v_rcp_f32 v97, v97
    v_mfma_f32_32x32x16_bf16 v[48:63], a[152:155], a[36:39], v[48:63]
    ds_read_b64_tr_b16 a[148:149], v106 offset:25088
    ds_read_b64_tr_b16 a[150:151], v106 offset:25344
    v_rcp_f32 v98, v98
    v_mul_f32 v22, v22, v96
    v_mul_f32 v23, v23, v97
    v_mfma_f32_32x32x16_bf16 v[64:79], a[156:159], a[36:39], v[64:79]
    ds_read_b64_tr_b16 a[152:153], v106 offset:26624
    ds_read_b64_tr_b16 a[154:155], v106 offset:26880
    v_mul_f32 v24, v24, v98
    v_fma_f32 v99, v25, v25, v11
    v_fma_f32 v100, v26, v26, v11
    v_fma_f32 v101, v27, v27, v11
    s_waitcnt lgkmcnt(6)
    v_mfma_f32_32x32x16_bf16 v[48:63], a[160:163], a[40:43], v[48:63]
    ds_read_b64_tr_b16 a[156:157], v106 offset:27136
    ds_read_b64_tr_b16 a[158:159], v106 offset:27392
    v_mul_f32 v99, v25, v99
    v_mul_f32 v100, v26, v100
    v_mul_f32 v101, v27, v101
    v_exp_f32 v99, -v99
    v_mfma_f32_32x32x16_bf16 v[64:79], a[164:167], a[40:43], v[64:79]
    ds_read_b64_tr_b16 a[160:161], v106 offset:28672
    ds_read_b64_tr_b16 a[162:163], v106 offset:28928
    buffer_load_dwordx4 v3, s[28:31], s44 offen offset:1024 lds
    v_exp_f32 v100, -v100
    v_exp_f32 v101, -v101
    v_mfma_f32_32x32x16_bf16 v[48:63], a[168:171], a[44:47], v[48:63]
    ds_read_b64_tr_b16 a[164:165], v106 offset:29184
    ds_read_b64_tr_b16 a[166:167], v106 offset:29440
    v_add_f32 v99, 1.0, v99
    v_add_f32 v100, 1.0, v100
    v_add_f32 v101, 1.0, v101
    v_rcp_f32 v99, v99
    v_mfma_f32_32x32x16_bf16 v[64:79], a[172:175], a[44:47], v[64:79]
    ds_read_b64_tr_b16 a[168:169], v106 offset:30720
    ds_read_b64_tr_b16 a[170:171], v106 offset:30976
    v_rcp_f32 v100, v100
    v_rcp_f32 v101, v101
    s_waitcnt lgkmcnt(6)
    v_mfma_f32_32x32x16_bf16 v[48:63], a[144:147], a[48:51], v[48:63]
    ds_read_b64_tr_b16 a[172:173], v106 offset:31232
    ds_read_b64_tr_b16 a[174:175], v106 offset:31488
    v_mul_f32 v25, v25, v99
    v_mul_f32 v26, v26, v100
    v_mul_f32 v27, v27, v101
    v_fma_f32 v96, v28, v28, v11
    v_mfma_f32_32x32x16_bf16 v[64:79], a[148:151], a[48:51], v[64:79]
    ds_read_b64_tr_b16 a[144:145], v106 offset:32768
    ds_read_b64_tr_b16 a[146:147], v106 offset:33024
    buffer_load_dwordx4 v4, s[28:31], s44 offen offset:2048 lds
    v_fma_f32 v97, v29, v29, v11
    v_mul_f32 v96, v28, v96
    v_mul_f32 v97, v29, v97
    v_exp_f32 v96, -v96
    v_mfma_f32_32x32x16_bf16 v[48:63], a[152:155], a[52:55], v[48:63]
    ds_read_b64_tr_b16 a[148:149], v106 offset:33280
    ds_read_b64_tr_b16 a[150:151], v106 offset:33536
    v_exp_f32 v97, -v97
    v_add_f32 v96, 1.0, v96
    v_add_f32 v97, 1.0, v97
    v_mfma_f32_32x32x16_bf16 v[64:79], a[156:159], a[52:55], v[64:79]
    ds_read_b64_tr_b16 a[152:153], v106 offset:34816
    ds_read_b64_tr_b16 a[154:155], v106 offset:35072
    v_rcp_f32 v96, v96
    v_rcp_f32 v97, v97
    s_waitcnt lgkmcnt(6)
    v_mfma_f32_32x32x16_bf16 v[48:63], a[160:163], a[56:59], v[48:63]
    ds_read_b64_tr_b16 a[156:157], v106 offset:35328
    ds_read_b64_tr_b16 a[158:159], v106 offset:35584
    v_mul_f32 v28, v28, v96
    v_mul_f32 v29, v29, v97
    v_fma_f32 v96, v30, v30, v11
    v_fma_f32 v97, v31, v31, v11
    v_mul_f32 v96, v30, v96
    v_mfma_f32_32x32x16_bf16 v[64:79], a[164:167], a[56:59], v[64:79]
    s_waitcnt vmcnt(16)
    s_barrier
    ds_read_b64_tr_b16 a[160:161], v107 offset:0
    ds_read_b64_tr_b16 a[162:163], v107 offset:256
    buffer_load_dwordx4 v5, s[28:31], s44 offen offset:3072 lds
    v_mul_f32 v97, v31, v97
    v_exp_f32 v96, -v96
    v_exp_f32 v97, -v97
    v_mfma_f32_32x32x16_bf16 v[48:63], a[168:171], a[60:63], v[48:63]
    ds_read_b64_tr_b16 a[164:165], v107 offset:512
    ds_read_b64_tr_b16 a[166:167], v107 offset:768
    v_add_f32 v96, 1.0, v96
    v_add_f32 v97, 1.0, v97
    v_rcp_f32 v96, v96
    v_mfma_f32_32x32x16_bf16 v[64:79], a[172:175], a[60:63], v[64:79]
    ds_read_b64_tr_b16 a[168:169], v107 offset:2048
    ds_read_b64_tr_b16 a[170:171], v107 offset:2304
    v_rcp_f32 v97, v97
    v_mul_f32 v30, v30, v96
    v_mul_f32 v31, v31, v97
    s_waitcnt lgkmcnt(6)
    v_mfma_f32_32x32x16_bf16 v[48:63], a[144:147], a[64:67], v[48:63]
    ds_read_b64_tr_b16 a[172:173], v107 offset:2560
    ds_read_b64_tr_b16 a[174:175], v107 offset:2816
    v_cvt_pk_bf16_f32 v144, v16, v17
    v_cvt_pk_bf16_f32 v145, v18, v19
    v_cvt_pk_bf16_f32 v146, v20, v21
    v_cvt_pk_bf16_f32 v147, v22, v23
    v_mfma_f32_32x32x16_bf16 v[64:79], a[148:151], a[64:67], v[64:79]
    ds_read_b64_tr_b16 a[144:145], v107 offset:4096
    ds_read_b64_tr_b16 a[146:147], v107 offset:4352
    s_add_u32 m0, s43, 45056
    s_add_u32 s44, s40, 3244544
    buffer_load_dwordx4 v2, s[28:31], s44 offen offset:0 lds
    v_cvt_pk_bf16_f32 v148, v24, v25
    v_cvt_pk_bf16_f32 v149, v26, v27
    v_cvt_pk_bf16_f32 v150, v28, v29
    v_cvt_pk_bf16_f32 v151, v30, v31
    v_mfma_f32_32x32x16_bf16 v[48:63], a[152:155], a[68:71], v[48:63]
    ds_read_b64_tr_b16 a[148:149], v107 offset:4608
    ds_read_b64_tr_b16 a[150:151], v107 offset:4864
    v_fma_f32 v96, v32, v32, v11
    v_fma_f32 v97, v33, v33, v11
    v_fma_f32 v98, v34, v34, v11
    v_mul_f32 v96, v32, v96
    v_mul_f32 v97, v33, v97
    v_mfma_f32_32x32x16_bf16 v[64:79], a[156:159], a[68:71], v[64:79]
    ds_read_b64_tr_b16 a[152:153], v107 offset:6144
    ds_read_b64_tr_b16 a[154:155], v107 offset:6400
    v_mul_f32 v98, v34, v98
    v_exp_f32 v96, -v96
    v_exp_f32 v97, -v97
    s_waitcnt lgkmcnt(6)
    v_mfma_f32_32x32x16_bf16 v[48:63], a[160:163], a[72:75], v[48:63]
    ds_read_b64_tr_b16 a[156:157], v107 offset:6656
    ds_read_b64_tr_b16 a[158:159], v107 offset:6912
    v_exp_f32 v98, -v98
    v_add_f32 v96, 1.0, v96
    v_add_f32 v97, 1.0, v97
    v_mfma_f32_32x32x16_bf16 v[64:79], a[164:167], a[72:75], v[64:79]
    ds_read_b64_tr_b16 a[160:161], v107 offset:8192
    ds_read_b64_tr_b16 a[162:163], v107 offset:8448
    s_add_u32 m0, s43, 73728
    s_add_u32 s44, s40, 640
    buffer_load_dwordx4 v2, s[28:31], s44 offen offset:0 lds
    v_add_f32 v98, 1.0, v98
    v_rcp_f32 v96, v96
    v_rcp_f32 v97, v97
    v_mfma_f32_32x32x16_bf16 v[48:63], a[168:171], a[76:79], v[48:63]
    ds_read_b64_tr_b16 a[164:165], v107 offset:8704
    ds_read_b64_tr_b16 a[166:167], v107 offset:8960
    v_rcp_f32 v98, v98
    v_mul_f32 v32, v32, v96
    v_mfma_f32_32x32x16_bf16 v[64:79], a[172:175], a[76:79], v[64:79]
    ds_read_b64_tr_b16 a[168:169], v107 offset:10240
    ds_read_b64_tr_b16 a[170:171], v107 offset:10496
    v_mul_f32 v33, v33, v97
    v_mul_f32 v34, v34, v98
    v_fma_f32 v99, v35, v35, v11
    v_fma_f32 v100, v36, v36, v11
    v_fma_f32 v101, v37, v37, v11
    s_waitcnt lgkmcnt(6)
    v_mfma_f32_32x32x16_bf16 v[48:63], a[144:147], a[80:83], v[48:63]
    ds_read_b64_tr_b16 a[172:173], v107 offset:10752
    ds_read_b64_tr_b16 a[174:175], v107 offset:11008
    v_mul_f32 v99, v35, v99
    v_mul_f32 v100, v36, v100
    v_mul_f32 v101, v37, v101
    v_exp_f32 v99, -v99
    v_mfma_f32_32x32x16_bf16 v[64:79], a[148:151], a[80:83], v[64:79]
    ds_read_b64_tr_b16 a[144:145], v107 offset:12288
    ds_read_b64_tr_b16 a[146:147], v107 offset:12544
    buffer_load_dwordx4 v3, s[28:31], s44 offen offset:1024 lds
    v_exp_f32 v100, -v100
    v_exp_f32 v101, -v101
    v_mfma_f32_32x32x16_bf16 v[48:63], a[152:155], a[84:87], v[48:63]
    ds_read_b64_tr_b16 a[148:149], v107 offset:12800
    ds_read_b64_tr_b16 a[150:151], v107 offset:13056
    v_add_f32 v99, 1.0, v99
    v_add_f32 v100, 1.0, v100
    v_add_f32 v101, 1.0, v101
    v_rcp_f32 v99, v99
    v_mfma_f32_32x32x16_bf16 v[64:79], a[156:159], a[84:87], v[64:79]
    ds_read_b64_tr_b16 a[152:153], v107 offset:14336
    ds_read_b64_tr_b16 a[154:155], v107 offset:14592
    v_rcp_f32 v100, v100
    v_rcp_f32 v101, v101
    s_waitcnt lgkmcnt(6)
    v_mfma_f32_32x32x16_bf16 v[48:63], a[160:163], a[88:91], v[48:63]
    ds_read_b64_tr_b16 a[156:157], v107 offset:14848
    ds_read_b64_tr_b16 a[158:159], v107 offset:15104
    v_mul_f32 v35, v35, v99
    v_mul_f32 v36, v36, v100
    v_mul_f32 v37, v37, v101
    v_fma_f32 v96, v38, v38, v11
    v_mfma_f32_32x32x16_bf16 v[64:79], a[164:167], a[88:91], v[64:79]
    ds_read_b64_tr_b16 a[160:161], v107 offset:16384
    ds_read_b64_tr_b16 a[162:163], v107 offset:16640
    buffer_load_dwordx4 v4, s[28:31], s44 offen offset:2048 lds
    v_fma_f32 v97, v39, v39, v11
    v_fma_f32 v98, v40, v40, v11
    v_mul_f32 v96, v38, v96
    v_mul_f32 v97, v39, v97
    v_mfma_f32_32x32x16_bf16 v[48:63], a[168:171], a[92:95], v[48:63]
    ds_read_b64_tr_b16 a[164:165], v107 offset:16896
    ds_read_b64_tr_b16 a[166:167], v107 offset:17152
    v_mul_f32 v98, v40, v98
    v_exp_f32 v96, -v96
    v_exp_f32 v97, -v97
    v_mfma_f32_32x32x16_bf16 v[64:79], a[172:175], a[92:95], v[64:79]
    ds_read_b64_tr_b16 a[168:169], v107 offset:18432
    ds_read_b64_tr_b16 a[170:171], v107 offset:18688
    v_exp_f32 v98, -v98
    v_add_f32 v96, 1.0, v96
    v_add_f32 v97, 1.0, v97
    s_waitcnt lgkmcnt(6)
    v_mfma_f32_32x32x16_bf16 v[48:63], a[144:147], a[96:99], v[48:63]
    ds_read_b64_tr_b16 a[172:173], v107 offset:18944
    ds_read_b64_tr_b16 a[174:175], v107 offset:19200
    v_add_f32 v98, 1.0, v98
    v_rcp_f32 v96, v96
    v_rcp_f32 v97, v97
    v_mfma_f32_32x32x16_bf16 v[64:79], a[148:151], a[96:99], v[64:79]
    ds_read_b64_tr_b16 a[144:145], v107 offset:20480
    ds_read_b64_tr_b16 a[146:147], v107 offset:20736
    buffer_load_dwordx4 v5, s[28:31], s44 offen offset:3072 lds
    v_rcp_f32 v98, v98
    v_mul_f32 v38, v38, v96
    v_mul_f32 v39, v39, v97
    v_mfma_f32_32x32x16_bf16 v[48:63], a[152:155], a[100:103], v[48:63]
    ds_read_b64_tr_b16 a[148:149], v107 offset:20992
    ds_read_b64_tr_b16 a[150:151], v107 offset:21248
    v_mul_f32 v40, v40, v98
    v_fma_f32 v99, v41, v41, v11
    v_fma_f32 v100, v42, v42, v11
    v_fma_f32 v101, v43, v43, v11
    v_mfma_f32_32x32x16_bf16 v[64:79], a[156:159], a[100:103], v[64:79]
    ds_read_b64_tr_b16 a[152:153], v107 offset:22528
    ds_read_b64_tr_b16 a[154:155], v107 offset:22784
    v_mul_f32 v99, v41, v99
    v_mul_f32 v100, v42, v100
    v_mul_f32 v101, v43, v101
    v_exp_f32 v99, -v99
    s_waitcnt lgkmcnt(6)
    v_mfma_f32_32x32x16_bf16 v[48:63], a[160:163], a[104:107], v[48:63]
    ds_read_b64_tr_b16 a[156:157], v107 offset:23040
    ds_read_b64_tr_b16 a[158:159], v107 offset:23296
    v_exp_f32 v100, -v100
    v_exp_f32 v101, -v101
    v_mfma_f32_32x32x16_bf16 v[64:79], a[164:167], a[104:107], v[64:79]
    ds_read_b64_tr_b16 a[160:161], v107 offset:24576
    ds_read_b64_tr_b16 a[162:163], v107 offset:24832
    s_add_u32 m0, s43, 77824
    s_add_u32 s44, s40, 295552
    buffer_load_dwordx4 v2, s[28:31], s44 offen offset:0 lds
    v_add_f32 v99, 1.0, v99
    v_add_f32 v100, 1.0, v100
    v_add_f32 v101, 1.0, v101
    v_rcp_f32 v99, v99
    v_mfma_f32_32x32x16_bf16 v[48:63], a[168:171], a[108:111], v[48:63]
    ds_read_b64_tr_b16 a[164:165], v107 offset:25088
    ds_read_b64_tr_b16 a[166:167], v107 offset:25344
    v_rcp_f32 v100, v100
    v_rcp_f32 v101, v101
    v_mfma_f32_32x32x16_bf16 v[64:79], a[172:175], a[108:111], v[64:79]
    ds_read_b64_tr_b16 a[168:169], v107 offset:26624
    ds_read_b64_tr_b16 a[170:171], v107 offset:26880
    v_mul_f32 v41, v41, v99
    v_mul_f32 v42, v42, v100
    v_mul_f32 v43, v43, v101
    v_fma_f32 v96, v44, v44, v11
    s_waitcnt lgkmcnt(6)
    v_mfma_f32_32x32x16_bf16 v[48:63], a[144:147], a[112:115], v[48:63]
    ds_read_b64_tr_b16 a[172:173], v107 offset:27136
    ds_read_b64_tr_b16 a[174:175], v107 offset:27392
    v_fma_f32 v97, v45, v45, v11
    v_mul_f32 v96, v44, v96
    v_mul_f32 v97, v45, v97
    v_exp_f32 v96, -v96
    v_mfma_f32_32x32x16_bf16 v[64:79], a[148:151], a[112:115], v[64:79]
    ds_read_b64_tr_b16 a[144:145], v107 offset:28672
    ds_read_b64_tr_b16 a[146:147], v107 offset:28928
    buffer_load_dwordx4 v3, s[28:31], s44 offen offset:1024 lds
    v_exp_f32 v97, -v97
    v_add_f32 v96, 1.0, v96
    v_add_f32 v97, 1.0, v97
    v_mfma_f32_32x32x16_bf16 v[48:63], a[152:155], a[116:119], v[48:63]
    ds_read_b64_tr_b16 a[148:149], v107 offset:29184
    ds_read_b64_tr_b16 a[150:151], v107 offset:29440
    v_rcp_f32 v96, v96
    v_rcp_f32 v97, v97
    v_mfma_f32_32x32x16_bf16 v[64:79], a[156:159], a[116:119], v[64:79]
    ds_read_b64_tr_b16 a[152:153], v107 offset:30720
    ds_read_b64_tr_b16 a[154:155], v107 offset:30976
    v_mul_f32 v44, v44, v96
    v_mul_f32 v45, v45, v97
    v_fma_f32 v96, v46, v46, v11
    v_fma_f32 v97, v47, v47, v11
    v_mul_f32 v96, v46, v96
    s_waitcnt lgkmcnt(6)
    v_mfma_f32_32x32x16_bf16 v[48:63], a[160:163], a[120:123], v[48:63]
    ds_read_b64_tr_b16 a[156:157], v107 offset:31232
    ds_read_b64_tr_b16 a[158:159], v107 offset:31488
    v_mul_f32 v97, v47, v97
    v_exp_f32 v96, -v96
    v_exp_f32 v97, -v97
    v_mfma_f32_32x32x16_bf16 v[64:79], a[164:167], a[120:123], v[64:79]
    ds_read_b64_tr_b16 a[160:161], v107 offset:32768
    ds_read_b64_tr_b16 a[162:163], v107 offset:33024
    buffer_load_dwordx4 v4, s[28:31], s44 offen offset:2048 lds
    v_add_f32 v96, 1.0, v96
    v_add_f32 v97, 1.0, v97
    v_rcp_f32 v96, v96
    v_mfma_f32_32x32x16_bf16 v[48:63], a[168:171], a[124:127], v[48:63]
    ds_read_b64_tr_b16 a[164:165], v107 offset:33280
    ds_read_b64_tr_b16 a[166:167], v107 offset:33536
    v_rcp_f32 v97, v97
    v_mul_f32 v46, v46, v96
    v_mul_f32 v47, v47, v97
    v_mfma_f32_32x32x16_bf16 v[64:79], a[172:175], a[124:127], v[64:79]
    ds_read_b64_tr_b16 a[168:169], v107 offset:34816
    ds_read_b64_tr_b16 a[170:171], v107 offset:35072
    v_cvt_pk_bf16_f32 v152, v32, v33
    v_cvt_pk_bf16_f32 v153, v34, v35
    v_cvt_pk_bf16_f32 v154, v36, v37
    v_cvt_pk_bf16_f32 v155, v38, v39
    s_waitcnt lgkmcnt(6)
    v_mfma_f32_32x32x16_bf16 v[48:63], a[144:147], a[128:131], v[48:63]
    ds_read_b64_tr_b16 a[172:173], v107 offset:35328
    ds_read_b64_tr_b16 a[174:175], v107 offset:35584
    v_cvt_pk_bf16_f32 v156, v40, v41
    v_cvt_pk_bf16_f32 v157, v42, v43
    v_cvt_pk_bf16_f32 v158, v44, v45
    v_cvt_pk_bf16_f32 v159, v46, v47
    v_mfma_f32_32x32x16_bf16 v[64:79], a[148:151], a[128:131], v[64:79]
    s_waitcnt vmcnt(16)
    s_barrier
    ds_read_b64_tr_b16 a[144:145], v104 offset:0
    ds_read_b64_tr_b16 a[146:147], v104 offset:256
    buffer_load_dwordx4 v5, s[28:31], s44 offen offset:3072 lds
    v_mfma_f32_32x32x16_bf16 v[48:63], a[152:155], a[132:135], v[48:63]
    ds_read_b64_tr_b16 a[148:149], v104 offset:512
    ds_read_b64_tr_b16 a[150:151], v104 offset:768
    ds_read_b128 v[16:19], v10 offset:1024
    ds_read_b128 v[20:23], v10 offset:1056
    ds_read_b128 v[24:27], v10 offset:1088
    ds_read_b128 v[28:31], v10 offset:1120
    ds_read_b128 v[32:35], v10 offset:1152
    ds_read_b128 v[36:39], v10 offset:1184
    ds_read_b128 v[40:43], v10 offset:1216
    ds_read_b128 v[44:47], v10 offset:1248
    v_mfma_f32_32x32x16_bf16 v[64:79], a[156:159], a[132:135], v[64:79]
    ds_read_b64_tr_b16 a[152:153], v104 offset:2048
    ds_read_b64_tr_b16 a[154:155], v104 offset:2304
    s_waitcnt lgkmcnt(14)
    v_mfma_f32_32x32x16_bf16 v[48:63], a[160:163], a[136:139], v[48:63]
    ds_read_b64_tr_b16 a[156:157], v104 offset:2560
    ds_read_b64_tr_b16 a[158:159], v104 offset:2816
    v_mfma_f32_32x32x16_bf16 v[64:79], a[164:167], a[136:139], v[64:79]
    ds_read_b64_tr_b16 a[160:161], v104 offset:4096
    ds_read_b64_tr_b16 a[162:163], v104 offset:4352
    s_add_u32 m0, s43, 81920
    s_add_u32 s44, s40, 590464
    buffer_load_dwordx4 v2, s[28:31], s44 offen offset:0 lds
    v_mfma_f32_32x32x16_bf16 v[48:63], a[168:171], a[140:143], v[48:63]
    ds_read_b64_tr_b16 a[164:165], v104 offset:4608
    ds_read_b64_tr_b16 a[166:167], v104 offset:4864
    v_mfma_f32_32x32x16_bf16 v[64:79], a[172:175], a[140:143], v[64:79]
    ds_read_b64_tr_b16 a[168:169], v104 offset:6144
    ds_read_b64_tr_b16 a[170:171], v104 offset:6400
    s_waitcnt lgkmcnt(6)
    v_mfma_f32_32x32x16_bf16 v[16:31], a[144:147], a[0:3], v[16:31]
    ds_read_b64_tr_b16 a[172:173], v104 offset:6656
    ds_read_b64_tr_b16 a[174:175], v104 offset:6912
    v_mfma_f32_32x32x16_bf16 v[32:47], a[148:151], a[0:3], v[32:47]
    ds_read_b64_tr_b16 a[144:145], v104 offset:8192
    ds_read_b64_tr_b16 a[146:147], v104 offset:8448
    s_add_u32 m0, s43, 110592
    s_add_u32 s44, s40, 2654848
    buffer_load_dwordx4 v2, s[28:31], s44 offen offset:0 lds
    v_mfma_f32_32x32x16_bf16 v[16:31], a[152:155], a[4:7], v[16:31]
    ds_read_b64_tr_b16 a[148:149], v104 offset:8704
    ds_read_b64_tr_b16 a[150:151], v104 offset:8960
    v_mfma_f32_32x32x16_bf16 v[32:47], a[156:159], a[4:7], v[32:47]
    ds_read_b64_tr_b16 a[152:153], v104 offset:10240
    ds_read_b64_tr_b16 a[154:155], v104 offset:10496
    v_fma_f32 v96, v48, v48, v11
    v_fma_f32 v97, v49, v49, v11
    v_fma_f32 v98, v50, v50, v11
    v_mul_f32 v96, v48, v96
    v_mul_f32 v97, v49, v97
    s_waitcnt lgkmcnt(6)
    v_mfma_f32_32x32x16_bf16 v[16:31], a[160:163], a[8:11], v[16:31]
    ds_read_b64_tr_b16 a[156:157], v104 offset:10752
    ds_read_b64_tr_b16 a[158:159], v104 offset:11008
    v_mul_f32 v98, v50, v98
    v_exp_f32 v96, -v96
    v_exp_f32 v97, -v97
    v_mfma_f32_32x32x16_bf16 v[32:47], a[164:167], a[8:11], v[32:47]
    ds_read_b64_tr_b16 a[160:161], v104 offset:12288
    ds_read_b64_tr_b16 a[162:163], v104 offset:12544
    buffer_load_dwordx4 v3, s[28:31], s44 offen offset:1024 lds
    v_exp_f32 v98, -v98
    v_add_f32 v96, 1.0, v96
    v_add_f32 v97, 1.0, v97
    v_mfma_f32_32x32x16_bf16 v[16:31], a[168:171], a[12:15], v[16:31]
    ds_read_b64_tr_b16 a[164:165], v104 offset:12800
    ds_read_b64_tr_b16 a[166:167], v104 offset:13056
    v_add_f32 v98, 1.0, v98
    v_rcp_f32 v96, v96
    v_rcp_f32 v97, v97
    v_mfma_f32_32x32x16_bf16 v[32:47], a[172:175], a[12:15], v[32:47]
    ds_read_b64_tr_b16 a[168:169], v104 offset:14336
    ds_read_b64_tr_b16 a[170:171], v104 offset:14592
    v_rcp_f32 v98, v98
    v_mul_f32 v48, v48, v96
    s_waitcnt lgkmcnt(6)
    v_mfma_f32_32x32x16_bf16 v[16:31], a[144:147], a[16:19], v[16:31]
    ds_read_b64_tr_b16 a[172:173], v104 offset:14848
    ds_read_b64_tr_b16 a[174:175], v104 offset:15104
    v_mul_f32 v49, v49, v97
    v_mul_f32 v50, v50, v98
    v_fma_f32 v99, v51, v51, v11
    v_fma_f32 v100, v52, v52, v11
    v_fma_f32 v101, v53, v53, v11
    v_mfma_f32_32x32x16_bf16 v[32:47], a[148:151], a[16:19], v[32:47]
    ds_read_b64_tr_b16 a[144:145], v104 offset:16384
    ds_read_b64_tr_b16 a[146:147], v104 offset:16640
    buffer_load_dwordx4 v4, s[28:31], s44 offen offset:2048 lds
    v_mul_f32 v99, v51, v99
    v_mul_f32 v100, v52, v100
    v_mul_f32 v101, v53, v101
    v_exp_f32 v99, -v99
    v_mfma_f32_32x32x16_bf16 v[16:31], a[152:155], a[20:23], v[16:31]
    ds_read_b64_tr_b16 a[148:149], v104 offset:16896
    ds_read_b64_tr_b16 a[150:151], v104 offset:17152
    v_exp_f32 v100, -v100
    v_exp_f32 v101, -v101
    v_mfma_f32_32x32x16_bf16 v[32:47], a[156:159], a[20:23], v[32:47]
    ds_read_b64_tr_b16 a[152:153], v104 offset:18432
    ds_read_b64_tr_b16 a[154:155], v104 offset:18688
    v_add_f32 v99, 1.0, v99
    v_add_f32 v100, 1.0, v100
    v_add_f32 v101, 1.0, v101
    v_rcp_f32 v99, v99
    s_waitcnt lgkmcnt(6)
    v_mfma_f32_32x32x16_bf16 v[16:31], a[160:163], a[24:27], v[16:31]
    ds_read_b64_tr_b16 a[156:157], v104 offset:18944
    ds_read_b64_tr_b16 a[158:159], v104 offset:19200
    v_rcp_f32 v100, v100
    v_rcp_f32 v101, v101
    v_mfma_f32_32x32x16_bf16 v[32:47], a[164:167], a[24:27], v[32:47]
    ds_read_b64_tr_b16 a[160:161], v104 offset:20480
    ds_read_b64_tr_b16 a[162:163], v104 offset:20736
    buffer_load_dwordx4 v5, s[28:31], s44 offen offset:3072 lds
    v_mul_f32 v51, v51, v99
    v_mul_f32 v52, v52, v100
    v_mul_f32 v53, v53, v101
    v_fma_f32 v96, v54, v54, v11
    v_mfma_f32_32x32x16_bf16 v[16:31], a[168:171], a[28:31], v[16:31]
    ds_read_b64_tr_b16 a[164:165], v104 offset:20992
    ds_read_b64_tr_b16 a[166:167], v104 offset:21248
    v_fma_f32 v97, v55, v55, v11
    v_fma_f32 v98, v56, v56, v11
    v_mul_f32 v96, v54, v96
    v_mul_f32 v97, v55, v97
    v_mfma_f32_32x32x16_bf16 v[32:47], a[172:175], a[28:31], v[32:47]
    ds_read_b64_tr_b16 a[168:169], v104 offset:22528
    ds_read_b64_tr_b16 a[170:171], v104 offset:22784
    v_mul_f32 v98, v56, v98
    v_exp_f32 v96, -v96
    v_exp_f32 v97, -v97
    s_waitcnt lgkmcnt(6)
    v_mfma_f32_32x32x16_bf16 v[16:31], a[144:147], a[32:35], v[16:31]
    ds_read_b64_tr_b16 a[172:173], v104 offset:23040
    ds_read_b64_tr_b16 a[174:175], v104 offset:23296
    v_exp_f32 v98, -v98
    v_add_f32 v96, 1.0, v96
    v_add_f32 v97, 1.0, v97
    v_mfma_f32_32x32x16_bf16 v[32:47], a[148:151], a[32:35], v[32:47]
    ds_read_b64_tr_b16 a[144:145], v104 offset:24576
    ds_read_b64_tr_b16 a[146:147], v104 offset:24832
    s_add_u32 m0, s43, 114688
    s_add_u32 s44, s40, 2949760
    buffer_load_dwordx4 v2, s[28:31], s44 offen offset:0 lds
    v_add_f32 v98, 1.0, v98
    v_rcp_f32 v96, v96
    v_rcp_f32 v97, v97
    v_mfma_f32_32x32x16_bf16 v[16:31], a[152:155], a[36:39], v[16:31]
    ds_read_b64_tr_b16 a[148:149], v104 offset:25088
    ds_read_b64_tr_b16 a[150:151], v104 offset:25344
    v_rcp_f32 v98, v98
    v_mul_f32 v54, v54, v96
    v_mul_f32 v55, v55, v97
    v_mfma_f32_32x32x16_bf16 v[32:47], a[156:159], a[36:39], v[32:47]
    ds_read_b64_tr_b16 a[152:153], v104 offset:26624
    ds_read_b64_tr_b16 a[154:155], v104 offset:26880
    v_mul_f32 v56, v56, v98
    v_fma_f32 v99, v57, v57, v11
    v_fma_f32 v100, v58, v58, v11
    v_fma_f32 v101, v59, v59, v11
    s_waitcnt lgkmcnt(6)
    v_mfma_f32_32x32x16_bf16 v[16:31], a[160:163], a[40:43], v[16:31]
    ds_read_b64_tr_b16 a[156:157], v104 offset:27136
    ds_read_b64_tr_b16 a[158:159], v104 offset:27392
    v_mul_f32 v99, v57, v99
    v_mul_f32 v100, v58, v100
    v_mul_f32 v101, v59, v101
    v_exp_f32 v99, -v99
    v_mfma_f32_32x32x16_bf16 v[32:47], a[164:167], a[40:43], v[32:47]
    ds_read_b64_tr_b16 a[160:161], v104 offset:28672
    ds_read_b64_tr_b16 a[162:163], v104 offset:28928
    buffer_load_dwordx4 v3, s[28:31], s44 offen offset:1024 lds
    v_exp_f32 v100, -v100
    v_exp_f32 v101, -v101
    v_mfma_f32_32x32x16_bf16 v[16:31], a[168:171], a[44:47], v[16:31]
    ds_read_b64_tr_b16 a[164:165], v104 offset:29184
    ds_read_b64_tr_b16 a[166:167], v104 offset:29440
    v_add_f32 v99, 1.0, v99
    v_add_f32 v100, 1.0, v100
    v_add_f32 v101, 1.0, v101
    v_rcp_f32 v99, v99
    v_mfma_f32_32x32x16_bf16 v[32:47], a[172:175], a[44:47], v[32:47]
    ds_read_b64_tr_b16 a[168:169], v104 offset:30720
    ds_read_b64_tr_b16 a[170:171], v104 offset:30976
    v_rcp_f32 v100, v100
    v_rcp_f32 v101, v101
    s_waitcnt lgkmcnt(6)
    v_mfma_f32_32x32x16_bf16 v[16:31], a[144:147], a[48:51], v[16:31]
    ds_read_b64_tr_b16 a[172:173], v104 offset:31232
    ds_read_b64_tr_b16 a[174:175], v104 offset:31488
    v_mul_f32 v57, v57, v99
    v_mul_f32 v58, v58, v100
    v_mul_f32 v59, v59, v101
    v_fma_f32 v96, v60, v60, v11
    v_mfma_f32_32x32x16_bf16 v[32:47], a[148:151], a[48:51], v[32:47]
    ds_read_b64_tr_b16 a[144:145], v104 offset:32768
    ds_read_b64_tr_b16 a[146:147], v104 offset:33024
    buffer_load_dwordx4 v4, s[28:31], s44 offen offset:2048 lds
    v_fma_f32 v97, v61, v61, v11
    v_mul_f32 v96, v60, v96
    v_mul_f32 v97, v61, v97
    v_exp_f32 v96, -v96
    v_mfma_f32_32x32x16_bf16 v[16:31], a[152:155], a[52:55], v[16:31]
    ds_read_b64_tr_b16 a[148:149], v104 offset:33280
    ds_read_b64_tr_b16 a[150:151], v104 offset:33536
    v_exp_f32 v97, -v97
    v_add_f32 v96, 1.0, v96
    v_add_f32 v97, 1.0, v97
    v_mfma_f32_32x32x16_bf16 v[32:47], a[156:159], a[52:55], v[32:47]
    ds_read_b64_tr_b16 a[152:153], v104 offset:34816
    ds_read_b64_tr_b16 a[154:155], v104 offset:35072
    v_rcp_f32 v96, v96
    v_rcp_f32 v97, v97
    s_waitcnt lgkmcnt(6)
    v_mfma_f32_32x32x16_bf16 v[16:31], a[160:163], a[56:59], v[16:31]
    ds_read_b64_tr_b16 a[156:157], v104 offset:35328
    ds_read_b64_tr_b16 a[158:159], v104 offset:35584
    v_mul_f32 v60, v60, v96
    v_mul_f32 v61, v61, v97
    v_fma_f32 v96, v62, v62, v11
    v_fma_f32 v97, v63, v63, v11
    v_mul_f32 v96, v62, v96
    v_mfma_f32_32x32x16_bf16 v[32:47], a[164:167], a[56:59], v[32:47]
    s_waitcnt vmcnt(16)
    s_barrier
    ds_read_b64_tr_b16 a[160:161], v105 offset:0
    ds_read_b64_tr_b16 a[162:163], v105 offset:256
    buffer_load_dwordx4 v5, s[28:31], s44 offen offset:3072 lds
    v_mul_f32 v97, v63, v97
    v_exp_f32 v96, -v96
    v_exp_f32 v97, -v97
    v_mfma_f32_32x32x16_bf16 v[16:31], a[168:171], a[60:63], v[16:31]
    ds_read_b64_tr_b16 a[164:165], v105 offset:512
    ds_read_b64_tr_b16 a[166:167], v105 offset:768
    v_add_f32 v96, 1.0, v96
    v_add_f32 v97, 1.0, v97
    v_rcp_f32 v96, v96
    v_mfma_f32_32x32x16_bf16 v[32:47], a[172:175], a[60:63], v[32:47]
    ds_read_b64_tr_b16 a[168:169], v105 offset:2048
    ds_read_b64_tr_b16 a[170:171], v105 offset:2304
    v_rcp_f32 v97, v97
    v_mul_f32 v62, v62, v96
    v_mul_f32 v63, v63, v97
    s_waitcnt lgkmcnt(6)
    v_mfma_f32_32x32x16_bf16 v[16:31], a[144:147], a[64:67], v[16:31]
    ds_read_b64_tr_b16 a[172:173], v105 offset:2560
    ds_read_b64_tr_b16 a[174:175], v105 offset:2816
    v_cvt_pk_bf16_f32 v160, v48, v49
    v_cvt_pk_bf16_f32 v161, v50, v51
    v_cvt_pk_bf16_f32 v162, v52, v53
    v_cvt_pk_bf16_f32 v163, v54, v55
    v_mfma_f32_32x32x16_bf16 v[32:47], a[148:151], a[64:67], v[32:47]
    ds_read_b64_tr_b16 a[144:145], v105 offset:4096
    ds_read_b64_tr_b16 a[146:147], v105 offset:4352
    s_add_u32 m0, s43, 118784
    s_add_u32 s44, s40, 3244672
    buffer_load_dwordx4 v2, s[28:31], s44 offen offset:0 lds
    v_cvt_pk_bf16_f32 v164, v56, v57
    v_cvt_pk_bf16_f32 v165, v58, v59
    v_cvt_pk_bf16_f32 v166, v60, v61
    v_cvt_pk_bf16_f32 v167, v62, v63
    v_mfma_f32_32x32x16_bf16 v[16:31], a[152:155], a[68:71], v[16:31]
    ds_read_b64_tr_b16 a[148:149], v105 offset:4608
    ds_read_b64_tr_b16 a[150:151], v105 offset:4864
    v_fma_f32 v96, v64, v64, v11
    v_fma_f32 v97, v65, v65, v11
    v_fma_f32 v98, v66, v66, v11
    v_mul_f32 v96, v64, v96
    v_mul_f32 v97, v65, v97
    v_mfma_f32_32x32x16_bf16 v[32:47], a[156:159], a[68:71], v[32:47]
    ds_read_b64_tr_b16 a[152:153], v105 offset:6144
    ds_read_b64_tr_b16 a[154:155], v105 offset:6400
    v_mul_f32 v98, v66, v98
    v_exp_f32 v96, -v96
    v_exp_f32 v97, -v97
    s_waitcnt lgkmcnt(6)
    v_mfma_f32_32x32x16_bf16 v[16:31], a[160:163], a[72:75], v[16:31]
    ds_read_b64_tr_b16 a[156:157], v105 offset:6656
    ds_read_b64_tr_b16 a[158:159], v105 offset:6912
    v_exp_f32 v98, -v98
    v_add_f32 v96, 1.0, v96
    v_add_f32 v97, 1.0, v97
    v_mfma_f32_32x32x16_bf16 v[32:47], a[164:167], a[72:75], v[32:47]
    ds_read_b64_tr_b16 a[160:161], v105 offset:8192
    ds_read_b64_tr_b16 a[162:163], v105 offset:8448
    s_add_u32 m0, s43, 0
    s_add_u32 s44, s40, 768
    buffer_load_dwordx4 v2, s[28:31], s44 offen offset:0 lds
    v_add_f32 v98, 1.0, v98
    v_rcp_f32 v96, v96
    v_rcp_f32 v97, v97
    v_mfma_f32_32x32x16_bf16 v[16:31], a[168:171], a[76:79], v[16:31]
    ds_read_b64_tr_b16 a[164:165], v105 offset:8704
    ds_read_b64_tr_b16 a[166:167], v105 offset:8960
    v_rcp_f32 v98, v98
    v_mul_f32 v64, v64, v96
    v_mfma_f32_32x32x16_bf16 v[32:47], a[172:175], a[76:79], v[32:47]
    ds_read_b64_tr_b16 a[168:169], v105 offset:10240
    ds_read_b64_tr_b16 a[170:171], v105 offset:10496
    v_mul_f32 v65, v65, v97
    v_mul_f32 v66, v66, v98
    v_fma_f32 v99, v67, v67, v11
    v_fma_f32 v100, v68, v68, v11
    v_fma_f32 v101, v69, v69, v11
    s_waitcnt lgkmcnt(6)
    v_mfma_f32_32x32x16_bf16 v[16:31], a[144:147], a[80:83], v[16:31]
    ds_read_b64_tr_b16 a[172:173], v105 offset:10752
    ds_read_b64_tr_b16 a[174:175], v105 offset:11008
    v_mul_f32 v99, v67, v99
    v_mul_f32 v100, v68, v100
    v_mul_f32 v101, v69, v101
    v_exp_f32 v99, -v99
    v_mfma_f32_32x32x16_bf16 v[32:47], a[148:151], a[80:83], v[32:47]
    ds_read_b64_tr_b16 a[144:145], v105 offset:12288
    ds_read_b64_tr_b16 a[146:147], v105 offset:12544
    buffer_load_dwordx4 v3, s[28:31], s44 offen offset:1024 lds
    v_exp_f32 v100, -v100
    v_exp_f32 v101, -v101
    v_mfma_f32_32x32x16_bf16 v[16:31], a[152:155], a[84:87], v[16:31]
    ds_read_b64_tr_b16 a[148:149], v105 offset:12800
    ds_read_b64_tr_b16 a[150:151], v105 offset:13056
    v_add_f32 v99, 1.0, v99
    v_add_f32 v100, 1.0, v100
    v_add_f32 v101, 1.0, v101
    v_rcp_f32 v99, v99
    v_mfma_f32_32x32x16_bf16 v[32:47], a[156:159], a[84:87], v[32:47]
    ds_read_b64_tr_b16 a[152:153], v105 offset:14336
    ds_read_b64_tr_b16 a[154:155], v105 offset:14592
    v_rcp_f32 v100, v100
    v_rcp_f32 v101, v101
    s_waitcnt lgkmcnt(6)
    v_mfma_f32_32x32x16_bf16 v[16:31], a[160:163], a[88:91], v[16:31]
    ds_read_b64_tr_b16 a[156:157], v105 offset:14848
    ds_read_b64_tr_b16 a[158:159], v105 offset:15104
    v_mul_f32 v67, v67, v99
    v_mul_f32 v68, v68, v100
    v_mul_f32 v69, v69, v101
    v_fma_f32 v96, v70, v70, v11
    v_mfma_f32_32x32x16_bf16 v[32:47], a[164:167], a[88:91], v[32:47]
    ds_read_b64_tr_b16 a[160:161], v105 offset:16384
    ds_read_b64_tr_b16 a[162:163], v105 offset:16640
    buffer_load_dwordx4 v4, s[28:31], s44 offen offset:2048 lds
    v_fma_f32 v97, v71, v71, v11
    v_fma_f32 v98, v72, v72, v11
    v_mul_f32 v96, v70, v96
    v_mul_f32 v97, v71, v97
    v_mfma_f32_32x32x16_bf16 v[16:31], a[168:171], a[92:95], v[16:31]
    ds_read_b64_tr_b16 a[164:165], v105 offset:16896
    ds_read_b64_tr_b16 a[166:167], v105 offset:17152
    v_mul_f32 v98, v72, v98
    v_exp_f32 v96, -v96
    v_exp_f32 v97, -v97
    v_mfma_f32_32x32x16_bf16 v[32:47], a[172:175], a[92:95], v[32:47]
    ds_read_b64_tr_b16 a[168:169], v105 offset:18432
    ds_read_b64_tr_b16 a[170:171], v105 offset:18688
    v_exp_f32 v98, -v98
    v_add_f32 v96, 1.0, v96
    v_add_f32 v97, 1.0, v97
    s_waitcnt lgkmcnt(6)
    v_mfma_f32_32x32x16_bf16 v[16:31], a[144:147], a[96:99], v[16:31]
    ds_read_b64_tr_b16 a[172:173], v105 offset:18944
    ds_read_b64_tr_b16 a[174:175], v105 offset:19200
    v_add_f32 v98, 1.0, v98
    v_rcp_f32 v96, v96
    v_rcp_f32 v97, v97
    v_mfma_f32_32x32x16_bf16 v[32:47], a[148:151], a[96:99], v[32:47]
    ds_read_b64_tr_b16 a[144:145], v105 offset:20480
    ds_read_b64_tr_b16 a[146:147], v105 offset:20736
    buffer_load_dwordx4 v5, s[28:31], s44 offen offset:3072 lds
    v_rcp_f32 v98, v98
    v_mul_f32 v70, v70, v96
    v_mul_f32 v71, v71, v97
    v_mfma_f32_32x32x16_bf16 v[16:31], a[152:155], a[100:103], v[16:31]
    ds_read_b64_tr_b16 a[148:149], v105 offset:20992
    ds_read_b64_tr_b16 a[150:151], v105 offset:21248
    v_mul_f32 v72, v72, v98
    v_fma_f32 v99, v73, v73, v11
    v_fma_f32 v100, v74, v74, v11
    v_fma_f32 v101, v75, v75, v11
    v_mfma_f32_32x32x16_bf16 v[32:47], a[156:159], a[100:103], v[32:47]
    ds_read_b64_tr_b16 a[152:153], v105 offset:22528
    ds_read_b64_tr_b16 a[154:155], v105 offset:22784
    v_mul_f32 v99, v73, v99
    v_mul_f32 v100, v74, v100
    v_mul_f32 v101, v75, v101
    v_exp_f32 v99, -v99
    s_waitcnt lgkmcnt(6)
    v_mfma_f32_32x32x16_bf16 v[16:31], a[160:163], a[104:107], v[16:31]
    ds_read_b64_tr_b16 a[156:157], v105 offset:23040
    ds_read_b64_tr_b16 a[158:159], v105 offset:23296
    v_exp_f32 v100, -v100
    v_exp_f32 v101, -v101
    v_mfma_f32_32x32x16_bf16 v[32:47], a[164:167], a[104:107], v[32:47]
    ds_read_b64_tr_b16 a[160:161], v105 offset:24576
    ds_read_b64_tr_b16 a[162:163], v105 offset:24832
    s_add_u32 m0, s43, 4096
    s_add_u32 s44, s40, 295680
    buffer_load_dwordx4 v2, s[28:31], s44 offen offset:0 lds
    v_add_f32 v99, 1.0, v99
    v_add_f32 v100, 1.0, v100
    v_add_f32 v101, 1.0, v101
    v_rcp_f32 v99, v99
    v_mfma_f32_32x32x16_bf16 v[16:31], a[168:171], a[108:111], v[16:31]
    ds_read_b64_tr_b16 a[164:165], v105 offset:25088
    ds_read_b64_tr_b16 a[166:167], v105 offset:25344
    v_rcp_f32 v100, v100
    v_rcp_f32 v101, v101
    v_mfma_f32_32x32x16_bf16 v[32:47], a[172:175], a[108:111], v[32:47]
    ds_read_b64_tr_b16 a[168:169], v105 offset:26624
    ds_read_b64_tr_b16 a[170:171], v105 offset:26880
    v_mul_f32 v73, v73, v99
    v_mul_f32 v74, v74, v100
    v_mul_f32 v75, v75, v101
    v_fma_f32 v96, v76, v76, v11
    s_waitcnt lgkmcnt(6)
    v_mfma_f32_32x32x16_bf16 v[16:31], a[144:147], a[112:115], v[16:31]
    ds_read_b64_tr_b16 a[172:173], v105 offset:27136
    ds_read_b64_tr_b16 a[174:175], v105 offset:27392
    v_fma_f32 v97, v77, v77, v11
    v_mul_f32 v96, v76, v96
    v_mul_f32 v97, v77, v97
    v_exp_f32 v96, -v96
    v_mfma_f32_32x32x16_bf16 v[32:47], a[148:151], a[112:115], v[32:47]
    ds_read_b64_tr_b16 a[144:145], v105 offset:28672
    ds_read_b64_tr_b16 a[146:147], v105 offset:28928
    buffer_load_dwordx4 v3, s[28:31], s44 offen offset:1024 lds
    v_exp_f32 v97, -v97
    v_add_f32 v96, 1.0, v96
    v_add_f32 v97, 1.0, v97
    v_mfma_f32_32x32x16_bf16 v[16:31], a[152:155], a[116:119], v[16:31]
    ds_read_b64_tr_b16 a[148:149], v105 offset:29184
    ds_read_b64_tr_b16 a[150:151], v105 offset:29440
    v_rcp_f32 v96, v96
    v_rcp_f32 v97, v97
    v_mfma_f32_32x32x16_bf16 v[32:47], a[156:159], a[116:119], v[32:47]
    ds_read_b64_tr_b16 a[152:153], v105 offset:30720
    ds_read_b64_tr_b16 a[154:155], v105 offset:30976
    v_mul_f32 v76, v76, v96
    v_mul_f32 v77, v77, v97
    v_fma_f32 v96, v78, v78, v11
    v_fma_f32 v97, v79, v79, v11
    v_mul_f32 v96, v78, v96
    s_waitcnt lgkmcnt(6)
    v_mfma_f32_32x32x16_bf16 v[16:31], a[160:163], a[120:123], v[16:31]
    ds_read_b64_tr_b16 a[156:157], v105 offset:31232
    ds_read_b64_tr_b16 a[158:159], v105 offset:31488
    v_mul_f32 v97, v79, v97
    v_exp_f32 v96, -v96
    v_exp_f32 v97, -v97
    v_mfma_f32_32x32x16_bf16 v[32:47], a[164:167], a[120:123], v[32:47]
    ds_read_b64_tr_b16 a[160:161], v105 offset:32768
    ds_read_b64_tr_b16 a[162:163], v105 offset:33024
    buffer_load_dwordx4 v4, s[28:31], s44 offen offset:2048 lds
    v_add_f32 v96, 1.0, v96
    v_add_f32 v97, 1.0, v97
    v_rcp_f32 v96, v96
    v_mfma_f32_32x32x16_bf16 v[16:31], a[168:171], a[124:127], v[16:31]
    ds_read_b64_tr_b16 a[164:165], v105 offset:33280
    ds_read_b64_tr_b16 a[166:167], v105 offset:33536
    v_rcp_f32 v97, v97
    v_mul_f32 v78, v78, v96
    v_mul_f32 v79, v79, v97
    v_mfma_f32_32x32x16_bf16 v[32:47], a[172:175], a[124:127], v[32:47]
    ds_read_b64_tr_b16 a[168:169], v105 offset:34816
    ds_read_b64_tr_b16 a[170:171], v105 offset:35072
    v_cvt_pk_bf16_f32 v168, v64, v65
    v_cvt_pk_bf16_f32 v169, v66, v67
    v_cvt_pk_bf16_f32 v170, v68, v69
    v_cvt_pk_bf16_f32 v171, v70, v71
    s_waitcnt lgkmcnt(6)
    v_mfma_f32_32x32x16_bf16 v[16:31], a[144:147], a[128:131], v[16:31]
    ds_read_b64_tr_b16 a[172:173], v105 offset:35328
    ds_read_b64_tr_b16 a[174:175], v105 offset:35584
    v_cvt_pk_bf16_f32 v172, v72, v73
    v_cvt_pk_bf16_f32 v173, v74, v75
    v_cvt_pk_bf16_f32 v174, v76, v77
    v_cvt_pk_bf16_f32 v175, v78, v79
    v_mfma_f32_32x32x16_bf16 v[32:47], a[148:151], a[128:131], v[32:47]
    s_waitcnt vmcnt(16)
    s_barrier
    ds_read_b64_tr_b16 a[144:145], v106 offset:0
    ds_read_b64_tr_b16 a[146:147], v106 offset:256
    buffer_load_dwordx4 v5, s[28:31], s44 offen offset:3072 lds
    v_mfma_f32_32x32x16_bf16 v[16:31], a[152:155], a[132:135], v[16:31]
    ds_read_b64_tr_b16 a[148:149], v106 offset:512
    ds_read_b64_tr_b16 a[150:151], v106 offset:768
    ds_read_b128 v[48:51], v10 offset:1280
    ds_read_b128 v[52:55], v10 offset:1312
    ds_read_b128 v[56:59], v10 offset:1344
    ds_read_b128 v[60:63], v10 offset:1376
    ds_read_b128 v[64:67], v10 offset:1408
    ds_read_b128 v[68:71], v10 offset:1440
    ds_read_b128 v[72:75], v10 offset:1472
    ds_read_b128 v[76:79], v10 offset:1504
    v_mfma_f32_32x32x16_bf16 v[32:47], a[156:159], a[132:135], v[32:47]
    ds_read_b64_tr_b16 a[152:153], v106 offset:2048
    ds_read_b64_tr_b16 a[154:155], v106 offset:2304
    s_waitcnt lgkmcnt(14)
    v_mfma_f32_32x32x16_bf16 v[16:31], a[160:163], a[136:139], v[16:31]
    ds_read_b64_tr_b16 a[156:157], v106 offset:2560
    ds_read_b64_tr_b16 a[158:159], v106 offset:2816
    v_mfma_f32_32x32x16_bf16 v[32:47], a[164:167], a[136:139], v[32:47]
    ds_read_b64_tr_b16 a[160:161], v106 offset:4096
    ds_read_b64_tr_b16 a[162:163], v106 offset:4352
    s_add_u32 m0, s43, 8192
    s_add_u32 s44, s40, 590592
    buffer_load_dwordx4 v2, s[28:31], s44 offen offset:0 lds
    v_mfma_f32_32x32x16_bf16 v[16:31], a[168:171], a[140:143], v[16:31]
    ds_read_b64_tr_b16 a[164:165], v106 offset:4608
    ds_read_b64_tr_b16 a[166:167], v106 offset:4864
    v_mfma_f32_32x32x16_bf16 v[32:47], a[172:175], a[140:143], v[32:47]
    ds_read_b64_tr_b16 a[168:169], v106 offset:6144
    ds_read_b64_tr_b16 a[170:171], v106 offset:6400
    s_waitcnt lgkmcnt(6)
    v_mfma_f32_32x32x16_bf16 v[48:63], a[144:147], a[0:3], v[48:63]
    ds_read_b64_tr_b16 a[172:173], v106 offset:6656
    ds_read_b64_tr_b16 a[174:175], v106 offset:6912
    v_mfma_f32_32x32x16_bf16 v[64:79], a[148:151], a[0:3], v[64:79]
    ds_read_b64_tr_b16 a[144:145], v106 offset:8192
    ds_read_b64_tr_b16 a[146:147], v106 offset:8448
    s_add_u32 m0, s43, 36864
    s_add_u32 s44, s40, 2654976
    buffer_load_dwordx4 v2, s[28:31], s44 offen offset:0 lds
    v_mfma_f32_32x32x16_bf16 v[48:63], a[152:155], a[4:7], v[48:63]
    ds_read_b64_tr_b16 a[148:149], v106 offset:8704
    ds_read_b64_tr_b16 a[150:151], v106 offset:8960
    v_mfma_f32_32x32x16_bf16 v[64:79], a[156:159], a[4:7], v[64:79]
    ds_read_b64_tr_b16 a[152:153], v106 offset:10240
    ds_read_b64_tr_b16 a[154:155], v106 offset:10496
    v_fma_f32 v96, v16, v16, v11
    v_fma_f32 v97, v17, v17, v11
    v_fma_f32 v98, v18, v18, v11
    v_mul_f32 v96, v16, v96
    v_mul_f32 v97, v17, v97
    s_waitcnt lgkmcnt(6)
    v_mfma_f32_32x32x16_bf16 v[48:63], a[160:163], a[8:11], v[48:63]
    ds_read_b64_tr_b16 a[156:157], v106 offset:10752
    ds_read_b64_tr_b16 a[158:159], v106 offset:11008
    v_mul_f32 v98, v18, v98
    v_exp_f32 v96, -v96
    v_exp_f32 v97, -v97
    v_mfma_f32_32x32x16_bf16 v[64:79], a[164:167], a[8:11], v[64:79]
    ds_read_b64_tr_b16 a[160:161], v106 offset:12288
    ds_read_b64_tr_b16 a[162:163], v106 offset:12544
    buffer_load_dwordx4 v3, s[28:31], s44 offen offset:1024 lds
    v_exp_f32 v98, -v98
    v_add_f32 v96, 1.0, v96
    v_add_f32 v97, 1.0, v97
    v_mfma_f32_32x32x16_bf16 v[48:63], a[168:171], a[12:15], v[48:63]
    ds_read_b64_tr_b16 a[164:165], v106 offset:12800
    ds_read_b64_tr_b16 a[166:167], v106 offset:13056
    v_add_f32 v98, 1.0, v98
    v_rcp_f32 v96, v96
    v_rcp_f32 v97, v97
    v_mfma_f32_32x32x16_bf16 v[64:79], a[172:175], a[12:15], v[64:79]
    ds_read_b64_tr_b16 a[168:169], v106 offset:14336
    ds_read_b64_tr_b16 a[170:171], v106 offset:14592
    v_rcp_f32 v98, v98
    v_mul_f32 v16, v16, v96
    s_waitcnt lgkmcnt(6)
    v_mfma_f32_32x32x16_bf16 v[48:63], a[144:147], a[16:19], v[48:63]
    ds_read_b64_tr_b16 a[172:173], v106 offset:14848
    ds_read_b64_tr_b16 a[174:175], v106 offset:15104
    v_mul_f32 v17, v17, v97
    v_mul_f32 v18, v18, v98
    v_fma_f32 v99, v19, v19, v11
    v_fma_f32 v100, v20, v20, v11
    v_fma_f32 v101, v21, v21, v11
    v_mfma_f32_32x32x16_bf16 v[64:79], a[148:151], a[16:19], v[64:79]
    ds_read_b64_tr_b16 a[144:145], v106 offset:16384
    ds_read_b64_tr_b16 a[146:147], v106 offset:16640
    buffer_load_dwordx4 v4, s[28:31], s44 offen offset:2048 lds
    v_mul_f32 v99, v19, v99
    v_mul_f32 v100, v20, v100
    v_mul_f32 v101, v21, v101
    v_exp_f32 v99, -v99
    v_mfma_f32_32x32x16_bf16 v[48:63], a[152:155], a[20:23], v[48:63]
    ds_read_b64_tr_b16 a[148:149], v106 offset:16896
    ds_read_b64_tr_b16 a[150:151], v106 offset:17152
    v_exp_f32 v100, -v100
    v_exp_f32 v101, -v101
    v_mfma_f32_32x32x16_bf16 v[64:79], a[156:159], a[20:23], v[64:79]
    ds_read_b64_tr_b16 a[152:153], v106 offset:18432
    ds_read_b64_tr_b16 a[154:155], v106 offset:18688
    v_add_f32 v99, 1.0, v99
    v_add_f32 v100, 1.0, v100
    v_add_f32 v101, 1.0, v101
    v_rcp_f32 v99, v99
    s_waitcnt lgkmcnt(6)
    v_mfma_f32_32x32x16_bf16 v[48:63], a[160:163], a[24:27], v[48:63]
    ds_read_b64_tr_b16 a[156:157], v106 offset:18944
    ds_read_b64_tr_b16 a[158:159], v106 offset:19200
    v_rcp_f32 v100, v100
    v_rcp_f32 v101, v101
    v_mfma_f32_32x32x16_bf16 v[64:79], a[164:167], a[24:27], v[64:79]
    ds_read_b64_tr_b16 a[160:161], v106 offset:20480
    ds_read_b64_tr_b16 a[162:163], v106 offset:20736
    buffer_load_dwordx4 v5, s[28:31], s44 offen offset:3072 lds
    v_mul_f32 v19, v19, v99
    v_mul_f32 v20, v20, v100
    v_mul_f32 v21, v21, v101
    v_fma_f32 v96, v22, v22, v11
    v_mfma_f32_32x32x16_bf16 v[48:63], a[168:171], a[28:31], v[48:63]
    ds_read_b64_tr_b16 a[164:165], v106 offset:20992
    ds_read_b64_tr_b16 a[166:167], v106 offset:21248
    v_fma_f32 v97, v23, v23, v11
    v_fma_f32 v98, v24, v24, v11
    v_mul_f32 v96, v22, v96
    v_mul_f32 v97, v23, v97
    v_mfma_f32_32x32x16_bf16 v[64:79], a[172:175], a[28:31], v[64:79]
    ds_read_b64_tr_b16 a[168:169], v106 offset:22528
    ds_read_b64_tr_b16 a[170:171], v106 offset:22784
    v_mul_f32 v98, v24, v98
    v_exp_f32 v96, -v96
    v_exp_f32 v97, -v97
    s_waitcnt lgkmcnt(6)
    v_mfma_f32_32x32x16_bf16 v[48:63], a[144:147], a[32:35], v[48:63]
    ds_read_b64_tr_b16 a[172:173], v106 offset:23040
    ds_read_b64_tr_b16 a[174:175], v106 offset:23296
    v_exp_f32 v98, -v98
    v_add_f32 v96, 1.0, v96
    v_add_f32 v97, 1.0, v97
    v_mfma_f32_32x32x16_bf16 v[64:79], a[148:151], a[32:35], v[64:79]
    ds_read_b64_tr_b16 a[144:145], v106 offset:24576
    ds_read_b64_tr_b16 a[146:147], v106 offset:24832
    s_add_u32 m0, s43, 40960
    s_add_u32 s44, s40, 2949888
    buffer_load_dwordx4 v2, s[28:31], s44 offen offset:0 lds
    v_add_f32 v98, 1.0, v98
    v_rcp_f32 v96, v96
    v_rcp_f32 v97, v97
    v_mfma_f32_32x32x16_bf16 v[48:63], a[152:155], a[36:39], v[48:63]
    ds_read_b64_tr_b16 a[148:149], v106 offset:25088
    ds_read_b64_tr_b16 a[150:151], v106 offset:25344
    v_rcp_f32 v98, v98
    v_mul_f32 v22, v22, v96
    v_mul_f32 v23, v23, v97
    v_mfma_f32_32x32x16_bf16 v[64:79], a[156:159], a[36:39], v[64:79]
    ds_read_b64_tr_b16 a[152:153], v106 offset:26624
    ds_read_b64_tr_b16 a[154:155], v106 offset:26880
    v_mul_f32 v24, v24, v98
    v_fma_f32 v99, v25, v25, v11
    v_fma_f32 v100, v26, v26, v11
    v_fma_f32 v101, v27, v27, v11
    s_waitcnt lgkmcnt(6)
    v_mfma_f32_32x32x16_bf16 v[48:63], a[160:163], a[40:43], v[48:63]
    ds_read_b64_tr_b16 a[156:157], v106 offset:27136
    ds_read_b64_tr_b16 a[158:159], v106 offset:27392
    v_mul_f32 v99, v25, v99
    v_mul_f32 v100, v26, v100
    v_mul_f32 v101, v27, v101
    v_exp_f32 v99, -v99
    v_mfma_f32_32x32x16_bf16 v[64:79], a[164:167], a[40:43], v[64:79]
    ds_read_b64_tr_b16 a[160:161], v106 offset:28672
    ds_read_b64_tr_b16 a[162:163], v106 offset:28928
    buffer_load_dwordx4 v3, s[28:31], s44 offen offset:1024 lds
    v_exp_f32 v100, -v100
    v_exp_f32 v101, -v101
    v_mfma_f32_32x32x16_bf16 v[48:63], a[168:171], a[44:47], v[48:63]
    ds_read_b64_tr_b16 a[164:165], v106 offset:29184
    ds_read_b64_tr_b16 a[166:167], v106 offset:29440
    v_add_f32 v99, 1.0, v99
    v_add_f32 v100, 1.0, v100
    v_add_f32 v101, 1.0, v101
    v_rcp_f32 v99, v99
    v_mfma_f32_32x32x16_bf16 v[64:79], a[172:175], a[44:47], v[64:79]
    ds_read_b64_tr_b16 a[168:169], v106 offset:30720
    ds_read_b64_tr_b16 a[170:171], v106 offset:30976
    v_rcp_f32 v100, v100
    v_rcp_f32 v101, v101
    s_waitcnt lgkmcnt(6)
    v_mfma_f32_32x32x16_bf16 v[48:63], a[144:147], a[48:51], v[48:63]
    ds_read_b64_tr_b16 a[172:173], v106 offset:31232
    ds_read_b64_tr_b16 a[174:175], v106 offset:31488
    v_mul_f32 v25, v25, v99
    v_mul_f32 v26, v26, v100
    v_mul_f32 v27, v27, v101
    v_fma_f32 v96, v28, v28, v11
    v_mfma_f32_32x32x16_bf16 v[64:79], a[148:151], a[48:51], v[64:79]
    ds_read_b64_tr_b16 a[144:145], v106 offset:32768
    ds_read_b64_tr_b16 a[146:147], v106 offset:33024
    buffer_load_dwordx4 v4, s[28:31], s44 offen offset:2048 lds
    v_fma_f32 v97, v29, v29, v11
    v_mul_f32 v96, v28, v96
    v_mul_f32 v97, v29, v97
    v_exp_f32 v96, -v96
    v_mfma_f32_32x32x16_bf16 v[48:63], a[152:155], a[52:55], v[48:63]
    ds_read_b64_tr_b16 a[148:149], v106 offset:33280
    ds_read_b64_tr_b16 a[150:151], v106 offset:33536
    v_exp_f32 v97, -v97
    v_add_f32 v96, 1.0, v96
    v_add_f32 v97, 1.0, v97
    v_mfma_f32_32x32x16_bf16 v[64:79], a[156:159], a[52:55], v[64:79]
    ds_read_b64_tr_b16 a[152:153], v106 offset:34816
    ds_read_b64_tr_b16 a[154:155], v106 offset:35072
    v_rcp_f32 v96, v96
    v_rcp_f32 v97, v97
    s_waitcnt lgkmcnt(6)
    v_mfma_f32_32x32x16_bf16 v[48:63], a[160:163], a[56:59], v[48:63]
    ds_read_b64_tr_b16 a[156:157], v106 offset:35328
    ds_read_b64_tr_b16 a[158:159], v106 offset:35584
    v_mul_f32 v28, v28, v96
    v_mul_f32 v29, v29, v97
    v_fma_f32 v96, v30, v30, v11
    v_fma_f32 v97, v31, v31, v11
    v_mul_f32 v96, v30, v96
    v_mfma_f32_32x32x16_bf16 v[64:79], a[164:167], a[56:59], v[64:79]
    s_waitcnt vmcnt(16)
    s_barrier
    ds_read_b64_tr_b16 a[160:161], v107 offset:0
    ds_read_b64_tr_b16 a[162:163], v107 offset:256
    buffer_load_dwordx4 v5, s[28:31], s44 offen offset:3072 lds
    v_mul_f32 v97, v31, v97
    v_exp_f32 v96, -v96
    v_exp_f32 v97, -v97
    v_mfma_f32_32x32x16_bf16 v[48:63], a[168:171], a[60:63], v[48:63]
    ds_read_b64_tr_b16 a[164:165], v107 offset:512
    ds_read_b64_tr_b16 a[166:167], v107 offset:768
    v_add_f32 v96, 1.0, v96
    v_add_f32 v97, 1.0, v97
    v_rcp_f32 v96, v96
    v_mfma_f32_32x32x16_bf16 v[64:79], a[172:175], a[60:63], v[64:79]
    ds_read_b64_tr_b16 a[168:169], v107 offset:2048
    ds_read_b64_tr_b16 a[170:171], v107 offset:2304
    v_rcp_f32 v97, v97
    v_mul_f32 v30, v30, v96
    v_mul_f32 v31, v31, v97
    s_waitcnt lgkmcnt(6)
    v_mfma_f32_32x32x16_bf16 v[48:63], a[144:147], a[64:67], v[48:63]
    ds_read_b64_tr_b16 a[172:173], v107 offset:2560
    ds_read_b64_tr_b16 a[174:175], v107 offset:2816
    v_cvt_pk_bf16_f32 v176, v16, v17
    v_cvt_pk_bf16_f32 v177, v18, v19
    v_cvt_pk_bf16_f32 v178, v20, v21
    v_cvt_pk_bf16_f32 v179, v22, v23
    v_mfma_f32_32x32x16_bf16 v[64:79], a[148:151], a[64:67], v[64:79]
    ds_read_b64_tr_b16 a[144:145], v107 offset:4096
    ds_read_b64_tr_b16 a[146:147], v107 offset:4352
    s_add_u32 m0, s43, 45056
    s_add_u32 s44, s40, 3244800
    buffer_load_dwordx4 v2, s[28:31], s44 offen offset:0 lds
    v_cvt_pk_bf16_f32 v180, v24, v25
    v_cvt_pk_bf16_f32 v181, v26, v27
    v_cvt_pk_bf16_f32 v182, v28, v29
    v_cvt_pk_bf16_f32 v183, v30, v31
    v_mfma_f32_32x32x16_bf16 v[48:63], a[152:155], a[68:71], v[48:63]
    ds_read_b64_tr_b16 a[148:149], v107 offset:4608
    ds_read_b64_tr_b16 a[150:151], v107 offset:4864
    v_fma_f32 v96, v32, v32, v11
    v_fma_f32 v97, v33, v33, v11
    v_fma_f32 v98, v34, v34, v11
    v_mul_f32 v96, v32, v96
    v_mul_f32 v97, v33, v97
    v_mfma_f32_32x32x16_bf16 v[64:79], a[156:159], a[68:71], v[64:79]
    ds_read_b64_tr_b16 a[152:153], v107 offset:6144
    ds_read_b64_tr_b16 a[154:155], v107 offset:6400
    v_mul_f32 v98, v34, v98
    v_exp_f32 v96, -v96
    v_exp_f32 v97, -v97
    s_waitcnt lgkmcnt(6)
    v_mfma_f32_32x32x16_bf16 v[48:63], a[160:163], a[72:75], v[48:63]
    ds_read_b64_tr_b16 a[156:157], v107 offset:6656
    ds_read_b64_tr_b16 a[158:159], v107 offset:6912
    v_exp_f32 v98, -v98
    v_add_f32 v96, 1.0, v96
    v_add_f32 v97, 1.0, v97
    v_mfma_f32_32x32x16_bf16 v[64:79], a[164:167], a[72:75], v[64:79]
    ds_read_b64_tr_b16 a[160:161], v107 offset:8192
    ds_read_b64_tr_b16 a[162:163], v107 offset:8448
    s_add_u32 m0, s43, 73728
    s_add_u32 s44, s40, 896
    buffer_load_dwordx4 v2, s[28:31], s44 offen offset:0 lds
    v_add_f32 v98, 1.0, v98
    v_rcp_f32 v96, v96
    v_rcp_f32 v97, v97
    v_mfma_f32_32x32x16_bf16 v[48:63], a[168:171], a[76:79], v[48:63]
    ds_read_b64_tr_b16 a[164:165], v107 offset:8704
    ds_read_b64_tr_b16 a[166:167], v107 offset:8960
    v_rcp_f32 v98, v98
    v_mul_f32 v32, v32, v96
    v_mfma_f32_32x32x16_bf16 v[64:79], a[172:175], a[76:79], v[64:79]
    ds_read_b64_tr_b16 a[168:169], v107 offset:10240
    ds_read_b64_tr_b16 a[170:171], v107 offset:10496
    v_mul_f32 v33, v33, v97
    v_mul_f32 v34, v34, v98
    v_fma_f32 v99, v35, v35, v11
    v_fma_f32 v100, v36, v36, v11
    v_fma_f32 v101, v37, v37, v11
    s_waitcnt lgkmcnt(6)
    v_mfma_f32_32x32x16_bf16 v[48:63], a[144:147], a[80:83], v[48:63]
    ds_read_b64_tr_b16 a[172:173], v107 offset:10752
    ds_read_b64_tr_b16 a[174:175], v107 offset:11008
    v_mul_f32 v99, v35, v99
    v_mul_f32 v100, v36, v100
    v_mul_f32 v101, v37, v101
    v_exp_f32 v99, -v99
    v_mfma_f32_32x32x16_bf16 v[64:79], a[148:151], a[80:83], v[64:79]
    ds_read_b64_tr_b16 a[144:145], v107 offset:12288
    ds_read_b64_tr_b16 a[146:147], v107 offset:12544
    buffer_load_dwordx4 v3, s[28:31], s44 offen offset:1024 lds
    v_exp_f32 v100, -v100
    v_exp_f32 v101, -v101
    v_mfma_f32_32x32x16_bf16 v[48:63], a[152:155], a[84:87], v[48:63]
    ds_read_b64_tr_b16 a[148:149], v107 offset:12800
    ds_read_b64_tr_b16 a[150:151], v107 offset:13056
    v_add_f32 v99, 1.0, v99
    v_add_f32 v100, 1.0, v100
    v_add_f32 v101, 1.0, v101
    v_rcp_f32 v99, v99
    v_mfma_f32_32x32x16_bf16 v[64:79], a[156:159], a[84:87], v[64:79]
    ds_read_b64_tr_b16 a[152:153], v107 offset:14336
    ds_read_b64_tr_b16 a[154:155], v107 offset:14592
    v_rcp_f32 v100, v100
    v_rcp_f32 v101, v101
    s_waitcnt lgkmcnt(6)
    v_mfma_f32_32x32x16_bf16 v[48:63], a[160:163], a[88:91], v[48:63]
    ds_read_b64_tr_b16 a[156:157], v107 offset:14848
    ds_read_b64_tr_b16 a[158:159], v107 offset:15104
    v_mul_f32 v35, v35, v99
    v_mul_f32 v36, v36, v100
    v_mul_f32 v37, v37, v101
    v_fma_f32 v96, v38, v38, v11
    v_mfma_f32_32x32x16_bf16 v[64:79], a[164:167], a[88:91], v[64:79]
    ds_read_b64_tr_b16 a[160:161], v107 offset:16384
    ds_read_b64_tr_b16 a[162:163], v107 offset:16640
    buffer_load_dwordx4 v4, s[28:31], s44 offen offset:2048 lds
    v_fma_f32 v97, v39, v39, v11
    v_fma_f32 v98, v40, v40, v11
    v_mul_f32 v96, v38, v96
    v_mul_f32 v97, v39, v97
    v_mfma_f32_32x32x16_bf16 v[48:63], a[168:171], a[92:95], v[48:63]
    ds_read_b64_tr_b16 a[164:165], v107 offset:16896
    ds_read_b64_tr_b16 a[166:167], v107 offset:17152
    v_mul_f32 v98, v40, v98
    v_exp_f32 v96, -v96
    v_exp_f32 v97, -v97
    v_mfma_f32_32x32x16_bf16 v[64:79], a[172:175], a[92:95], v[64:79]
    ds_read_b64_tr_b16 a[168:169], v107 offset:18432
    ds_read_b64_tr_b16 a[170:171], v107 offset:18688
    v_exp_f32 v98, -v98
    v_add_f32 v96, 1.0, v96
    v_add_f32 v97, 1.0, v97
    s_waitcnt lgkmcnt(6)
    v_mfma_f32_32x32x16_bf16 v[48:63], a[144:147], a[96:99], v[48:63]
    ds_read_b64_tr_b16 a[172:173], v107 offset:18944
    ds_read_b64_tr_b16 a[174:175], v107 offset:19200
    v_add_f32 v98, 1.0, v98
    v_rcp_f32 v96, v96
    v_rcp_f32 v97, v97
    v_mfma_f32_32x32x16_bf16 v[64:79], a[148:151], a[96:99], v[64:79]
    ds_read_b64_tr_b16 a[144:145], v107 offset:20480
    ds_read_b64_tr_b16 a[146:147], v107 offset:20736
    buffer_load_dwordx4 v5, s[28:31], s44 offen offset:3072 lds
    v_rcp_f32 v98, v98
    v_mul_f32 v38, v38, v96
    v_mul_f32 v39, v39, v97
    v_mfma_f32_32x32x16_bf16 v[48:63], a[152:155], a[100:103], v[48:63]
    ds_read_b64_tr_b16 a[148:149], v107 offset:20992
    ds_read_b64_tr_b16 a[150:151], v107 offset:21248
    v_mul_f32 v40, v40, v98
    v_fma_f32 v99, v41, v41, v11
    v_fma_f32 v100, v42, v42, v11
    v_fma_f32 v101, v43, v43, v11
    v_mfma_f32_32x32x16_bf16 v[64:79], a[156:159], a[100:103], v[64:79]
    ds_read_b64_tr_b16 a[152:153], v107 offset:22528
    ds_read_b64_tr_b16 a[154:155], v107 offset:22784
    v_mul_f32 v99, v41, v99
    v_mul_f32 v100, v42, v100
    v_mul_f32 v101, v43, v101
    v_exp_f32 v99, -v99
    s_waitcnt lgkmcnt(6)
    v_mfma_f32_32x32x16_bf16 v[48:63], a[160:163], a[104:107], v[48:63]
    ds_read_b64_tr_b16 a[156:157], v107 offset:23040
    ds_read_b64_tr_b16 a[158:159], v107 offset:23296
    v_exp_f32 v100, -v100
    v_exp_f32 v101, -v101
    v_mfma_f32_32x32x16_bf16 v[64:79], a[164:167], a[104:107], v[64:79]
    ds_read_b64_tr_b16 a[160:161], v107 offset:24576
    ds_read_b64_tr_b16 a[162:163], v107 offset:24832
    s_add_u32 m0, s43, 77824
    s_add_u32 s44, s40, 295808
    buffer_load_dwordx4 v2, s[28:31], s44 offen offset:0 lds
    v_add_f32 v99, 1.0, v99
    v_add_f32 v100, 1.0, v100
    v_add_f32 v101, 1.0, v101
    v_rcp_f32 v99, v99
    v_mfma_f32_32x32x16_bf16 v[48:63], a[168:171], a[108:111], v[48:63]
    ds_read_b64_tr_b16 a[164:165], v107 offset:25088
    ds_read_b64_tr_b16 a[166:167], v107 offset:25344
    v_rcp_f32 v100, v100
    v_rcp_f32 v101, v101
    v_mfma_f32_32x32x16_bf16 v[64:79], a[172:175], a[108:111], v[64:79]
    ds_read_b64_tr_b16 a[168:169], v107 offset:26624
    ds_read_b64_tr_b16 a[170:171], v107 offset:26880
    v_mul_f32 v41, v41, v99
    v_mul_f32 v42, v42, v100
    v_mul_f32 v43, v43, v101
    v_fma_f32 v96, v44, v44, v11
    s_waitcnt lgkmcnt(6)
    v_mfma_f32_32x32x16_bf16 v[48:63], a[144:147], a[112:115], v[48:63]
    ds_read_b64_tr_b16 a[172:173], v107 offset:27136
    ds_read_b64_tr_b16 a[174:175], v107 offset:27392
    v_fma_f32 v97, v45, v45, v11
    v_mul_f32 v96, v44, v96
    v_mul_f32 v97, v45, v97
    v_exp_f32 v96, -v96
    v_mfma_f32_32x32x16_bf16 v[64:79], a[148:151], a[112:115], v[64:79]
    ds_read_b64_tr_b16 a[144:145], v107 offset:28672
    ds_read_b64_tr_b16 a[146:147], v107 offset:28928
    buffer_load_dwordx4 v3, s[28:31], s44 offen offset:1024 lds
    v_exp_f32 v97, -v97
    v_add_f32 v96, 1.0, v96
    v_add_f32 v97, 1.0, v97
    v_mfma_f32_32x32x16_bf16 v[48:63], a[152:155], a[116:119], v[48:63]
    ds_read_b64_tr_b16 a[148:149], v107 offset:29184
    ds_read_b64_tr_b16 a[150:151], v107 offset:29440
    v_rcp_f32 v96, v96
    v_rcp_f32 v97, v97
    v_mfma_f32_32x32x16_bf16 v[64:79], a[156:159], a[116:119], v[64:79]
    ds_read_b64_tr_b16 a[152:153], v107 offset:30720
    ds_read_b64_tr_b16 a[154:155], v107 offset:30976
    v_mul_f32 v44, v44, v96
    v_mul_f32 v45, v45, v97
    v_fma_f32 v96, v46, v46, v11
    v_fma_f32 v97, v47, v47, v11
    v_mul_f32 v96, v46, v96
    s_waitcnt lgkmcnt(6)
    v_mfma_f32_32x32x16_bf16 v[48:63], a[160:163], a[120:123], v[48:63]
    ds_read_b64_tr_b16 a[156:157], v107 offset:31232
    ds_read_b64_tr_b16 a[158:159], v107 offset:31488
    v_mul_f32 v97, v47, v97
    v_exp_f32 v96, -v96
    v_exp_f32 v97, -v97
    v_mfma_f32_32x32x16_bf16 v[64:79], a[164:167], a[120:123], v[64:79]
    ds_read_b64_tr_b16 a[160:161], v107 offset:32768
    ds_read_b64_tr_b16 a[162:163], v107 offset:33024
    buffer_load_dwordx4 v4, s[28:31], s44 offen offset:2048 lds
    v_add_f32 v96, 1.0, v96
    v_add_f32 v97, 1.0, v97
    v_rcp_f32 v96, v96
    v_mfma_f32_32x32x16_bf16 v[48:63], a[168:171], a[124:127], v[48:63]
    ds_read_b64_tr_b16 a[164:165], v107 offset:33280
    ds_read_b64_tr_b16 a[166:167], v107 offset:33536
    v_rcp_f32 v97, v97
    v_mul_f32 v46, v46, v96
    v_mul_f32 v47, v47, v97
    v_mfma_f32_32x32x16_bf16 v[64:79], a[172:175], a[124:127], v[64:79]
    ds_read_b64_tr_b16 a[168:169], v107 offset:34816
    ds_read_b64_tr_b16 a[170:171], v107 offset:35072
    v_cvt_pk_bf16_f32 v184, v32, v33
    v_cvt_pk_bf16_f32 v185, v34, v35
    v_cvt_pk_bf16_f32 v186, v36, v37
    v_cvt_pk_bf16_f32 v187, v38, v39
    s_waitcnt lgkmcnt(6)
    v_mfma_f32_32x32x16_bf16 v[48:63], a[144:147], a[128:131], v[48:63]
    ds_read_b64_tr_b16 a[172:173], v107 offset:35328
    ds_read_b64_tr_b16 a[174:175], v107 offset:35584
    v_cvt_pk_bf16_f32 v188, v40, v41
    v_cvt_pk_bf16_f32 v189, v42, v43
    v_cvt_pk_bf16_f32 v190, v44, v45
    v_cvt_pk_bf16_f32 v191, v46, v47
    v_mfma_f32_32x32x16_bf16 v[64:79], a[148:151], a[128:131], v[64:79]
    s_waitcnt vmcnt(16)
    s_barrier
    ds_read_b64_tr_b16 a[144:145], v104 offset:0
    ds_read_b64_tr_b16 a[146:147], v104 offset:256
    buffer_load_dwordx4 v5, s[28:31], s44 offen offset:3072 lds
    v_mfma_f32_32x32x16_bf16 v[48:63], a[152:155], a[132:135], v[48:63]
    ds_read_b64_tr_b16 a[148:149], v104 offset:512
    ds_read_b64_tr_b16 a[150:151], v104 offset:768
    ds_read_b128 v[16:19], v10 offset:1536
    ds_read_b128 v[20:23], v10 offset:1568
    ds_read_b128 v[24:27], v10 offset:1600
    ds_read_b128 v[28:31], v10 offset:1632
    ds_read_b128 v[32:35], v10 offset:1664
    ds_read_b128 v[36:39], v10 offset:1696
    ds_read_b128 v[40:43], v10 offset:1728
    ds_read_b128 v[44:47], v10 offset:1760
    v_mfma_f32_32x32x16_bf16 v[64:79], a[156:159], a[132:135], v[64:79]
    ds_read_b64_tr_b16 a[152:153], v104 offset:2048
    ds_read_b64_tr_b16 a[154:155], v104 offset:2304
    s_waitcnt lgkmcnt(14)
    v_mfma_f32_32x32x16_bf16 v[48:63], a[160:163], a[136:139], v[48:63]
    ds_read_b64_tr_b16 a[156:157], v104 offset:2560
    ds_read_b64_tr_b16 a[158:159], v104 offset:2816
    v_mfma_f32_32x32x16_bf16 v[64:79], a[164:167], a[136:139], v[64:79]
    ds_read_b64_tr_b16 a[160:161], v104 offset:4096
    ds_read_b64_tr_b16 a[162:163], v104 offset:4352
    s_add_u32 m0, s43, 81920
    s_add_u32 s44, s40, 590720
    buffer_load_dwordx4 v2, s[28:31], s44 offen offset:0 lds
    v_mfma_f32_32x32x16_bf16 v[48:63], a[168:171], a[140:143], v[48:63]
    ds_read_b64_tr_b16 a[164:165], v104 offset:4608
    ds_read_b64_tr_b16 a[166:167], v104 offset:4864
    v_mfma_f32_32x32x16_bf16 v[64:79], a[172:175], a[140:143], v[64:79]
    ds_read_b64_tr_b16 a[168:169], v104 offset:6144
    ds_read_b64_tr_b16 a[170:171], v104 offset:6400
    s_waitcnt lgkmcnt(6)
    v_mfma_f32_32x32x16_bf16 v[16:31], a[144:147], a[0:3], v[16:31]
    ds_read_b64_tr_b16 a[172:173], v104 offset:6656
    ds_read_b64_tr_b16 a[174:175], v104 offset:6912
    v_mfma_f32_32x32x16_bf16 v[32:47], a[148:151], a[0:3], v[32:47]
    ds_read_b64_tr_b16 a[144:145], v104 offset:8192
    ds_read_b64_tr_b16 a[146:147], v104 offset:8448
    s_add_u32 m0, s43, 110592
    s_add_u32 s44, s40, 2655104
    buffer_load_dwordx4 v2, s[28:31], s44 offen offset:0 lds
    v_mfma_f32_32x32x16_bf16 v[16:31], a[152:155], a[4:7], v[16:31]
    ds_read_b64_tr_b16 a[148:149], v104 offset:8704
    ds_read_b64_tr_b16 a[150:151], v104 offset:8960
    v_mfma_f32_32x32x16_bf16 v[32:47], a[156:159], a[4:7], v[32:47]
    ds_read_b64_tr_b16 a[152:153], v104 offset:10240
    ds_read_b64_tr_b16 a[154:155], v104 offset:10496
    v_fma_f32 v96, v48, v48, v11
    v_fma_f32 v97, v49, v49, v11
    v_fma_f32 v98, v50, v50, v11
    v_mul_f32 v96, v48, v96
    v_mul_f32 v97, v49, v97
    s_waitcnt lgkmcnt(6)
    v_mfma_f32_32x32x16_bf16 v[16:31], a[160:163], a[8:11], v[16:31]
    ds_read_b64_tr_b16 a[156:157], v104 offset:10752
    ds_read_b64_tr_b16 a[158:159], v104 offset:11008
    v_mul_f32 v98, v50, v98
    v_exp_f32 v96, -v96
    v_exp_f32 v97, -v97
    v_mfma_f32_32x32x16_bf16 v[32:47], a[164:167], a[8:11], v[32:47]
    ds_read_b64_tr_b16 a[160:161], v104 offset:12288
    ds_read_b64_tr_b16 a[162:163], v104 offset:12544
    buffer_load_dwordx4 v3, s[28:31], s44 offen offset:1024 lds
    v_exp_f32 v98, -v98
    v_add_f32 v96, 1.0, v96
    v_add_f32 v97, 1.0, v97
    v_mfma_f32_32x32x16_bf16 v[16:31], a[168:171], a[12:15], v[16:31]
    ds_read_b64_tr_b16 a[164:165], v104 offset:12800
    ds_read_b64_tr_b16 a[166:167], v104 offset:13056
    v_add_f32 v98, 1.0, v98
    v_rcp_f32 v96, v96
    v_rcp_f32 v97, v97
    v_mfma_f32_32x32x16_bf16 v[32:47], a[172:175], a[12:15], v[32:47]
    ds_read_b64_tr_b16 a[168:169], v104 offset:14336
    ds_read_b64_tr_b16 a[170:171], v104 offset:14592
    v_rcp_f32 v98, v98
    v_mul_f32 v48, v48, v96
    s_waitcnt lgkmcnt(6)
    v_mfma_f32_32x32x16_bf16 v[16:31], a[144:147], a[16:19], v[16:31]
    ds_read_b64_tr_b16 a[172:173], v104 offset:14848
    ds_read_b64_tr_b16 a[174:175], v104 offset:15104
    v_mul_f32 v49, v49, v97
    v_mul_f32 v50, v50, v98
    v_fma_f32 v99, v51, v51, v11
    v_fma_f32 v100, v52, v52, v11
    v_fma_f32 v101, v53, v53, v11
    v_mfma_f32_32x32x16_bf16 v[32:47], a[148:151], a[16:19], v[32:47]
    ds_read_b64_tr_b16 a[144:145], v104 offset:16384
    ds_read_b64_tr_b16 a[146:147], v104 offset:16640
    buffer_load_dwordx4 v4, s[28:31], s44 offen offset:2048 lds
    v_mul_f32 v99, v51, v99
    v_mul_f32 v100, v52, v100
    v_mul_f32 v101, v53, v101
    v_exp_f32 v99, -v99
    v_mfma_f32_32x32x16_bf16 v[16:31], a[152:155], a[20:23], v[16:31]
    ds_read_b64_tr_b16 a[148:149], v104 offset:16896
    ds_read_b64_tr_b16 a[150:151], v104 offset:17152
    v_exp_f32 v100, -v100
    v_exp_f32 v101, -v101
    v_mfma_f32_32x32x16_bf16 v[32:47], a[156:159], a[20:23], v[32:47]
    ds_read_b64_tr_b16 a[152:153], v104 offset:18432
    ds_read_b64_tr_b16 a[154:155], v104 offset:18688
    v_add_f32 v99, 1.0, v99
    v_add_f32 v100, 1.0, v100
    v_add_f32 v101, 1.0, v101
    v_rcp_f32 v99, v99
    s_waitcnt lgkmcnt(6)
    v_mfma_f32_32x32x16_bf16 v[16:31], a[160:163], a[24:27], v[16:31]
    ds_read_b64_tr_b16 a[156:157], v104 offset:18944
    ds_read_b64_tr_b16 a[158:159], v104 offset:19200
    v_rcp_f32 v100, v100
    v_rcp_f32 v101, v101
    v_mfma_f32_32x32x16_bf16 v[32:47], a[164:167], a[24:27], v[32:47]
    ds_read_b64_tr_b16 a[160:161], v104 offset:20480
    ds_read_b64_tr_b16 a[162:163], v104 offset:20736
    buffer_load_dwordx4 v5, s[28:31], s44 offen offset:3072 lds
    v_mul_f32 v51, v51, v99
    v_mul_f32 v52, v52, v100
    v_mul_f32 v53, v53, v101
    v_fma_f32 v96, v54, v54, v11
    v_mfma_f32_32x32x16_bf16 v[16:31], a[168:171], a[28:31], v[16:31]
    ds_read_b64_tr_b16 a[164:165], v104 offset:20992
    ds_read_b64_tr_b16 a[166:167], v104 offset:21248
    v_fma_f32 v97, v55, v55, v11
    v_fma_f32 v98, v56, v56, v11
    v_mul_f32 v96, v54, v96
    v_mul_f32 v97, v55, v97
    v_mfma_f32_32x32x16_bf16 v[32:47], a[172:175], a[28:31], v[32:47]
    ds_read_b64_tr_b16 a[168:169], v104 offset:22528
    ds_read_b64_tr_b16 a[170:171], v104 offset:22784
    v_mul_f32 v98, v56, v98
    v_exp_f32 v96, -v96
    v_exp_f32 v97, -v97
    s_waitcnt lgkmcnt(6)
    v_mfma_f32_32x32x16_bf16 v[16:31], a[144:147], a[32:35], v[16:31]
    ds_read_b64_tr_b16 a[172:173], v104 offset:23040
    ds_read_b64_tr_b16 a[174:175], v104 offset:23296
    v_exp_f32 v98, -v98
    v_add_f32 v96, 1.0, v96
    v_add_f32 v97, 1.0, v97
    v_mfma_f32_32x32x16_bf16 v[32:47], a[148:151], a[32:35], v[32:47]
    ds_read_b64_tr_b16 a[144:145], v104 offset:24576
    ds_read_b64_tr_b16 a[146:147], v104 offset:24832
    s_add_u32 m0, s43, 114688
    s_add_u32 s44, s40, 2950016
    buffer_load_dwordx4 v2, s[28:31], s44 offen offset:0 lds
    v_add_f32 v98, 1.0, v98
    v_rcp_f32 v96, v96
    v_rcp_f32 v97, v97
    v_mfma_f32_32x32x16_bf16 v[16:31], a[152:155], a[36:39], v[16:31]
    ds_read_b64_tr_b16 a[148:149], v104 offset:25088
    ds_read_b64_tr_b16 a[150:151], v104 offset:25344
    v_rcp_f32 v98, v98
    v_mul_f32 v54, v54, v96
    v_mul_f32 v55, v55, v97
    v_mfma_f32_32x32x16_bf16 v[32:47], a[156:159], a[36:39], v[32:47]
    ds_read_b64_tr_b16 a[152:153], v104 offset:26624
    ds_read_b64_tr_b16 a[154:155], v104 offset:26880
    v_mul_f32 v56, v56, v98
    v_fma_f32 v99, v57, v57, v11
    v_fma_f32 v100, v58, v58, v11
    v_fma_f32 v101, v59, v59, v11
    s_waitcnt lgkmcnt(6)
    v_mfma_f32_32x32x16_bf16 v[16:31], a[160:163], a[40:43], v[16:31]
    ds_read_b64_tr_b16 a[156:157], v104 offset:27136
    ds_read_b64_tr_b16 a[158:159], v104 offset:27392
    v_mul_f32 v99, v57, v99
    v_mul_f32 v100, v58, v100
    v_mul_f32 v101, v59, v101
    v_exp_f32 v99, -v99
    v_mfma_f32_32x32x16_bf16 v[32:47], a[164:167], a[40:43], v[32:47]
    ds_read_b64_tr_b16 a[160:161], v104 offset:28672
    ds_read_b64_tr_b16 a[162:163], v104 offset:28928
    buffer_load_dwordx4 v3, s[28:31], s44 offen offset:1024 lds
    v_exp_f32 v100, -v100
    v_exp_f32 v101, -v101
    v_mfma_f32_32x32x16_bf16 v[16:31], a[168:171], a[44:47], v[16:31]
    ds_read_b64_tr_b16 a[164:165], v104 offset:29184
    ds_read_b64_tr_b16 a[166:167], v104 offset:29440
    v_add_f32 v99, 1.0, v99
    v_add_f32 v100, 1.0, v100
    v_add_f32 v101, 1.0, v101
    v_rcp_f32 v99, v99
    v_mfma_f32_32x32x16_bf16 v[32:47], a[172:175], a[44:47], v[32:47]
    ds_read_b64_tr_b16 a[168:169], v104 offset:30720
    ds_read_b64_tr_b16 a[170:171], v104 offset:30976
    v_rcp_f32 v100, v100
    v_rcp_f32 v101, v101
    s_waitcnt lgkmcnt(6)
    v_mfma_f32_32x32x16_bf16 v[16:31], a[144:147], a[48:51], v[16:31]
    ds_read_b64_tr_b16 a[172:173], v104 offset:31232
    ds_read_b64_tr_b16 a[174:175], v104 offset:31488
    v_mul_f32 v57, v57, v99
    v_mul_f32 v58, v58, v100
    v_mul_f32 v59, v59, v101
    v_fma_f32 v96, v60, v60, v11
    v_mfma_f32_32x32x16_bf16 v[32:47], a[148:151], a[48:51], v[32:47]
    ds_read_b64_tr_b16 a[144:145], v104 offset:32768
    ds_read_b64_tr_b16 a[146:147], v104 offset:33024
    buffer_load_dwordx4 v4, s[28:31], s44 offen offset:2048 lds
    v_fma_f32 v97, v61, v61, v11
    v_mul_f32 v96, v60, v96
    v_mul_f32 v97, v61, v97
    v_exp_f32 v96, -v96
    v_mfma_f32_32x32x16_bf16 v[16:31], a[152:155], a[52:55], v[16:31]
    ds_read_b64_tr_b16 a[148:149], v104 offset:33280
    ds_read_b64_tr_b16 a[150:151], v104 offset:33536
    v_exp_f32 v97, -v97
    v_add_f32 v96, 1.0, v96
    v_add_f32 v97, 1.0, v97
    v_mfma_f32_32x32x16_bf16 v[32:47], a[156:159], a[52:55], v[32:47]
    ds_read_b64_tr_b16 a[152:153], v104 offset:34816
    ds_read_b64_tr_b16 a[154:155], v104 offset:35072
    v_rcp_f32 v96, v96
    v_rcp_f32 v97, v97
    s_waitcnt lgkmcnt(6)
    v_mfma_f32_32x32x16_bf16 v[16:31], a[160:163], a[56:59], v[16:31]
    ds_read_b64_tr_b16 a[156:157], v104 offset:35328
    ds_read_b64_tr_b16 a[158:159], v104 offset:35584
    v_mul_f32 v60, v60, v96
    v_mul_f32 v61, v61, v97
    v_fma_f32 v96, v62, v62, v11
    v_fma_f32 v97, v63, v63, v11
    v_mul_f32 v96, v62, v96
    v_mfma_f32_32x32x16_bf16 v[32:47], a[164:167], a[56:59], v[32:47]
    s_waitcnt vmcnt(16)
    s_barrier
    ds_read_b64_tr_b16 a[160:161], v105 offset:0
    ds_read_b64_tr_b16 a[162:163], v105 offset:256
    buffer_load_dwordx4 v5, s[28:31], s44 offen offset:3072 lds
    v_mul_f32 v97, v63, v97
    v_exp_f32 v96, -v96
    v_exp_f32 v97, -v97
    v_mfma_f32_32x32x16_bf16 v[16:31], a[168:171], a[60:63], v[16:31]
    ds_read_b64_tr_b16 a[164:165], v105 offset:512
    ds_read_b64_tr_b16 a[166:167], v105 offset:768
    v_add_f32 v96, 1.0, v96
    v_add_f32 v97, 1.0, v97
    v_rcp_f32 v96, v96
    v_mfma_f32_32x32x16_bf16 v[32:47], a[172:175], a[60:63], v[32:47]
    ds_read_b64_tr_b16 a[168:169], v105 offset:2048
    ds_read_b64_tr_b16 a[170:171], v105 offset:2304
    v_rcp_f32 v97, v97
    v_mul_f32 v62, v62, v96
    v_mul_f32 v63, v63, v97
    s_waitcnt lgkmcnt(6)
    v_mfma_f32_32x32x16_bf16 v[16:31], a[144:147], a[64:67], v[16:31]
    ds_read_b64_tr_b16 a[172:173], v105 offset:2560
    ds_read_b64_tr_b16 a[174:175], v105 offset:2816
    v_cvt_pk_bf16_f32 v192, v48, v49
    v_cvt_pk_bf16_f32 v193, v50, v51
    v_cvt_pk_bf16_f32 v194, v52, v53
    v_cvt_pk_bf16_f32 v195, v54, v55
    v_mfma_f32_32x32x16_bf16 v[32:47], a[148:151], a[64:67], v[32:47]
    ds_read_b64_tr_b16 a[144:145], v105 offset:4096
    ds_read_b64_tr_b16 a[146:147], v105 offset:4352
    s_add_u32 m0, s43, 118784
    s_add_u32 s44, s40, 3244928
    buffer_load_dwordx4 v2, s[28:31], s44 offen offset:0 lds
    v_cvt_pk_bf16_f32 v196, v56, v57
    v_cvt_pk_bf16_f32 v197, v58, v59
    v_cvt_pk_bf16_f32 v198, v60, v61
    v_cvt_pk_bf16_f32 v199, v62, v63
    v_mfma_f32_32x32x16_bf16 v[16:31], a[152:155], a[68:71], v[16:31]
    ds_read_b64_tr_b16 a[148:149], v105 offset:4608
    ds_read_b64_tr_b16 a[150:151], v105 offset:4864
    v_fma_f32 v96, v64, v64, v11
    v_fma_f32 v97, v65, v65, v11
    v_fma_f32 v98, v66, v66, v11
    v_mul_f32 v96, v64, v96
    v_mul_f32 v97, v65, v97
    v_mfma_f32_32x32x16_bf16 v[32:47], a[156:159], a[68:71], v[32:47]
    ds_read_b64_tr_b16 a[152:153], v105 offset:6144
    ds_read_b64_tr_b16 a[154:155], v105 offset:6400
    v_mul_f32 v98, v66, v98
    v_exp_f32 v96, -v96
    v_exp_f32 v97, -v97
    s_waitcnt lgkmcnt(6)
    v_mfma_f32_32x32x16_bf16 v[16:31], a[160:163], a[72:75], v[16:31]
    ds_read_b64_tr_b16 a[156:157], v105 offset:6656
    ds_read_b64_tr_b16 a[158:159], v105 offset:6912
    v_exp_f32 v98, -v98
    v_add_f32 v96, 1.0, v96
    v_add_f32 v97, 1.0, v97
    v_mfma_f32_32x32x16_bf16 v[32:47], a[164:167], a[72:75], v[32:47]
    ds_read_b64_tr_b16 a[160:161], v105 offset:8192
    ds_read_b64_tr_b16 a[162:163], v105 offset:8448
    s_add_u32 m0, s43, 0
    s_add_u32 s44, s40, 1024
    buffer_load_dwordx4 v2, s[28:31], s44 offen offset:0 lds
    v_add_f32 v98, 1.0, v98
    v_rcp_f32 v96, v96
    v_rcp_f32 v97, v97
    v_mfma_f32_32x32x16_bf16 v[16:31], a[168:171], a[76:79], v[16:31]
    ds_read_b64_tr_b16 a[164:165], v105 offset:8704
    ds_read_b64_tr_b16 a[166:167], v105 offset:8960
    v_rcp_f32 v98, v98
    v_mul_f32 v64, v64, v96
    v_mfma_f32_32x32x16_bf16 v[32:47], a[172:175], a[76:79], v[32:47]
    ds_read_b64_tr_b16 a[168:169], v105 offset:10240
    ds_read_b64_tr_b16 a[170:171], v105 offset:10496
    v_mul_f32 v65, v65, v97
    v_mul_f32 v66, v66, v98
    v_fma_f32 v99, v67, v67, v11
    v_fma_f32 v100, v68, v68, v11
    v_fma_f32 v101, v69, v69, v11
    s_waitcnt lgkmcnt(6)
    v_mfma_f32_32x32x16_bf16 v[16:31], a[144:147], a[80:83], v[16:31]
    ds_read_b64_tr_b16 a[172:173], v105 offset:10752
    ds_read_b64_tr_b16 a[174:175], v105 offset:11008
    v_mul_f32 v99, v67, v99
    v_mul_f32 v100, v68, v100
    v_mul_f32 v101, v69, v101
    v_exp_f32 v99, -v99
    v_mfma_f32_32x32x16_bf16 v[32:47], a[148:151], a[80:83], v[32:47]
    ds_read_b64_tr_b16 a[144:145], v105 offset:12288
    ds_read_b64_tr_b16 a[146:147], v105 offset:12544
    buffer_load_dwordx4 v3, s[28:31], s44 offen offset:1024 lds
    v_exp_f32 v100, -v100
    v_exp_f32 v101, -v101
    v_mfma_f32_32x32x16_bf16 v[16:31], a[152:155], a[84:87], v[16:31]
    ds_read_b64_tr_b16 a[148:149], v105 offset:12800
    ds_read_b64_tr_b16 a[150:151], v105 offset:13056
    v_add_f32 v99, 1.0, v99
    v_add_f32 v100, 1.0, v100
    v_add_f32 v101, 1.0, v101
    v_rcp_f32 v99, v99
    v_mfma_f32_32x32x16_bf16 v[32:47], a[156:159], a[84:87], v[32:47]
    ds_read_b64_tr_b16 a[152:153], v105 offset:14336
    ds_read_b64_tr_b16 a[154:155], v105 offset:14592
    v_rcp_f32 v100, v100
    v_rcp_f32 v101, v101
    s_waitcnt lgkmcnt(6)
    v_mfma_f32_32x32x16_bf16 v[16:31], a[160:163], a[88:91], v[16:31]
    ds_read_b64_tr_b16 a[156:157], v105 offset:14848
    ds_read_b64_tr_b16 a[158:159], v105 offset:15104
    v_mul_f32 v67, v67, v99
    v_mul_f32 v68, v68, v100
    v_mul_f32 v69, v69, v101
    v_fma_f32 v96, v70, v70, v11
    v_mfma_f32_32x32x16_bf16 v[32:47], a[164:167], a[88:91], v[32:47]
    ds_read_b64_tr_b16 a[160:161], v105 offset:16384
    ds_read_b64_tr_b16 a[162:163], v105 offset:16640
    buffer_load_dwordx4 v4, s[28:31], s44 offen offset:2048 lds
    v_fma_f32 v97, v71, v71, v11
    v_fma_f32 v98, v72, v72, v11
    v_mul_f32 v96, v70, v96
    v_mul_f32 v97, v71, v97
    v_mfma_f32_32x32x16_bf16 v[16:31], a[168:171], a[92:95], v[16:31]
    ds_read_b64_tr_b16 a[164:165], v105 offset:16896
    ds_read_b64_tr_b16 a[166:167], v105 offset:17152
    v_mul_f32 v98, v72, v98
    v_exp_f32 v96, -v96
    v_exp_f32 v97, -v97
    v_mfma_f32_32x32x16_bf16 v[32:47], a[172:175], a[92:95], v[32:47]
    ds_read_b64_tr_b16 a[168:169], v105 offset:18432
    ds_read_b64_tr_b16 a[170:171], v105 offset:18688
    v_exp_f32 v98, -v98
    v_add_f32 v96, 1.0, v96
    v_add_f32 v97, 1.0, v97
    s_waitcnt lgkmcnt(6)
    v_mfma_f32_32x32x16_bf16 v[16:31], a[144:147], a[96:99], v[16:31]
    ds_read_b64_tr_b16 a[172:173], v105 offset:18944
    ds_read_b64_tr_b16 a[174:175], v105 offset:19200
    v_add_f32 v98, 1.0, v98
    v_rcp_f32 v96, v96
    v_rcp_f32 v97, v97
    v_mfma_f32_32x32x16_bf16 v[32:47], a[148:151], a[96:99], v[32:47]
    ds_read_b64_tr_b16 a[144:145], v105 offset:20480
    ds_read_b64_tr_b16 a[146:147], v105 offset:20736
    buffer_load_dwordx4 v5, s[28:31], s44 offen offset:3072 lds
    v_rcp_f32 v98, v98
    v_mul_f32 v70, v70, v96
    v_mul_f32 v71, v71, v97
    v_mfma_f32_32x32x16_bf16 v[16:31], a[152:155], a[100:103], v[16:31]
    ds_read_b64_tr_b16 a[148:149], v105 offset:20992
    ds_read_b64_tr_b16 a[150:151], v105 offset:21248
    v_mul_f32 v72, v72, v98
    v_fma_f32 v99, v73, v73, v11
    v_fma_f32 v100, v74, v74, v11
    v_fma_f32 v101, v75, v75, v11
    v_mfma_f32_32x32x16_bf16 v[32:47], a[156:159], a[100:103], v[32:47]
    ds_read_b64_tr_b16 a[152:153], v105 offset:22528
    ds_read_b64_tr_b16 a[154:155], v105 offset:22784
    v_mul_f32 v99, v73, v99
    v_mul_f32 v100, v74, v100
    v_mul_f32 v101, v75, v101
    v_exp_f32 v99, -v99
    s_waitcnt lgkmcnt(6)
    v_mfma_f32_32x32x16_bf16 v[16:31], a[160:163], a[104:107], v[16:31]
    ds_read_b64_tr_b16 a[156:157], v105 offset:23040
    ds_read_b64_tr_b16 a[158:159], v105 offset:23296
    v_exp_f32 v100, -v100
    v_exp_f32 v101, -v101
    v_mfma_f32_32x32x16_bf16 v[32:47], a[164:167], a[104:107], v[32:47]
    ds_read_b64_tr_b16 a[160:161], v105 offset:24576
    ds_read_b64_tr_b16 a[162:163], v105 offset:24832
    s_add_u32 m0, s43, 4096
    s_add_u32 s44, s40, 295936
    buffer_load_dwordx4 v2, s[28:31], s44 offen offset:0 lds
    v_add_f32 v99, 1.0, v99
    v_add_f32 v100, 1.0, v100
    v_add_f32 v101, 1.0, v101
    v_rcp_f32 v99, v99
    v_mfma_f32_32x32x16_bf16 v[16:31], a[168:171], a[108:111], v[16:31]
    ds_read_b64_tr_b16 a[164:165], v105 offset:25088
    ds_read_b64_tr_b16 a[166:167], v105 offset:25344
    v_rcp_f32 v100, v100
    v_rcp_f32 v101, v101
    v_mfma_f32_32x32x16_bf16 v[32:47], a[172:175], a[108:111], v[32:47]
    ds_read_b64_tr_b16 a[168:169], v105 offset:26624
    ds_read_b64_tr_b16 a[170:171], v105 offset:26880
    v_mul_f32 v73, v73, v99
    v_mul_f32 v74, v74, v100
    v_mul_f32 v75, v75, v101
    v_fma_f32 v96, v76, v76, v11
    s_waitcnt lgkmcnt(6)
    v_mfma_f32_32x32x16_bf16 v[16:31], a[144:147], a[112:115], v[16:31]
    ds_read_b64_tr_b16 a[172:173], v105 offset:27136
    ds_read_b64_tr_b16 a[174:175], v105 offset:27392
    v_fma_f32 v97, v77, v77, v11
    v_mul_f32 v96, v76, v96
    v_mul_f32 v97, v77, v97
    v_exp_f32 v96, -v96
    v_mfma_f32_32x32x16_bf16 v[32:47], a[148:151], a[112:115], v[32:47]
    ds_read_b64_tr_b16 a[144:145], v105 offset:28672
    ds_read_b64_tr_b16 a[146:147], v105 offset:28928
    buffer_load_dwordx4 v3, s[28:31], s44 offen offset:1024 lds
    v_exp_f32 v97, -v97
    v_add_f32 v96, 1.0, v96
    v_add_f32 v97, 1.0, v97
    v_mfma_f32_32x32x16_bf16 v[16:31], a[152:155], a[116:119], v[16:31]
    ds_read_b64_tr_b16 a[148:149], v105 offset:29184
    ds_read_b64_tr_b16 a[150:151], v105 offset:29440
    v_rcp_f32 v96, v96
    v_rcp_f32 v97, v97
    v_mfma_f32_32x32x16_bf16 v[32:47], a[156:159], a[116:119], v[32:47]
    ds_read_b64_tr_b16 a[152:153], v105 offset:30720
    ds_read_b64_tr_b16 a[154:155], v105 offset:30976
    v_mul_f32 v76, v76, v96
    v_mul_f32 v77, v77, v97
    v_fma_f32 v96, v78, v78, v11
    v_fma_f32 v97, v79, v79, v11
    v_mul_f32 v96, v78, v96
    s_waitcnt lgkmcnt(6)
    v_mfma_f32_32x32x16_bf16 v[16:31], a[160:163], a[120:123], v[16:31]
    ds_read_b64_tr_b16 a[156:157], v105 offset:31232
    ds_read_b64_tr_b16 a[158:159], v105 offset:31488
    v_mul_f32 v97, v79, v97
    v_exp_f32 v96, -v96
    v_exp_f32 v97, -v97
    v_mfma_f32_32x32x16_bf16 v[32:47], a[164:167], a[120:123], v[32:47]
    ds_read_b64_tr_b16 a[160:161], v105 offset:32768
    ds_read_b64_tr_b16 a[162:163], v105 offset:33024
    buffer_load_dwordx4 v4, s[28:31], s44 offen offset:2048 lds
    v_add_f32 v96, 1.0, v96
    v_add_f32 v97, 1.0, v97
    v_rcp_f32 v96, v96
    v_mfma_f32_32x32x16_bf16 v[16:31], a[168:171], a[124:127], v[16:31]
    ds_read_b64_tr_b16 a[164:165], v105 offset:33280
    ds_read_b64_tr_b16 a[166:167], v105 offset:33536
    v_rcp_f32 v97, v97
    v_mul_f32 v78, v78, v96
    v_mul_f32 v79, v79, v97
    v_mfma_f32_32x32x16_bf16 v[32:47], a[172:175], a[124:127], v[32:47]
    ds_read_b64_tr_b16 a[168:169], v105 offset:34816
    ds_read_b64_tr_b16 a[170:171], v105 offset:35072
    v_cvt_pk_bf16_f32 v200, v64, v65
    v_cvt_pk_bf16_f32 v201, v66, v67
    v_cvt_pk_bf16_f32 v202, v68, v69
    v_cvt_pk_bf16_f32 v203, v70, v71
    s_waitcnt lgkmcnt(6)
    v_mfma_f32_32x32x16_bf16 v[16:31], a[144:147], a[128:131], v[16:31]
    ds_read_b64_tr_b16 a[172:173], v105 offset:35328
    ds_read_b64_tr_b16 a[174:175], v105 offset:35584
    v_cvt_pk_bf16_f32 v204, v72, v73
    v_cvt_pk_bf16_f32 v205, v74, v75
    v_cvt_pk_bf16_f32 v206, v76, v77
    v_cvt_pk_bf16_f32 v207, v78, v79
    v_mfma_f32_32x32x16_bf16 v[32:47], a[148:151], a[128:131], v[32:47]
    s_waitcnt vmcnt(16)
    s_barrier
    ds_read_b64_tr_b16 a[144:145], v106 offset:0
    ds_read_b64_tr_b16 a[146:147], v106 offset:256
    buffer_load_dwordx4 v5, s[28:31], s44 offen offset:3072 lds
    v_mfma_f32_32x32x16_bf16 v[16:31], a[152:155], a[132:135], v[16:31]
    ds_read_b64_tr_b16 a[148:149], v106 offset:512
    ds_read_b64_tr_b16 a[150:151], v106 offset:768
    ds_read_b128 v[48:51], v10 offset:1792
    ds_read_b128 v[52:55], v10 offset:1824
    ds_read_b128 v[56:59], v10 offset:1856
    ds_read_b128 v[60:63], v10 offset:1888
    ds_read_b128 v[64:67], v10 offset:1920
    ds_read_b128 v[68:71], v10 offset:1952
    ds_read_b128 v[72:75], v10 offset:1984
    ds_read_b128 v[76:79], v10 offset:2016
    v_mfma_f32_32x32x16_bf16 v[32:47], a[156:159], a[132:135], v[32:47]
    ds_read_b64_tr_b16 a[152:153], v106 offset:2048
    ds_read_b64_tr_b16 a[154:155], v106 offset:2304
    s_waitcnt lgkmcnt(14)
    v_mfma_f32_32x32x16_bf16 v[16:31], a[160:163], a[136:139], v[16:31]
    ds_read_b64_tr_b16 a[156:157], v106 offset:2560
    ds_read_b64_tr_b16 a[158:159], v106 offset:2816
    v_mfma_f32_32x32x16_bf16 v[32:47], a[164:167], a[136:139], v[32:47]
    ds_read_b64_tr_b16 a[160:161], v106 offset:4096
    ds_read_b64_tr_b16 a[162:163], v106 offset:4352
    s_add_u32 m0, s43, 8192
    s_add_u32 s44, s40, 590848
    buffer_load_dwordx4 v2, s[28:31], s44 offen offset:0 lds
    v_mfma_f32_32x32x16_bf16 v[16:31], a[168:171], a[140:143], v[16:31]
    ds_read_b64_tr_b16 a[164:165], v106 offset:4608
    ds_read_b64_tr_b16 a[166:167], v106 offset:4864
    v_mfma_f32_32x32x16_bf16 v[32:47], a[172:175], a[140:143], v[32:47]
    ds_read_b64_tr_b16 a[168:169], v106 offset:6144
    ds_read_b64_tr_b16 a[170:171], v106 offset:6400
    s_waitcnt lgkmcnt(6)
    v_mfma_f32_32x32x16_bf16 v[48:63], a[144:147], a[0:3], v[48:63]
    ds_read_b64_tr_b16 a[172:173], v106 offset:6656
    ds_read_b64_tr_b16 a[174:175], v106 offset:6912
    v_mfma_f32_32x32x16_bf16 v[64:79], a[148:151], a[0:3], v[64:79]
    ds_read_b64_tr_b16 a[144:145], v106 offset:8192
    ds_read_b64_tr_b16 a[146:147], v106 offset:8448
    s_add_u32 m0, s43, 36864
    s_add_u32 s44, s40, 2655232
    buffer_load_dwordx4 v2, s[28:31], s44 offen offset:0 lds
    v_mfma_f32_32x32x16_bf16 v[48:63], a[152:155], a[4:7], v[48:63]
    ds_read_b64_tr_b16 a[148:149], v106 offset:8704
    ds_read_b64_tr_b16 a[150:151], v106 offset:8960
    v_mfma_f32_32x32x16_bf16 v[64:79], a[156:159], a[4:7], v[64:79]
    ds_read_b64_tr_b16 a[152:153], v106 offset:10240
    ds_read_b64_tr_b16 a[154:155], v106 offset:10496
    v_fma_f32 v96, v16, v16, v11
    v_fma_f32 v97, v17, v17, v11
    v_fma_f32 v98, v18, v18, v11
    v_mul_f32 v96, v16, v96
    v_mul_f32 v97, v17, v97
    s_waitcnt lgkmcnt(6)
    v_mfma_f32_32x32x16_bf16 v[48:63], a[160:163], a[8:11], v[48:63]
    ds_read_b64_tr_b16 a[156:157], v106 offset:10752
    ds_read_b64_tr_b16 a[158:159], v106 offset:11008
    v_mul_f32 v98, v18, v98
    v_exp_f32 v96, -v96
    v_exp_f32 v97, -v97
    v_mfma_f32_32x32x16_bf16 v[64:79], a[164:167], a[8:11], v[64:79]
    ds_read_b64_tr_b16 a[160:161], v106 offset:12288
    ds_read_b64_tr_b16 a[162:163], v106 offset:12544
    buffer_load_dwordx4 v3, s[28:31], s44 offen offset:1024 lds
    v_exp_f32 v98, -v98
    v_add_f32 v96, 1.0, v96
    v_add_f32 v97, 1.0, v97
    v_mfma_f32_32x32x16_bf16 v[48:63], a[168:171], a[12:15], v[48:63]
    ds_read_b64_tr_b16 a[164:165], v106 offset:12800
    ds_read_b64_tr_b16 a[166:167], v106 offset:13056
    v_add_f32 v98, 1.0, v98
    v_rcp_f32 v96, v96
    v_rcp_f32 v97, v97
    v_mfma_f32_32x32x16_bf16 v[64:79], a[172:175], a[12:15], v[64:79]
    ds_read_b64_tr_b16 a[168:169], v106 offset:14336
    ds_read_b64_tr_b16 a[170:171], v106 offset:14592
    v_rcp_f32 v98, v98
    v_mul_f32 v16, v16, v96
    s_waitcnt lgkmcnt(6)
    v_mfma_f32_32x32x16_bf16 v[48:63], a[144:147], a[16:19], v[48:63]
    ds_read_b64_tr_b16 a[172:173], v106 offset:14848
    ds_read_b64_tr_b16 a[174:175], v106 offset:15104
    v_mul_f32 v17, v17, v97
    v_mul_f32 v18, v18, v98
    v_fma_f32 v99, v19, v19, v11
    v_fma_f32 v100, v20, v20, v11
    v_fma_f32 v101, v21, v21, v11
    v_mfma_f32_32x32x16_bf16 v[64:79], a[148:151], a[16:19], v[64:79]
    ds_read_b64_tr_b16 a[144:145], v106 offset:16384
    ds_read_b64_tr_b16 a[146:147], v106 offset:16640
    buffer_load_dwordx4 v4, s[28:31], s44 offen offset:2048 lds
    v_mul_f32 v99, v19, v99
    v_mul_f32 v100, v20, v100
    v_mul_f32 v101, v21, v101
    v_exp_f32 v99, -v99
    v_mfma_f32_32x32x16_bf16 v[48:63], a[152:155], a[20:23], v[48:63]
    ds_read_b64_tr_b16 a[148:149], v106 offset:16896
    ds_read_b64_tr_b16 a[150:151], v106 offset:17152
    v_exp_f32 v100, -v100
    v_exp_f32 v101, -v101
    v_mfma_f32_32x32x16_bf16 v[64:79], a[156:159], a[20:23], v[64:79]
    ds_read_b64_tr_b16 a[152:153], v106 offset:18432
    ds_read_b64_tr_b16 a[154:155], v106 offset:18688
    v_add_f32 v99, 1.0, v99
    v_add_f32 v100, 1.0, v100
    v_add_f32 v101, 1.0, v101
    v_rcp_f32 v99, v99
    s_waitcnt lgkmcnt(6)
    v_mfma_f32_32x32x16_bf16 v[48:63], a[160:163], a[24:27], v[48:63]
    ds_read_b64_tr_b16 a[156:157], v106 offset:18944
    ds_read_b64_tr_b16 a[158:159], v106 offset:19200
    v_rcp_f32 v100, v100
    v_rcp_f32 v101, v101
    v_mfma_f32_32x32x16_bf16 v[64:79], a[164:167], a[24:27], v[64:79]
    ds_read_b64_tr_b16 a[160:161], v106 offset:20480
    ds_read_b64_tr_b16 a[162:163], v106 offset:20736
    buffer_load_dwordx4 v5, s[28:31], s44 offen offset:3072 lds
    v_mul_f32 v19, v19, v99
    v_mul_f32 v20, v20, v100
    v_mul_f32 v21, v21, v101
    v_fma_f32 v96, v22, v22, v11
    v_mfma_f32_32x32x16_bf16 v[48:63], a[168:171], a[28:31], v[48:63]
    ds_read_b64_tr_b16 a[164:165], v106 offset:20992
    ds_read_b64_tr_b16 a[166:167], v106 offset:21248
    v_fma_f32 v97, v23, v23, v11
    v_fma_f32 v98, v24, v24, v11
    v_mul_f32 v96, v22, v96
    v_mul_f32 v97, v23, v97
    v_mfma_f32_32x32x16_bf16 v[64:79], a[172:175], a[28:31], v[64:79]
    ds_read_b64_tr_b16 a[168:169], v106 offset:22528
    ds_read_b64_tr_b16 a[170:171], v106 offset:22784
    v_mul_f32 v98, v24, v98
    v_exp_f32 v96, -v96
    v_exp_f32 v97, -v97
    s_waitcnt lgkmcnt(6)
    v_mfma_f32_32x32x16_bf16 v[48:63], a[144:147], a[32:35], v[48:63]
    ds_read_b64_tr_b16 a[172:173], v106 offset:23040
    ds_read_b64_tr_b16 a[174:175], v106 offset:23296
    v_exp_f32 v98, -v98
    v_add_f32 v96, 1.0, v96
    v_add_f32 v97, 1.0, v97
    v_mfma_f32_32x32x16_bf16 v[64:79], a[148:151], a[32:35], v[64:79]
    ds_read_b64_tr_b16 a[144:145], v106 offset:24576
    ds_read_b64_tr_b16 a[146:147], v106 offset:24832
    s_add_u32 m0, s43, 40960
    s_add_u32 s44, s40, 2950144
    buffer_load_dwordx4 v2, s[28:31], s44 offen offset:0 lds
    v_add_f32 v98, 1.0, v98
    v_rcp_f32 v96, v96
    v_rcp_f32 v97, v97
    v_mfma_f32_32x32x16_bf16 v[48:63], a[152:155], a[36:39], v[48:63]
    ds_read_b64_tr_b16 a[148:149], v106 offset:25088
    ds_read_b64_tr_b16 a[150:151], v106 offset:25344
    v_rcp_f32 v98, v98
    v_mul_f32 v22, v22, v96
    v_mul_f32 v23, v23, v97
    v_mfma_f32_32x32x16_bf16 v[64:79], a[156:159], a[36:39], v[64:79]
    ds_read_b64_tr_b16 a[152:153], v106 offset:26624
    ds_read_b64_tr_b16 a[154:155], v106 offset:26880
    v_mul_f32 v24, v24, v98
    v_fma_f32 v99, v25, v25, v11
    v_fma_f32 v100, v26, v26, v11
    v_fma_f32 v101, v27, v27, v11
    s_waitcnt lgkmcnt(6)
    v_mfma_f32_32x32x16_bf16 v[48:63], a[160:163], a[40:43], v[48:63]
    ds_read_b64_tr_b16 a[156:157], v106 offset:27136
    ds_read_b64_tr_b16 a[158:159], v106 offset:27392
    v_mul_f32 v99, v25, v99
    v_mul_f32 v100, v26, v100
    v_mul_f32 v101, v27, v101
    v_exp_f32 v99, -v99
    v_mfma_f32_32x32x16_bf16 v[64:79], a[164:167], a[40:43], v[64:79]
    ds_read_b64_tr_b16 a[160:161], v106 offset:28672
    ds_read_b64_tr_b16 a[162:163], v106 offset:28928
    buffer_load_dwordx4 v3, s[28:31], s44 offen offset:1024 lds
    v_exp_f32 v100, -v100
    v_exp_f32 v101, -v101
    v_mfma_f32_32x32x16_bf16 v[48:63], a[168:171], a[44:47], v[48:63]
    ds_read_b64_tr_b16 a[164:165], v106 offset:29184
    ds_read_b64_tr_b16 a[166:167], v106 offset:29440
    v_add_f32 v99, 1.0, v99
    v_add_f32 v100, 1.0, v100
    v_add_f32 v101, 1.0, v101
    v_rcp_f32 v99, v99
    v_mfma_f32_32x32x16_bf16 v[64:79], a[172:175], a[44:47], v[64:79]
    ds_read_b64_tr_b16 a[168:169], v106 offset:30720
    ds_read_b64_tr_b16 a[170:171], v106 offset:30976
    v_rcp_f32 v100, v100
    v_rcp_f32 v101, v101
    s_waitcnt lgkmcnt(6)
    v_mfma_f32_32x32x16_bf16 v[48:63], a[144:147], a[48:51], v[48:63]
    ds_read_b64_tr_b16 a[172:173], v106 offset:31232
    ds_read_b64_tr_b16 a[174:175], v106 offset:31488
    v_mul_f32 v25, v25, v99
    v_mul_f32 v26, v26, v100
    v_mul_f32 v27, v27, v101
    v_fma_f32 v96, v28, v28, v11
    v_mfma_f32_32x32x16_bf16 v[64:79], a[148:151], a[48:51], v[64:79]
    ds_read_b64_tr_b16 a[144:145], v106 offset:32768
    ds_read_b64_tr_b16 a[146:147], v106 offset:33024
    buffer_load_dwordx4 v4, s[28:31], s44 offen offset:2048 lds
    v_fma_f32 v97, v29, v29, v11
    v_mul_f32 v96, v28, v96
    v_mul_f32 v97, v29, v97
    v_exp_f32 v96, -v96
    v_mfma_f32_32x32x16_bf16 v[48:63], a[152:155], a[52:55], v[48:63]
    ds_read_b64_tr_b16 a[148:149], v106 offset:33280
    ds_read_b64_tr_b16 a[150:151], v106 offset:33536
    v_exp_f32 v97, -v97
    v_add_f32 v96, 1.0, v96
    v_add_f32 v97, 1.0, v97
    v_mfma_f32_32x32x16_bf16 v[64:79], a[156:159], a[52:55], v[64:79]
    ds_read_b64_tr_b16 a[152:153], v106 offset:34816
    ds_read_b64_tr_b16 a[154:155], v106 offset:35072
    v_rcp_f32 v96, v96
    v_rcp_f32 v97, v97
    s_waitcnt lgkmcnt(6)
    v_mfma_f32_32x32x16_bf16 v[48:63], a[160:163], a[56:59], v[48:63]
    ds_read_b64_tr_b16 a[156:157], v106 offset:35328
    ds_read_b64_tr_b16 a[158:159], v106 offset:35584
    v_mul_f32 v28, v28, v96
    v_mul_f32 v29, v29, v97
    v_fma_f32 v96, v30, v30, v11
    v_fma_f32 v97, v31, v31, v11
    v_mul_f32 v96, v30, v96
    v_mfma_f32_32x32x16_bf16 v[64:79], a[164:167], a[56:59], v[64:79]
    s_waitcnt vmcnt(16)
    s_barrier
    ds_read_b64_tr_b16 a[160:161], v107 offset:0
    ds_read_b64_tr_b16 a[162:163], v107 offset:256
    buffer_load_dwordx4 v5, s[28:31], s44 offen offset:3072 lds
    v_mul_f32 v97, v31, v97
    v_exp_f32 v96, -v96
    v_exp_f32 v97, -v97
    v_mfma_f32_32x32x16_bf16 v[48:63], a[168:171], a[60:63], v[48:63]
    ds_read_b64_tr_b16 a[164:165], v107 offset:512
    ds_read_b64_tr_b16 a[166:167], v107 offset:768
    v_add_f32 v96, 1.0, v96
    v_add_f32 v97, 1.0, v97
    v_rcp_f32 v96, v96
    v_mfma_f32_32x32x16_bf16 v[64:79], a[172:175], a[60:63], v[64:79]
    ds_read_b64_tr_b16 a[168:169], v107 offset:2048
    ds_read_b64_tr_b16 a[170:171], v107 offset:2304
    v_rcp_f32 v97, v97
    v_mul_f32 v30, v30, v96
    v_mul_f32 v31, v31, v97
    s_waitcnt lgkmcnt(6)
    v_mfma_f32_32x32x16_bf16 v[48:63], a[144:147], a[64:67], v[48:63]
    ds_read_b64_tr_b16 a[172:173], v107 offset:2560
    ds_read_b64_tr_b16 a[174:175], v107 offset:2816
    v_cvt_pk_bf16_f32 v208, v16, v17
    v_cvt_pk_bf16_f32 v209, v18, v19
    v_cvt_pk_bf16_f32 v210, v20, v21
    v_cvt_pk_bf16_f32 v211, v22, v23
    v_mfma_f32_32x32x16_bf16 v[64:79], a[148:151], a[64:67], v[64:79]
    ds_read_b64_tr_b16 a[144:145], v107 offset:4096
    ds_read_b64_tr_b16 a[146:147], v107 offset:4352
    s_add_u32 m0, s43, 45056
    s_add_u32 s44, s40, 3245056
    buffer_load_dwordx4 v2, s[28:31], s44 offen offset:0 lds
    v_cvt_pk_bf16_f32 v212, v24, v25
    v_cvt_pk_bf16_f32 v213, v26, v27
    v_cvt_pk_bf16_f32 v214, v28, v29
    v_cvt_pk_bf16_f32 v215, v30, v31
    v_mfma_f32_32x32x16_bf16 v[48:63], a[152:155], a[68:71], v[48:63]
    ds_read_b64_tr_b16 a[148:149], v107 offset:4608
    ds_read_b64_tr_b16 a[150:151], v107 offset:4864
    v_fma_f32 v96, v32, v32, v11
    v_fma_f32 v97, v33, v33, v11
    v_fma_f32 v98, v34, v34, v11
    v_mul_f32 v96, v32, v96
    v_mul_f32 v97, v33, v97
    v_mfma_f32_32x32x16_bf16 v[64:79], a[156:159], a[68:71], v[64:79]
    ds_read_b64_tr_b16 a[152:153], v107 offset:6144
    ds_read_b64_tr_b16 a[154:155], v107 offset:6400
    v_mul_f32 v98, v34, v98
    v_exp_f32 v96, -v96
    v_exp_f32 v97, -v97
    s_waitcnt lgkmcnt(6)
    v_mfma_f32_32x32x16_bf16 v[48:63], a[160:163], a[72:75], v[48:63]
    ds_read_b64_tr_b16 a[156:157], v107 offset:6656
    ds_read_b64_tr_b16 a[158:159], v107 offset:6912
    v_exp_f32 v98, -v98
    v_add_f32 v96, 1.0, v96
    v_add_f32 v97, 1.0, v97
    v_mfma_f32_32x32x16_bf16 v[64:79], a[164:167], a[72:75], v[64:79]
    ds_read_b64_tr_b16 a[160:161], v107 offset:8192
    ds_read_b64_tr_b16 a[162:163], v107 offset:8448
    s_add_u32 m0, s43, 73728
    s_add_u32 s44, s41, 0
    buffer_load_dwordx4 v6, s[32:35], s44 offen offset:0 lds
    v_add_f32 v98, 1.0, v98
    v_rcp_f32 v96, v96
    v_rcp_f32 v97, v97
    v_mfma_f32_32x32x16_bf16 v[48:63], a[168:171], a[76:79], v[48:63]
    ds_read_b64_tr_b16 a[164:165], v107 offset:8704
    ds_read_b64_tr_b16 a[166:167], v107 offset:8960
    v_rcp_f32 v98, v98
    v_mul_f32 v32, v32, v96
    v_mfma_f32_32x32x16_bf16 v[64:79], a[172:175], a[76:79], v[64:79]
    ds_read_b64_tr_b16 a[168:169], v107 offset:10240
    ds_read_b64_tr_b16 a[170:171], v107 offset:10496
    v_mul_f32 v33, v33, v97
    v_mul_f32 v34, v34, v98
    v_fma_f32 v99, v35, v35, v11
    v_fma_f32 v100, v36, v36, v11
    v_fma_f32 v101, v37, v37, v11
    s_waitcnt lgkmcnt(6)
    v_mfma_f32_32x32x16_bf16 v[48:63], a[144:147], a[80:83], v[48:63]
    ds_read_b64_tr_b16 a[172:173], v107 offset:10752
    ds_read_b64_tr_b16 a[174:175], v107 offset:11008
    v_mul_f32 v99, v35, v99
    v_mul_f32 v100, v36, v100
    v_mul_f32 v101, v37, v101
    v_exp_f32 v99, -v99
    v_mfma_f32_32x32x16_bf16 v[64:79], a[148:151], a[80:83], v[64:79]
    ds_read_b64_tr_b16 a[144:145], v107 offset:12288
    ds_read_b64_tr_b16 a[146:147], v107 offset:12544
    buffer_load_dwordx4 v7, s[32:35], s44 offen offset:1024 lds
    v_exp_f32 v100, -v100
    v_exp_f32 v101, -v101
    v_mfma_f32_32x32x16_bf16 v[48:63], a[152:155], a[84:87], v[48:63]
    ds_read_b64_tr_b16 a[148:149], v107 offset:12800
    ds_read_b64_tr_b16 a[150:151], v107 offset:13056
    v_add_f32 v99, 1.0, v99
    v_add_f32 v100, 1.0, v100
    v_add_f32 v101, 1.0, v101
    v_rcp_f32 v99, v99
    v_mfma_f32_32x32x16_bf16 v[64:79], a[156:159], a[84:87], v[64:79]
    ds_read_b64_tr_b16 a[152:153], v107 offset:14336
    ds_read_b64_tr_b16 a[154:155], v107 offset:14592
    v_rcp_f32 v100, v100
    v_rcp_f32 v101, v101
    s_waitcnt lgkmcnt(6)
    v_mfma_f32_32x32x16_bf16 v[48:63], a[160:163], a[88:91], v[48:63]
    ds_read_b64_tr_b16 a[156:157], v107 offset:14848
    ds_read_b64_tr_b16 a[158:159], v107 offset:15104
    v_mul_f32 v35, v35, v99
    v_mul_f32 v36, v36, v100
    v_mul_f32 v37, v37, v101
    v_fma_f32 v96, v38, v38, v11
    v_mfma_f32_32x32x16_bf16 v[64:79], a[164:167], a[88:91], v[64:79]
    ds_read_b64_tr_b16 a[160:161], v107 offset:16384
    ds_read_b64_tr_b16 a[162:163], v107 offset:16640
    buffer_load_dwordx4 v8, s[32:35], s44 offen offset:2048 lds
    v_fma_f32 v97, v39, v39, v11
    v_fma_f32 v98, v40, v40, v11
    v_mul_f32 v96, v38, v96
    v_mul_f32 v97, v39, v97
    v_mfma_f32_32x32x16_bf16 v[48:63], a[168:171], a[92:95], v[48:63]
    ds_read_b64_tr_b16 a[164:165], v107 offset:16896
    ds_read_b64_tr_b16 a[166:167], v107 offset:17152
    v_mul_f32 v98, v40, v98
    v_exp_f32 v96, -v96
    v_exp_f32 v97, -v97
    v_mfma_f32_32x32x16_bf16 v[64:79], a[172:175], a[92:95], v[64:79]
    ds_read_b64_tr_b16 a[168:169], v107 offset:18432
    ds_read_b64_tr_b16 a[170:171], v107 offset:18688
    v_exp_f32 v98, -v98
    v_add_f32 v96, 1.0, v96
    v_add_f32 v97, 1.0, v97
    s_waitcnt lgkmcnt(6)
    v_mfma_f32_32x32x16_bf16 v[48:63], a[144:147], a[96:99], v[48:63]
    ds_read_b64_tr_b16 a[172:173], v107 offset:18944
    ds_read_b64_tr_b16 a[174:175], v107 offset:19200
    v_add_f32 v98, 1.0, v98
    v_rcp_f32 v96, v96
    v_rcp_f32 v97, v97
    v_mfma_f32_32x32x16_bf16 v[64:79], a[148:151], a[96:99], v[64:79]
    ds_read_b64_tr_b16 a[144:145], v107 offset:20480
    ds_read_b64_tr_b16 a[146:147], v107 offset:20736
    buffer_load_dwordx4 v9, s[32:35], s44 offen offset:3072 lds
    v_rcp_f32 v98, v98
    v_mul_f32 v38, v38, v96
    v_mul_f32 v39, v39, v97
    v_mfma_f32_32x32x16_bf16 v[48:63], a[152:155], a[100:103], v[48:63]
    ds_read_b64_tr_b16 a[148:149], v107 offset:20992
    ds_read_b64_tr_b16 a[150:151], v107 offset:21248
    v_mul_f32 v40, v40, v98
    v_fma_f32 v99, v41, v41, v11
    v_fma_f32 v100, v42, v42, v11
    v_fma_f32 v101, v43, v43, v11
    v_mfma_f32_32x32x16_bf16 v[64:79], a[156:159], a[100:103], v[64:79]
    ds_read_b64_tr_b16 a[152:153], v107 offset:22528
    ds_read_b64_tr_b16 a[154:155], v107 offset:22784
    v_mul_f32 v99, v41, v99
    v_mul_f32 v100, v42, v100
    v_mul_f32 v101, v43, v101
    v_exp_f32 v99, -v99
    s_waitcnt lgkmcnt(6)
    v_mfma_f32_32x32x16_bf16 v[48:63], a[160:163], a[104:107], v[48:63]
    ds_read_b64_tr_b16 a[156:157], v107 offset:23040
    ds_read_b64_tr_b16 a[158:159], v107 offset:23296
    v_exp_f32 v100, -v100
    v_exp_f32 v101, -v101
    v_mfma_f32_32x32x16_bf16 v[64:79], a[164:167], a[104:107], v[64:79]
    ds_read_b64_tr_b16 a[160:161], v107 offset:24576
    ds_read_b64_tr_b16 a[162:163], v107 offset:24832
    s_add_u32 m0, s43, 77824
    s_add_u32 s44, s41, 36864
    buffer_load_dwordx4 v6, s[32:35], s44 offen offset:0 lds
    v_add_f32 v99, 1.0, v99
    v_add_f32 v100, 1.0, v100
    v_add_f32 v101, 1.0, v101
    v_rcp_f32 v99, v99
    v_mfma_f32_32x32x16_bf16 v[48:63], a[168:171], a[108:111], v[48:63]
    ds_read_b64_tr_b16 a[164:165], v107 offset:25088
    ds_read_b64_tr_b16 a[166:167], v107 offset:25344
    v_rcp_f32 v100, v100
    v_rcp_f32 v101, v101
    v_mfma_f32_32x32x16_bf16 v[64:79], a[172:175], a[108:111], v[64:79]
    ds_read_b64_tr_b16 a[168:169], v107 offset:26624
    ds_read_b64_tr_b16 a[170:171], v107 offset:26880
    v_mul_f32 v41, v41, v99
    v_mul_f32 v42, v42, v100
    v_mul_f32 v43, v43, v101
    v_fma_f32 v96, v44, v44, v11
    s_waitcnt lgkmcnt(6)
    v_mfma_f32_32x32x16_bf16 v[48:63], a[144:147], a[112:115], v[48:63]
    ds_read_b64_tr_b16 a[172:173], v107 offset:27136
    ds_read_b64_tr_b16 a[174:175], v107 offset:27392
    v_fma_f32 v97, v45, v45, v11
    v_mul_f32 v96, v44, v96
    v_mul_f32 v97, v45, v97
    v_exp_f32 v96, -v96
    v_mfma_f32_32x32x16_bf16 v[64:79], a[148:151], a[112:115], v[64:79]
    ds_read_b64_tr_b16 a[144:145], v107 offset:28672
    ds_read_b64_tr_b16 a[146:147], v107 offset:28928
    buffer_load_dwordx4 v7, s[32:35], s44 offen offset:1024 lds
    v_exp_f32 v97, -v97
    v_add_f32 v96, 1.0, v96
    v_add_f32 v97, 1.0, v97
    v_mfma_f32_32x32x16_bf16 v[48:63], a[152:155], a[116:119], v[48:63]
    ds_read_b64_tr_b16 a[148:149], v107 offset:29184
    ds_read_b64_tr_b16 a[150:151], v107 offset:29440
    v_rcp_f32 v96, v96
    v_rcp_f32 v97, v97
    v_mfma_f32_32x32x16_bf16 v[64:79], a[156:159], a[116:119], v[64:79]
    ds_read_b64_tr_b16 a[152:153], v107 offset:30720
    ds_read_b64_tr_b16 a[154:155], v107 offset:30976
    v_mul_f32 v44, v44, v96
    v_mul_f32 v45, v45, v97
    v_fma_f32 v96, v46, v46, v11
    v_fma_f32 v97, v47, v47, v11
    v_mul_f32 v96, v46, v96
    s_waitcnt lgkmcnt(6)
    v_mfma_f32_32x32x16_bf16 v[48:63], a[160:163], a[120:123], v[48:63]
    ds_read_b64_tr_b16 a[156:157], v107 offset:31232
    ds_read_b64_tr_b16 a[158:159], v107 offset:31488
    v_mul_f32 v97, v47, v97
    v_exp_f32 v96, -v96
    v_exp_f32 v97, -v97
    v_mfma_f32_32x32x16_bf16 v[64:79], a[164:167], a[120:123], v[64:79]
    ds_read_b64_tr_b16 a[160:161], v107 offset:32768
    ds_read_b64_tr_b16 a[162:163], v107 offset:33024
    buffer_load_dwordx4 v8, s[32:35], s44 offen offset:2048 lds
    v_add_f32 v96, 1.0, v96
    v_add_f32 v97, 1.0, v97
    v_rcp_f32 v96, v96
    v_mfma_f32_32x32x16_bf16 v[48:63], a[168:171], a[124:127], v[48:63]
    ds_read_b64_tr_b16 a[164:165], v107 offset:33280
    ds_read_b64_tr_b16 a[166:167], v107 offset:33536
    v_rcp_f32 v97, v97
    v_mul_f32 v46, v46, v96
    v_mul_f32 v47, v47, v97
    v_mfma_f32_32x32x16_bf16 v[64:79], a[172:175], a[124:127], v[64:79]
    ds_read_b64_tr_b16 a[168:169], v107 offset:34816
    ds_read_b64_tr_b16 a[170:171], v107 offset:35072
    v_cvt_pk_bf16_f32 v216, v32, v33
    v_cvt_pk_bf16_f32 v217, v34, v35
    v_cvt_pk_bf16_f32 v218, v36, v37
    v_cvt_pk_bf16_f32 v219, v38, v39
    s_waitcnt lgkmcnt(6)
    v_mfma_f32_32x32x16_bf16 v[48:63], a[144:147], a[128:131], v[48:63]
    ds_read_b64_tr_b16 a[172:173], v107 offset:35328
    ds_read_b64_tr_b16 a[174:175], v107 offset:35584
    v_cvt_pk_bf16_f32 v220, v40, v41
    v_cvt_pk_bf16_f32 v221, v42, v43
    v_cvt_pk_bf16_f32 v222, v44, v45
    v_cvt_pk_bf16_f32 v223, v46, v47
    v_mfma_f32_32x32x16_bf16 v[64:79], a[148:151], a[128:131], v[64:79]
    s_waitcnt vmcnt(16)
    s_barrier
    ds_read_b64_tr_b16 a[144:145], v104 offset:0
    ds_read_b64_tr_b16 a[146:147], v104 offset:256
    buffer_load_dwordx4 v9, s[32:35], s44 offen offset:3072 lds
    v_mfma_f32_32x32x16_bf16 v[48:63], a[152:155], a[132:135], v[48:63]
    ds_read_b64_tr_b16 a[148:149], v104 offset:512
    ds_read_b64_tr_b16 a[150:151], v104 offset:768
    ds_read_b128 v[16:19], v10 offset:2048
    ds_read_b128 v[20:23], v10 offset:2080
    ds_read_b128 v[24:27], v10 offset:2112
    ds_read_b128 v[28:31], v10 offset:2144
    ds_read_b128 v[32:35], v10 offset:2176
    ds_read_b128 v[36:39], v10 offset:2208
    ds_read_b128 v[40:43], v10 offset:2240
    ds_read_b128 v[44:47], v10 offset:2272
    v_mfma_f32_32x32x16_bf16 v[64:79], a[156:159], a[132:135], v[64:79]
    ds_read_b64_tr_b16 a[152:153], v104 offset:2048
    ds_read_b64_tr_b16 a[154:155], v104 offset:2304
    s_waitcnt lgkmcnt(14)
    v_mfma_f32_32x32x16_bf16 v[48:63], a[160:163], a[136:139], v[48:63]
    ds_read_b64_tr_b16 a[156:157], v104 offset:2560
    ds_read_b64_tr_b16 a[158:159], v104 offset:2816
    v_mfma_f32_32x32x16_bf16 v[64:79], a[164:167], a[136:139], v[64:79]
    ds_read_b64_tr_b16 a[160:161], v104 offset:4096
    ds_read_b64_tr_b16 a[162:163], v104 offset:4352
    s_add_u32 m0, s43, 81920
    s_add_u32 s44, s41, 73728
    buffer_load_dwordx4 v6, s[32:35], s44 offen offset:0 lds
    v_mfma_f32_32x32x16_bf16 v[48:63], a[168:171], a[140:143], v[48:63]
    ds_read_b64_tr_b16 a[164:165], v104 offset:4608
    ds_read_b64_tr_b16 a[166:167], v104 offset:4864
    v_mfma_f32_32x32x16_bf16 v[64:79], a[172:175], a[140:143], v[64:79]
    ds_read_b64_tr_b16 a[168:169], v104 offset:6144
    ds_read_b64_tr_b16 a[170:171], v104 offset:6400
    s_waitcnt lgkmcnt(6)
    v_mfma_f32_32x32x16_bf16 v[16:31], a[144:147], a[0:3], v[16:31]
    ds_read_b64_tr_b16 a[172:173], v104 offset:6656
    ds_read_b64_tr_b16 a[174:175], v104 offset:6912
    v_mfma_f32_32x32x16_bf16 v[32:47], a[148:151], a[0:3], v[32:47]
    ds_read_b64_tr_b16 a[144:145], v104 offset:8192
    ds_read_b64_tr_b16 a[146:147], v104 offset:8448
    s_add_u32 m0, s43, 110592
    s_add_u32 s44, s41, 331776
    buffer_load_dwordx4 v6, s[32:35], s44 offen offset:0 lds
    v_mfma_f32_32x32x16_bf16 v[16:31], a[152:155], a[4:7], v[16:31]
    ds_read_b64_tr_b16 a[148:149], v104 offset:8704
    ds_read_b64_tr_b16 a[150:151], v104 offset:8960
    v_mfma_f32_32x32x16_bf16 v[32:47], a[156:159], a[4:7], v[32:47]
    ds_read_b64_tr_b16 a[152:153], v104 offset:10240
    ds_read_b64_tr_b16 a[154:155], v104 offset:10496
    v_fma_f32 v96, v48, v48, v11
    v_fma_f32 v97, v49, v49, v11
    v_fma_f32 v98, v50, v50, v11
    v_mul_f32 v96, v48, v96
    v_mul_f32 v97, v49, v97
    s_waitcnt lgkmcnt(6)
    v_mfma_f32_32x32x16_bf16 v[16:31], a[160:163], a[8:11], v[16:31]
    ds_read_b64_tr_b16 a[156:157], v104 offset:10752
    ds_read_b64_tr_b16 a[158:159], v104 offset:11008
    v_mul_f32 v98, v50, v98
    v_exp_f32 v96, -v96
    v_exp_f32 v97, -v97
    v_mfma_f32_32x32x16_bf16 v[32:47], a[164:167], a[8:11], v[32:47]
    ds_read_b64_tr_b16 a[160:161], v104 offset:12288
    ds_read_b64_tr_b16 a[162:163], v104 offset:12544
    buffer_load_dwordx4 v7, s[32:35], s44 offen offset:1024 lds
    v_exp_f32 v98, -v98
    v_add_f32 v96, 1.0, v96
    v_add_f32 v97, 1.0, v97
    v_mfma_f32_32x32x16_bf16 v[16:31], a[168:171], a[12:15], v[16:31]
    ds_read_b64_tr_b16 a[164:165], v104 offset:12800
    ds_read_b64_tr_b16 a[166:167], v104 offset:13056
    v_add_f32 v98, 1.0, v98
    v_rcp_f32 v96, v96
    v_rcp_f32 v97, v97
    v_mfma_f32_32x32x16_bf16 v[32:47], a[172:175], a[12:15], v[32:47]
    ds_read_b64_tr_b16 a[168:169], v104 offset:14336
    ds_read_b64_tr_b16 a[170:171], v104 offset:14592
    v_rcp_f32 v98, v98
    v_mul_f32 v48, v48, v96
    s_waitcnt lgkmcnt(6)
    v_mfma_f32_32x32x16_bf16 v[16:31], a[144:147], a[16:19], v[16:31]
    ds_read_b64_tr_b16 a[172:173], v104 offset:14848
    ds_read_b64_tr_b16 a[174:175], v104 offset:15104
    v_mul_f32 v49, v49, v97
    v_mul_f32 v50, v50, v98
    v_fma_f32 v99, v51, v51, v11
    v_fma_f32 v100, v52, v52, v11
    v_fma_f32 v101, v53, v53, v11
    v_mfma_f32_32x32x16_bf16 v[32:47], a[148:151], a[16:19], v[32:47]
    ds_read_b64_tr_b16 a[144:145], v104 offset:16384
    ds_read_b64_tr_b16 a[146:147], v104 offset:16640
    buffer_load_dwordx4 v8, s[32:35], s44 offen offset:2048 lds
    v_mul_f32 v99, v51, v99
    v_mul_f32 v100, v52, v100
    v_mul_f32 v101, v53, v101
    v_exp_f32 v99, -v99
    v_mfma_f32_32x32x16_bf16 v[16:31], a[152:155], a[20:23], v[16:31]
    ds_read_b64_tr_b16 a[148:149], v104 offset:16896
    ds_read_b64_tr_b16 a[150:151], v104 offset:17152
    v_exp_f32 v100, -v100
    v_exp_f32 v101, -v101
    v_mfma_f32_32x32x16_bf16 v[32:47], a[156:159], a[20:23], v[32:47]
    ds_read_b64_tr_b16 a[152:153], v104 offset:18432
    ds_read_b64_tr_b16 a[154:155], v104 offset:18688
    v_add_f32 v99, 1.0, v99
    v_add_f32 v100, 1.0, v100
    v_add_f32 v101, 1.0, v101
    v_rcp_f32 v99, v99
    s_waitcnt lgkmcnt(6)
    v_mfma_f32_32x32x16_bf16 v[16:31], a[160:163], a[24:27], v[16:31]
    ds_read_b64_tr_b16 a[156:157], v104 offset:18944
    ds_read_b64_tr_b16 a[158:159], v104 offset:19200
    v_rcp_f32 v100, v100
    v_rcp_f32 v101, v101
    v_mfma_f32_32x32x16_bf16 v[32:47], a[164:167], a[24:27], v[32:47]
    ds_read_b64_tr_b16 a[160:161], v104 offset:20480
    ds_read_b64_tr_b16 a[162:163], v104 offset:20736
    buffer_load_dwordx4 v9, s[32:35], s44 offen offset:3072 lds
    v_mul_f32 v51, v51, v99
    v_mul_f32 v52, v52, v100
    v_mul_f32 v53, v53, v101
    v_fma_f32 v96, v54, v54, v11
    v_mfma_f32_32x32x16_bf16 v[16:31], a[168:171], a[28:31], v[16:31]
    ds_read_b64_tr_b16 a[164:165], v104 offset:20992
    ds_read_b64_tr_b16 a[166:167], v104 offset:21248
    v_fma_f32 v97, v55, v55, v11
    v_fma_f32 v98, v56, v56, v11
    v_mul_f32 v96, v54, v96
    v_mul_f32 v97, v55, v97
    v_mfma_f32_32x32x16_bf16 v[32:47], a[172:175], a[28:31], v[32:47]
    ds_read_b64_tr_b16 a[168:169], v104 offset:22528
    ds_read_b64_tr_b16 a[170:171], v104 offset:22784
    v_mul_f32 v98, v56, v98
    v_exp_f32 v96, -v96
    v_exp_f32 v97, -v97
    s_waitcnt lgkmcnt(6)
    v_mfma_f32_32x32x16_bf16 v[16:31], a[144:147], a[32:35], v[16:31]
    ds_read_b64_tr_b16 a[172:173], v104 offset:23040
    ds_read_b64_tr_b16 a[174:175], v104 offset:23296
    v_exp_f32 v98, -v98
    v_add_f32 v96, 1.0, v96
    v_add_f32 v97, 1.0, v97
    v_mfma_f32_32x32x16_bf16 v[32:47], a[148:151], a[32:35], v[32:47]
    ds_read_b64_tr_b16 a[144:145], v104 offset:24576
    ds_read_b64_tr_b16 a[146:147], v104 offset:24832
    s_add_u32 m0, s43, 114688
    s_add_u32 s44, s41, 368640
    buffer_load_dwordx4 v6, s[32:35], s44 offen offset:0 lds
    v_add_f32 v98, 1.0, v98
    v_rcp_f32 v96, v96
    v_rcp_f32 v97, v97
    v_mfma_f32_32x32x16_bf16 v[16:31], a[152:155], a[36:39], v[16:31]
    ds_read_b64_tr_b16 a[148:149], v104 offset:25088
    ds_read_b64_tr_b16 a[150:151], v104 offset:25344
    v_rcp_f32 v98, v98
    v_mul_f32 v54, v54, v96
    v_mul_f32 v55, v55, v97
    v_mfma_f32_32x32x16_bf16 v[32:47], a[156:159], a[36:39], v[32:47]
    ds_read_b64_tr_b16 a[152:153], v104 offset:26624
    ds_read_b64_tr_b16 a[154:155], v104 offset:26880
    v_mul_f32 v56, v56, v98
    v_fma_f32 v99, v57, v57, v11
    v_fma_f32 v100, v58, v58, v11
    v_fma_f32 v101, v59, v59, v11
    s_waitcnt lgkmcnt(6)
    v_mfma_f32_32x32x16_bf16 v[16:31], a[160:163], a[40:43], v[16:31]
    ds_read_b64_tr_b16 a[156:157], v104 offset:27136
    ds_read_b64_tr_b16 a[158:159], v104 offset:27392
    v_mul_f32 v99, v57, v99
    v_mul_f32 v100, v58, v100
    v_mul_f32 v101, v59, v101
    v_exp_f32 v99, -v99
    v_mfma_f32_32x32x16_bf16 v[32:47], a[164:167], a[40:43], v[32:47]
    ds_read_b64_tr_b16 a[160:161], v104 offset:28672
    ds_read_b64_tr_b16 a[162:163], v104 offset:28928
    buffer_load_dwordx4 v7, s[32:35], s44 offen offset:1024 lds
    v_exp_f32 v100, -v100
    v_exp_f32 v101, -v101
    v_mfma_f32_32x32x16_bf16 v[16:31], a[168:171], a[44:47], v[16:31]
    ds_read_b64_tr_b16 a[164:165], v104 offset:29184
    ds_read_b64_tr_b16 a[166:167], v104 offset:29440
    v_add_f32 v99, 1.0, v99
    v_add_f32 v100, 1.0, v100
    v_add_f32 v101, 1.0, v101
    v_rcp_f32 v99, v99
    v_mfma_f32_32x32x16_bf16 v[32:47], a[172:175], a[44:47], v[32:47]
    ds_read_b64_tr_b16 a[168:169], v104 offset:30720
    ds_read_b64_tr_b16 a[170:171], v104 offset:30976
    v_rcp_f32 v100, v100
    v_rcp_f32 v101, v101
    s_waitcnt lgkmcnt(6)
    v_mfma_f32_32x32x16_bf16 v[16:31], a[144:147], a[48:51], v[16:31]
    ds_read_b64_tr_b16 a[172:173], v104 offset:31232
    ds_read_b64_tr_b16 a[174:175], v104 offset:31488
    v_mul_f32 v57, v57, v99
    v_mul_f32 v58, v58, v100
    v_mul_f32 v59, v59, v101
    v_fma_f32 v96, v60, v60, v11
    v_mfma_f32_32x32x16_bf16 v[32:47], a[148:151], a[48:51], v[32:47]
    ds_read_b64_tr_b16 a[144:145], v104 offset:32768
    ds_read_b64_tr_b16 a[146:147], v104 offset:33024
    buffer_load_dwordx4 v8, s[32:35], s44 offen offset:2048 lds
    v_fma_f32 v97, v61, v61, v11
    v_mul_f32 v96, v60, v96
    v_mul_f32 v97, v61, v97
    v_exp_f32 v96, -v96
    v_mfma_f32_32x32x16_bf16 v[16:31], a[152:155], a[52:55], v[16:31]
    ds_read_b64_tr_b16 a[148:149], v104 offset:33280
    ds_read_b64_tr_b16 a[150:151], v104 offset:33536
    v_exp_f32 v97, -v97
    v_add_f32 v96, 1.0, v96
    v_add_f32 v97, 1.0, v97
    v_mfma_f32_32x32x16_bf16 v[32:47], a[156:159], a[52:55], v[32:47]
    ds_read_b64_tr_b16 a[152:153], v104 offset:34816
    ds_read_b64_tr_b16 a[154:155], v104 offset:35072
    v_rcp_f32 v96, v96
    v_rcp_f32 v97, v97
    s_waitcnt lgkmcnt(6)
    v_mfma_f32_32x32x16_bf16 v[16:31], a[160:163], a[56:59], v[16:31]
    ds_read_b64_tr_b16 a[156:157], v104 offset:35328
    ds_read_b64_tr_b16 a[158:159], v104 offset:35584
    v_mul_f32 v60, v60, v96
    v_mul_f32 v61, v61, v97
    v_fma_f32 v96, v62, v62, v11
    v_fma_f32 v97, v63, v63, v11
    v_mul_f32 v96, v62, v96
    v_mfma_f32_32x32x16_bf16 v[32:47], a[164:167], a[56:59], v[32:47]
    s_waitcnt vmcnt(16)
    s_barrier
    ds_read_b64_tr_b16 a[160:161], v105 offset:0
    ds_read_b64_tr_b16 a[162:163], v105 offset:256
    buffer_load_dwordx4 v9, s[32:35], s44 offen offset:3072 lds
    v_mul_f32 v97, v63, v97
    v_exp_f32 v96, -v96
    v_exp_f32 v97, -v97
    v_mfma_f32_32x32x16_bf16 v[16:31], a[168:171], a[60:63], v[16:31]
    ds_read_b64_tr_b16 a[164:165], v105 offset:512
    ds_read_b64_tr_b16 a[166:167], v105 offset:768
    v_add_f32 v96, 1.0, v96
    v_add_f32 v97, 1.0, v97
    v_rcp_f32 v96, v96
    v_mfma_f32_32x32x16_bf16 v[32:47], a[172:175], a[60:63], v[32:47]
    ds_read_b64_tr_b16 a[168:169], v105 offset:2048
    ds_read_b64_tr_b16 a[170:171], v105 offset:2304
    v_rcp_f32 v97, v97
    v_mul_f32 v62, v62, v96
    v_mul_f32 v63, v63, v97
    s_waitcnt lgkmcnt(6)
    v_mfma_f32_32x32x16_bf16 v[16:31], a[144:147], a[64:67], v[16:31]
    ds_read_b64_tr_b16 a[172:173], v105 offset:2560
    ds_read_b64_tr_b16 a[174:175], v105 offset:2816
    v_cvt_pk_bf16_f32 v224, v48, v49
    v_cvt_pk_bf16_f32 v225, v50, v51
    v_cvt_pk_bf16_f32 v226, v52, v53
    v_cvt_pk_bf16_f32 v227, v54, v55
    v_mfma_f32_32x32x16_bf16 v[32:47], a[148:151], a[64:67], v[32:47]
    ds_read_b64_tr_b16 a[144:145], v105 offset:4096
    ds_read_b64_tr_b16 a[146:147], v105 offset:4352
    s_add_u32 m0, s43, 118784
    s_add_u32 s44, s41, 405504
    buffer_load_dwordx4 v6, s[32:35], s44 offen offset:0 lds
    v_cvt_pk_bf16_f32 v228, v56, v57
    v_cvt_pk_bf16_f32 v229, v58, v59
    v_cvt_pk_bf16_f32 v230, v60, v61
    v_cvt_pk_bf16_f32 v231, v62, v63
    v_mfma_f32_32x32x16_bf16 v[16:31], a[152:155], a[68:71], v[16:31]
    ds_read_b64_tr_b16 a[148:149], v105 offset:4608
    ds_read_b64_tr_b16 a[150:151], v105 offset:4864
    v_fma_f32 v96, v64, v64, v11
    v_fma_f32 v97, v65, v65, v11
    v_fma_f32 v98, v66, v66, v11
    v_mul_f32 v96, v64, v96
    v_mul_f32 v97, v65, v97
    v_mfma_f32_32x32x16_bf16 v[32:47], a[156:159], a[68:71], v[32:47]
    ds_read_b64_tr_b16 a[152:153], v105 offset:6144
    ds_read_b64_tr_b16 a[154:155], v105 offset:6400
    v_mul_f32 v98, v66, v98
    v_exp_f32 v96, -v96
    v_exp_f32 v97, -v97
    s_waitcnt lgkmcnt(6)
    v_mfma_f32_32x32x16_bf16 v[16:31], a[160:163], a[72:75], v[16:31]
    ds_read_b64_tr_b16 a[156:157], v105 offset:6656
    ds_read_b64_tr_b16 a[158:159], v105 offset:6912
    v_exp_f32 v98, -v98
    v_add_f32 v96, 1.0, v96
    v_add_f32 v97, 1.0, v97
    v_mfma_f32_32x32x16_bf16 v[32:47], a[164:167], a[72:75], v[32:47]
    ds_read_b64_tr_b16 a[160:161], v105 offset:8192
    ds_read_b64_tr_b16 a[162:163], v105 offset:8448
    s_add_u32 m0, s43, 0
    s_add_u32 s44, s41, 128
    buffer_load_dwordx4 v6, s[32:35], s44 offen offset:0 lds
    v_add_f32 v98, 1.0, v98
    v_rcp_f32 v96, v96
    v_rcp_f32 v97, v97
    v_mfma_f32_32x32x16_bf16 v[16:31], a[168:171], a[76:79], v[16:31]
    ds_read_b64_tr_b16 a[164:165], v105 offset:8704
    ds_read_b64_tr_b16 a[166:167], v105 offset:8960
    v_rcp_f32 v98, v98
    v_mul_f32 v64, v64, v96
    v_mfma_f32_32x32x16_bf16 v[32:47], a[172:175], a[76:79], v[32:47]
    ds_read_b64_tr_b16 a[168:169], v105 offset:10240
    ds_read_b64_tr_b16 a[170:171], v105 offset:10496
    v_mul_f32 v65, v65, v97
    v_mul_f32 v66, v66, v98
    v_fma_f32 v99, v67, v67, v11
    v_fma_f32 v100, v68, v68, v11
    v_fma_f32 v101, v69, v69, v11
    s_waitcnt lgkmcnt(6)
    v_mfma_f32_32x32x16_bf16 v[16:31], a[144:147], a[80:83], v[16:31]
    ds_read_b64_tr_b16 a[172:173], v105 offset:10752
    ds_read_b64_tr_b16 a[174:175], v105 offset:11008
    v_mul_f32 v99, v67, v99
    v_mul_f32 v100, v68, v100
    v_mul_f32 v101, v69, v101
    v_exp_f32 v99, -v99
    v_mfma_f32_32x32x16_bf16 v[32:47], a[148:151], a[80:83], v[32:47]
    ds_read_b64_tr_b16 a[144:145], v105 offset:12288
    ds_read_b64_tr_b16 a[146:147], v105 offset:12544
    buffer_load_dwordx4 v7, s[32:35], s44 offen offset:1024 lds
    v_exp_f32 v100, -v100
    v_exp_f32 v101, -v101
    v_mfma_f32_32x32x16_bf16 v[16:31], a[152:155], a[84:87], v[16:31]
    ds_read_b64_tr_b16 a[148:149], v105 offset:12800
    ds_read_b64_tr_b16 a[150:151], v105 offset:13056
    v_add_f32 v99, 1.0, v99
    v_add_f32 v100, 1.0, v100
    v_add_f32 v101, 1.0, v101
    v_rcp_f32 v99, v99
    v_mfma_f32_32x32x16_bf16 v[32:47], a[156:159], a[84:87], v[32:47]
    ds_read_b64_tr_b16 a[152:153], v105 offset:14336
    ds_read_b64_tr_b16 a[154:155], v105 offset:14592
    v_rcp_f32 v100, v100
    v_rcp_f32 v101, v101
    s_waitcnt lgkmcnt(6)
    v_mfma_f32_32x32x16_bf16 v[16:31], a[160:163], a[88:91], v[16:31]
    ds_read_b64_tr_b16 a[156:157], v105 offset:14848
    ds_read_b64_tr_b16 a[158:159], v105 offset:15104
    v_mul_f32 v67, v67, v99
    v_mul_f32 v68, v68, v100
    v_mul_f32 v69, v69, v101
    v_fma_f32 v96, v70, v70, v11
    v_mfma_f32_32x32x16_bf16 v[32:47], a[164:167], a[88:91], v[32:47]
    ds_read_b64_tr_b16 a[160:161], v105 offset:16384
    ds_read_b64_tr_b16 a[162:163], v105 offset:16640
    buffer_load_dwordx4 v8, s[32:35], s44 offen offset:2048 lds
    v_fma_f32 v97, v71, v71, v11
    v_fma_f32 v98, v72, v72, v11
    v_mul_f32 v96, v70, v96
    v_mul_f32 v97, v71, v97
    v_mfma_f32_32x32x16_bf16 v[16:31], a[168:171], a[92:95], v[16:31]
    ds_read_b64_tr_b16 a[164:165], v105 offset:16896
    ds_read_b64_tr_b16 a[166:167], v105 offset:17152
    v_mul_f32 v98, v72, v98
    v_exp_f32 v96, -v96
    v_exp_f32 v97, -v97
    v_mfma_f32_32x32x16_bf16 v[32:47], a[172:175], a[92:95], v[32:47]
    ds_read_b64_tr_b16 a[168:169], v105 offset:18432
    ds_read_b64_tr_b16 a[170:171], v105 offset:18688
    v_exp_f32 v98, -v98
    v_add_f32 v96, 1.0, v96
    v_add_f32 v97, 1.0, v97
    s_waitcnt lgkmcnt(6)
    v_mfma_f32_32x32x16_bf16 v[16:31], a[144:147], a[96:99], v[16:31]
    ds_read_b64_tr_b16 a[172:173], v105 offset:18944
    ds_read_b64_tr_b16 a[174:175], v105 offset:19200
    v_add_f32 v98, 1.0, v98
    v_rcp_f32 v96, v96
    v_rcp_f32 v97, v97
    v_mfma_f32_32x32x16_bf16 v[32:47], a[148:151], a[96:99], v[32:47]
    ds_read_b64_tr_b16 a[144:145], v105 offset:20480
    ds_read_b64_tr_b16 a[146:147], v105 offset:20736
    buffer_load_dwordx4 v9, s[32:35], s44 offen offset:3072 lds
    v_rcp_f32 v98, v98
    v_mul_f32 v70, v70, v96
    v_mul_f32 v71, v71, v97
    v_mfma_f32_32x32x16_bf16 v[16:31], a[152:155], a[100:103], v[16:31]
    ds_read_b64_tr_b16 a[148:149], v105 offset:20992
    ds_read_b64_tr_b16 a[150:151], v105 offset:21248
    v_mul_f32 v72, v72, v98
    v_fma_f32 v99, v73, v73, v11
    v_fma_f32 v100, v74, v74, v11
    v_fma_f32 v101, v75, v75, v11
    v_mfma_f32_32x32x16_bf16 v[32:47], a[156:159], a[100:103], v[32:47]
    ds_read_b64_tr_b16 a[152:153], v105 offset:22528
    ds_read_b64_tr_b16 a[154:155], v105 offset:22784
    v_mul_f32 v99, v73, v99
    v_mul_f32 v100, v74, v100
    v_mul_f32 v101, v75, v101
    v_exp_f32 v99, -v99
    s_waitcnt lgkmcnt(6)
    v_mfma_f32_32x32x16_bf16 v[16:31], a[160:163], a[104:107], v[16:31]
    ds_read_b64_tr_b16 a[156:157], v105 offset:23040
    ds_read_b64_tr_b16 a[158:159], v105 offset:23296
    v_exp_f32 v100, -v100
    v_exp_f32 v101, -v101
    v_mfma_f32_32x32x16_bf16 v[32:47], a[164:167], a[104:107], v[32:47]
    ds_read_b64_tr_b16 a[160:161], v105 offset:24576
    ds_read_b64_tr_b16 a[162:163], v105 offset:24832
    s_add_u32 m0, s43, 4096
    s_add_u32 s44, s41, 36992
    buffer_load_dwordx4 v6, s[32:35], s44 offen offset:0 lds
    v_add_f32 v99, 1.0, v99
    v_add_f32 v100, 1.0, v100
    v_add_f32 v101, 1.0, v101
    v_rcp_f32 v99, v99
    v_mfma_f32_32x32x16_bf16 v[16:31], a[168:171], a[108:111], v[16:31]
    ds_read_b64_tr_b16 a[164:165], v105 offset:25088
    ds_read_b64_tr_b16 a[166:167], v105 offset:25344
    v_rcp_f32 v100, v100
    v_rcp_f32 v101, v101
    v_mfma_f32_32x32x16_bf16 v[32:47], a[172:175], a[108:111], v[32:47]
    ds_read_b64_tr_b16 a[168:169], v105 offset:26624
    ds_read_b64_tr_b16 a[170:171], v105 offset:26880
    v_mul_f32 v73, v73, v99
    v_mul_f32 v74, v74, v100
    v_mul_f32 v75, v75, v101
    v_fma_f32 v96, v76, v76, v11
    s_waitcnt lgkmcnt(6)
    v_mfma_f32_32x32x16_bf16 v[16:31], a[144:147], a[112:115], v[16:31]
    ds_read_b64_tr_b16 a[172:173], v105 offset:27136
    ds_read_b64_tr_b16 a[174:175], v105 offset:27392
    v_fma_f32 v97, v77, v77, v11
    v_mul_f32 v96, v76, v96
    v_mul_f32 v97, v77, v97
    v_exp_f32 v96, -v96
    v_mfma_f32_32x32x16_bf16 v[32:47], a[148:151], a[112:115], v[32:47]
    ds_read_b64_tr_b16 a[144:145], v105 offset:28672
    ds_read_b64_tr_b16 a[146:147], v105 offset:28928
    buffer_load_dwordx4 v7, s[32:35], s44 offen offset:1024 lds
    v_exp_f32 v97, -v97
    v_add_f32 v96, 1.0, v96
    v_add_f32 v97, 1.0, v97
    v_mfma_f32_32x32x16_bf16 v[16:31], a[152:155], a[116:119], v[16:31]
    ds_read_b64_tr_b16 a[148:149], v105 offset:29184
    ds_read_b64_tr_b16 a[150:151], v105 offset:29440
    v_rcp_f32 v96, v96
    v_rcp_f32 v97, v97
    v_mfma_f32_32x32x16_bf16 v[32:47], a[156:159], a[116:119], v[32:47]
    ds_read_b64_tr_b16 a[152:153], v105 offset:30720
    ds_read_b64_tr_b16 a[154:155], v105 offset:30976
    v_mul_f32 v76, v76, v96
    v_mul_f32 v77, v77, v97
    v_fma_f32 v96, v78, v78, v11
    v_fma_f32 v97, v79, v79, v11
    v_mul_f32 v96, v78, v96
    s_waitcnt lgkmcnt(6)
    v_mfma_f32_32x32x16_bf16 v[16:31], a[160:163], a[120:123], v[16:31]
    ds_read_b64_tr_b16 a[156:157], v105 offset:31232
    ds_read_b64_tr_b16 a[158:159], v105 offset:31488
    v_mul_f32 v97, v79, v97
    v_exp_f32 v96, -v96
    v_exp_f32 v97, -v97
    v_mfma_f32_32x32x16_bf16 v[32:47], a[164:167], a[120:123], v[32:47]
    ds_read_b64_tr_b16 a[160:161], v105 offset:32768
    ds_read_b64_tr_b16 a[162:163], v105 offset:33024
    buffer_load_dwordx4 v8, s[32:35], s44 offen offset:2048 lds
    v_add_f32 v96, 1.0, v96
    v_add_f32 v97, 1.0, v97
    v_rcp_f32 v96, v96
    v_mfma_f32_32x32x16_bf16 v[16:31], a[168:171], a[124:127], v[16:31]
    ds_read_b64_tr_b16 a[164:165], v105 offset:33280
    ds_read_b64_tr_b16 a[166:167], v105 offset:33536
    v_rcp_f32 v97, v97
    v_mul_f32 v78, v78, v96
    v_mul_f32 v79, v79, v97
    v_mfma_f32_32x32x16_bf16 v[32:47], a[172:175], a[124:127], v[32:47]
    ds_read_b64_tr_b16 a[168:169], v105 offset:34816
    ds_read_b64_tr_b16 a[170:171], v105 offset:35072
    v_cvt_pk_bf16_f32 v232, v64, v65
    v_cvt_pk_bf16_f32 v233, v66, v67
    v_cvt_pk_bf16_f32 v234, v68, v69
    v_cvt_pk_bf16_f32 v235, v70, v71
    s_waitcnt lgkmcnt(6)
    v_mfma_f32_32x32x16_bf16 v[16:31], a[144:147], a[128:131], v[16:31]
    ds_read_b64_tr_b16 a[172:173], v105 offset:35328
    ds_read_b64_tr_b16 a[174:175], v105 offset:35584
    v_cvt_pk_bf16_f32 v236, v72, v73
    v_cvt_pk_bf16_f32 v237, v74, v75
    v_cvt_pk_bf16_f32 v238, v76, v77
    v_cvt_pk_bf16_f32 v239, v78, v79
    v_mfma_f32_32x32x16_bf16 v[32:47], a[148:151], a[128:131], v[32:47]
    s_waitcnt vmcnt(16)
    s_barrier
    ds_read_b64_tr_b16 a[144:145], v110 offset:0
    ds_read_b64_tr_b16 a[146:147], v110 offset:1024
    buffer_load_dwordx4 v9, s[32:35], s44 offen offset:3072 lds
    v_mfma_f32_32x32x16_bf16 v[16:31], a[152:155], a[132:135], v[16:31]
    ds_read_b64_tr_b16 a[148:149], v110 offset:512
    ds_read_b64_tr_b16 a[150:151], v110 offset:1536
    v_mfma_f32_32x32x16_bf16 v[32:47], a[156:159], a[132:135], v[32:47]
    ds_read_b64_tr_b16 a[152:153], v110 offset:2048
    ds_read_b64_tr_b16 a[154:155], v110 offset:3072
    s_waitcnt lgkmcnt(6)
    v_mfma_f32_32x32x16_bf16 v[16:31], a[160:163], a[136:139], v[16:31]
    ds_read_b64_tr_b16 a[156:157], v110 offset:2560
    ds_read_b64_tr_b16 a[158:159], v110 offset:3584
    v_mfma_f32_32x32x16_bf16 v[32:47], a[164:167], a[136:139], v[32:47]
    ds_read_b64_tr_b16 a[160:161], v110 offset:4096
    ds_read_b64_tr_b16 a[162:163], v110 offset:5120
    s_add_u32 m0, s43, 8192
    s_add_u32 s44, s41, 73856
    buffer_load_dwordx4 v6, s[32:35], s44 offen offset:0 lds
    v_mfma_f32_32x32x16_bf16 v[16:31], a[168:171], a[140:143], v[16:31]
    ds_read_b64_tr_b16 a[164:165], v110 offset:4608
    ds_read_b64_tr_b16 a[166:167], v110 offset:5632
    v_mfma_f32_32x32x16_bf16 v[32:47], a[172:175], a[140:143], v[32:47]
    ds_read_b64_tr_b16 a[168:169], v110 offset:6144
    ds_read_b64_tr_b16 a[170:171], v110 offset:7168
    s_waitcnt lgkmcnt(6)
    s_lshl_b32 s52, s3, 6
    s_add_u32 s52, s52, s6
    s_mul_i32 s52, s52, 36864
    s_add_u32 s52, s52, 7254016
    s_lshl_b32 s57, s4, 7
    s_add_u32 s57, s57, 29360128
    s_lshl_b32 s99, s3, 2
    s_add_u32 s99, s99, s57
    s_lshl_b32 s8, s2, 2
    s_add_u32 s8, s8, s5
    s_lshl_b32 s8, s8, 7
    s_add_u32 s8, s8, 26128384
    s_cmp_eq_u32 s5, 0
    s_cselect_b32 s99, s99, s8
    s_lshl_b32 s97, s98, 4
    s_mov_b32 s46, -1
    s_mov_b32 s48, -3
    s_lshr_b32 s8, s3, 1
    s_lshl_b32 s9, s4, 2
    s_add_u32 s8, s8, s9
    s_mul_i32 s8, s8, 18
    s_and_b32 s9, s3, 1
    s_add_u32 s8, s8, s9
    s_lshl_b32 s45, s8, 11
    s_and_b32 s9, s5, 1
    s_lshl_b32 s9, s9, 10
    s_add_u32 s45, s45, s9
    s_lshr_b32 s9, s5, 1
    s_lshl_b32 s9, s9, 9
    s_add_u32 s45, s45, s9
    s_add_u32 s45, s45, 7254016
    s_add_u32 s47, s45, 18907136
    s_mov_b32 s64, 0x3f80
    s_mov_b32 s65, 0x3f800000
    v_lshlrev_b32 v0, 2, v1
    v_lshlrev_b32 v1, 3, v1
    v_mov_b32 v15, 0
    v_mfma_f32_32x32x16_bf16 v[48:63], a[144:147], v[112:115], 0
    ds_read_b64_tr_b16 a[172:173], v110 offset:6656
    ds_read_b64_tr_b16 a[174:175], v110 offset:7680
    v_mfma_f32_32x32x16_bf16 v[64:79], a[148:151], v[112:115], 0
    ds_read_b64_tr_b16 a[144:145], v110 offset:8192
    ds_read_b64_tr_b16 a[146:147], v110 offset:9216
    s_add_u32 m0, s43, 36864
    s_add_u32 s44, s41, 331904
    buffer_load_dwordx4 v6, s[32:35], s44 offen offset:0 lds
    v_mfma_f32_32x32x16_bf16 v[48:63], a[152:155], v[116:119], v[48:63]
    ds_read_b64_tr_b16 a[148:149], v110 offset:8704
    ds_read_b64_tr_b16 a[150:151], v110 offset:9728
    v_mfma_f32_32x32x16_bf16 v[64:79], a[156:159], v[116:119], v[64:79]
    ds_read_b64_tr_b16 a[152:153], v110 offset:10240
    ds_read_b64_tr_b16 a[154:155], v110 offset:11264
    v_fma_f32 v96, v16, v16, v11
    v_fma_f32 v97, v17, v17, v11
    v_fma_f32 v98, v18, v18, v11
    v_mul_f32 v96, v16, v96
    v_mul_f32 v97, v17, v97
    s_waitcnt lgkmcnt(6)
    v_mfma_f32_32x32x16_bf16 v[48:63], a[160:163], v[120:123], v[48:63]
    ds_read_b64_tr_b16 a[156:157], v110 offset:10752
    ds_read_b64_tr_b16 a[158:159], v110 offset:11776
    v_mul_f32 v98, v18, v98
    v_exp_f32 v96, -v96
    v_exp_f32 v97, -v97
    v_mfma_f32_32x32x16_bf16 v[64:79], a[164:167], v[120:123], v[64:79]
    ds_read_b64_tr_b16 a[160:161], v110 offset:12288
    ds_read_b64_tr_b16 a[162:163], v110 offset:13312
    buffer_load_dwordx4 v7, s[32:35], s44 offen offset:1024 lds
    v_exp_f32 v98, -v98
    v_add_f32 v96, 1.0, v96
    v_add_f32 v97, 1.0, v97
    v_add_f32 v98, 1.0, v98
    v_mfma_f32_32x32x16_bf16 v[48:63], a[168:171], v[124:127], v[48:63]
    ds_read_b64_tr_b16 a[164:165], v110 offset:12800
    ds_read_b64_tr_b16 a[166:167], v110 offset:13824
    v_rcp_f32 v96, v96
    v_rcp_f32 v97, v97
    v_rcp_f32 v98, v98
    v_mfma_f32_32x32x16_bf16 v[64:79], a[172:175], v[124:127], v[64:79]
    ds_read_b64_tr_b16 a[168:169], v110 offset:14336
    ds_read_b64_tr_b16 a[170:171], v110 offset:15360
    v_mul_f32 v16, v16, v96
    v_mul_f32 v17, v17, v97
    v_mul_f32 v18, v18, v98
    v_fma_f32 v99, v19, v19, v11
    s_waitcnt lgkmcnt(6)
    v_mfma_f32_32x32x16_bf16 v[48:63], a[144:147], v[128:131], v[48:63]
    ds_read_b64_tr_b16 a[172:173], v110 offset:14848
    ds_read_b64_tr_b16 a[174:175], v110 offset:15872
    v_fma_f32 v100, v20, v20, v11
    v_fma_f32 v101, v21, v21, v11
    v_mul_f32 v99, v19, v99
    v_mul_f32 v100, v20, v100
    v_mul_f32 v101, v21, v101
    v_mfma_f32_32x32x16_bf16 v[64:79], a[148:151], v[128:131], v[64:79]
    ds_read_b64_tr_b16 a[144:145], v110 offset:16384
    ds_read_b64_tr_b16 a[146:147], v110 offset:17408
    buffer_load_dwordx4 v8, s[32:35], s44 offen offset:2048 lds
    v_exp_f32 v99, -v99
    v_exp_f32 v100, -v100
    v_mfma_f32_32x32x16_bf16 v[48:63], a[152:155], v[132:135], v[48:63]
    ds_read_b64_tr_b16 a[148:149], v110 offset:16896
    ds_read_b64_tr_b16 a[150:151], v110 offset:17920
    v_exp_f32 v101, -v101
    v_add_f32 v99, 1.0, v99
    v_add_f32 v100, 1.0, v100
    v_add_f32 v101, 1.0, v101
    v_mfma_f32_32x32x16_bf16 v[64:79], a[156:159], v[132:135], v[64:79]
    ds_read_b64_tr_b16 a[152:153], v110 offset:18432
    ds_read_b64_tr_b16 a[154:155], v110 offset:19456
    v_rcp_f32 v99, v99
    v_rcp_f32 v100, v100
    v_rcp_f32 v101, v101
    s_waitcnt lgkmcnt(6)
    v_mfma_f32_32x32x16_bf16 v[48:63], a[160:163], v[136:139], v[48:63]
    ds_read_b64_tr_b16 a[156:157], v110 offset:18944
    ds_read_b64_tr_b16 a[158:159], v110 offset:19968
    v_mul_f32 v19, v19, v99
    v_mul_f32 v20, v20, v100
    v_mul_f32 v21, v21, v101
    v_fma_f32 v96, v22, v22, v11
    v_mfma_f32_32x32x16_bf16 v[64:79], a[164:167], v[136:139], v[64:79]
    ds_read_b64_tr_b16 a[160:161], v110 offset:20480
    ds_read_b64_tr_b16 a[162:163], v110 offset:21504
    buffer_load_dwordx4 v9, s[32:35], s44 offen offset:3072 lds
    v_fma_f32 v97, v23, v23, v11
    v_fma_f32 v98, v24, v24, v11
    v_mul_f32 v96, v22, v96
    v_mul_f32 v97, v23, v97
    v_mul_f32 v98, v24, v98
    v_mfma_f32_32x32x16_bf16 v[48:63], a[168:171], v[140:143], v[48:63]
    ds_read_b64_tr_b16 a[164:165], v110 offset:20992
    ds_read_b64_tr_b16 a[166:167], v110 offset:22016
    v_exp_f32 v96, -v96
    v_exp_f32 v97, -v97
    v_exp_f32 v98, -v98
    v_mfma_f32_32x32x16_bf16 v[64:79], a[172:175], v[140:143], v[64:79]
    ds_read_b64_tr_b16 a[168:169], v110 offset:22528
    ds_read_b64_tr_b16 a[170:171], v110 offset:23552
    v_add_f32 v96, 1.0, v96
    v_add_f32 v97, 1.0, v97
    v_add_f32 v98, 1.0, v98
    v_rcp_f32 v96, v96
    s_waitcnt lgkmcnt(6)
    v_mfma_f32_32x32x16_bf16 v[48:63], a[144:147], v[144:147], v[48:63]
    ds_read_b64_tr_b16 a[172:173], v110 offset:23040
    ds_read_b64_tr_b16 a[174:175], v110 offset:24064
    v_rcp_f32 v97, v97
    v_rcp_f32 v98, v98
    v_mfma_f32_32x32x16_bf16 v[64:79], a[148:151], v[144:147], v[64:79]
    ds_read_b64_tr_b16 a[144:145], v110 offset:24576
    ds_read_b64_tr_b16 a[146:147], v110 offset:25600
    s_add_u32 m0, s43, 40960
    s_add_u32 s44, s41, 368768
    buffer_load_dwordx4 v6, s[32:35], s44 offen offset:0 lds
    v_mul_f32 v22, v22, v96
    v_mul_f32 v23, v23, v97
    v_mul_f32 v24, v24, v98
    v_fma_f32 v99, v25, v25, v11
    v_mfma_f32_32x32x16_bf16 v[48:63], a[152:155], v[148:151], v[48:63]
    ds_read_b64_tr_b16 a[148:149], v110 offset:25088
    ds_read_b64_tr_b16 a[150:151], v110 offset:26112
    v_fma_f32 v100, v26, v26, v11
    v_fma_f32 v101, v27, v27, v11
    v_mul_f32 v99, v25, v99
    v_mul_f32 v100, v26, v100
    v_mul_f32 v101, v27, v101
    v_mfma_f32_32x32x16_bf16 v[64:79], a[156:159], v[148:151], v[64:79]
    ds_read_b64_tr_b16 a[152:153], v110 offset:26624
    ds_read_b64_tr_b16 a[154:155], v110 offset:27648
    v_exp_f32 v99, -v99
    v_exp_f32 v100, -v100
    v_exp_f32 v101, -v101
    s_waitcnt lgkmcnt(6)
    v_mfma_f32_32x32x16_bf16 v[48:63], a[160:163], v[152:155], v[48:63]
    ds_read_b64_tr_b16 a[156:157], v110 offset:27136
    ds_read_b64_tr_b16 a[158:159], v110 offset:28160
    v_add_f32 v99, 1.0, v99
    v_add_f32 v100, 1.0, v100
    v_add_f32 v101, 1.0, v101
    v_rcp_f32 v99, v99
    v_mfma_f32_32x32x16_bf16 v[64:79], a[164:167], v[152:155], v[64:79]
    ds_read_b64_tr_b16 a[160:161], v110 offset:28672
    ds_read_b64_tr_b16 a[162:163], v110 offset:29696
    buffer_load_dwordx4 v7, s[32:35], s44 offen offset:1024 lds
    v_rcp_f32 v100, v100
    v_rcp_f32 v101, v101
    v_mfma_f32_32x32x16_bf16 v[48:63], a[168:171], v[156:159], v[48:63]
    ds_read_b64_tr_b16 a[164:165], v110 offset:29184
    ds_read_b64_tr_b16 a[166:167], v110 offset:30208
    v_mul_f32 v25, v25, v99
    v_mul_f32 v26, v26, v100
    v_mul_f32 v27, v27, v101
    v_fma_f32 v96, v28, v28, v11
    v_fma_f32 v97, v29, v29, v11
    v_mfma_f32_32x32x16_bf16 v[64:79], a[172:175], v[156:159], v[64:79]
    ds_read_b64_tr_b16 a[168:169], v110 offset:30720
    ds_read_b64_tr_b16 a[170:171], v110 offset:31744
    v_mul_f32 v96, v28, v96
    v_mul_f32 v97, v29, v97
    v_exp_f32 v96, -v96
    s_waitcnt lgkmcnt(6)
    v_mfma_f32_32x32x16_bf16 v[48:63], a[144:147], v[160:163], v[48:63]
    ds_read_b64_tr_b16 a[172:173], v110 offset:31232
    ds_read_b64_tr_b16 a[174:175], v110 offset:32256
    v_exp_f32 v97, -v97
    v_add_f32 v96, 1.0, v96
    v_add_f32 v97, 1.0, v97
    v_rcp_f32 v96, v96
    v_mfma_f32_32x32x16_bf16 v[64:79], a[148:151], v[160:163], v[64:79]
    ds_read_b64_tr_b16 a[144:145], v110 offset:32768
    ds_read_b64_tr_b16 a[146:147], v110 offset:33792
    buffer_load_dwordx4 v8, s[32:35], s44 offen offset:2048 lds
    v_rcp_f32 v97, v97
    v_mul_f32 v28, v28, v96
    v_mul_f32 v29, v29, v97
    v_mfma_f32_32x32x16_bf16 v[48:63], a[152:155], v[164:167], v[48:63]
    ds_read_b64_tr_b16 a[148:149], v110 offset:33280
    ds_read_b64_tr_b16 a[150:151], v110 offset:34304
    v_fma_f32 v96, v30, v30, v11
    v_fma_f32 v97, v31, v31, v11
    v_mul_f32 v96, v30, v96
    v_mul_f32 v97, v31, v97
    v_exp_f32 v96, -v96
    v_mfma_f32_32x32x16_bf16 v[64:79], a[156:159], v[164:167], v[64:79]
    ds_read_b64_tr_b16 a[152:153], v110 offset:34816
    ds_read_b64_tr_b16 a[154:155], v110 offset:35840
    v_exp_f32 v97, -v97
    v_add_f32 v96, 1.0, v96
    v_add_f32 v97, 1.0, v97
    s_waitcnt lgkmcnt(6)
    v_mfma_f32_32x32x16_bf16 v[48:63], a[160:163], v[168:171], v[48:63]
    ds_read_b64_tr_b16 a[156:157], v110 offset:35328
    ds_read_b64_tr_b16 a[158:159], v110 offset:36352
    v_rcp_f32 v96, v96
    v_rcp_f32 v97, v97
    v_mul_f32 v30, v30, v96
    v_mfma_f32_32x32x16_bf16 v[64:79], a[164:167], v[168:171], v[64:79]
    s_waitcnt vmcnt(16)
    s_barrier
    ds_read_b64_tr_b16 a[160:161], v111 offset:0
    ds_read_b64_tr_b16 a[162:163], v111 offset:1024
    buffer_load_dwordx4 v9, s[32:35], s44 offen offset:3072 lds
    v_mul_f32 v31, v31, v97
    v_cvt_pk_bf16_f32 v240, v16, v17
    v_cvt_pk_bf16_f32 v241, v18, v19
    v_cvt_pk_bf16_f32 v242, v20, v21
    v_cvt_pk_bf16_f32 v243, v22, v23
    v_mfma_f32_32x32x16_bf16 v[48:63], a[168:171], v[172:175], v[48:63]
    ds_read_b64_tr_b16 a[164:165], v111 offset:512
    ds_read_b64_tr_b16 a[166:167], v111 offset:1536
    v_cvt_pk_bf16_f32 v244, v24, v25
    v_cvt_pk_bf16_f32 v245, v26, v27
    v_cvt_pk_bf16_f32 v246, v28, v29
    v_cvt_pk_bf16_f32 v247, v30, v31
    v_mfma_f32_32x32x16_bf16 v[64:79], a[172:175], v[172:175], v[64:79]
    ds_read_b64_tr_b16 a[168:169], v111 offset:2048
    ds_read_b64_tr_b16 a[170:171], v111 offset:3072
    v_fma_f32 v96, v32, v32, v11
    v_fma_f32 v97, v33, v33, v11
    v_fma_f32 v98, v34, v34, v11
    v_mul_f32 v96, v32, v96
    v_mul_f32 v97, v33, v97
    s_waitcnt lgkmcnt(6)
    v_mfma_f32_32x32x16_bf16 v[48:63], a[144:147], v[176:179], v[48:63]
    ds_read_b64_tr_b16 a[172:173], v111 offset:2560
    ds_read_b64_tr_b16 a[174:175], v111 offset:3584
    v_mul_f32 v98, v34, v98
    v_exp_f32 v96, -v96
    v_exp_f32 v97, -v97
    v_mfma_f32_32x32x16_bf16 v[64:79], a[148:151], v[176:179], v[64:79]
    ds_read_b64_tr_b16 a[144:145], v111 offset:4096
    ds_read_b64_tr_b16 a[146:147], v111 offset:5120
    s_add_u32 m0, s43, 45056
    s_add_u32 s44, s41, 405632
    buffer_load_dwordx4 v6, s[32:35], s44 offen offset:0 lds
    v_exp_f32 v98, -v98
    v_add_f32 v96, 1.0, v96
    v_add_f32 v97, 1.0, v97
    v_add_f32 v98, 1.0, v98
    v_mfma_f32_32x32x16_bf16 v[48:63], a[152:155], v[180:183], v[48:63]
    ds_read_b64_tr_b16 a[148:149], v111 offset:4608
    ds_read_b64_tr_b16 a[150:151], v111 offset:5632
    v_rcp_f32 v96, v96
    v_rcp_f32 v97, v97
    v_rcp_f32 v98, v98
    v_mfma_f32_32x32x16_bf16 v[64:79], a[156:159], v[180:183], v[64:79]
    ds_read_b64_tr_b16 a[152:153], v111 offset:6144
    ds_read_b64_tr_b16 a[154:155], v111 offset:7168
    v_mul_f32 v32, v32, v96
    v_mul_f32 v33, v33, v97
    v_mul_f32 v34, v34, v98
    v_fma_f32 v99, v35, v35, v11
    s_waitcnt lgkmcnt(6)
    v_mfma_f32_32x32x16_bf16 v[48:63], a[160:163], v[184:187], v[48:63]
    ds_read_b64_tr_b16 a[156:157], v111 offset:6656
    ds_read_b64_tr_b16 a[158:159], v111 offset:7680
    v_fma_f32 v100, v36, v36, v11
    v_fma_f32 v101, v37, v37, v11
    v_mul_f32 v99, v35, v99
    v_mul_f32 v100, v36, v100
    v_mul_f32 v101, v37, v101
    v_mfma_f32_32x32x16_bf16 v[64:79], a[164:167], v[184:187], v[64:79]
    ds_read_b64_tr_b16 a[160:161], v111 offset:8192
    ds_read_b64_tr_b16 a[162:163], v111 offset:9216
    s_add_u32 m0, s43, 73728
    s_add_u32 s44, s41, 256
    buffer_load_dwordx4 v6, s[32:35], s44 offen offset:0 lds
    v_exp_f32 v99, -v99
    v_exp_f32 v100, -v100
    v_mfma_f32_32x32x16_bf16 v[48:63], a[168:171], v[188:191], v[48:63]
    ds_read_b64_tr_b16 a[164:165], v111 offset:8704
    ds_read_b64_tr_b16 a[166:167], v111 offset:9728
    v_exp_f32 v101, -v101
    v_add_f32 v99, 1.0, v99
    v_add_f32 v100, 1.0, v100
    v_add_f32 v101, 1.0, v101
    v_mfma_f32_32x32x16_bf16 v[64:79], a[172:175], v[188:191], v[64:79]
    ds_read_b64_tr_b16 a[168:169], v111 offset:10240
    ds_read_b64_tr_b16 a[170:171], v111 offset:11264
    v_rcp_f32 v99, v99
    v_rcp_f32 v100, v100
    v_rcp_f32 v101, v101
    s_waitcnt lgkmcnt(6)
    v_mfma_f32_32x32x16_bf16 v[48:63], a[144:147], v[192:195], v[48:63]
    ds_read_b64_tr_b16 a[172:173], v111 offset:10752
    ds_read_b64_tr_b16 a[174:175], v111 offset:11776
    v_mul_f32 v35, v35, v99
    v_mul_f32 v36, v36, v100
    v_mul_f32 v37, v37, v101
    v_fma_f32 v96, v38, v38, v11
    v_mfma_f32_32x32x16_bf16 v[64:79], a[148:151], v[192:195], v[64:79]
    ds_read_b64_tr_b16 a[144:145], v111 offset:12288
    ds_read_b64_tr_b16 a[146:147], v111 offset:13312
    buffer_load_dwordx4 v7, s[32:35], s44 offen offset:1024 lds
    v_fma_f32 v97, v39, v39, v11
    v_fma_f32 v98, v40, v40, v11
    v_mul_f32 v96, v38, v96
    v_mul_f32 v97, v39, v97
    v_mul_f32 v98, v40, v98
    v_mfma_f32_32x32x16_bf16 v[48:63], a[152:155], v[196:199], v[48:63]
    ds_read_b64_tr_b16 a[148:149], v111 offset:12800
    ds_read_b64_tr_b16 a[150:151], v111 offset:13824
    v_exp_f32 v96, -v96
    v_exp_f32 v97, -v97
    v_exp_f32 v98, -v98
    v_mfma_f32_32x32x16_bf16 v[64:79], a[156:159], v[196:199], v[64:79]
    ds_read_b64_tr_b16 a[152:153], v111 offset:14336
    ds_read_b64_tr_b16 a[154:155], v111 offset:15360
    v_add_f32 v96, 1.0, v96
    v_add_f32 v97, 1.0, v97
    v_add_f32 v98, 1.0, v98
    v_rcp_f32 v96, v96
    s_waitcnt lgkmcnt(6)
    v_mfma_f32_32x32x16_bf16 v[48:63], a[160:163], v[200:203], v[48:63]
    ds_read_b64_tr_b16 a[156:157], v111 offset:14848
    ds_read_b64_tr_b16 a[158:159], v111 offset:15872
    v_rcp_f32 v97, v97
    v_rcp_f32 v98, v98
    v_mfma_f32_32x32x16_bf16 v[64:79], a[164:167], v[200:203], v[64:79]
    ds_read_b64_tr_b16 a[160:161], v111 offset:16384
    ds_read_b64_tr_b16 a[162:163], v111 offset:17408
    buffer_load_dwordx4 v8, s[32:35], s44 offen offset:2048 lds
    v_mul_f32 v38, v38, v96
    v_mul_f32 v39, v39, v97
    v_mul_f32 v40, v40, v98
    v_fma_f32 v99, v41, v41, v11
    v_mfma_f32_32x32x16_bf16 v[48:63], a[168:171], v[204:207], v[48:63]
    ds_read_b64_tr_b16 a[164:165], v111 offset:16896
    ds_read_b64_tr_b16 a[166:167], v111 offset:17920
    v_fma_f32 v100, v42, v42, v11
    v_fma_f32 v101, v43, v43, v11
    v_mul_f32 v99, v41, v99
    v_mul_f32 v100, v42, v100
    v_mul_f32 v101, v43, v101
    v_mfma_f32_32x32x16_bf16 v[64:79], a[172:175], v[204:207], v[64:79]
    ds_read_b64_tr_b16 a[168:169], v111 offset:18432
    ds_read_b64_tr_b16 a[170:171], v111 offset:19456
    v_exp_f32 v99, -v99
    v_exp_f32 v100, -v100
    v_exp_f32 v101, -v101
    s_waitcnt lgkmcnt(6)
    v_mfma_f32_32x32x16_bf16 v[48:63], a[144:147], v[208:211], v[48:63]
    ds_read_b64_tr_b16 a[172:173], v111 offset:18944
    ds_read_b64_tr_b16 a[174:175], v111 offset:19968
    v_add_f32 v99, 1.0, v99
    v_add_f32 v100, 1.0, v100
    v_add_f32 v101, 1.0, v101
    v_rcp_f32 v99, v99
    v_mfma_f32_32x32x16_bf16 v[64:79], a[148:151], v[208:211], v[64:79]
    ds_read_b64_tr_b16 a[144:145], v111 offset:20480
    ds_read_b64_tr_b16 a[146:147], v111 offset:21504
    buffer_load_dwordx4 v9, s[32:35], s44 offen offset:3072 lds
    v_rcp_f32 v100, v100
    v_rcp_f32 v101, v101
    v_mfma_f32_32x32x16_bf16 v[48:63], a[152:155], v[212:215], v[48:63]
    ds_read_b64_tr_b16 a[148:149], v111 offset:20992
    ds_read_b64_tr_b16 a[150:151], v111 offset:22016
    v_mul_f32 v41, v41, v99
    v_mul_f32 v42, v42, v100
    v_mul_f32 v43, v43, v101
    v_fma_f32 v96, v44, v44, v11
    v_fma_f32 v97, v45, v45, v11
    v_mfma_f32_32x32x16_bf16 v[64:79], a[156:159], v[212:215], v[64:79]
    ds_read_b64_tr_b16 a[152:153], v111 offset:22528
    ds_read_b64_tr_b16 a[154:155], v111 offset:23552
    v_mul_f32 v96, v44, v96
    v_mul_f32 v97, v45, v97
    v_exp_f32 v96, -v96
    s_waitcnt lgkmcnt(6)
    v_mfma_f32_32x32x16_bf16 v[48:63], a[160:163], v[216:219], v[48:63]
    ds_read_b64_tr_b16 a[156:157], v111 offset:23040
    ds_read_b64_tr_b16 a[158:159], v111 offset:24064
    v_exp_f32 v97, -v97
    v_add_f32 v96, 1.0, v96
    v_add_f32 v97, 1.0, v97
    v_rcp_f32 v96, v96
    v_mfma_f32_32x32x16_bf16 v[64:79], a[164:167], v[216:219], v[64:79]
    ds_read_b64_tr_b16 a[160:161], v111 offset:24576
    ds_read_b64_tr_b16 a[162:163], v111 offset:25600
    s_add_u32 m0, s43, 77824
    s_add_u32 s44, s41, 37120
    buffer_load_dwordx4 v6, s[32:35], s44 offen offset:0 lds
    v_rcp_f32 v97, v97
    v_mul_f32 v44, v44, v96
    v_mul_f32 v45, v45, v97
    v_mfma_f32_32x32x16_bf16 v[48:63], a[168:171], v[220:223], v[48:63]
    ds_read_b64_tr_b16 a[164:165], v111 offset:25088
    ds_read_b64_tr_b16 a[166:167], v111 offset:26112
    v_fma_f32 v96, v46, v46, v11
    v_fma_f32 v97, v47, v47, v11
    v_mul_f32 v96, v46, v96
    v_mul_f32 v97, v47, v97
    v_exp_f32 v96, -v96
    v_mfma_f32_32x32x16_bf16 v[64:79], a[172:175], v[220:223], v[64:79]
    ds_read_b64_tr_b16 a[168:169], v111 offset:26624
    ds_read_b64_tr_b16 a[170:171], v111 offset:27648
    v_exp_f32 v97, -v97
    v_add_f32 v96, 1.0, v96
    v_add_f32 v97, 1.0, v97
    s_waitcnt lgkmcnt(6)
    v_mfma_f32_32x32x16_bf16 v[48:63], a[144:147], v[224:227], v[48:63]
    ds_read_b64_tr_b16 a[172:173], v111 offset:27136
    ds_read_b64_tr_b16 a[174:175], v111 offset:28160
    v_rcp_f32 v96, v96
    v_rcp_f32 v97, v97
    v_mul_f32 v46, v46, v96
    v_mfma_f32_32x32x16_bf16 v[64:79], a[148:151], v[224:227], v[64:79]
    ds_read_b64_tr_b16 a[144:145], v111 offset:28672
    ds_read_b64_tr_b16 a[146:147], v111 offset:29696
    buffer_load_dwordx4 v7, s[32:35], s44 offen offset:1024 lds
    v_mul_f32 v47, v47, v97
    v_cvt_pk_bf16_f32 v248, v32, v33
    v_cvt_pk_bf16_f32 v249, v34, v35
    v_cvt_pk_bf16_f32 v250, v36, v37
    v_cvt_pk_bf16_f32 v251, v38, v39
    v_mfma_f32_32x32x16_bf16 v[48:63], a[152:155], v[228:231], v[48:63]
    ds_read_b64_tr_b16 a[148:149], v111 offset:29184
    ds_read_b64_tr_b16 a[150:151], v111 offset:30208
    v_cvt_pk_bf16_f32 v252, v40, v41
    v_cvt_pk_bf16_f32 v253, v42, v43
    v_cvt_pk_bf16_f32 v254, v44, v45
    v_cvt_pk_bf16_f32 v255, v46, v47
    v_mfma_f32_32x32x16_bf16 v[64:79], a[156:159], v[228:231], v[64:79]
    ds_read_b64_tr_b16 a[152:153], v111 offset:30720
    ds_read_b64_tr_b16 a[154:155], v111 offset:31744
    s_waitcnt lgkmcnt(6)
    v_mfma_f32_32x32x16_bf16 v[48:63], a[160:163], v[232:235], v[48:63]
    ds_read_b64_tr_b16 a[156:157], v111 offset:31232
    ds_read_b64_tr_b16 a[158:159], v111 offset:32256
    v_mfma_f32_32x32x16_bf16 v[64:79], a[164:167], v[232:235], v[64:79]
    ds_read_b64_tr_b16 a[160:161], v111 offset:32768
    ds_read_b64_tr_b16 a[162:163], v111 offset:33792
    buffer_load_dwordx4 v8, s[32:35], s44 offen offset:2048 lds
    v_mfma_f32_32x32x16_bf16 v[48:63], a[168:171], v[236:239], v[48:63]
    ds_read_b64_tr_b16 a[164:165], v111 offset:33280
    ds_read_b64_tr_b16 a[166:167], v111 offset:34304
    v_mfma_f32_32x32x16_bf16 v[64:79], a[172:175], v[236:239], v[64:79]
    ds_read_b64_tr_b16 a[168:169], v111 offset:34816
    ds_read_b64_tr_b16 a[170:171], v111 offset:35840
    s_waitcnt lgkmcnt(6)
    v_mfma_f32_32x32x16_bf16 v[48:63], a[144:147], v[240:243], v[48:63]
    ds_read_b64_tr_b16 a[172:173], v111 offset:35328
    ds_read_b64_tr_b16 a[174:175], v111 offset:36352
    v_mfma_f32_32x32x16_bf16 v[64:79], a[148:151], v[240:243], v[64:79]
    s_waitcnt vmcnt(16)
    s_barrier
    ds_read_b64_tr_b16 a[144:145], v108 offset:0
    ds_read_b64_tr_b16 a[146:147], v108 offset:1024
    buffer_load_dwordx4 v9, s[32:35], s44 offen offset:3072 lds
    v_mfma_f32_32x32x16_bf16 v[48:63], a[152:155], v[244:247], v[48:63]
    ds_read_b64_tr_b16 a[148:149], v108 offset:512
    ds_read_b64_tr_b16 a[150:151], v108 offset:1536
    v_mfma_f32_32x32x16_bf16 v[64:79], a[156:159], v[244:247], v[64:79]
    ds_read_b64_tr_b16 a[152:153], v108 offset:2048
    ds_read_b64_tr_b16 a[154:155], v108 offset:3072
    s_waitcnt lgkmcnt(6)
    v_mfma_f32_32x32x16_bf16 v[48:63], a[160:163], v[248:251], v[48:63]
    ds_read_b64_tr_b16 a[156:157], v108 offset:2560
    ds_read_b64_tr_b16 a[158:159], v108 offset:3584
    v_mfma_f32_32x32x16_bf16 v[64:79], a[164:167], v[248:251], v[64:79]
    ds_read_b64_tr_b16 a[160:161], v108 offset:4096
    ds_read_b64_tr_b16 a[162:163], v108 offset:5120
    s_add_u32 m0, s43, 81920
    s_add_u32 s44, s41, 73984
    buffer_load_dwordx4 v6, s[32:35], s44 offen offset:0 lds
    v_mfma_f32_32x32x16_bf16 v[48:63], a[168:171], v[252:255], v[48:63]
    ds_read_b64_tr_b16 a[164:165], v108 offset:4608
    ds_read_b64_tr_b16 a[166:167], v108 offset:5632
    v_mfma_f32_32x32x16_bf16 v[64:79], a[172:175], v[252:255], v[64:79]
    ds_read_b64_tr_b16 a[168:169], v108 offset:6144
    ds_read_b64_tr_b16 a[170:171], v108 offset:7168
    s_waitcnt lgkmcnt(6)
    s_mov_b32 s15, 3
M_loop:
    v_mfma_f32_32x32x16_bf16 v[16:31], a[144:147], v[112:115], 0
    ds_read_b64_tr_b16 a[172:173], v108 offset:6656
    ds_read_b64_tr_b16 a[174:175], v108 offset:7680
    v_mfma_f32_32x32x16_bf16 v[32:47], a[148:151], v[112:115], 0
    ds_read_b64_tr_b16 a[144:145], v108 offset:8192
    ds_read_b64_tr_b16 a[146:147], v108 offset:9216
    s_add_u32 m0, s43, 110592
    s_add_u32 s44, s41, 332032
    buffer_load_dwordx4 v6, s[32:35], s44 offen offset:0 lds
    v_mfma_f32_32x32x16_bf16 v[16:31], a[152:155], v[116:119], v[16:31]
    ds_read_b64_tr_b16 a[148:149], v108 offset:8704
    ds_read_b64_tr_b16 a[150:151], v108 offset:9728
    v_mfma_f32_32x32x16_bf16 v[32:47], a[156:159], v[116:119], v[32:47]
    ds_read_b64_tr_b16 a[152:153], v108 offset:10240
    ds_read_b64_tr_b16 a[154:155], v108 offset:11264
    v_cvt_pk_bf16_f32 v80, v48, v49
    v_cvt_pk_bf16_f32 v81, v50, v51
    s_waitcnt lgkmcnt(6)
    v_mfma_f32_32x32x16_bf16 v[16:31], a[160:163], v[120:123], v[16:31]
    ds_read_b64_tr_b16 a[156:157], v108 offset:10752
    ds_read_b64_tr_b16 a[158:159], v108 offset:11776
    v_cvt_pk_bf16_f32 v82, v52, v53
    v_cvt_pk_bf16_f32 v83, v54, v55
    v_mfma_f32_32x32x16_bf16 v[32:47], a[164:167], v[120:123], v[32:47]
    ds_read_b64_tr_b16 a[160:161], v108 offset:12288
    ds_read_b64_tr_b16 a[162:163], v108 offset:13312
    buffer_load_dwordx4 v7, s[32:35], s44 offen offset:1024 lds
    v_mfma_f32_32x32x16_bf16 v[16:31], a[168:171], v[124:127], v[16:31]
    ds_read_b64_tr_b16 a[164:165], v108 offset:12800
    ds_read_b64_tr_b16 a[166:167], v108 offset:13824
    v_cvt_pk_bf16_f32 v84, v56, v57
    v_cvt_pk_bf16_f32 v85, v58, v59
    v_mfma_f32_32x32x16_bf16 v[32:47], a[172:175], v[124:127], v[32:47]
    ds_read_b64_tr_b16 a[168:169], v108 offset:14336
    ds_read_b64_tr_b16 a[170:171], v108 offset:15360
    v_cvt_pk_bf16_f32 v86, v60, v61
    v_cvt_pk_bf16_f32 v87, v62, v63
    s_waitcnt lgkmcnt(6)
    v_mfma_f32_32x32x16_bf16 v[16:31], a[144:147], v[128:131], v[16:31]
    ds_read_b64_tr_b16 a[172:173], v108 offset:14848
    ds_read_b64_tr_b16 a[174:175], v108 offset:15872
    buffer_store_dwordx4 v[80:83], v12, s[24:27], s52 offen offset:0 sc1
    v_mfma_f32_32x32x16_bf16 v[32:47], a[148:151], v[128:131], v[32:47]
    ds_read_b64_tr_b16 a[144:145], v108 offset:16384
    ds_read_b64_tr_b16 a[146:147], v108 offset:17408
    buffer_load_dwordx4 v8, s[32:35], s44 offen offset:2048 lds
    v_mfma_f32_32x32x16_bf16 v[16:31], a[152:155], v[132:135], v[16:31]
    ds_read_b64_tr_b16 a[148:149], v108 offset:16896
    ds_read_b64_tr_b16 a[150:151], v108 offset:17920
    buffer_store_dwordx4 v[84:87], v12, s[24:27], s52 offen offset:1024 sc1
    v_mfma_f32_32x32x16_bf16 v[32:47], a[156:159], v[132:135], v[32:47]
    ds_read_b64_tr_b16 a[152:153], v108 offset:18432
    ds_read_b64_tr_b16 a[154:155], v108 offset:19456
    v_cvt_pk_bf16_f32 v88, v64, v65
    v_cvt_pk_bf16_f32 v89, v66, v67
    s_waitcnt lgkmcnt(6)
    v_mfma_f32_32x32x16_bf16 v[16:31], a[160:163], v[136:139], v[16:31]
    ds_read_b64_tr_b16 a[156:157], v108 offset:18944
    ds_read_b64_tr_b16 a[158:159], v108 offset:19968
    v_cvt_pk_bf16_f32 v90, v68, v69
    v_cvt_pk_bf16_f32 v91, v70, v71
    v_mfma_f32_32x32x16_bf16 v[32:47], a[164:167], v[136:139], v[32:47]
    ds_read_b64_tr_b16 a[160:161], v108 offset:20480
    ds_read_b64_tr_b16 a[162:163], v108 offset:21504
    buffer_load_dwordx4 v9, s[32:35], s44 offen offset:3072 lds
    v_mfma_f32_32x32x16_bf16 v[16:31], a[168:171], v[140:143], v[16:31]
    ds_read_b64_tr_b16 a[164:165], v108 offset:20992
    ds_read_b64_tr_b16 a[166:167], v108 offset:22016
    v_cvt_pk_bf16_f32 v92, v72, v73
    v_cvt_pk_bf16_f32 v93, v74, v75
    v_mfma_f32_32x32x16_bf16 v[32:47], a[172:175], v[140:143], v[32:47]
    ds_read_b64_tr_b16 a[168:169], v108 offset:22528
    ds_read_b64_tr_b16 a[170:171], v108 offset:23552
    v_cvt_pk_bf16_f32 v94, v76, v77
    v_cvt_pk_bf16_f32 v95, v78, v79
    s_waitcnt lgkmcnt(6)
    v_mfma_f32_32x32x16_bf16 v[16:31], a[144:147], v[144:147], v[16:31]
    ds_read_b64_tr_b16 a[172:173], v108 offset:23040
    ds_read_b64_tr_b16 a[174:175], v108 offset:24064
    buffer_store_dwordx4 v[88:91], v12, s[24:27], s52 offen offset:2048 sc1
    v_mfma_f32_32x32x16_bf16 v[32:47], a[148:151], v[144:147], v[32:47]
    ds_read_b64_tr_b16 a[144:145], v108 offset:24576
    ds_read_b64_tr_b16 a[146:147], v108 offset:25600
    s_add_u32 m0, s43, 114688
    s_add_u32 s44, s41, 368896
    buffer_load_dwordx4 v6, s[32:35], s44 offen offset:0 lds
    v_mfma_f32_32x32x16_bf16 v[16:31], a[152:155], v[148:151], v[16:31]
    ds_read_b64_tr_b16 a[148:149], v108 offset:25088
    ds_read_b64_tr_b16 a[150:151], v108 offset:26112
    buffer_store_dwordx4 v[92:95], v12, s[24:27], s52 offen offset:3072 sc1
    v_mfma_f32_32x32x16_bf16 v[32:47], a[156:159], v[148:151], v[32:47]
    ds_read_b64_tr_b16 a[152:153], v108 offset:26624
    ds_read_b64_tr_b16 a[154:155], v108 offset:27648
    s_waitcnt lgkmcnt(6)
    v_mfma_f32_32x32x16_bf16 v[16:31], a[160:163], v[152:155], v[16:31]
    ds_read_b64_tr_b16 a[156:157], v108 offset:27136
    ds_read_b64_tr_b16 a[158:159], v108 offset:28160
    s_add_u32 s52, s52, 4096
    v_mfma_f32_32x32x16_bf16 v[32:47], a[164:167], v[152:155], v[32:47]
    ds_read_b64_tr_b16 a[160:161], v108 offset:28672
    ds_read_b64_tr_b16 a[162:163], v108 offset:29696
    buffer_load_dwordx4 v7, s[32:35], s44 offen offset:1024 lds
    v_mfma_f32_32x32x16_bf16 v[16:31], a[168:171], v[156:159], v[16:31]
    ds_read_b64_tr_b16 a[164:165], v108 offset:29184
    ds_read_b64_tr_b16 a[166:167], v108 offset:30208
    v_mfma_f32_32x32x16_bf16 v[32:47], a[172:175], v[156:159], v[32:47]
    ds_read_b64_tr_b16 a[168:169], v108 offset:30720
    ds_read_b64_tr_b16 a[170:171], v108 offset:31744
    s_waitcnt lgkmcnt(6)
    v_mfma_f32_32x32x16_bf16 v[16:31], a[144:147], v[160:163], v[16:31]
    ds_read_b64_tr_b16 a[172:173], v108 offset:31232
    ds_read_b64_tr_b16 a[174:175], v108 offset:32256
    v_mfma_f32_32x32x16_bf16 v[32:47], a[148:151], v[160:163], v[32:47]
    ds_read_b64_tr_b16 a[144:145], v108 offset:32768
    ds_read_b64_tr_b16 a[146:147], v108 offset:33792
    buffer_load_dwordx4 v8, s[32:35], s44 offen offset:2048 lds
    v_mfma_f32_32x32x16_bf16 v[16:31], a[152:155], v[164:167], v[16:31]
    ds_read_b64_tr_b16 a[148:149], v108 offset:33280
    ds_read_b64_tr_b16 a[150:151], v108 offset:34304
    v_mfma_f32_32x32x16_bf16 v[32:47], a[156:159], v[164:167], v[32:47]
    ds_read_b64_tr_b16 a[152:153], v108 offset:34816
    ds_read_b64_tr_b16 a[154:155], v108 offset:35840
    s_waitcnt lgkmcnt(6)
    v_mfma_f32_32x32x16_bf16 v[16:31], a[160:163], v[168:171], v[16:31]
    ds_read_b64_tr_b16 a[156:157], v108 offset:35328
    ds_read_b64_tr_b16 a[158:159], v108 offset:36352
    v_mfma_f32_32x32x16_bf16 v[32:47], a[164:167], v[168:171], v[32:47]
    s_waitcnt vmcnt(20)
    s_barrier
    ds_read_b64_tr_b16 a[160:161], v109 offset:0
    ds_read_b64_tr_b16 a[162:163], v109 offset:1024
    buffer_load_dwordx4 v9, s[32:35], s44 offen offset:3072 lds
    v_mfma_f32_32x32x16_bf16 v[16:31], a[168:171], v[172:175], v[16:31]
    ds_read_b64_tr_b16 a[164:165], v109 offset:512
    ds_read_b64_tr_b16 a[166:167], v109 offset:1536
    v_mfma_f32_32x32x16_bf16 v[32:47], a[172:175], v[172:175], v[32:47]
    ds_read_b64_tr_b16 a[168:169], v109 offset:2048
    ds_read_b64_tr_b16 a[170:171], v109 offset:3072
    s_add_u32 s46, s46, 1
    s_max_i32 s8, s46, 0
    s_add_u32 s8, s8, s97
    v_mov_b32 v14, s8
    s_mov_b64 exec, 1
    buffer_store_dword v14, v15, s[24:27], s99 offen sc1
    s_mov_b64 exec, -1
    s_waitcnt lgkmcnt(6)
    v_mfma_f32_32x32x16_bf16 v[16:31], a[144:147], v[176:179], v[16:31]
    ds_read_b64_tr_b16 a[172:173], v109 offset:2560
    ds_read_b64_tr_b16 a[174:175], v109 offset:3584
    v_mfma_f32_32x32x16_bf16 v[32:47], a[148:151], v[176:179], v[32:47]
    ds_read_b64_tr_b16 a[144:145], v109 offset:4096
    ds_read_b64_tr_b16 a[146:147], v109 offset:5120
    s_add_u32 m0, s43, 118784
    s_add_u32 s44, s41, 405760
    buffer_load_dwordx4 v6, s[32:35], s44 offen offset:0 lds
    v_mfma_f32_32x32x16_bf16 v[16:31], a[152:155], v[180:183], v[16:31]
    ds_read_b64_tr_b16 a[148:149], v109 offset:4608
    ds_read_b64_tr_b16 a[150:151], v109 offset:5632
    v_mfma_f32_32x32x16_bf16 v[32:47], a[156:159], v[180:183], v[32:47]
    ds_read_b64_tr_b16 a[152:153], v109 offset:6144
    ds_read_b64_tr_b16 a[154:155], v109 offset:7168
    s_waitcnt lgkmcnt(6)
    v_mfma_f32_32x32x16_bf16 v[16:31], a[160:163], v[184:187], v[16:31]
    ds_read_b64_tr_b16 a[156:157], v109 offset:6656
    ds_read_b64_tr_b16 a[158:159], v109 offset:7680
    v_mfma_f32_32x32x16_bf16 v[32:47], a[164:167], v[184:187], v[32:47]
    ds_read_b64_tr_b16 a[160:161], v109 offset:8192
    ds_read_b64_tr_b16 a[162:163], v109 offset:9216
    s_add_u32 m0, s43, 0
    s_add_u32 s44, s41, 384
    buffer_load_dwordx4 v6, s[32:35], s44 offen offset:0 lds
    v_mfma_f32_32x32x16_bf16 v[16:31], a[168:171], v[188:191], v[16:31]
    ds_read_b64_tr_b16 a[164:165], v109 offset:8704
    ds_read_b64_tr_b16 a[166:167], v109 offset:9728
    v_mfma_f32_32x32x16_bf16 v[32:47], a[172:175], v[188:191], v[32:47]
    ds_read_b64_tr_b16 a[168:169], v109 offset:10240
    ds_read_b64_tr_b16 a[170:171], v109 offset:11264
    s_waitcnt lgkmcnt(6)
    v_mfma_f32_32x32x16_bf16 v[16:31], a[144:147], v[192:195], v[16:31]
    ds_read_b64_tr_b16 a[172:173], v109 offset:10752
    ds_read_b64_tr_b16 a[174:175], v109 offset:11776
    v_mfma_f32_32x32x16_bf16 v[32:47], a[148:151], v[192:195], v[32:47]
    ds_read_b64_tr_b16 a[144:145], v109 offset:12288
    ds_read_b64_tr_b16 a[146:147], v109 offset:13312
    buffer_load_dwordx4 v7, s[32:35], s44 offen offset:1024 lds
    v_mfma_f32_32x32x16_bf16 v[16:31], a[152:155], v[196:199], v[16:31]
    ds_read_b64_tr_b16 a[148:149], v109 offset:12800
    ds_read_b64_tr_b16 a[150:151], v109 offset:13824
    v_mfma_f32_32x32x16_bf16 v[32:47], a[156:159], v[196:199], v[32:47]
    ds_read_b64_tr_b16 a[152:153], v109 offset:14336
    ds_read_b64_tr_b16 a[154:155], v109 offset:15360
    s_waitcnt lgkmcnt(6)
    v_mfma_f32_32x32x16_bf16 v[16:31], a[160:163], v[200:203], v[16:31]
    ds_read_b64_tr_b16 a[156:157], v109 offset:14848
    ds_read_b64_tr_b16 a[158:159], v109 offset:15872
    v_mfma_f32_32x32x16_bf16 v[32:47], a[164:167], v[200:203], v[32:47]
    ds_read_b64_tr_b16 a[160:161], v109 offset:16384
    ds_read_b64_tr_b16 a[162:163], v109 offset:17408
    buffer_load_dwordx4 v8, s[32:35], s44 offen offset:2048 lds
    v_mfma_f32_32x32x16_bf16 v[16:31], a[168:171], v[204:207], v[16:31]
    ds_read_b64_tr_b16 a[164:165], v109 offset:16896
    ds_read_b64_tr_b16 a[166:167], v109 offset:17920
    v_mfma_f32_32x32x16_bf16 v[32:47], a[172:175], v[204:207], v[32:47]
    ds_read_b64_tr_b16 a[168:169], v109 offset:18432
    ds_read_b64_tr_b16 a[170:171], v109 offset:19456
    s_waitcnt lgkmcnt(6)
    v_mfma_f32_32x32x16_bf16 v[16:31], a[144:147], v[208:211], v[16:31]
    ds_read_b64_tr_b16 a[172:173], v109 offset:18944
    ds_read_b64_tr_b16 a[174:175], v109 offset:19968
    v_mfma_f32_32x32x16_bf16 v[32:47], a[148:151], v[208:211], v[32:47]
    ds_read_b64_tr_b16 a[144:145], v109 offset:20480
    ds_read_b64_tr_b16 a[146:147], v109 offset:21504
    buffer_load_dwordx4 v9, s[32:35], s44 offen offset:3072 lds
    v_mfma_f32_32x32x16_bf16 v[16:31], a[152:155], v[212:215], v[16:31]
    ds_read_b64_tr_b16 a[148:149], v109 offset:20992
    ds_read_b64_tr_b16 a[150:151], v109 offset:22016
    v_mfma_f32_32x32x16_bf16 v[32:47], a[156:159], v[212:215], v[32:47]
    ds_read_b64_tr_b16 a[152:153], v109 offset:22528
    ds_read_b64_tr_b16 a[154:155], v109 offset:23552
    s_waitcnt lgkmcnt(6)
    v_mfma_f32_32x32x16_bf16 v[16:31], a[160:163], v[216:219], v[16:31]
    ds_read_b64_tr_b16 a[156:157], v109 offset:23040
    ds_read_b64_tr_b16 a[158:159], v109 offset:24064
    v_mfma_f32_32x32x16_bf16 v[32:47], a[164:167], v[216:219], v[32:47]
    ds_read_b64_tr_b16 a[160:161], v109 offset:24576
    ds_read_b64_tr_b16 a[162:163], v109 offset:25600
    s_add_u32 m0, s43, 4096
    s_add_u32 s44, s41, 37248
    buffer_load_dwordx4 v6, s[32:35], s44 offen offset:0 lds
    v_mfma_f32_32x32x16_bf16 v[16:31], a[168:171], v[220:223], v[16:31]
    ds_read_b64_tr_b16 a[164:165], v109 offset:25088
    ds_read_b64_tr_b16 a[166:167], v109 offset:26112
    v_mfma_f32_32x32x16_bf16 v[32:47], a[172:175], v[220:223], v[32:47]
    ds_read_b64_tr_b16 a[168:169], v109 offset:26624
    ds_read_b64_tr_b16 a[170:171], v109 offset:27648
    s_waitcnt lgkmcnt(6)
    v_mfma_f32_32x32x16_bf16 v[16:31], a[144:147], v[224:227], v[16:31]
    ds_read_b64_tr_b16 a[172:173], v109 offset:27136
    ds_read_b64_tr_b16 a[174:175], v109 offset:28160
    v_mfma_f32_32x32x16_bf16 v[32:47], a[148:151], v[224:227], v[32:47]
    ds_read_b64_tr_b16 a[144:145], v109 offset:28672
    ds_read_b64_tr_b16 a[146:147], v109 offset:29696
    buffer_load_dwordx4 v7, s[32:35], s44 offen offset:1024 lds
    v_mfma_f32_32x32x16_bf16 v[16:31], a[152:155], v[228:231], v[16:31]
    ds_read_b64_tr_b16 a[148:149], v109 offset:29184
    ds_read_b64_tr_b16 a[150:151], v109 offset:30208
    v_mfma_f32_32x32x16_bf16 v[32:47], a[156:159], v[228:231], v[32:47]
    ds_read_b64_tr_b16 a[152:153], v109 offset:30720
    ds_read_b64_tr_b16 a[154:155], v109 offset:31744
    s_waitcnt lgkmcnt(6)
    v_mfma_f32_32x32x16_bf16 v[16:31], a[160:163], v[232:235], v[16:31]
    ds_read_b64_tr_b16 a[156:157], v109 offset:31232
    ds_read_b64_tr_b16 a[158:159], v109 offset:32256
    v_mfma_f32_32x32x16_bf16 v[32:47], a[164:167], v[232:235], v[32:47]
    ds_read_b64_tr_b16 a[160:161], v109 offset:32768
    ds_read_b64_tr_b16 a[162:163], v109 offset:33792
    buffer_load_dwordx4 v8, s[32:35], s44 offen offset:2048 lds
    v_mfma_f32_32x32x16_bf16 v[16:31], a[168:171], v[236:239], v[16:31]
    ds_read_b64_tr_b16 a[164:165], v109 offset:33280
    ds_read_b64_tr_b16 a[166:167], v109 offset:34304
    v_mfma_f32_32x32x16_bf16 v[32:47], a[172:175], v[236:239], v[32:47]
    ds_read_b64_tr_b16 a[168:169], v109 offset:34816
    ds_read_b64_tr_b16 a[170:171], v109 offset:35840
    s_waitcnt lgkmcnt(6)
    v_mfma_f32_32x32x16_bf16 v[16:31], a[144:147], v[240:243], v[16:31]
    ds_read_b64_tr_b16 a[172:173], v109 offset:35328
    ds_read_b64_tr_b16 a[174:175], v109 offset:36352
    v_mfma_f32_32x32x16_bf16 v[32:47], a[148:151], v[240:243], v[32:47]
    s_waitcnt vmcnt(21)
    s_barrier
    ds_read_b64_tr_b16 a[144:145], v110 offset:0
    ds_read_b64_tr_b16 a[146:147], v110 offset:1024
    buffer_load_dwordx4 v9, s[32:35], s44 offen offset:3072 lds
    v_mfma_f32_32x32x16_bf16 v[16:31], a[152:155], v[244:247], v[16:31]
    ds_read_b64_tr_b16 a[148:149], v110 offset:512
    ds_read_b64_tr_b16 a[150:151], v110 offset:1536
    v_mfma_f32_32x32x16_bf16 v[32:47], a[156:159], v[244:247], v[32:47]
    ds_read_b64_tr_b16 a[152:153], v110 offset:2048
    ds_read_b64_tr_b16 a[154:155], v110 offset:3072
    s_waitcnt lgkmcnt(6)
    v_mfma_f32_32x32x16_bf16 v[16:31], a[160:163], v[248:251], v[16:31]
    ds_read_b64_tr_b16 a[156:157], v110 offset:2560
    ds_read_b64_tr_b16 a[158:159], v110 offset:3584
    v_mfma_f32_32x32x16_bf16 v[32:47], a[164:167], v[248:251], v[32:47]
    ds_read_b64_tr_b16 a[160:161], v110 offset:4096
    ds_read_b64_tr_b16 a[162:163], v110 offset:5120
    s_add_u32 m0, s43, 8192
    s_add_u32 s44, s41, 74112
    buffer_load_dwordx4 v6, s[32:35], s44 offen offset:0 lds
    v_mfma_f32_32x32x16_bf16 v[16:31], a[168:171], v[252:255], v[16:31]
    ds_read_b64_tr_b16 a[164:165], v110 offset:4608
    ds_read_b64_tr_b16 a[166:167], v110 offset:5632
    v_mfma_f32_32x32x16_bf16 v[32:47], a[172:175], v[252:255], v[32:47]
    ds_read_b64_tr_b16 a[168:169], v110 offset:6144
    ds_read_b64_tr_b16 a[170:171], v110 offset:7168
    s_waitcnt lgkmcnt(6)
    v_mfma_f32_32x32x16_bf16 v[48:63], a[144:147], v[112:115], 0
    ds_read_b64_tr_b16 a[172:173], v110 offset:6656
    ds_read_b64_tr_b16 a[174:175], v110 offset:7680
    v_mfma_f32_32x32x16_bf16 v[64:79], a[148:151], v[112:115], 0
    ds_read_b64_tr_b16 a[144:145], v110 offset:8192
    ds_read_b64_tr_b16 a[146:147], v110 offset:9216
    s_add_u32 m0, s43, 36864
    s_add_u32 s44, s41, 332160
    buffer_load_dwordx4 v6, s[32:35], s44 offen offset:0 lds
    v_mfma_f32_32x32x16_bf16 v[48:63], a[152:155], v[116:119], v[48:63]
    ds_read_b64_tr_b16 a[148:149], v110 offset:8704
    ds_read_b64_tr_b16 a[150:151], v110 offset:9728
    v_mfma_f32_32x32x16_bf16 v[64:79], a[156:159], v[116:119], v[64:79]
    ds_read_b64_tr_b16 a[152:153], v110 offset:10240
    ds_read_b64_tr_b16 a[154:155], v110 offset:11264
    v_cvt_pk_bf16_f32 v80, v16, v17
    v_cvt_pk_bf16_f32 v81, v18, v19
    s_waitcnt lgkmcnt(6)
    v_mfma_f32_32x32x16_bf16 v[48:63], a[160:163], v[120:123], v[48:63]
    ds_read_b64_tr_b16 a[156:157], v110 offset:10752
    ds_read_b64_tr_b16 a[158:159], v110 offset:11776
    v_cvt_pk_bf16_f32 v82, v20, v21
    v_cvt_pk_bf16_f32 v83, v22, v23
    v_mfma_f32_32x32x16_bf16 v[64:79], a[164:167], v[120:123], v[64:79]
    ds_read_b64_tr_b16 a[160:161], v110 offset:12288
    ds_read_b64_tr_b16 a[162:163], v110 offset:13312
    buffer_load_dwordx4 v7, s[32:35], s44 offen offset:1024 lds
    v_mfma_f32_32x32x16_bf16 v[48:63], a[168:171], v[124:127], v[48:63]
    ds_read_b64_tr_b16 a[164:165], v110 offset:12800
    ds_read_b64_tr_b16 a[166:167], v110 offset:13824
    v_cvt_pk_bf16_f32 v84, v24, v25
    v_cvt_pk_bf16_f32 v85, v26, v27
    v_mfma_f32_32x32x16_bf16 v[64:79], a[172:175], v[124:127], v[64:79]
    ds_read_b64_tr_b16 a[168:169], v110 offset:14336
    ds_read_b64_tr_b16 a[170:171], v110 offset:15360
    v_cvt_pk_bf16_f32 v86, v28, v29
    v_cvt_pk_bf16_f32 v87, v30, v31
    s_waitcnt lgkmcnt(6)
    v_mfma_f32_32x32x16_bf16 v[48:63], a[144:147], v[128:131], v[48:63]
    ds_read_b64_tr_b16 a[172:173], v110 offset:14848
    ds_read_b64_tr_b16 a[174:175], v110 offset:15872
    buffer_store_dwordx4 v[80:83], v12, s[24:27], s52 offen offset:0 sc1
    v_mfma_f32_32x32x16_bf16 v[64:79], a[148:151], v[128:131], v[64:79]
    ds_read_b64_tr_b16 a[144:145], v110 offset:16384
    ds_read_b64_tr_b16 a[146:147], v110 offset:17408
    buffer_load_dwordx4 v8, s[32:35], s44 offen offset:2048 lds
    v_mfma_f32_32x32x16_bf16 v[48:63], a[152:155], v[132:135], v[48:63]
    ds_read_b64_tr_b16 a[148:149], v110 offset:16896
    ds_read_b64_tr_b16 a[150:151], v110 offset:17920
    buffer_store_dwordx4 v[84:87], v12, s[24:27], s52 offen offset:1024 sc1
    v_mfma_f32_32x32x16_bf16 v[64:79], a[156:159], v[132:135], v[64:79]
    ds_read_b64_tr_b16 a[152:153], v110 offset:18432
    ds_read_b64_tr_b16 a[154:155], v110 offset:19456
    v_cvt_pk_bf16_f32 v88, v32, v33
    v_cvt_pk_bf16_f32 v89, v34, v35
    s_waitcnt lgkmcnt(6)
    v_mfma_f32_32x32x16_bf16 v[48:63], a[160:163], v[136:139], v[48:63]
    ds_read_b64_tr_b16 a[156:157], v110 offset:18944
    ds_read_b64_tr_b16 a[158:159], v110 offset:19968
    v_cvt_pk_bf16_f32 v90, v36, v37
    v_cvt_pk_bf16_f32 v91, v38, v39
    v_mfma_f32_32x32x16_bf16 v[64:79], a[164:167], v[136:139], v[64:79]
    ds_read_b64_tr_b16 a[160:161], v110 offset:20480
    ds_read_b64_tr_b16 a[162:163], v110 offset:21504
    buffer_load_dwordx4 v9, s[32:35], s44 offen offset:3072 lds
    v_mfma_f32_32x32x16_bf16 v[48:63], a[168:171], v[140:143], v[48:63]
    ds_read_b64_tr_b16 a[164:165], v110 offset:20992
    ds_read_b64_tr_b16 a[166:167], v110 offset:22016
    v_cvt_pk_bf16_f32 v92, v40, v41
    v_cvt_pk_bf16_f32 v93, v42, v43
    v_mfma_f32_32x32x16_bf16 v[64:79], a[172:175], v[140:143], v[64:79]
    ds_read_b64_tr_b16 a[168:169], v110 offset:22528
    ds_read_b64_tr_b16 a[170:171], v110 offset:23552
    v_cvt_pk_bf16_f32 v94, v44, v45
    v_cvt_pk_bf16_f32 v95, v46, v47
    s_waitcnt lgkmcnt(6)
    v_mfma_f32_32x32x16_bf16 v[48:63], a[144:147], v[144:147], v[48:63]
    ds_read_b64_tr_b16 a[172:173], v110 offset:23040
    ds_read_b64_tr_b16 a[174:175], v110 offset:24064
    buffer_store_dwordx4 v[88:91], v12, s[24:27], s52 offen offset:2048 sc1
    v_mfma_f32_32x32x16_bf16 v[64:79], a[148:151], v[144:147], v[64:79]
    ds_read_b64_tr_b16 a[144:145], v110 offset:24576
    ds_read_b64_tr_b16 a[146:147], v110 offset:25600
    s_add_u32 m0, s43, 40960
    s_add_u32 s44, s41, 369024
    buffer_load_dwordx4 v6, s[32:35], s44 offen offset:0 lds
    v_mfma_f32_32x32x16_bf16 v[48:63], a[152:155], v[148:151], v[48:63]
    ds_read_b64_tr_b16 a[148:149], v110 offset:25088
    ds_read_b64_tr_b16 a[150:151], v110 offset:26112
    buffer_store_dwordx4 v[92:95], v12, s[24:27], s52 offen offset:3072 sc1
    v_mfma_f32_32x32x16_bf16 v[64:79], a[156:159], v[148:151], v[64:79]
    ds_read_b64_tr_b16 a[152:153], v110 offset:26624
    ds_read_b64_tr_b16 a[154:155], v110 offset:27648
    s_waitcnt lgkmcnt(6)
    v_mfma_f32_32x32x16_bf16 v[48:63], a[160:163], v[152:155], v[48:63]
    ds_read_b64_tr_b16 a[156:157], v110 offset:27136
    ds_read_b64_tr_b16 a[158:159], v110 offset:28160
    s_add_u32 s52, s52, 4096
    v_mfma_f32_32x32x16_bf16 v[64:79], a[164:167], v[152:155], v[64:79]
    ds_read_b64_tr_b16 a[160:161], v110 offset:28672
    ds_read_b64_tr_b16 a[162:163], v110 offset:29696
    buffer_load_dwordx4 v7, s[32:35], s44 offen offset:1024 lds
    v_mfma_f32_32x32x16_bf16 v[48:63], a[168:171], v[156:159], v[48:63]
    ds_read_b64_tr_b16 a[164:165], v110 offset:29184
    ds_read_b64_tr_b16 a[166:167], v110 offset:30208
    v_mfma_f32_32x32x16_bf16 v[64:79], a[172:175], v[156:159], v[64:79]
    ds_read_b64_tr_b16 a[168:169], v110 offset:30720
    ds_read_b64_tr_b16 a[170:171], v110 offset:31744
    s_waitcnt lgkmcnt(6)
    v_mfma_f32_32x32x16_bf16 v[48:63], a[144:147], v[160:163], v[48:63]
    ds_read_b64_tr_b16 a[172:173], v110 offset:31232
    ds_read_b64_tr_b16 a[174:175], v110 offset:32256
    v_mfma_f32_32x32x16_bf16 v[64:79], a[148:151], v[160:163], v[64:79]
    ds_read_b64_tr_b16 a[144:145], v110 offset:32768
    ds_read_b64_tr_b16 a[146:147], v110 offset:33792
    buffer_load_dwordx4 v8, s[32:35], s44 offen offset:2048 lds
    v_mfma_f32_32x32x16_bf16 v[48:63], a[152:155], v[164:167], v[48:63]
    ds_read_b64_tr_b16 a[148:149], v110 offset:33280
    ds_read_b64_tr_b16 a[150:151], v110 offset:34304
    v_mfma_f32_32x32x16_bf16 v[64:79], a[156:159], v[164:167], v[64:79]
    ds_read_b64_tr_b16 a[152:153], v110 offset:34816
    ds_read_b64_tr_b16 a[154:155], v110 offset:35840
    s_waitcnt lgkmcnt(6)
    v_mfma_f32_32x32x16_bf16 v[48:63], a[160:163], v[168:171], v[48:63]
    ds_read_b64_tr_b16 a[156:157], v110 offset:35328
    ds_read_b64_tr_b16 a[158:159], v110 offset:36352
    v_mfma_f32_32x32x16_bf16 v[64:79], a[164:167], v[168:171], v[64:79]
    s_waitcnt vmcnt(20)
    s_barrier
    ds_read_b64_tr_b16 a[160:161], v111 offset:0
    ds_read_b64_tr_b16 a[162:163], v111 offset:1024
    buffer_load_dwordx4 v9, s[32:35], s44 offen offset:3072 lds
    v_mfma_f32_32x32x16_bf16 v[48:63], a[168:171], v[172:175], v[48:63]
    ds_read_b64_tr_b16 a[164:165], v111 offset:512
    ds_read_b64_tr_b16 a[166:167], v111 offset:1536
    v_mfma_f32_32x32x16_bf16 v[64:79], a[172:175], v[172:175], v[64:79]
    ds_read_b64_tr_b16 a[168:169], v111 offset:2048
    ds_read_b64_tr_b16 a[170:171], v111 offset:3072
    s_add_u32 s46, s46, 1
    s_max_i32 s8, s46, 0
    s_add_u32 s8, s8, s97
    v_mov_b32 v14, s8
    s_mov_b64 exec, 1
    buffer_store_dword v14, v15, s[24:27], s99 offen sc1
    s_mov_b64 exec, -1
    s_waitcnt lgkmcnt(6)
    v_mfma_f32_32x32x16_bf16 v[48:63], a[144:147], v[176:179], v[48:63]
    ds_read_b64_tr_b16 a[172:173], v111 offset:2560
    ds_read_b64_tr_b16 a[174:175], v111 offset:3584
    v_mfma_f32_32x32x16_bf16 v[64:79], a[148:151], v[176:179], v[64:79]
    ds_read_b64_tr_b16 a[144:145], v111 offset:4096
    ds_read_b64_tr_b16 a[146:147], v111 offset:5120
    s_add_u32 m0, s43, 45056
    s_add_u32 s44, s41, 405888
    buffer_load_dwordx4 v6, s[32:35], s44 offen offset:0 lds
    v_mfma_f32_32x32x16_bf16 v[48:63], a[152:155], v[180:183], v[48:63]
    ds_read_b64_tr_b16 a[148:149], v111 offset:4608
    ds_read_b64_tr_b16 a[150:151], v111 offset:5632
    v_mfma_f32_32x32x16_bf16 v[64:79], a[156:159], v[180:183], v[64:79]
    ds_read_b64_tr_b16 a[152:153], v111 offset:6144
    ds_read_b64_tr_b16 a[154:155], v111 offset:7168
    s_waitcnt lgkmcnt(6)
    v_mfma_f32_32x32x16_bf16 v[48:63], a[160:163], v[184:187], v[48:63]
    ds_read_b64_tr_b16 a[156:157], v111 offset:6656
    ds_read_b64_tr_b16 a[158:159], v111 offset:7680
    v_mfma_f32_32x32x16_bf16 v[64:79], a[164:167], v[184:187], v[64:79]
    ds_read_b64_tr_b16 a[160:161], v111 offset:8192
    ds_read_b64_tr_b16 a[162:163], v111 offset:9216
    s_add_u32 m0, s43, 73728
    s_add_u32 s44, s41, 512
    buffer_load_dwordx4 v6, s[32:35], s44 offen offset:0 lds
    v_mfma_f32_32x32x16_bf16 v[48:63], a[168:171], v[188:191], v[48:63]
    ds_read_b64_tr_b16 a[164:165], v111 offset:8704
    ds_read_b64_tr_b16 a[166:167], v111 offset:9728
    v_mfma_f32_32x32x16_bf16 v[64:79], a[172:175], v[188:191], v[64:79]
    ds_read_b64_tr_b16 a[168:169], v111 offset:10240
    ds_read_b64_tr_b16 a[170:171], v111 offset:11264
    s_waitcnt lgkmcnt(6)
    v_mfma_f32_32x32x16_bf16 v[48:63], a[144:147], v[192:195], v[48:63]
    ds_read_b64_tr_b16 a[172:173], v111 offset:10752
    ds_read_b64_tr_b16 a[174:175], v111 offset:11776
    v_mfma_f32_32x32x16_bf16 v[64:79], a[148:151], v[192:195], v[64:79]
    ds_read_b64_tr_b16 a[144:145], v111 offset:12288
    ds_read_b64_tr_b16 a[146:147], v111 offset:13312
    buffer_load_dwordx4 v7, s[32:35], s44 offen offset:1024 lds
    v_mfma_f32_32x32x16_bf16 v[48:63], a[152:155], v[196:199], v[48:63]
    ds_read_b64_tr_b16 a[148:149], v111 offset:12800
    ds_read_b64_tr_b16 a[150:151], v111 offset:13824
    v_mfma_f32_32x32x16_bf16 v[64:79], a[156:159], v[196:199], v[64:79]
    ds_read_b64_tr_b16 a[152:153], v111 offset:14336
    ds_read_b64_tr_b16 a[154:155], v111 offset:15360
    s_waitcnt lgkmcnt(6)
    v_mfma_f32_32x32x16_bf16 v[48:63], a[160:163], v[200:203], v[48:63]
    ds_read_b64_tr_b16 a[156:157], v111 offset:14848
    ds_read_b64_tr_b16 a[158:159], v111 offset:15872
    v_mfma_f32_32x32x16_bf16 v[64:79], a[164:167], v[200:203], v[64:79]
    ds_read_b64_tr_b16 a[160:161], v111 offset:16384
    ds_read_b64_tr_b16 a[162:163], v111 offset:17408
    buffer_load_dwordx4 v8, s[32:35], s44 offen offset:2048 lds
    v_mfma_f32_32x32x16_bf16 v[48:63], a[168:171], v[204:207], v[48:63]
    ds_read_b64_tr_b16 a[164:165], v111 offset:16896
    ds_read_b64_tr_b16 a[166:167], v111 offset:17920
    v_mfma_f32_32x32x16_bf16 v[64:79], a[172:175], v[204:207], v[64:79]
    ds_read_b64_tr_b16 a[168:169], v111 offset:18432
    ds_read_b64_tr_b16 a[170:171], v111 offset:19456
    s_waitcnt lgkmcnt(6)
    v_mfma_f32_32x32x16_bf16 v[48:63], a[144:147], v[208:211], v[48:63]
    ds_read_b64_tr_b16 a[172:173], v111 offset:18944
    ds_read_b64_tr_b16 a[174:175], v111 offset:19968
    v_mfma_f32_32x32x16_bf16 v[64:79], a[148:151], v[208:211], v[64:79]
    ds_read_b64_tr_b16 a[144:145], v111 offset:20480
    ds_read_b64_tr_b16 a[146:147], v111 offset:21504
    buffer_load_dwordx4 v9, s[32:35], s44 offen offset:3072 lds
    v_mfma_f32_32x32x16_bf16 v[48:63], a[152:155], v[212:215], v[48:63]
    ds_read_b64_tr_b16 a[148:149], v111 offset:20992
    ds_read_b64_tr_b16 a[150:151], v111 offset:22016
    v_mfma_f32_32x32x16_bf16 v[64:79], a[156:159], v[212:215], v[64:79]
    ds_read_b64_tr_b16 a[152:153], v111 offset:22528
    ds_read_b64_tr_b16 a[154:155], v111 offset:23552
    s_waitcnt lgkmcnt(6)
    v_mfma_f32_32x32x16_bf16 v[48:63], a[160:163], v[216:219], v[48:63]
    ds_read_b64_tr_b16 a[156:157], v111 offset:23040
    ds_read_b64_tr_b16 a[158:159], v111 offset:24064
    v_mfma_f32_32x32x16_bf16 v[64:79], a[164:167], v[216:219], v[64:79]
    ds_read_b64_tr_b16 a[160:161], v111 offset:24576
    ds_read_b64_tr_b16 a[162:163], v111 offset:25600
    s_add_u32 m0, s43, 77824
    s_add_u32 s44, s41, 37376
    buffer_load_dwordx4 v6, s[32:35], s44 offen offset:0 lds
    v_mfma_f32_32x32x16_bf16 v[48:63], a[168:171], v[220:223], v[48:63]
    ds_read_b64_tr_b16 a[164:165], v111 offset:25088
    ds_read_b64_tr_b16 a[166:167], v111 offset:26112
    v_mfma_f32_32x32x16_bf16 v[64:79], a[172:175], v[220:223], v[64:79]
    ds_read_b64_tr_b16 a[168:169], v111 offset:26624
    ds_read_b64_tr_b16 a[170:171], v111 offset:27648
    s_waitcnt lgkmcnt(6)
    v_mfma_f32_32x32x16_bf16 v[48:63], a[144:147], v[224:227], v[48:63]
    ds_read_b64_tr_b16 a[172:173], v111 offset:27136
    ds_read_b64_tr_b16 a[174:175], v111 offset:28160
    v_mfma_f32_32x32x16_bf16 v[64:79], a[148:151], v[224:227], v[64:79]
    ds_read_b64_tr_b16 a[144:145], v111 offset:28672
    ds_read_b64_tr_b16 a[146:147], v111 offset:29696
    buffer_load_dwordx4 v7, s[32:35], s44 offen offset:1024 lds
    v_mfma_f32_32x32x16_bf16 v[48:63], a[152:155], v[228:231], v[48:63]
    ds_read_b64_tr_b16 a[148:149], v111 offset:29184
    ds_read_b64_tr_b16 a[150:151], v111 offset:30208
    v_mfma_f32_32x32x16_bf16 v[64:79], a[156:159], v[228:231], v[64:79]
    ds_read_b64_tr_b16 a[152:153], v111 offset:30720
    ds_read_b64_tr_b16 a[154:155], v111 offset:31744
    s_waitcnt lgkmcnt(6)
    v_mfma_f32_32x32x16_bf16 v[48:63], a[160:163], v[232:235], v[48:63]
    ds_read_b64_tr_b16 a[156:157], v111 offset:31232
    ds_read_b64_tr_b16 a[158:159], v111 offset:32256
    v_mfma_f32_32x32x16_bf16 v[64:79], a[164:167], v[232:235], v[64:79]
    ds_read_b64_tr_b16 a[160:161], v111 offset:32768
    ds_read_b64_tr_b16 a[162:163], v111 offset:33792
    buffer_load_dwordx4 v8, s[32:35], s44 offen offset:2048 lds
    v_mfma_f32_32x32x16_bf16 v[48:63], a[168:171], v[236:239], v[48:63]
    ds_read_b64_tr_b16 a[164:165], v111 offset:33280
    ds_read_b64_tr_b16 a[166:167], v111 offset:34304
    v_mfma_f32_32x32x16_bf16 v[64:79], a[172:175], v[236:239], v[64:79]
    ds_read_b64_tr_b16 a[168:169], v111 offset:34816
    ds_read_b64_tr_b16 a[170:171], v111 offset:35840
    s_waitcnt lgkmcnt(6)
    v_mfma_f32_32x32x16_bf16 v[48:63], a[144:147], v[240:243], v[48:63]
    ds_read_b64_tr_b16 a[172:173], v111 offset:35328
    ds_read_b64_tr_b16 a[174:175], v111 offset:36352
    v_mfma_f32_32x32x16_bf16 v[64:79], a[148:151], v[240:243], v[64:79]
    s_waitcnt vmcnt(21)
    s_barrier
    ds_read_b64_tr_b16 a[144:145], v108 offset:0
    ds_read_b64_tr_b16 a[146:147], v108 offset:1024
    buffer_load_dwordx4 v9, s[32:35], s44 offen offset:3072 lds
    v_mfma_f32_32x32x16_bf16 v[48:63], a[152:155], v[244:247], v[48:63]
    ds_read_b64_tr_b16 a[148:149], v108 offset:512
    ds_read_b64_tr_b16 a[150:151], v108 offset:1536
    v_mfma_f32_32x32x16_bf16 v[64:79], a[156:159], v[244:247], v[64:79]
    ds_read_b64_tr_b16 a[152:153], v108 offset:2048
    ds_read_b64_tr_b16 a[154:155], v108 offset:3072
    s_waitcnt lgkmcnt(6)
    v_mfma_f32_32x32x16_bf16 v[48:63], a[160:163], v[248:251], v[48:63]
    ds_read_b64_tr_b16 a[156:157], v108 offset:2560
    ds_read_b64_tr_b16 a[158:159], v108 offset:3584
    v_mfma_f32_32x32x16_bf16 v[64:79], a[164:167], v[248:251], v[64:79]
    ds_read_b64_tr_b16 a[160:161], v108 offset:4096
    ds_read_b64_tr_b16 a[162:163], v108 offset:5120
    s_add_u32 m0, s43, 81920
    s_add_u32 s44, s41, 74240
    buffer_load_dwordx4 v6, s[32:35], s44 offen offset:0 lds
    v_mfma_f32_32x32x16_bf16 v[48:63], a[168:171], v[252:255], v[48:63]
    ds_read_b64_tr_b16 a[164:165], v108 offset:4608
    ds_read_b64_tr_b16 a[166:167], v108 offset:5632
    v_mfma_f32_32x32x16_bf16 v[64:79], a[172:175], v[252:255], v[64:79]
    ds_read_b64_tr_b16 a[168:169], v108 offset:6144
    ds_read_b64_tr_b16 a[170:171], v108 offset:7168
    s_waitcnt lgkmcnt(6)
    s_add_u32 s41, s41, 256
    s_sub_u32 s15, s15, 1
    s_cmp_lg_u32 s15, 0
    s_cbranch_scc1 M_loop
    s_load_dwordx2 s[92:93], s[0:1], 32
    s_waitcnt lgkmcnt(0)
    s_mov_b32 s16, s92
    s_and_b32 s17, s93, 0xffff
    s_mov_b32 s18, 663552
    s_mov_b32 s19, 0x20000
    v_mbcnt_lo_u32_b32 v14, -1, 0
    v_mbcnt_hi_u32_b32 v14, -1, v14
    v_lshrrev_b32 v13, 2, v14
    v_mul_u32_u24 v13, 1152, v13
    v_and_b32 v14, 3, v14
    v_lshlrev_b32 v14, 4, v14
    v_add_u32 v13, v13, v14
    s_mul_i32 s53, s5, 165888
    s_and_b32 s8, s3, 1
    s_lshl_b32 s8, s8, 6
    s_add_u32 s54, s53, s8
    s_add_u32 s54, s54, 1024
    s_lshl_b32 s8, s3, 7
    s_add_u32 s53, s53, s8
    v_mfma_f32_32x32x16_bf16 v[16:31], a[144:147], v[112:115], 0
    ds_read_b64_tr_b16 a[172:173], v108 offset:6656
    ds_read_b64_tr_b16 a[174:175], v108 offset:7680
    v_mfma_f32_32x32x16_bf16 v[32:47], a[148:151], v[112:115], 0
    ds_read_b64_tr_b16 a[144:145], v108 offset:8192
    ds_read_b64_tr_b16 a[146:147], v108 offset:9216
    s_add_u32 m0, s43, 110592
    s_add_u32 s44, s41, 332032
    buffer_load_dwordx4 v6, s[32:35], s44 offen offset:0 lds
    v_mfma_f32_32x32x16_bf16 v[16:31], a[152:155], v[116:119], v[16:31]
    ds_read_b64_tr_b16 a[148:149], v108 offset:8704
    ds_read_b64_tr_b16 a[150:151], v108 offset:9728
    v_mfma_f32_32x32x16_bf16 v[32:47], a[156:159], v[116:119], v[32:47]
    ds_read_b64_tr_b16 a[152:153], v108 offset:10240
    ds_read_b64_tr_b16 a[154:155], v108 offset:11264
    v_cvt_pk_bf16_f32 v80, v48, v49
    v_cvt_pk_bf16_f32 v81, v50, v51
    s_waitcnt lgkmcnt(6)
    v_mfma_f32_32x32x16_bf16 v[16:31], a[160:163], v[120:123], v[16:31]
    ds_read_b64_tr_b16 a[156:157], v108 offset:10752
    ds_read_b64_tr_b16 a[158:159], v108 offset:11776
    v_cvt_pk_bf16_f32 v82, v52, v53
    v_cvt_pk_bf16_f32 v83, v54, v55
    v_mfma_f32_32x32x16_bf16 v[32:47], a[164:167], v[120:123], v[32:47]
    ds_read_b64_tr_b16 a[160:161], v108 offset:12288
    ds_read_b64_tr_b16 a[162:163], v108 offset:13312
    buffer_load_dwordx4 v7, s[32:35], s44 offen offset:1024 lds
    v_mfma_f32_32x32x16_bf16 v[16:31], a[168:171], v[124:127], v[16:31]
    ds_read_b64_tr_b16 a[164:165], v108 offset:12800
    ds_read_b64_tr_b16 a[166:167], v108 offset:13824
    v_cvt_pk_bf16_f32 v84, v56, v57
    v_cvt_pk_bf16_f32 v85, v58, v59
    v_mfma_f32_32x32x16_bf16 v[32:47], a[172:175], v[124:127], v[32:47]
    ds_read_b64_tr_b16 a[168:169], v108 offset:14336
    ds_read_b64_tr_b16 a[170:171], v108 offset:15360
    v_cvt_pk_bf16_f32 v86, v60, v61
    v_cvt_pk_bf16_f32 v87, v62, v63
    s_waitcnt lgkmcnt(6)
    v_mfma_f32_32x32x16_bf16 v[16:31], a[144:147], v[128:131], v[16:31]
    ds_read_b64_tr_b16 a[172:173], v108 offset:14848
    ds_read_b64_tr_b16 a[174:175], v108 offset:15872
    buffer_store_dwordx4 v[80:83], v12, s[24:27], s52 offen offset:0 sc1
    v_mfma_f32_32x32x16_bf16 v[32:47], a[148:151], v[128:131], v[32:47]
    ds_read_b64_tr_b16 a[144:145], v108 offset:16384
    ds_read_b64_tr_b16 a[146:147], v108 offset:17408
    buffer_load_dwordx4 v8, s[32:35], s44 offen offset:2048 lds
    v_mfma_f32_32x32x16_bf16 v[16:31], a[152:155], v[132:135], v[16:31]
    ds_read_b64_tr_b16 a[148:149], v108 offset:16896
    ds_read_b64_tr_b16 a[150:151], v108 offset:17920
    buffer_store_dwordx4 v[84:87], v12, s[24:27], s52 offen offset:1024 sc1
    v_mfma_f32_32x32x16_bf16 v[32:47], a[156:159], v[132:135], v[32:47]
    ds_read_b64_tr_b16 a[152:153], v108 offset:18432
    ds_read_b64_tr_b16 a[154:155], v108 offset:19456
    v_cvt_pk_bf16_f32 v88, v64, v65
    v_cvt_pk_bf16_f32 v89, v66, v67
    s_waitcnt lgkmcnt(6)
    v_mfma_f32_32x32x16_bf16 v[16:31], a[160:163], v[136:139], v[16:31]
    ds_read_b64_tr_b16 a[156:157], v108 offset:18944
    ds_read_b64_tr_b16 a[158:159], v108 offset:19968
    v_cvt_pk_bf16_f32 v90, v68, v69
    v_cvt_pk_bf16_f32 v91, v70, v71
    v_mfma_f32_32x32x16_bf16 v[32:47], a[164:167], v[136:139], v[32:47]
    ds_read_b64_tr_b16 a[160:161], v108 offset:20480
    ds_read_b64_tr_b16 a[162:163], v108 offset:21504
    buffer_load_dwordx4 v9, s[32:35], s44 offen offset:3072 lds
    v_mfma_f32_32x32x16_bf16 v[16:31], a[168:171], v[140:143], v[16:31]
    ds_read_b64_tr_b16 a[164:165], v108 offset:20992
    ds_read_b64_tr_b16 a[166:167], v108 offset:22016
    v_cvt_pk_bf16_f32 v92, v72, v73
    v_cvt_pk_bf16_f32 v93, v74, v75
    v_mfma_f32_32x32x16_bf16 v[32:47], a[172:175], v[140:143], v[32:47]
    ds_read_b64_tr_b16 a[168:169], v108 offset:22528
    ds_read_b64_tr_b16 a[170:171], v108 offset:23552
    v_cvt_pk_bf16_f32 v94, v76, v77
    v_cvt_pk_bf16_f32 v95, v78, v79
    s_waitcnt lgkmcnt(6)
    v_mfma_f32_32x32x16_bf16 v[16:31], a[144:147], v[144:147], v[16:31]
    ds_read_b64_tr_b16 a[172:173], v108 offset:23040
    ds_read_b64_tr_b16 a[174:175], v108 offset:24064
    buffer_store_dwordx4 v[88:91], v12, s[24:27], s52 offen offset:2048 sc1
    v_mfma_f32_32x32x16_bf16 v[32:47], a[148:151], v[144:147], v[32:47]
    ds_read_b64_tr_b16 a[144:145], v108 offset:24576
    ds_read_b64_tr_b16 a[146:147], v108 offset:25600
    s_add_u32 m0, s43, 114688
    s_add_u32 s44, s41, 368896
    buffer_load_dwordx4 v6, s[32:35], s44 offen offset:0 lds
    v_mfma_f32_32x32x16_bf16 v[16:31], a[152:155], v[148:151], v[16:31]
    ds_read_b64_tr_b16 a[148:149], v108 offset:25088
    ds_read_b64_tr_b16 a[150:151], v108 offset:26112
    buffer_store_dwordx4 v[92:95], v12, s[24:27], s52 offen offset:3072 sc1
    v_mfma_f32_32x32x16_bf16 v[32:47], a[156:159], v[148:151], v[32:47]
    ds_read_b64_tr_b16 a[152:153], v108 offset:26624
    ds_read_b64_tr_b16 a[154:155], v108 offset:27648
    s_waitcnt lgkmcnt(6)
    v_mfma_f32_32x32x16_bf16 v[16:31], a[160:163], v[152:155], v[16:31]
    ds_read_b64_tr_b16 a[156:157], v108 offset:27136
    ds_read_b64_tr_b16 a[158:159], v108 offset:28160
    s_add_u32 s52, s52, 4096
    v_mfma_f32_32x32x16_bf16 v[32:47], a[164:167], v[152:155], v[32:47]
    ds_read_b64_tr_b16 a[160:161], v108 offset:28672
    ds_read_b64_tr_b16 a[162:163], v108 offset:29696
    buffer_load_dwordx4 v7, s[32:35], s44 offen offset:1024 lds
    v_mfma_f32_32x32x16_bf16 v[16:31], a[168:171], v[156:159], v[16:31]
    ds_read_b64_tr_b16 a[164:165], v108 offset:29184
    ds_read_b64_tr_b16 a[166:167], v108 offset:30208
    v_mfma_f32_32x32x16_bf16 v[32:47], a[172:175], v[156:159], v[32:47]
    ds_read_b64_tr_b16 a[168:169], v108 offset:30720
    ds_read_b64_tr_b16 a[170:171], v108 offset:31744
    s_waitcnt lgkmcnt(6)
    v_mfma_f32_32x32x16_bf16 v[16:31], a[144:147], v[160:163], v[16:31]
    ds_read_b64_tr_b16 a[172:173], v108 offset:31232
    ds_read_b64_tr_b16 a[174:175], v108 offset:32256
    v_mfma_f32_32x32x16_bf16 v[32:47], a[148:151], v[160:163], v[32:47]
    ds_read_b64_tr_b16 a[144:145], v108 offset:32768
    ds_read_b64_tr_b16 a[146:147], v108 offset:33792
    buffer_load_dwordx4 v8, s[32:35], s44 offen offset:2048 lds
    v_mfma_f32_32x32x16_bf16 v[16:31], a[152:155], v[164:167], v[16:31]
    ds_read_b64_tr_b16 a[148:149], v108 offset:33280
    ds_read_b64_tr_b16 a[150:151], v108 offset:34304
    v_mfma_f32_32x32x16_bf16 v[32:47], a[156:159], v[164:167], v[32:47]
    ds_read_b64_tr_b16 a[152:153], v108 offset:34816
    ds_read_b64_tr_b16 a[154:155], v108 offset:35840
    s_waitcnt lgkmcnt(6)
    v_mfma_f32_32x32x16_bf16 v[16:31], a[160:163], v[168:171], v[16:31]
    ds_read_b64_tr_b16 a[156:157], v108 offset:35328
    ds_read_b64_tr_b16 a[158:159], v108 offset:36352
    v_mfma_f32_32x32x16_bf16 v[32:47], a[164:167], v[168:171], v[32:47]
    s_waitcnt vmcnt(20)
    s_barrier
    ds_read_b64_tr_b16 a[160:161], v109 offset:0
    ds_read_b64_tr_b16 a[162:163], v109 offset:1024
    buffer_load_dwordx4 v9, s[32:35], s44 offen offset:3072 lds
    v_mfma_f32_32x32x16_bf16 v[16:31], a[168:171], v[172:175], v[16:31]
    ds_read_b64_tr_b16 a[164:165], v109 offset:512
    ds_read_b64_tr_b16 a[166:167], v109 offset:1536
    v_mfma_f32_32x32x16_bf16 v[32:47], a[172:175], v[172:175], v[32:47]
    ds_read_b64_tr_b16 a[168:169], v109 offset:2048
    ds_read_b64_tr_b16 a[170:171], v109 offset:3072
    s_add_u32 s46, s46, 1
    s_max_i32 s8, s46, 0
    s_add_u32 s8, s8, s97
    v_mov_b32 v14, s8
    s_mov_b64 exec, 1
    buffer_store_dword v14, v15, s[24:27], s99 offen sc1
    s_mov_b64 exec, -1
    s_waitcnt lgkmcnt(6)
    v_mfma_f32_32x32x16_bf16 v[16:31], a[144:147], v[176:179], v[16:31]
    ds_read_b64_tr_b16 a[172:173], v109 offset:2560
    ds_read_b64_tr_b16 a[174:175], v109 offset:3584
    v_mfma_f32_32x32x16_bf16 v[32:47], a[148:151], v[176:179], v[32:47]
    ds_read_b64_tr_b16 a[144:145], v109 offset:4096
    ds_read_b64_tr_b16 a[146:147], v109 offset:5120
    s_add_u32 m0, s43, 118784
    s_add_u32 s44, s41, 405760
    buffer_load_dwordx4 v6, s[32:35], s44 offen offset:0 lds
    v_mfma_f32_32x32x16_bf16 v[16:31], a[152:155], v[180:183], v[16:31]
    ds_read_b64_tr_b16 a[148:149], v109 offset:4608
    ds_read_b64_tr_b16 a[150:151], v109 offset:5632
    v_mfma_f32_32x32x16_bf16 v[32:47], a[156:159], v[180:183], v[32:47]
    ds_read_b64_tr_b16 a[152:153], v109 offset:6144
    ds_read_b64_tr_b16 a[154:155], v109 offset:7168
    s_waitcnt lgkmcnt(6)
    v_mfma_f32_32x32x16_bf16 v[16:31], a[160:163], v[184:187], v[16:31]
    ds_read_b64_tr_b16 a[156:157], v109 offset:6656
    ds_read_b64_tr_b16 a[158:159], v109 offset:7680
    v_mfma_f32_32x32x16_bf16 v[32:47], a[164:167], v[184:187], v[32:47]
    ds_read_b64_tr_b16 a[160:161], v109 offset:8192
    ds_read_b64_tr_b16 a[162:163], v109 offset:9216
    s_add_u32 m0, s43, 0
    s_add_u32 s44, s53, 0
    buffer_load_dwordx4 v13, s[16:19], s44 offen lds
    v_mfma_f32_32x32x16_bf16 v[16:31], a[168:171], v[188:191], v[16:31]
    ds_read_b64_tr_b16 a[164:165], v109 offset:8704
    ds_read_b64_tr_b16 a[166:167], v109 offset:9728
    v_mfma_f32_32x32x16_bf16 v[32:47], a[172:175], v[188:191], v[32:47]
    ds_read_b64_tr_b16 a[168:169], v109 offset:10240
    ds_read_b64_tr_b16 a[170:171], v109 offset:11264
    s_waitcnt lgkmcnt(6)
    v_mfma_f32_32x32x16_bf16 v[16:31], a[144:147], v[192:195], v[16:31]
    ds_read_b64_tr_b16 a[172:173], v109 offset:10752
    ds_read_b64_tr_b16 a[174:175], v109 offset:11776
    v_mfma_f32_32x32x16_bf16 v[32:47], a[148:151], v[192:195], v[32:47]
    ds_read_b64_tr_b16 a[144:145], v109 offset:12288
    ds_read_b64_tr_b16 a[146:147], v109 offset:13312
    s_add_u32 m0, s43, 1024
    s_add_u32 s44, s53, 18432
    buffer_load_dwordx4 v13, s[16:19], s44 offen lds
    v_mfma_f32_32x32x16_bf16 v[16:31], a[152:155], v[196:199], v[16:31]
    ds_read_b64_tr_b16 a[148:149], v109 offset:12800
    ds_read_b64_tr_b16 a[150:151], v109 offset:13824
    v_mfma_f32_32x32x16_bf16 v[32:47], a[156:159], v[196:199], v[32:47]
    ds_read_b64_tr_b16 a[152:153], v109 offset:14336
    ds_read_b64_tr_b16 a[154:155], v109 offset:15360
    s_waitcnt lgkmcnt(6)
    v_mfma_f32_32x32x16_bf16 v[16:31], a[160:163], v[200:203], v[16:31]
    ds_read_b64_tr_b16 a[156:157], v109 offset:14848
    ds_read_b64_tr_b16 a[158:159], v109 offset:15872
    v_mfma_f32_32x32x16_bf16 v[32:47], a[164:167], v[200:203], v[32:47]
    ds_read_b64_tr_b16 a[160:161], v109 offset:16384
    ds_read_b64_tr_b16 a[162:163], v109 offset:17408
    s_add_u32 m0, s43, 2048
    s_add_u32 s44, s53, 36864
    buffer_load_dwordx4 v13, s[16:19], s44 offen lds
    v_mfma_f32_32x32x16_bf16 v[16:31], a[168:171], v[204:207], v[16:31]
    ds_read_b64_tr_b16 a[164:165], v109 offset:16896
    ds_read_b64_tr_b16 a[166:167], v109 offset:17920
    v_mfma_f32_32x32x16_bf16 v[32:47], a[172:175], v[204:207], v[32:47]
    ds_read_b64_tr_b16 a[168:169], v109 offset:18432
    ds_read_b64_tr_b16 a[170:171], v109 offset:19456
    s_waitcnt lgkmcnt(6)
    v_mfma_f32_32x32x16_bf16 v[16:31], a[144:147], v[208:211], v[16:31]
    ds_read_b64_tr_b16 a[172:173], v109 offset:18944
    ds_read_b64_tr_b16 a[174:175], v109 offset:19968
    v_mfma_f32_32x32x16_bf16 v[32:47], a[148:151], v[208:211], v[32:47]
    ds_read_b64_tr_b16 a[144:145], v109 offset:20480
    ds_read_b64_tr_b16 a[146:147], v109 offset:21504
    s_add_u32 m0, s43, 3072
    s_add_u32 s44, s53, 55296
    buffer_load_dwordx4 v13, s[16:19], s44 offen lds
    v_mfma_f32_32x32x16_bf16 v[16:31], a[152:155], v[212:215], v[16:31]
    ds_read_b64_tr_b16 a[148:149], v109 offset:20992
    ds_read_b64_tr_b16 a[150:151], v109 offset:22016
    v_mfma_f32_32x32x16_bf16 v[32:47], a[156:159], v[212:215], v[32:47]
    ds_read_b64_tr_b16 a[152:153], v109 offset:22528
    ds_read_b64_tr_b16 a[154:155], v109 offset:23552
    s_waitcnt lgkmcnt(6)
    v_mfma_f32_32x32x16_bf16 v[16:31], a[160:163], v[216:219], v[16:31]
    ds_read_b64_tr_b16 a[156:157], v109 offset:23040
    ds_read_b64_tr_b16 a[158:159], v109 offset:24064
    v_mfma_f32_32x32x16_bf16 v[32:47], a[164:167], v[216:219], v[32:47]
    ds_read_b64_tr_b16 a[160:161], v109 offset:24576
    ds_read_b64_tr_b16 a[162:163], v109 offset:25600
    s_add_u32 m0, s43, 4096
    s_add_u32 s44, s53, 73728
    buffer_load_dwordx4 v13, s[16:19], s44 offen lds
    v_mfma_f32_32x32x16_bf16 v[16:31], a[168:171], v[220:223], v[16:31]
    ds_read_b64_tr_b16 a[164:165], v109 offset:25088
    ds_read_b64_tr_b16 a[166:167], v109 offset:26112
    v_mfma_f32_32x32x16_bf16 v[32:47], a[172:175], v[220:223], v[32:47]
    ds_read_b64_tr_b16 a[168:169], v109 offset:26624
    ds_read_b64_tr_b16 a[170:171], v109 offset:27648
    s_waitcnt lgkmcnt(6)
    v_mfma_f32_32x32x16_bf16 v[16:31], a[144:147], v[224:227], v[16:31]
    ds_read_b64_tr_b16 a[172:173], v109 offset:27136
    ds_read_b64_tr_b16 a[174:175], v109 offset:28160
    v_mfma_f32_32x32x16_bf16 v[32:47], a[148:151], v[224:227], v[32:47]
    ds_read_b64_tr_b16 a[144:145], v109 offset:28672
    ds_read_b64_tr_b16 a[146:147], v109 offset:29696
    s_add_u32 m0, s43, 5120
    s_add_u32 s44, s53, 92160
    buffer_load_dwordx4 v13, s[16:19], s44 offen lds
    v_mfma_f32_32x32x16_bf16 v[16:31], a[152:155], v[228:231], v[16:31]
    ds_read_b64_tr_b16 a[148:149], v109 offset:29184
    ds_read_b64_tr_b16 a[150:151], v109 offset:30208
    v_mfma_f32_32x32x16_bf16 v[32:47], a[156:159], v[228:231], v[32:47]
    ds_read_b64_tr_b16 a[152:153], v109 offset:30720
    ds_read_b64_tr_b16 a[154:155], v109 offset:31744
    s_waitcnt lgkmcnt(6)
    v_mfma_f32_32x32x16_bf16 v[16:31], a[160:163], v[232:235], v[16:31]
    ds_read_b64_tr_b16 a[156:157], v109 offset:31232
    ds_read_b64_tr_b16 a[158:159], v109 offset:32256
    v_mfma_f32_32x32x16_bf16 v[32:47], a[164:167], v[232:235], v[32:47]
    ds_read_b64_tr_b16 a[160:161], v109 offset:32768
    ds_read_b64_tr_b16 a[162:163], v109 offset:33792
    s_add_u32 m0, s43, 6144
    s_add_u32 s44, s53, 110592
    buffer_load_dwordx4 v13, s[16:19], s44 offen lds
    v_mfma_f32_32x32x16_bf16 v[16:31], a[168:171], v[236:239], v[16:31]
    ds_read_b64_tr_b16 a[164:165], v109 offset:33280
    ds_read_b64_tr_b16 a[166:167], v109 offset:34304
    v_mfma_f32_32x32x16_bf16 v[32:47], a[172:175], v[236:239], v[32:47]
    ds_read_b64_tr_b16 a[168:169], v109 offset:34816
    ds_read_b64_tr_b16 a[170:171], v109 offset:35840
    s_waitcnt lgkmcnt(6)
    v_mfma_f32_32x32x16_bf16 v[16:31], a[144:147], v[240:243], v[16:31]
    ds_read_b64_tr_b16 a[172:173], v109 offset:35328
    ds_read_b64_tr_b16 a[174:175], v109 offset:36352
    v_mfma_f32_32x32x16_bf16 v[32:47], a[148:151], v[240:243], v[32:47]
    s_waitcnt vmcnt(21)
    s_barrier
    ds_read_b64_tr_b16 a[144:145], v110 offset:0
    ds_read_b64_tr_b16 a[146:147], v110 offset:1024
    s_add_u32 m0, s43, 7168
    s_add_u32 s44, s53, 129024
    buffer_load_dwordx4 v13, s[16:19], s44 offen lds
    v_mfma_f32_32x32x16_bf16 v[16:31], a[152:155], v[244:247], v[16:31]
    ds_read_b64_tr_b16 a[148:149], v110 offset:512
    ds_read_b64_tr_b16 a[150:151], v110 offset:1536
    v_mfma_f32_32x32x16_bf16 v[32:47], a[156:159], v[244:247], v[32:47]
    ds_read_b64_tr_b16 a[152:153], v110 offset:2048
    ds_read_b64_tr_b16 a[154:155], v110 offset:3072
    s_waitcnt lgkmcnt(6)
    v_mfma_f32_32x32x16_bf16 v[16:31], a[160:163], v[248:251], v[16:31]
    ds_read_b64_tr_b16 a[156:157], v110 offset:2560
    ds_read_b64_tr_b16 a[158:159], v110 offset:3584
    v_mfma_f32_32x32x16_bf16 v[32:47], a[164:167], v[248:251], v[32:47]
    ds_read_b64_tr_b16 a[160:161], v110 offset:4096
    ds_read_b64_tr_b16 a[162:163], v110 offset:5120
    s_add_u32 m0, s43, 8192
    s_add_u32 s44, s53, 147456
    buffer_load_dwordx4 v13, s[16:19], s44 offen lds
    v_mfma_f32_32x32x16_bf16 v[16:31], a[168:171], v[252:255], v[16:31]
    ds_read_b64_tr_b16 a[164:165], v110 offset:4608
    ds_read_b64_tr_b16 a[166:167], v110 offset:5632
    v_mfma_f32_32x32x16_bf16 v[32:47], a[172:175], v[252:255], v[32:47]
    ds_read_b64_tr_b16 a[168:169], v110 offset:6144
    ds_read_b64_tr_b16 a[170:171], v110 offset:7168
    s_waitcnt lgkmcnt(6)
    v_mfma_f32_32x32x16_bf16 v[48:63], a[144:147], v[112:115], 0
    ds_read_b64_tr_b16 a[172:173], v110 offset:6656
    ds_read_b64_tr_b16 a[174:175], v110 offset:7680
    v_mfma_f32_32x32x16_bf16 v[64:79], a[148:151], v[112:115], 0
    ds_read_b64_tr_b16 a[144:145], v110 offset:8192
    ds_read_b64_tr_b16 a[146:147], v110 offset:9216
    s_add_u32 m0, s43, 36864
    s_add_u32 s44, s53, 64
    buffer_load_dwordx4 v13, s[16:19], s44 offen lds
    v_mfma_f32_32x32x16_bf16 v[48:63], a[152:155], v[116:119], v[48:63]
    ds_read_b64_tr_b16 a[148:149], v110 offset:8704
    ds_read_b64_tr_b16 a[150:151], v110 offset:9728
    v_mfma_f32_32x32x16_bf16 v[64:79], a[156:159], v[116:119], v[64:79]
    ds_read_b64_tr_b16 a[152:153], v110 offset:10240
    ds_read_b64_tr_b16 a[154:155], v110 offset:11264
    v_cvt_pk_bf16_f32 v80, v16, v17
    v_cvt_pk_bf16_f32 v81, v18, v19
    s_waitcnt lgkmcnt(6)
    v_mfma_f32_32x32x16_bf16 v[48:63], a[160:163], v[120:123], v[48:63]
    ds_read_b64_tr_b16 a[156:157], v110 offset:10752
    ds_read_b64_tr_b16 a[158:159], v110 offset:11776
    v_cvt_pk_bf16_f32 v82, v20, v21
    v_cvt_pk_bf16_f32 v83, v22, v23
    v_mfma_f32_32x32x16_bf16 v[64:79], a[164:167], v[120:123], v[64:79]
    ds_read_b64_tr_b16 a[160:161], v110 offset:12288
    ds_read_b64_tr_b16 a[162:163], v110 offset:13312
    s_add_u32 m0, s43, 37888
    s_add_u32 s44, s53, 18496
    buffer_load_dwordx4 v13, s[16:19], s44 offen lds
    v_mfma_f32_32x32x16_bf16 v[48:63], a[168:171], v[124:127], v[48:63]
    ds_read_b64_tr_b16 a[164:165], v110 offset:12800
    ds_read_b64_tr_b16 a[166:167], v110 offset:13824
    v_cvt_pk_bf16_f32 v84, v24, v25
    v_cvt_pk_bf16_f32 v85, v26, v27
    v_mfma_f32_32x32x16_bf16 v[64:79], a[172:175], v[124:127], v[64:79]
    ds_read_b64_tr_b16 a[168:169], v110 offset:14336
    ds_read_b64_tr_b16 a[170:171], v110 offset:15360
    v_cvt_pk_bf16_f32 v86, v28, v29
    v_cvt_pk_bf16_f32 v87, v30, v31
    s_waitcnt lgkmcnt(6)
    v_mfma_f32_32x32x16_bf16 v[48:63], a[144:147], v[128:131], v[48:63]
    ds_read_b64_tr_b16 a[172:173], v110 offset:14848
    ds_read_b64_tr_b16 a[174:175], v110 offset:15872
    buffer_store_dwordx4 v[80:83], v12, s[24:27], s52 offen offset:0 sc1
    v_mfma_f32_32x32x16_bf16 v[64:79], a[148:151], v[128:131], v[64:79]
    ds_read_b64_tr_b16 a[144:145], v110 offset:16384
    ds_read_b64_tr_b16 a[146:147], v110 offset:17408
    s_add_u32 m0, s43, 38912
    s_add_u32 s44, s53, 36928
    buffer_load_dwordx4 v13, s[16:19], s44 offen lds
    v_mfma_f32_32x32x16_bf16 v[48:63], a[152:155], v[132:135], v[48:63]
    ds_read_b64_tr_b16 a[148:149], v110 offset:16896
    ds_read_b64_tr_b16 a[150:151], v110 offset:17920
    buffer_store_dwordx4 v[84:87], v12, s[24:27], s52 offen offset:1024 sc1
    v_mfma_f32_32x32x16_bf16 v[64:79], a[156:159], v[132:135], v[64:79]
    ds_read_b64_tr_b16 a[152:153], v110 offset:18432
    ds_read_b64_tr_b16 a[154:155], v110 offset:19456
    v_cvt_pk_bf16_f32 v88, v32, v33
    v_cvt_pk_bf16_f32 v89, v34, v35
    s_waitcnt lgkmcnt(6)
    v_mfma_f32_32x32x16_bf16 v[48:63], a[160:163], v[136:139], v[48:63]
    ds_read_b64_tr_b16 a[156:157], v110 offset:18944
    ds_read_b64_tr_b16 a[158:159], v110 offset:19968
    v_cvt_pk_bf16_f32 v90, v36, v37
    v_cvt_pk_bf16_f32 v91, v38, v39
    v_mfma_f32_32x32x16_bf16 v[64:79], a[164:167], v[136:139], v[64:79]
    ds_read_b64_tr_b16 a[160:161], v110 offset:20480
    ds_read_b64_tr_b16 a[162:163], v110 offset:21504
    s_add_u32 m0, s43, 39936
    s_add_u32 s44, s53, 55360
    buffer_load_dwordx4 v13, s[16:19], s44 offen lds
    v_mfma_f32_32x32x16_bf16 v[48:63], a[168:171], v[140:143], v[48:63]
    ds_read_b64_tr_b16 a[164:165], v110 offset:20992
    ds_read_b64_tr_b16 a[166:167], v110 offset:22016
    v_cvt_pk_bf16_f32 v92, v40, v41
    v_cvt_pk_bf16_f32 v93, v42, v43
    v_mfma_f32_32x32x16_bf16 v[64:79], a[172:175], v[140:143], v[64:79]
    ds_read_b64_tr_b16 a[168:169], v110 offset:22528
    ds_read_b64_tr_b16 a[170:171], v110 offset:23552
    v_cvt_pk_bf16_f32 v94, v44, v45
    v_cvt_pk_bf16_f32 v95, v46, v47
    s_waitcnt lgkmcnt(6)
    v_mfma_f32_32x32x16_bf16 v[48:63], a[144:147], v[144:147], v[48:63]
    ds_read_b64_tr_b16 a[172:173], v110 offset:23040
    ds_read_b64_tr_b16 a[174:175], v110 offset:24064
    buffer_store_dwordx4 v[88:91], v12, s[24:27], s52 offen offset:2048 sc1
    v_mfma_f32_32x32x16_bf16 v[64:79], a[148:151], v[144:147], v[64:79]
    ds_read_b64_tr_b16 a[144:145], v110 offset:24576
    ds_read_b64_tr_b16 a[146:147], v110 offset:25600
    s_add_u32 m0, s43, 40960
    s_add_u32 s44, s53, 73792
    buffer_load_dwordx4 v13, s[16:19], s44 offen lds
    v_mfma_f32_32x32x16_bf16 v[48:63], a[152:155], v[148:151], v[48:63]
    ds_read_b64_tr_b16 a[148:149], v110 offset:25088
    ds_read_b64_tr_b16 a[150:151], v110 offset:26112
    buffer_store_dwordx4 v[92:95], v12, s[24:27], s52 offen offset:3072 sc1
    v_mfma_f32_32x32x16_bf16 v[64:79], a[156:159], v[148:151], v[64:79]
    ds_read_b64_tr_b16 a[152:153], v110 offset:26624
    ds_read_b64_tr_b16 a[154:155], v110 offset:27648
    s_waitcnt lgkmcnt(6)
    v_mfma_f32_32x32x16_bf16 v[48:63], a[160:163], v[152:155], v[48:63]
    ds_read_b64_tr_b16 a[156:157], v110 offset:27136
    ds_read_b64_tr_b16 a[158:159], v110 offset:28160
    s_add_u32 s52, s52, 4096
    v_mfma_f32_32x32x16_bf16 v[64:79], a[164:167], v[152:155], v[64:79]
    ds_read_b64_tr_b16 a[160:161], v110 offset:28672
    ds_read_b64_tr_b16 a[162:163], v110 offset:29696
    s_add_u32 m0, s43, 41984
    s_add_u32 s44, s53, 92224
    buffer_load_dwordx4 v13, s[16:19], s44 offen lds
    v_mfma_f32_32x32x16_bf16 v[48:63], a[168:171], v[156:159], v[48:63]
    ds_read_b64_tr_b16 a[164:165], v110 offset:29184
    ds_read_b64_tr_b16 a[166:167], v110 offset:30208
    v_mfma_f32_32x32x16_bf16 v[64:79], a[172:175], v[156:159], v[64:79]
    ds_read_b64_tr_b16 a[168:169], v110 offset:30720
    ds_read_b64_tr_b16 a[170:171], v110 offset:31744
    s_waitcnt lgkmcnt(6)
    v_mfma_f32_32x32x16_bf16 v[48:63], a[144:147], v[160:163], v[48:63]
    ds_read_b64_tr_b16 a[172:173], v110 offset:31232
    ds_read_b64_tr_b16 a[174:175], v110 offset:32256
    v_mfma_f32_32x32x16_bf16 v[64:79], a[148:151], v[160:163], v[64:79]
    ds_read_b64_tr_b16 a[144:145], v110 offset:32768
    ds_read_b64_tr_b16 a[146:147], v110 offset:33792
    s_add_u32 m0, s43, 43008
    s_add_u32 s44, s53, 110656
    buffer_load_dwordx4 v13, s[16:19], s44 offen lds
    v_mfma_f32_32x32x16_bf16 v[48:63], a[152:155], v[164:167], v[48:63]
    ds_read_b64_tr_b16 a[148:149], v110 offset:33280
    ds_read_b64_tr_b16 a[150:151], v110 offset:34304
    v_mfma_f32_32x32x16_bf16 v[64:79], a[156:159], v[164:167], v[64:79]
    ds_read_b64_tr_b16 a[152:153], v110 offset:34816
    ds_read_b64_tr_b16 a[154:155], v110 offset:35840
    s_waitcnt lgkmcnt(6)
    v_mfma_f32_32x32x16_bf16 v[48:63], a[160:163], v[168:171], v[48:63]
    ds_read_b64_tr_b16 a[156:157], v110 offset:35328
    ds_read_b64_tr_b16 a[158:159], v110 offset:36352
    v_mfma_f32_32x32x16_bf16 v[64:79], a[164:167], v[168:171], v[64:79]
    s_waitcnt vmcnt(20)
    s_barrier
    ds_read_b64_tr_b16 a[160:161], v111 offset:0
    ds_read_b64_tr_b16 a[162:163], v111 offset:1024
    s_add_u32 m0, s43, 44032
    s_add_u32 s44, s53, 129088
    buffer_load_dwordx4 v13, s[16:19], s44 offen lds
    v_mfma_f32_32x32x16_bf16 v[48:63], a[168:171], v[172:175], v[48:63]
    ds_read_b64_tr_b16 a[164:165], v111 offset:512
    ds_read_b64_tr_b16 a[166:167], v111 offset:1536
    v_mfma_f32_32x32x16_bf16 v[64:79], a[172:175], v[172:175], v[64:79]
    ds_read_b64_tr_b16 a[168:169], v111 offset:2048
    ds_read_b64_tr_b16 a[170:171], v111 offset:3072
    s_add_u32 s46, s46, 1
    s_max_i32 s8, s46, 0
    s_add_u32 s8, s8, s97
    v_mov_b32 v14, s8
    s_mov_b64 exec, 1
    buffer_store_dword v14, v15, s[24:27], s99 offen sc1
    s_mov_b64 exec, -1
    s_waitcnt lgkmcnt(6)
    v_mfma_f32_32x32x16_bf16 v[48:63], a[144:147], v[176:179], v[48:63]
    ds_read_b64_tr_b16 a[172:173], v111 offset:2560
    ds_read_b64_tr_b16 a[174:175], v111 offset:3584
    v_mfma_f32_32x32x16_bf16 v[64:79], a[148:151], v[176:179], v[64:79]
    ds_read_b64_tr_b16 a[144:145], v111 offset:4096
    ds_read_b64_tr_b16 a[146:147], v111 offset:5120
    s_add_u32 m0, s43, 45056
    s_add_u32 s44, s53, 147520
    buffer_load_dwordx4 v13, s[16:19], s44 offen lds
    v_mfma_f32_32x32x16_bf16 v[48:63], a[152:155], v[180:183], v[48:63]
    ds_read_b64_tr_b16 a[148:149], v111 offset:4608
    ds_read_b64_tr_b16 a[150:151], v111 offset:5632
    v_mfma_f32_32x32x16_bf16 v[64:79], a[156:159], v[180:183], v[64:79]
    ds_read_b64_tr_b16 a[152:153], v111 offset:6144
    ds_read_b64_tr_b16 a[154:155], v111 offset:7168
    s_waitcnt lgkmcnt(6)
    v_mfma_f32_32x32x16_bf16 v[48:63], a[160:163], v[184:187], v[48:63]
    ds_read_b64_tr_b16 a[156:157], v111 offset:6656
    ds_read_b64_tr_b16 a[158:159], v111 offset:7680
    v_mfma_f32_32x32x16_bf16 v[64:79], a[164:167], v[184:187], v[64:79]
    ds_read_b64_tr_b16 a[160:161], v111 offset:8192
    ds_read_b64_tr_b16 a[162:163], v111 offset:9216
    s_add_u32 m0, s43, 73728
    s_add_u32 s44, s54, 0
    buffer_load_dwordx4 v13, s[16:19], s44 offen lds
    v_mfma_f32_32x32x16_bf16 v[48:63], a[168:171], v[188:191], v[48:63]
    ds_read_b64_tr_b16 a[164:165], v111 offset:8704
    ds_read_b64_tr_b16 a[166:167], v111 offset:9728
    v_mfma_f32_32x32x16_bf16 v[64:79], a[172:175], v[188:191], v[64:79]
    ds_read_b64_tr_b16 a[168:169], v111 offset:10240
    ds_read_b64_tr_b16 a[170:171], v111 offset:11264
    s_waitcnt lgkmcnt(6)
    v_mfma_f32_32x32x16_bf16 v[48:63], a[144:147], v[192:195], v[48:63]
    ds_read_b64_tr_b16 a[172:173], v111 offset:10752
    ds_read_b64_tr_b16 a[174:175], v111 offset:11776
    v_mfma_f32_32x32x16_bf16 v[64:79], a[148:151], v[192:195], v[64:79]
    ds_read_b64_tr_b16 a[144:145], v111 offset:12288
    ds_read_b64_tr_b16 a[146:147], v111 offset:13312
    s_add_u32 m0, s43, 74752
    s_add_u32 s44, s54, 18432
    buffer_load_dwordx4 v13, s[16:19], s44 offen lds
    v_mfma_f32_32x32x16_bf16 v[48:63], a[152:155], v[196:199], v[48:63]
    ds_read_b64_tr_b16 a[148:149], v111 offset:12800
    ds_read_b64_tr_b16 a[150:151], v111 offset:13824
    v_mfma_f32_32x32x16_bf16 v[64:79], a[156:159], v[196:199], v[64:79]
    ds_read_b64_tr_b16 a[152:153], v111 offset:14336
    ds_read_b64_tr_b16 a[154:155], v111 offset:15360
    s_waitcnt lgkmcnt(6)
    v_mfma_f32_32x32x16_bf16 v[48:63], a[160:163], v[200:203], v[48:63]
    ds_read_b64_tr_b16 a[156:157], v111 offset:14848
    ds_read_b64_tr_b16 a[158:159], v111 offset:15872
    v_mfma_f32_32x32x16_bf16 v[64:79], a[164:167], v[200:203], v[64:79]
    ds_read_b64_tr_b16 a[160:161], v111 offset:16384
    ds_read_b64_tr_b16 a[162:163], v111 offset:17408
    s_add_u32 m0, s43, 75776
    s_add_u32 s44, s54, 36864
    buffer_load_dwordx4 v13, s[16:19], s44 offen lds
    v_mfma_f32_32x32x16_bf16 v[48:63], a[168:171], v[204:207], v[48:63]
    ds_read_b64_tr_b16 a[164:165], v111 offset:16896
    ds_read_b64_tr_b16 a[166:167], v111 offset:17920
    v_mfma_f32_32x32x16_bf16 v[64:79], a[172:175], v[204:207], v[64:79]
    ds_read_b64_tr_b16 a[168:169], v111 offset:18432
    ds_read_b64_tr_b16 a[170:171], v111 offset:19456
    s_waitcnt lgkmcnt(6)
    v_mfma_f32_32x32x16_bf16 v[48:63], a[144:147], v[208:211], v[48:63]
    ds_read_b64_tr_b16 a[172:173], v111 offset:18944
    ds_read_b64_tr_b16 a[174:175], v111 offset:19968
    v_mfma_f32_32x32x16_bf16 v[64:79], a[148:151], v[208:211], v[64:79]
    ds_read_b64_tr_b16 a[144:145], v111 offset:20480
    ds_read_b64_tr_b16 a[146:147], v111 offset:21504
    s_add_u32 m0, s43, 76800
    s_add_u32 s44, s54, 55296
    buffer_load_dwordx4 v13, s[16:19], s44 offen lds
    v_mfma_f32_32x32x16_bf16 v[48:63], a[152:155], v[212:215], v[48:63]
    ds_read_b64_tr_b16 a[148:149], v111 offset:20992
    ds_read_b64_tr_b16 a[150:151], v111 offset:22016
    v_mfma_f32_32x32x16_bf16 v[64:79], a[156:159], v[212:215], v[64:79]
    ds_read_b64_tr_b16 a[152:153], v111 offset:22528
    ds_read_b64_tr_b16 a[154:155], v111 offset:23552
    s_waitcnt lgkmcnt(6)
    v_mfma_f32_32x32x16_bf16 v[48:63], a[160:163], v[216:219], v[48:63]
    ds_read_b64_tr_b16 a[156:157], v111 offset:23040
    ds_read_b64_tr_b16 a[158:159], v111 offset:24064
    v_mfma_f32_32x32x16_bf16 v[64:79], a[164:167], v[216:219], v[64:79]
    ds_read_b64_tr_b16 a[160:161], v111 offset:24576
    ds_read_b64_tr_b16 a[162:163], v111 offset:25600
    s_add_u32 m0, s43, 77824
    s_add_u32 s44, s54, 73728
    buffer_load_dwordx4 v13, s[16:19], s44 offen lds
    v_mfma_f32_32x32x16_bf16 v[48:63], a[168:171], v[220:223], v[48:63]
    ds_read_b64_tr_b16 a[164:165], v111 offset:25088
    ds_read_b64_tr_b16 a[166:167], v111 offset:26112
    v_mfma_f32_32x32x16_bf16 v[64:79], a[172:175], v[220:223], v[64:79]
    ds_read_b64_tr_b16 a[168:169], v111 offset:26624
    ds_read_b64_tr_b16 a[170:171], v111 offset:27648
    s_waitcnt lgkmcnt(6)
    v_mfma_f32_32x32x16_bf16 v[48:63], a[144:147], v[224:227], v[48:63]
    ds_read_b64_tr_b16 a[172:173], v111 offset:27136
    ds_read_b64_tr_b16 a[174:175], v111 offset:28160
    v_mfma_f32_32x32x16_bf16 v[64:79], a[148:151], v[224:227], v[64:79]
    ds_read_b64_tr_b16 a[144:145], v111 offset:28672
    ds_read_b64_tr_b16 a[146:147], v111 offset:29696
    s_add_u32 m0, s43, 78848
    s_add_u32 s44, s54, 92160
    buffer_load_dwordx4 v13, s[16:19], s44 offen lds
    v_mfma_f32_32x32x16_bf16 v[48:63], a[152:155], v[228:231], v[48:63]
    ds_read_b64_tr_b16 a[148:149], v111 offset:29184
    ds_read_b64_tr_b16 a[150:151], v111 offset:30208
    v_mfma_f32_32x32x16_bf16 v[64:79], a[156:159], v[228:231], v[64:79]
    ds_read_b64_tr_b16 a[152:153], v111 offset:30720
    ds_read_b64_tr_b16 a[154:155], v111 offset:31744
    s_waitcnt lgkmcnt(6)
    v_mfma_f32_32x32x16_bf16 v[48:63], a[160:163], v[232:235], v[48:63]
    ds_read_b64_tr_b16 a[156:157], v111 offset:31232
    ds_read_b64_tr_b16 a[158:159], v111 offset:32256
    v_mfma_f32_32x32x16_bf16 v[64:79], a[164:167], v[232:235], v[64:79]
    ds_read_b64_tr_b16 a[160:161], v111 offset:32768
    ds_read_b64_tr_b16 a[162:163], v111 offset:33792
    s_add_u32 m0, s43, 79872
    s_add_u32 s44, s54, 110592
    buffer_load_dwordx4 v13, s[16:19], s44 offen lds
    v_mfma_f32_32x32x16_bf16 v[48:63], a[168:171], v[236:239], v[48:63]
    ds_read_b64_tr_b16 a[164:165], v111 offset:33280
    ds_read_b64_tr_b16 a[166:167], v111 offset:34304
    v_mfma_f32_32x32x16_bf16 v[64:79], a[172:175], v[236:239], v[64:79]
    ds_read_b64_tr_b16 a[168:169], v111 offset:34816
    ds_read_b64_tr_b16 a[170:171], v111 offset:35840
    s_waitcnt lgkmcnt(6)
    v_mfma_f32_32x32x16_bf16 v[48:63], a[144:147], v[240:243], v[48:63]
    ds_read_b64_tr_b16 a[172:173], v111 offset:35328
    ds_read_b64_tr_b16 a[174:175], v111 offset:36352
    v_mfma_f32_32x32x16_bf16 v[64:79], a[148:151], v[240:243], v[64:79]
    s_add_u32 m0, s43, 80896
    s_add_u32 s44, s54, 129024
    buffer_load_dwordx4 v13, s[16:19], s44 offen lds
    v_mfma_f32_32x32x16_bf16 v[48:63], a[152:155], v[244:247], v[48:63]
    v_mfma_f32_32x32x16_bf16 v[64:79], a[156:159], v[244:247], v[64:79]
    s_waitcnt lgkmcnt(0)
    v_mfma_f32_32x32x16_bf16 v[48:63], a[160:163], v[248:251], v[48:63]
    v_mfma_f32_32x32x16_bf16 v[64:79], a[164:167], v[248:251], v[64:79]
    s_add_u32 m0, s43, 81920
    s_add_u32 s44, s54, 147456
    buffer_load_dwordx4 v13, s[16:19], s44 offen lds
    v_mfma_f32_32x32x16_bf16 v[48:63], a[168:171], v[252:255], v[48:63]
    v_mfma_f32_32x32x16_bf16 v[64:79], a[172:175], v[252:255], v[64:79]
    s_nop 7
    s_nop 3
    v_cvt_pk_bf16_f32 v80, v48, v49
    v_cvt_pk_bf16_f32 v81, v50, v51
    v_cvt_pk_bf16_f32 v82, v52, v53
    v_cvt_pk_bf16_f32 v83, v54, v55
    v_cvt_pk_bf16_f32 v84, v56, v57
    v_cvt_pk_bf16_f32 v85, v58, v59
    v_cvt_pk_bf16_f32 v86, v60, v61
    v_cvt_pk_bf16_f32 v87, v62, v63
    s_nop 0
    buffer_store_dwordx4 v[80:83], v12, s[24:27], s52 offen offset:0 sc1
    s_nop 0
    buffer_store_dwordx4 v[84:87], v12, s[24:27], s52 offen offset:1024 sc1
    v_cvt_pk_bf16_f32 v88, v64, v65
    v_cvt_pk_bf16_f32 v89, v66, v67
    v_cvt_pk_bf16_f32 v90, v68, v69
    v_cvt_pk_bf16_f32 v91, v70, v71
    v_cvt_pk_bf16_f32 v92, v72, v73
    v_cvt_pk_bf16_f32 v93, v74, v75
    v_cvt_pk_bf16_f32 v94, v76, v77
    v_cvt_pk_bf16_f32 v95, v78, v79
    s_nop 0
    buffer_store_dwordx4 v[88:91], v12, s[24:27], s52 offen offset:2048 sc1
    s_nop 0
    buffer_store_dwordx4 v[92:95], v12, s[24:27], s52 offen offset:3072 sc1
    s_load_dwordx2 s[42:43], s[0:1], 72
    s_load_dwordx2 s[92:93], s[0:1], 88
    s_waitcnt vmcnt(18) lgkmcnt(0)
    s_barrier
    s_mov_b32 s20, s42
    s_and_b32 s21, s43, 0xffff
    s_mov_b32 s22, 1152
    s_mov_b32 s23, 0x20000
    s_mov_b32 s12, s92
    s_and_b32 s13, s93, 0xffff
    s_mov_b32 s14, 2359296
    s_mov_b32 s15, 0x20000
    s_add_u32 s96, s97, 9
    s_cmp_lg_u32 s5, 0
    s_cbranch_scc1 T_nf1
    s_mov_b64 exec, 1
    v_mov_b32 v13, 0
    s_add_u32 s8, s97, 8
    v_mov_b32 v14, s8
    buffer_store_dword v14, v13, s[24:27], s99 offen sc1
    s_mov_b64 exec, -1
T_nf1:
    v_mbcnt_lo_u32_b32 v1, -1, 0
    v_mbcnt_hi_u32_b32 v1, -1, v1
    s_lshl_b32 s52, s3, 7
    v_and_b32 v6, 31, v1
    v_lshrrev_b32 v7, 5, v1
    v_lshrrev_b32 v2, 5, v1
    v_mul_u32_u24 v8, 256, v2
    v_bfe_u32 v2, v1, 2, 2
    v_lshlrev_b32 v2, 6, v2
    v_add_u32 v8, v8, v2
    v_bfe_u32 v2, v1, 4, 1
    v_lshlrev_b32 v2, 5, v2
    v_add_u32 v8, v8, v2
    v_and_b32 v2, 3, v1
    v_lshlrev_b32 v2, 3, v2
    v_add_u32 v8, v8, v2
    v_bfe_u32 v2, v1, 3, 1
    v_lshlrev_b32 v3, 2, v7
    v_add_u32 v2, v2, v3
    v_mul_u32_u24 v2, 18, v2
    v_bfe_u32 v3, v1, 2, 1
    v_add_u32 v2, v2, v3
    v_add_u32 v2, 16, v2
    v_lshlrev_b32 v9, 6, v2
    v_bfe_u32 v2, v1, 4, 1
    v_lshlrev_b32 v2, 5, v2
    v_add_u32 v9, v9, v2
    v_and_b32 v2, 3, v1
    v_lshlrev_b32 v2, 3, v2
    v_add_u32 v9, v9, v2
    v_add_u32 v10, 36864, v8
    v_add_u32 v11, 36864, v9
    s_add_u32 s8, s3, 1
    s_add_u32 s10, s97, s8
    s_sub_u32 s11, 9, s8
    s_cmp_lg_u32 s5, 0
    s_cbranch_scc1 T_pp_w
    v_lshlrev_b32 v13, 2, v1
T_pp_p:
    s_mov_b64 exec, 0xff
    buffer_load_dword v14, v13, s[24:27], s57 offen sc1
    s_waitcnt vmcnt(0)
    v_subrev_u32 v14, s10, v14
    v_cmp_lt_u32 vcc, s11, v14
    s_mov_b64 exec, -1
    s_nop 4
    s_cbranch_vccz T_pp_w
    s_sleep 2
    s_branch T_pp_p
T_pp_w:
    s_barrier
    s_mul_i32 s50, s6, 18
    s_lshl_b32 s54, s3, 1
    s_add_u32 s50, s50, s54
    s_lshl_b32 s50, s50, 11
    s_add_u32 s50, s50, 7254016
    s_lshl_b32 s46, s6, 7
    s_add_u32 s46, s46, 4886528
    v_lshlrev_b32 v4, 2, v6
    v_lshlrev_b32 v3, 3, v7
    buffer_load_dword v5, v4, s[24:27], s46 offen sc1
    v_mov_b32 v14, 159744
    v_mov_b32 v13, 0
    s_cmp_lg_u32 s5, 0
    s_cbranch_scc1 T_mbi
    ds_write_b32 v14, v13
T_mbi:
    buffer_load_dwordx2 v[80:81], v3, s[20:23], s52 offen offset:0
    buffer_load_dwordx2 v[82:83], v3, s[20:23], s52 offen offset:16
    buffer_load_dwordx2 v[84:85], v3, s[20:23], s52 offen offset:32
    buffer_load_dwordx2 v[86:87], v3, s[20:23], s52 offen offset:48
    buffer_load_dwordx2 v[88:89], v3, s[20:23], s52 offen offset:64
    buffer_load_dwordx2 v[90:91], v3, s[20:23], s52 offen offset:80
    buffer_load_dwordx2 v[92:93], v3, s[20:23], s52 offen offset:96
    buffer_load_dwordx2 v[94:95], v3, s[20:23], s52 offen offset:112
    s_add_u32 s54, s50, 0
    buffer_load_dwordx4 v[96:99], v12, s[24:27], s54 offen offset:0 sc1
    buffer_load_dwordx4 v[100:103], v12, s[24:27], s54 offen offset:1024 sc1
    buffer_load_dwordx4 v[104:107], v12, s[24:27], s54 offen offset:2048 sc1
    buffer_load_dwordx4 v[108:111], v12, s[24:27], s54 offen offset:3072 sc1
    s_add_u32 s54, s50, 2359296
    buffer_load_dwordx4 v[112:115], v12, s[24:27], s54 offen offset:0 sc1
    buffer_load_dwordx4 v[116:119], v12, s[24:27], s54 offen offset:1024 sc1
    buffer_load_dwordx4 v[120:123], v12, s[24:27], s54 offen offset:2048 sc1
    buffer_load_dwordx4 v[124:127], v12, s[24:27], s54 offen offset:3072 sc1
    s_add_u32 s54, s50, 4718592
    buffer_load_dwordx4 v[128:131], v12, s[24:27], s54 offen offset:0 sc1
    buffer_load_dwordx4 v[132:135], v12, s[24:27], s54 offen offset:1024 sc1
    buffer_load_dwordx4 v[136:139], v12, s[24:27], s54 offen offset:2048 sc1
    buffer_load_dwordx4 v[140:143], v12, s[24:27], s54 offen offset:3072 sc1
    s_add_u32 s54, s50, 7077888
    buffer_load_dwordx4 v[144:147], v12, s[24:27], s54 offen offset:0 sc1
    buffer_load_dwordx4 v[148:151], v12, s[24:27], s54 offen offset:1024 sc1
    buffer_load_dwordx4 v[152:155], v12, s[24:27], s54 offen offset:2048 sc1
    buffer_load_dwordx4 v[156:159], v12, s[24:27], s54 offen offset:3072 sc1
    s_add_u32 s54, s50, 9437184
    buffer_load_dwordx4 v[160:163], v12, s[24:27], s54 offen offset:0 sc1
    buffer_load_dwordx4 v[164:167], v12, s[24:27], s54 offen offset:1024 sc1
    buffer_load_dwordx4 v[168:171], v12, s[24:27], s54 offen offset:2048 sc1
    buffer_load_dwordx4 v[172:175], v12, s[24:27], s54 offen offset:3072 sc1
    s_add_u32 s54, s50, 11796480
    buffer_load_dwordx4 v[176:179], v12, s[24:27], s54 offen offset:0 sc1
    buffer_load_dwordx4 v[180:183], v12, s[24:27], s54 offen offset:1024 sc1
    buffer_load_dwordx4 v[184:187], v12, s[24:27], s54 offen offset:2048 sc1
    buffer_load_dwordx4 v[188:191], v12, s[24:27], s54 offen offset:3072 sc1
    s_add_u32 s54, s50, 14155776
    buffer_load_dwordx4 v[192:195], v12, s[24:27], s54 offen offset:0 sc1
    buffer_load_dwordx4 v[196:199], v12, s[24:27], s54 offen offset:1024 sc1
    buffer_load_dwordx4 v[200:203], v12, s[24:27], s54 offen offset:2048 sc1
    buffer_load_dwordx4 v[204:207], v12, s[24:27], s54 offen offset:3072 sc1
    s_add_u32 s54, s50, 16515072
    buffer_load_dwordx4 v[208:211], v12, s[24:27], s54 offen offset:0 sc1
    buffer_load_dwordx4 v[212:215], v12, s[24:27], s54 offen offset:1024 sc1
    buffer_load_dwordx4 v[216:219], v12, s[24:27], s54 offen offset:2048 sc1
    buffer_load_dwordx4 v[220:223], v12, s[24:27], s54 offen offset:3072 sc1
    s_lshr_b32 s47, s3, 1
    s_and_b32 s8, s3, 1
    s_lshl_b32 s48, s8, 6
    s_add_u32 s48, s48, 1024
    s_mul_i32 s49, s6, 18
    s_add_u32 s49, s49, s8
    s_add_u32 s49, s49, 16
    s_lshl_b32 s49, s49, 11
    s_add_u32 s49, s49, 7254016
    v_mul_u32_u24 v2, 1152, v6
    v_lshlrev_b32 v4, 4, v7
    v_add_u32 v2, v2, v4
    s_mul_i32 s51, s6, 36864
    s_add_u32 s51, s51, s52
    s_lshl_b32 s55, s6, 15
    s_add_u32 s55, s55, 4894720
    s_lshl_b32 s56, s6, 12
    s_add_u32 s56, s56, 6991872
    s_mov_b64 s[94:95], exec
    s_cmp_eq_u32 s5, 0
    s_cselect_b64 exec, 1, 0
    v_mov_b32 v16, 0
    v_mov_b32 v17, 1
    s_cbranch_execz L_arr0
    buffer_atomic_add v17, v16, s[60:63], 0 offen offset:4
L_arr0:
    s_mov_b64 exec, s[94:95]
    v_mov_b32 v16, 0
    v_mov_b32 v17, 0
    v_mov_b32 v18, 0
    v_mov_b32 v19, 0
    v_mov_b32 v20, 0
    v_mov_b32 v21, 0
    v_mov_b32 v22, 0
    v_mov_b32 v23, 0
    v_mov_b32 v24, 0
    v_mov_b32 v25, 0
    v_mov_b32 v26, 0
    v_mov_b32 v27, 0
    v_mov_b32 v28, 0
    v_mov_b32 v29, 0
    v_mov_b32 v30, 0
    v_mov_b32 v31, 0
    v_mov_b32 v32, 0
    v_mov_b32 v33, 0
    v_mov_b32 v34, 0
    v_mov_b32 v35, 0
    v_mov_b32 v36, 0
    v_mov_b32 v37, 0
    v_mov_b32 v38, 0
    v_mov_b32 v39, 0
    v_mov_b32 v40, 0
    v_mov_b32 v41, 0
    v_mov_b32 v42, 0
    v_mov_b32 v43, 0
    v_mov_b32 v44, 0
    v_mov_b32 v45, 0
    v_mov_b32 v46, 0
    v_mov_b32 v47, 0
    s_waitcnt vmcnt(41) lgkmcnt(0)
    s_barrier
    s_cmp_lg_u32 s5, 0
    s_cbranch_scc1 T_nf9
    s_mov_b64 exec, 1
    v_mov_b32 v13, 0
    v_mov_b32 v15, s96
    buffer_store_dword v15, v13, s[24:27], s99 offen sc1
    s_mov_b64 exec, -1
T_nf9:
    s_mov_b32 s8, 0x2000
    s_mov_b32 s9, 0
    v_mbcnt_lo_u32_b32 v15, -1, 0
    v_lshlrev_b32 v15, 2, v15
T_round:
    s_cmp_lg_u32 s5, 0
    s_cbranch_scc1 T_rd_mb
    s_mov_b32 exec_lo, 0xff00ff
    s_mov_b32 exec_hi, 0
    buffer_load_dword v13, v15, s[24:27], s57 offen sc1
    s_waitcnt vmcnt(0)
    v_cmp_eq_u32 vcc, s98, v13
    s_nop 4
    s_lshr_b32 s10, vcc_lo, 16
    v_cmp_eq_u32 vcc, s96, v13
    s_mov_b64 exec, -1
    s_nop 4
    s_and_b32 s7, vcc_lo, 0xff
    s_cmp_eq_u32 s7, 0xff
    s_cselect_b32 s7, 0x1000, 0
    s_or_b32 s10, s10, s7
    v_mov_b32 v13, s10
    ds_write_b32 v14, v13
    s_branch T_have
T_rd_mb:
    ds_read_b32 v13, v14
    s_waitcnt vmcnt(0) lgkmcnt(0)
    v_readfirstlane_b32 s10, v13
    s_nop 3
T_have:
    s_andn2_b32 s46, s8, s9
    s_lshr_b32 s11, s10, 1
    s_and_b32 s11, s11, s10
    s_bitcmp1_b32 s11, 0
    s_cselect_b32 s7, 256, 0
    s_or_b32 s10, s10, s7
    s_bitcmp1_b32 s11, 2
    s_cselect_b32 s7, 512, 0
    s_or_b32 s10, s10, s7
    s_bitcmp1_b32 s11, 4
    s_cselect_b32 s7, 1024, 0
    s_or_b32 s10, s10, s7
    s_bitcmp1_b32 s11, 6
    s_cselect_b32 s7, 2048, 0
    s_or_b32 s10, s10, s7
    s_bitcmp1_b32 s9, 13
    s_cbranch_scc1 T_b12
    s_andn2_b32 s10, s10, 0x1000
T_b12:
    s_andn2_b32 s11, s10, s8
    s_or_b32 s8, s8, s11
    s_bitcmp1_b32 s11, 0
    s_cbranch_scc0 T_nl0
    s_add_u32 s54, s55, 0
    buffer_load_dwordx4 a[0:3], v12, s[24:27], s54 offen offset:0 sc1
    buffer_load_dwordx4 a[4:7], v12, s[24:27], s54 offen offset:1024 sc1
    buffer_load_dwordx4 a[8:11], v12, s[24:27], s54 offen offset:2048 sc1
    buffer_load_dwordx4 a[12:15], v12, s[24:27], s54 offen offset:3072 sc1
T_nl0:
    s_bitcmp1_b32 s11, 1
    s_cbranch_scc0 T_nl1
    s_add_u32 s54, s55, 4096
    buffer_load_dwordx4 a[16:19], v12, s[24:27], s54 offen offset:0 sc1
    buffer_load_dwordx4 a[20:23], v12, s[24:27], s54 offen offset:1024 sc1
    buffer_load_dwordx4 a[24:27], v12, s[24:27], s54 offen offset:2048 sc1
    buffer_load_dwordx4 a[28:31], v12, s[24:27], s54 offen offset:3072 sc1
T_nl1:
    s_bitcmp1_b32 s11, 2
    s_cbranch_scc0 T_nl2
    s_add_u32 s54, s55, 8192
    buffer_load_dwordx4 a[32:35], v12, s[24:27], s54 offen offset:0 sc1
    buffer_load_dwordx4 a[36:39], v12, s[24:27], s54 offen offset:1024 sc1
    buffer_load_dwordx4 a[40:43], v12, s[24:27], s54 offen offset:2048 sc1
    buffer_load_dwordx4 a[44:47], v12, s[24:27], s54 offen offset:3072 sc1
T_nl2:
    s_bitcmp1_b32 s11, 3
    s_cbranch_scc0 T_nl3
    s_add_u32 s54, s55, 12288
    buffer_load_dwordx4 a[48:51], v12, s[24:27], s54 offen offset:0 sc1
    buffer_load_dwordx4 a[52:55], v12, s[24:27], s54 offen offset:1024 sc1
    buffer_load_dwordx4 a[56:59], v12, s[24:27], s54 offen offset:2048 sc1
    buffer_load_dwordx4 a[60:63], v12, s[24:27], s54 offen offset:3072 sc1
T_nl3:
    s_bitcmp1_b32 s11, 4
    s_cbranch_scc0 T_nl4
    s_add_u32 s54, s55, 16384
    buffer_load_dwordx4 a[64:67], v12, s[24:27], s54 offen offset:0 sc1
    buffer_load_dwordx4 a[68:71], v12, s[24:27], s54 offen offset:1024 sc1
    buffer_load_dwordx4 a[72:75], v12, s[24:27], s54 offen offset:2048 sc1
    buffer_load_dwordx4 a[76:79], v12, s[24:27], s54 offen offset:3072 sc1
T_nl4:
    s_bitcmp1_b32 s11, 5
    s_cbranch_scc0 T_nl5
    s_add_u32 s54, s55, 20480
    buffer_load_dwordx4 a[80:83], v12, s[24:27], s54 offen offset:0 sc1
    buffer_load_dwordx4 a[84:87], v12, s[24:27], s54 offen offset:1024 sc1
    buffer_load_dwordx4 a[88:91], v12, s[24:27], s54 offen offset:2048 sc1
    buffer_load_dwordx4 a[92:95], v12, s[24:27], s54 offen offset:3072 sc1
T_nl5:
    s_bitcmp1_b32 s11, 6
    s_cbranch_scc0 T_nl6
    s_add_u32 s54, s55, 24576
    buffer_load_dwordx4 a[96:99], v12, s[24:27], s54 offen offset:0 sc1
    buffer_load_dwordx4 a[100:103], v12, s[24:27], s54 offen offset:1024 sc1
    buffer_load_dwordx4 a[104:107], v12, s[24:27], s54 offen offset:2048 sc1
    buffer_load_dwordx4 a[108:111], v12, s[24:27], s54 offen offset:3072 sc1
T_nl6:
    s_bitcmp1_b32 s11, 7
    s_cbranch_scc0 T_nl7
    s_add_u32 s54, s55, 28672
    buffer_load_dwordx4 a[112:115], v12, s[24:27], s54 offen offset:0 sc1
    buffer_load_dwordx4 a[116:119], v12, s[24:27], s54 offen offset:1024 sc1
    buffer_load_dwordx4 a[120:123], v12, s[24:27], s54 offen offset:2048 sc1
    buffer_load_dwordx4 a[124:127], v12, s[24:27], s54 offen offset:3072 sc1
T_nl7:
    s_bitcmp1_b32 s11, 8
    s_cbranch_scc0 T_nlx0
    buffer_load_dwordx4 a[128:131], v12, s[24:27], s56 offen offset:0 sc1
T_nlx0:
    s_bitcmp1_b32 s11, 9
    s_cbranch_scc0 T_nlx1
    buffer_load_dwordx4 a[132:135], v12, s[24:27], s56 offen offset:1024 sc1
T_nlx1:
    s_bitcmp1_b32 s11, 10
    s_cbranch_scc0 T_nlx2
    buffer_load_dwordx4 a[136:139], v12, s[24:27], s56 offen offset:2048 sc1
T_nlx2:
    s_bitcmp1_b32 s11, 11
    s_cbranch_scc0 T_nlx3
    buffer_load_dwordx4 a[140:143], v12, s[24:27], s56 offen offset:3072 sc1
T_nlx3:
    s_bitcmp1_b32 s11, 12
    s_cbranch_scc0 T_nle
    s_cmp_eq_u32 s5, s47
    s_cbranch_scc1 T_lde
    s_or_b32 s9, s9, 0x1000
    s_branch T_nle
T_lde:
    buffer_load_dwordx2 v[240:241], v3, s[20:23], s48 offen offset:0
    buffer_load_dwordx2 v[242:243], v3, s[20:23], s48 offen offset:16
    buffer_load_dwordx2 v[244:245], v3, s[20:23], s48 offen offset:32
    buffer_load_dwordx2 v[246:247], v3, s[20:23], s48 offen offset:48
    s_add_u32 s54, s49, 0
    buffer_load_dwordx4 v[96:99], v12, s[24:27], s54 offen offset:0 sc1
    buffer_load_dwordx4 v[100:103], v12, s[24:27], s54 offen offset:1024 sc1
    s_add_u32 s54, s49, 2359296
    buffer_load_dwordx4 v[104:107], v12, s[24:27], s54 offen offset:0 sc1
    buffer_load_dwordx4 v[108:111], v12, s[24:27], s54 offen offset:1024 sc1
    s_add_u32 s54, s49, 4718592
    buffer_load_dwordx4 v[112:115], v12, s[24:27], s54 offen offset:0 sc1
    buffer_load_dwordx4 v[116:119], v12, s[24:27], s54 offen offset:1024 sc1
    s_add_u32 s54, s49, 7077888
    buffer_load_dwordx4 v[120:123], v12, s[24:27], s54 offen offset:0 sc1
    buffer_load_dwordx4 v[124:127], v12, s[24:27], s54 offen offset:1024 sc1
    s_add_u32 s54, s49, 9437184
    buffer_load_dwordx4 v[128:131], v12, s[24:27], s54 offen offset:0 sc1
    buffer_load_dwordx4 v[132:135], v12, s[24:27], s54 offen offset:1024 sc1
    s_add_u32 s54, s49, 11796480
    buffer_load_dwordx4 v[136:139], v12, s[24:27], s54 offen offset:0 sc1
    buffer_load_dwordx4 v[140:143], v12, s[24:27], s54 offen offset:1024 sc1
    s_add_u32 s54, s49, 14155776
    buffer_load_dwordx4 v[144:147], v12, s[24:27], s54 offen offset:0 sc1
    buffer_load_dwordx4 v[148:151], v12, s[24:27], s54 offen offset:1024 sc1
    s_add_u32 s54, s49, 16515072
    buffer_load_dwordx4 v[152:155], v12, s[24:27], s54 offen offset:0 sc1
    buffer_load_dwordx4 v[156:159], v12, s[24:27], s54 offen offset:1024 sc1
T_nle:
    s_or_b32 s9, s9, s46
    s_bitcmp1_b32 s46, 13
    s_cbranch_scc0 T_nc13
    v_dot2_f32_bf16 v48, v96, s64, 0
    v_dot2_f32_bf16 v49, v96, s65, 0
    v_dot2_f32_bf16 v50, v97, s64, 0
    v_dot2_f32_bf16 v51, v97, s65, 0
    v_dot2_f32_bf16 v52, v98, s64, 0
    v_dot2_f32_bf16 v53, v98, s65, 0
    v_dot2_f32_bf16 v54, v99, s64, 0
    v_dot2_f32_bf16 v55, v99, s65, 0
    v_dot2_f32_bf16 v56, v100, s64, 0
    v_dot2_f32_bf16 v57, v100, s65, 0
    v_dot2_f32_bf16 v58, v101, s64, 0
    v_dot2_f32_bf16 v59, v101, s65, 0
    v_dot2_f32_bf16 v60, v102, s64, 0
    v_dot2_f32_bf16 v61, v102, s65, 0
    v_dot2_f32_bf16 v62, v103, s64, 0
    v_dot2_f32_bf16 v63, v103, s65, 0
    v_dot2_f32_bf16 v64, v104, s64, 0
    v_dot2_f32_bf16 v65, v104, s65, 0
    v_dot2_f32_bf16 v66, v105, s64, 0
    v_dot2_f32_bf16 v67, v105, s65, 0
    v_dot2_f32_bf16 v68, v106, s64, 0
    v_dot2_f32_bf16 v69, v106, s65, 0
    v_dot2_f32_bf16 v70, v107, s64, 0
    v_dot2_f32_bf16 v71, v107, s65, 0
    v_dot2_f32_bf16 v72, v108, s64, 0
    v_dot2_f32_bf16 v73, v108, s65, 0
    v_dot2_f32_bf16 v74, v109, s64, 0
    v_dot2_f32_bf16 v75, v109, s65, 0
    v_dot2_f32_bf16 v76, v110, s64, 0
    v_dot2_f32_bf16 v77, v110, s65, 0
    v_dot2_f32_bf16 v78, v111, s64, 0
    v_dot2_f32_bf16 v79, v111, s65, 0
    v_dot2_f32_bf16 v48, v112, s64, v48
    v_dot2_f32_bf16 v49, v112, s65, v49
    v_dot2_f32_bf16 v50, v113, s64, v50
    v_dot2_f32_bf16 v51, v113, s65, v51
    v_dot2_f32_bf16 v52, v114, s64, v52
    v_dot2_f32_bf16 v53, v114, s65, v53
    v_dot2_f32_bf16 v54, v115, s64, v54
    v_dot2_f32_bf16 v55, v115, s65, v55
    v_dot2_f32_bf16 v56, v116, s64, v56
    v_dot2_f32_bf16 v57, v116, s65, v57
    v_dot2_f32_bf16 v58, v117, s64, v58
    v_dot2_f32_bf16 v59, v117, s65, v59
    v_dot2_f32_bf16 v60, v118, s64, v60
    v_dot2_f32_bf16 v61, v118, s65, v61
    v_dot2_f32_bf16 v62, v119, s64, v62
    v_dot2_f32_bf16 v63, v119, s65, v63
    v_dot2_f32_bf16 v64, v120, s64, v64
    v_dot2_f32_bf16 v65, v120, s65, v65
    v_dot2_f32_bf16 v66, v121, s64, v66
    v_dot2_f32_bf16 v67, v121, s65, v67
    v_dot2_f32_bf16 v68, v122, s64, v68
    v_dot2_f32_bf16 v69, v122, s65, v69
    v_dot2_f32_bf16 v70, v123, s64, v70
    v_dot2_f32_bf16 v71, v123, s65, v71
    v_dot2_f32_bf16 v72, v124, s64, v72
    v_dot2_f32_bf16 v73, v124, s65, v73
    v_dot2_f32_bf16 v74, v125, s64, v74
    v_dot2_f32_bf16 v75, v125, s65, v75
    v_dot2_f32_bf16 v76, v126, s64, v76
    v_dot2_f32_bf16 v77, v126, s65, v77
    v_dot2_f32_bf16 v78, v127, s64, v78
    v_dot2_f32_bf16 v79, v127, s65, v79
    v_dot2_f32_bf16 v48, v128, s64, v48
    v_dot2_f32_bf16 v49, v128, s65, v49
    v_dot2_f32_bf16 v50, v129, s64, v50
    v_dot2_f32_bf16 v51, v129, s65, v51
    v_dot2_f32_bf16 v52, v130, s64, v52
    v_dot2_f32_bf16 v53, v130, s65, v53
    v_dot2_f32_bf16 v54, v131, s64, v54
    v_dot2_f32_bf16 v55, v131, s65, v55
    v_dot2_f32_bf16 v56, v132, s64, v56
    v_dot2_f32_bf16 v57, v132, s65, v57
    v_dot2_f32_bf16 v58, v133, s64, v58
    v_dot2_f32_bf16 v59, v133, s65, v59
    v_dot2_f32_bf16 v60, v134, s64, v60
    v_dot2_f32_bf16 v61, v134, s65, v61
    v_dot2_f32_bf16 v62, v135, s64, v62
    v_dot2_f32_bf16 v63, v135, s65, v63
    v_dot2_f32_bf16 v64, v136, s64, v64
    v_dot2_f32_bf16 v65, v136, s65, v65
    v_dot2_f32_bf16 v66, v137, s64, v66
    v_dot2_f32_bf16 v67, v137, s65, v67
    v_dot2_f32_bf16 v68, v138, s64, v68
    v_dot2_f32_bf16 v69, v138, s65, v69
    v_dot2_f32_bf16 v70, v139, s64, v70
    v_dot2_f32_bf16 v71, v139, s65, v71
    v_dot2_f32_bf16 v72, v140, s64, v72
    v_dot2_f32_bf16 v73, v140, s65, v73
    v_dot2_f32_bf16 v74, v141, s64, v74
    v_dot2_f32_bf16 v75, v141, s65, v75
    v_dot2_f32_bf16 v76, v142, s64, v76
    v_dot2_f32_bf16 v77, v142, s65, v77
    v_dot2_f32_bf16 v78, v143, s64, v78
    v_dot2_f32_bf16 v79, v143, s65, v79
    v_dot2_f32_bf16 v48, v144, s64, v48
    v_dot2_f32_bf16 v49, v144, s65, v49
    v_dot2_f32_bf16 v50, v145, s64, v50
    v_dot2_f32_bf16 v51, v145, s65, v51
    v_dot2_f32_bf16 v52, v146, s64, v52
    v_dot2_f32_bf16 v53, v146, s65, v53
    v_dot2_f32_bf16 v54, v147, s64, v54
    v_dot2_f32_bf16 v55, v147, s65, v55
    v_dot2_f32_bf16 v56, v148, s64, v56
    v_dot2_f32_bf16 v57, v148, s65, v57
    v_dot2_f32_bf16 v58, v149, s64, v58
    v_dot2_f32_bf16 v59, v149, s65, v59
    v_dot2_f32_bf16 v60, v150, s64, v60
    v_dot2_f32_bf16 v61, v150, s65, v61
    v_dot2_f32_bf16 v62, v151, s64, v62
    v_dot2_f32_bf16 v63, v151, s65, v63
    v_dot2_f32_bf16 v64, v152, s64, v64
    v_dot2_f32_bf16 v65, v152, s65, v65
    v_dot2_f32_bf16 v66, v153, s64, v66
    v_dot2_f32_bf16 v67, v153, s65, v67
    v_dot2_f32_bf16 v68, v154, s64, v68
    v_dot2_f32_bf16 v69, v154, s65, v69
    v_dot2_f32_bf16 v70, v155, s64, v70
    v_dot2_f32_bf16 v71, v155, s65, v71
    v_dot2_f32_bf16 v72, v156, s64, v72
    v_dot2_f32_bf16 v73, v156, s65, v73
    v_dot2_f32_bf16 v74, v157, s64, v74
    v_dot2_f32_bf16 v75, v157, s65, v75
    v_dot2_f32_bf16 v76, v158, s64, v76
    v_dot2_f32_bf16 v77, v158, s65, v77
    v_dot2_f32_bf16 v78, v159, s64, v78
    v_dot2_f32_bf16 v79, v159, s65, v79
    v_dot2_f32_bf16 v48, v160, s64, v48
    v_dot2_f32_bf16 v49, v160, s65, v49
    v_dot2_f32_bf16 v50, v161, s64, v50
    v_dot2_f32_bf16 v51, v161, s65, v51
    v_dot2_f32_bf16 v52, v162, s64, v52
    v_dot2_f32_bf16 v53, v162, s65, v53
    v_dot2_f32_bf16 v54, v163, s64, v54
    v_dot2_f32_bf16 v55, v163, s65, v55
    v_dot2_f32_bf16 v56, v164, s64, v56
    v_dot2_f32_bf16 v57, v164, s65, v57
    v_dot2_f32_bf16 v58, v165, s64, v58
    v_dot2_f32_bf16 v59, v165, s65, v59
    v_dot2_f32_bf16 v60, v166, s64, v60
    v_dot2_f32_bf16 v61, v166, s65, v61
    v_dot2_f32_bf16 v62, v167, s64, v62
    v_dot2_f32_bf16 v63, v167, s65, v63
    v_dot2_f32_bf16 v64, v168, s64, v64
    v_dot2_f32_bf16 v65, v168, s65, v65
    v_dot2_f32_bf16 v66, v169, s64, v66
    v_dot2_f32_bf16 v67, v169, s65, v67
    v_dot2_f32_bf16 v68, v170, s64, v68
    v_dot2_f32_bf16 v69, v170, s65, v69
    v_dot2_f32_bf16 v70, v171, s64, v70
    v_dot2_f32_bf16 v71, v171, s65, v71
    v_dot2_f32_bf16 v72, v172, s64, v72
    v_dot2_f32_bf16 v73, v172, s65, v73
    v_dot2_f32_bf16 v74, v173, s64, v74
    v_dot2_f32_bf16 v75, v173, s65, v75
    v_dot2_f32_bf16 v76, v174, s64, v76
    v_dot2_f32_bf16 v77, v174, s65, v77
    v_dot2_f32_bf16 v78, v175, s64, v78
    v_dot2_f32_bf16 v79, v175, s65, v79
    v_dot2_f32_bf16 v48, v176, s64, v48
    v_dot2_f32_bf16 v49, v176, s65, v49
    v_dot2_f32_bf16 v50, v177, s64, v50
    v_dot2_f32_bf16 v51, v177, s65, v51
    v_dot2_f32_bf16 v52, v178, s64, v52
    v_dot2_f32_bf16 v53, v178, s65, v53
    v_dot2_f32_bf16 v54, v179, s64, v54
    v_dot2_f32_bf16 v55, v179, s65, v55
    v_dot2_f32_bf16 v56, v180, s64, v56
    v_dot2_f32_bf16 v57, v180, s65, v57
    v_dot2_f32_bf16 v58, v181, s64, v58
    v_dot2_f32_bf16 v59, v181, s65, v59
    v_dot2_f32_bf16 v60, v182, s64, v60
    v_dot2_f32_bf16 v61, v182, s65, v61
    v_dot2_f32_bf16 v62, v183, s64, v62
    v_dot2_f32_bf16 v63, v183, s65, v63
    v_dot2_f32_bf16 v64, v184, s64, v64
    v_dot2_f32_bf16 v65, v184, s65, v65
    v_dot2_f32_bf16 v66, v185, s64, v66
    v_dot2_f32_bf16 v67, v185, s65, v67
    v_dot2_f32_bf16 v68, v186, s64, v68
    v_dot2_f32_bf16 v69, v186, s65, v69
    v_dot2_f32_bf16 v70, v187, s64, v70
    v_dot2_f32_bf16 v71, v187, s65, v71
    v_dot2_f32_bf16 v72, v188, s64, v72
    v_dot2_f32_bf16 v73, v188, s65, v73
    v_dot2_f32_bf16 v74, v189, s64, v74
    v_dot2_f32_bf16 v75, v189, s65, v75
    v_dot2_f32_bf16 v76, v190, s64, v76
    v_dot2_f32_bf16 v77, v190, s65, v77
    v_dot2_f32_bf16 v78, v191, s64, v78
    v_dot2_f32_bf16 v79, v191, s65, v79
    v_dot2_f32_bf16 v48, v192, s64, v48
    v_dot2_f32_bf16 v49, v192, s65, v49
    v_dot2_f32_bf16 v50, v193, s64, v50
    v_dot2_f32_bf16 v51, v193, s65, v51
    v_dot2_f32_bf16 v52, v194, s64, v52
    v_dot2_f32_bf16 v53, v194, s65, v53
    v_dot2_f32_bf16 v54, v195, s64, v54
    v_dot2_f32_bf16 v55, v195, s65, v55
    v_dot2_f32_bf16 v56, v196, s64, v56
    v_dot2_f32_bf16 v57, v196, s65, v57
    v_dot2_f32_bf16 v58, v197, s64, v58
    v_dot2_f32_bf16 v59, v197, s65, v59
    v_dot2_f32_bf16 v60, v198, s64, v60
    v_dot2_f32_bf16 v61, v198, s65, v61
    v_dot2_f32_bf16 v62, v199, s64, v62
    v_dot2_f32_bf16 v63, v199, s65, v63
    v_dot2_f32_bf16 v64, v200, s64, v64
    v_dot2_f32_bf16 v65, v200, s65, v65
    v_dot2_f32_bf16 v66, v201, s64, v66
    v_dot2_f32_bf16 v67, v201, s65, v67
    v_dot2_f32_bf16 v68, v202, s64, v68
    v_dot2_f32_bf16 v69, v202, s65, v69
    v_dot2_f32_bf16 v70, v203, s64, v70
    v_dot2_f32_bf16 v71, v203, s65, v71
    v_dot2_f32_bf16 v72, v204, s64, v72
    v_dot2_f32_bf16 v73, v204, s65, v73
    v_dot2_f32_bf16 v74, v205, s64, v74
    v_dot2_f32_bf16 v75, v205, s65, v75
    v_dot2_f32_bf16 v76, v206, s64, v76
    v_dot2_f32_bf16 v77, v206, s65, v77
    v_dot2_f32_bf16 v78, v207, s64, v78
    v_dot2_f32_bf16 v79, v207, s65, v79
    v_dot2_f32_bf16 v48, v208, s64, v48
    v_dot2_f32_bf16 v49, v208, s65, v49
    v_dot2_f32_bf16 v50, v209, s64, v50
    v_dot2_f32_bf16 v51, v209, s65, v51
    v_dot2_f32_bf16 v52, v210, s64, v52
    v_dot2_f32_bf16 v53, v210, s65, v53
    v_dot2_f32_bf16 v54, v211, s64, v54
    v_dot2_f32_bf16 v55, v211, s65, v55
    v_dot2_f32_bf16 v56, v212, s64, v56
    v_dot2_f32_bf16 v57, v212, s65, v57
    v_dot2_f32_bf16 v58, v213, s64, v58
    v_dot2_f32_bf16 v59, v213, s65, v59
    v_dot2_f32_bf16 v60, v214, s64, v60
    v_dot2_f32_bf16 v61, v214, s65, v61
    v_dot2_f32_bf16 v62, v215, s64, v62
    v_dot2_f32_bf16 v63, v215, s65, v63
    v_dot2_f32_bf16 v64, v216, s64, v64
    v_dot2_f32_bf16 v65, v216, s65, v65
    v_dot2_f32_bf16 v66, v217, s64, v66
    v_dot2_f32_bf16 v67, v217, s65, v67
    v_dot2_f32_bf16 v68, v218, s64, v68
    v_dot2_f32_bf16 v69, v218, s65, v69
    v_dot2_f32_bf16 v70, v219, s64, v70
    v_dot2_f32_bf16 v71, v219, s65, v71
    v_dot2_f32_bf16 v72, v220, s64, v72
    v_dot2_f32_bf16 v73, v220, s65, v73
    v_dot2_f32_bf16 v74, v221, s64, v74
    v_dot2_f32_bf16 v75, v221, s65, v75
    v_dot2_f32_bf16 v76, v222, s64, v76
    v_dot2_f32_bf16 v77, v222, s65, v77
    v_dot2_f32_bf16 v78, v223, s64, v78
    v_dot2_f32_bf16 v79, v223, s65, v79
    s_nop 3
    v_mul_f32 v48, 0x40088e99, v48
    v_mul_f32 v49, 0x40088e99, v49
    v_mul_f32 v50, 0x40088e99, v50
    v_mul_f32 v51, 0x40088e99, v51
    v_mul_f32 v52, 0x40088e99, v52
    v_mul_f32 v53, 0x40088e99, v53
    v_mul_f32 v54, 0x40088e99, v54
    v_mul_f32 v55, 0x40088e99, v55
    v_mul_f32 v56, 0x40088e99, v56
    v_mul_f32 v57, 0x40088e99, v57
    v_mul_f32 v58, 0x40088e99, v58
    v_mul_f32 v59, 0x40088e99, v59
    v_mul_f32 v60, 0x40088e99, v60
    v_mul_f32 v61, 0x40088e99, v61
    v_mul_f32 v62, 0x40088e99, v62
    v_mul_f32 v63, 0x40088e99, v63
    v_dot2_f32_bf16 v48, v80, s64, v48
    v_dot2_f32_bf16 v49, v80, s65, v49
    v_dot2_f32_bf16 v50, v81, s64, v50
    v_dot2_f32_bf16 v51, v81, s65, v51
    v_dot2_f32_bf16 v52, v82, s64, v52
    v_dot2_f32_bf16 v53, v82, s65, v53
    v_dot2_f32_bf16 v54, v83, s64, v54
    v_dot2_f32_bf16 v55, v83, s65, v55
    v_dot2_f32_bf16 v56, v84, s64, v56
    v_dot2_f32_bf16 v57, v84, s65, v57
    v_dot2_f32_bf16 v58, v85, s64, v58
    v_dot2_f32_bf16 v59, v85, s65, v59
    v_dot2_f32_bf16 v60, v86, s64, v60
    v_dot2_f32_bf16 v61, v86, s65, v61
    v_dot2_f32_bf16 v62, v87, s64, v62
    v_dot2_f32_bf16 v63, v87, s65, v63
    v_mul_f32 v64, 0x40088e99, v64
    v_mul_f32 v65, 0x40088e99, v65
    v_mul_f32 v66, 0x40088e99, v66
    v_mul_f32 v67, 0x40088e99, v67
    v_mul_f32 v68, 0x40088e99, v68
    v_mul_f32 v69, 0x40088e99, v69
    v_mul_f32 v70, 0x40088e99, v70
    v_mul_f32 v71, 0x40088e99, v71
    v_mul_f32 v72, 0x40088e99, v72
    v_mul_f32 v73, 0x40088e99, v73
    v_mul_f32 v74, 0x40088e99, v74
    v_mul_f32 v75, 0x40088e99, v75
    v_mul_f32 v76, 0x40088e99, v76
    v_mul_f32 v77, 0x40088e99, v77
    v_mul_f32 v78, 0x40088e99, v78
    v_mul_f32 v79, 0x40088e99, v79
    v_dot2_f32_bf16 v64, v88, s64, v64
    v_dot2_f32_bf16 v65, v88, s65, v65
    v_dot2_f32_bf16 v66, v89, s64, v66
    v_dot2_f32_bf16 v67, v89, s65, v67
    v_dot2_f32_bf16 v68, v90, s64, v68
    v_dot2_f32_bf16 v69, v90, s65, v69
    v_dot2_f32_bf16 v70, v91, s64, v70
    v_dot2_f32_bf16 v71, v91, s65, v71
    v_dot2_f32_bf16 v72, v92, s64, v72
    v_dot2_f32_bf16 v73, v92, s65, v73
    v_dot2_f32_bf16 v74, v93, s64, v74
    v_dot2_f32_bf16 v75, v93, s65, v75
    v_dot2_f32_bf16 v76, v94, s64, v76
    v_dot2_f32_bf16 v77, v94, s65, v77
    v_dot2_f32_bf16 v78, v95, s64, v78
    v_dot2_f32_bf16 v79, v95, s65, v79
    s_nop 3
T_nc13:
    s_bitcmp1_b32 s46, 12
    s_cbranch_scc0 T_nc12
    v_dot2_f32_bf16 v224, v96, s64, 0
    v_dot2_f32_bf16 v225, v96, s65, 0
    v_dot2_f32_bf16 v226, v97, s64, 0
    v_dot2_f32_bf16 v227, v97, s65, 0
    v_dot2_f32_bf16 v228, v98, s64, 0
    v_dot2_f32_bf16 v229, v98, s65, 0
    v_dot2_f32_bf16 v230, v99, s64, 0
    v_dot2_f32_bf16 v231, v99, s65, 0
    v_dot2_f32_bf16 v232, v100, s64, 0
    v_dot2_f32_bf16 v233, v100, s65, 0
    v_dot2_f32_bf16 v234, v101, s64, 0
    v_dot2_f32_bf16 v235, v101, s65, 0
    v_dot2_f32_bf16 v236, v102, s64, 0
    v_dot2_f32_bf16 v237, v102, s65, 0
    v_dot2_f32_bf16 v238, v103, s64, 0
    v_dot2_f32_bf16 v239, v103, s65, 0
    v_dot2_f32_bf16 v224, v104, s64, v224
    v_dot2_f32_bf16 v225, v104, s65, v225
    v_dot2_f32_bf16 v226, v105, s64, v226
    v_dot2_f32_bf16 v227, v105, s65, v227
    v_dot2_f32_bf16 v228, v106, s64, v228
    v_dot2_f32_bf16 v229, v106, s65, v229
    v_dot2_f32_bf16 v230, v107, s64, v230
    v_dot2_f32_bf16 v231, v107, s65, v231
    v_dot2_f32_bf16 v232, v108, s64, v232
    v_dot2_f32_bf16 v233, v108, s65, v233
    v_dot2_f32_bf16 v234, v109, s64, v234
    v_dot2_f32_bf16 v235, v109, s65, v235
    v_dot2_f32_bf16 v236, v110, s64, v236
    v_dot2_f32_bf16 v237, v110, s65, v237
    v_dot2_f32_bf16 v238, v111, s64, v238
    v_dot2_f32_bf16 v239, v111, s65, v239
    v_dot2_f32_bf16 v224, v112, s64, v224
    v_dot2_f32_bf16 v225, v112, s65, v225
    v_dot2_f32_bf16 v226, v113, s64, v226
    v_dot2_f32_bf16 v227, v113, s65, v227
    v_dot2_f32_bf16 v228, v114, s64, v228
    v_dot2_f32_bf16 v229, v114, s65, v229
    v_dot2_f32_bf16 v230, v115, s64, v230
    v_dot2_f32_bf16 v231, v115, s65, v231
    v_dot2_f32_bf16 v232, v116, s64, v232
    v_dot2_f32_bf16 v233, v116, s65, v233
    v_dot2_f32_bf16 v234, v117, s64, v234
    v_dot2_f32_bf16 v235, v117, s65, v235
    v_dot2_f32_bf16 v236, v118, s64, v236
    v_dot2_f32_bf16 v237, v118, s65, v237
    v_dot2_f32_bf16 v238, v119, s64, v238
    v_dot2_f32_bf16 v239, v119, s65, v239
    v_dot2_f32_bf16 v224, v120, s64, v224
    v_dot2_f32_bf16 v225, v120, s65, v225
    v_dot2_f32_bf16 v226, v121, s64, v226
    v_dot2_f32_bf16 v227, v121, s65, v227
    v_dot2_f32_bf16 v228, v122, s64, v228
    v_dot2_f32_bf16 v229, v122, s65, v229
    v_dot2_f32_bf16 v230, v123, s64, v230
    v_dot2_f32_bf16 v231, v123, s65, v231
    v_dot2_f32_bf16 v232, v124, s64, v232
    v_dot2_f32_bf16 v233, v124, s65, v233
    v_dot2_f32_bf16 v234, v125, s64, v234
    v_dot2_f32_bf16 v235, v125, s65, v235
    v_dot2_f32_bf16 v236, v126, s64, v236
    v_dot2_f32_bf16 v237, v126, s65, v237
    v_dot2_f32_bf16 v238, v127, s64, v238
    v_dot2_f32_bf16 v239, v127, s65, v239
    v_dot2_f32_bf16 v224, v128, s64, v224
    v_dot2_f32_bf16 v225, v128, s65, v225
    v_dot2_f32_bf16 v226, v129, s64, v226
    v_dot2_f32_bf16 v227, v129, s65, v227
    v_dot2_f32_bf16 v228, v130, s64, v228
    v_dot2_f32_bf16 v229, v130, s65, v229
    v_dot2_f32_bf16 v230, v131, s64, v230
    v_dot2_f32_bf16 v231, v131, s65, v231
    v_dot2_f32_bf16 v232, v132, s64, v232
    v_dot2_f32_bf16 v233, v132, s65, v233
    v_dot2_f32_bf16 v234, v133, s64, v234
    v_dot2_f32_bf16 v235, v133, s65, v235
    v_dot2_f32_bf16 v236, v134, s64, v236
    v_dot2_f32_bf16 v237, v134, s65, v237
    v_dot2_f32_bf16 v238, v135, s64, v238
    v_dot2_f32_bf16 v239, v135, s65, v239
    v_dot2_f32_bf16 v224, v136, s64, v224
    v_dot2_f32_bf16 v225, v136, s65, v225
    v_dot2_f32_bf16 v226, v137, s64, v226
    v_dot2_f32_bf16 v227, v137, s65, v227
    v_dot2_f32_bf16 v228, v138, s64, v228
    v_dot2_f32_bf16 v229, v138, s65, v229
    v_dot2_f32_bf16 v230, v139, s64, v230
    v_dot2_f32_bf16 v231, v139, s65, v231
    v_dot2_f32_bf16 v232, v140, s64, v232
    v_dot2_f32_bf16 v233, v140, s65, v233
    v_dot2_f32_bf16 v234, v141, s64, v234
    v_dot2_f32_bf16 v235, v141, s65, v235
    v_dot2_f32_bf16 v236, v142, s64, v236
    v_dot2_f32_bf16 v237, v142, s65, v237
    v_dot2_f32_bf16 v238, v143, s64, v238
    v_dot2_f32_bf16 v239, v143, s65, v239
    v_dot2_f32_bf16 v224, v144, s64, v224
    v_dot2_f32_bf16 v225, v144, s65, v225
    v_dot2_f32_bf16 v226, v145, s64, v226
    v_dot2_f32_bf16 v227, v145, s65, v227
    v_dot2_f32_bf16 v228, v146, s64, v228
    v_dot2_f32_bf16 v229, v146, s65, v229
    v_dot2_f32_bf16 v230, v147, s64, v230
    v_dot2_f32_bf16 v231, v147, s65, v231
    v_dot2_f32_bf16 v232, v148, s64, v232
    v_dot2_f32_bf16 v233, v148, s65, v233
    v_dot2_f32_bf16 v234, v149, s64, v234
    v_dot2_f32_bf16 v235, v149, s65, v235
    v_dot2_f32_bf16 v236, v150, s64, v236
    v_dot2_f32_bf16 v237, v150, s65, v237
    v_dot2_f32_bf16 v238, v151, s64, v238
    v_dot2_f32_bf16 v239, v151, s65, v239
    v_dot2_f32_bf16 v224, v152, s64, v224
    v_dot2_f32_bf16 v225, v152, s65, v225
    v_dot2_f32_bf16 v226, v153, s64, v226
    v_dot2_f32_bf16 v227, v153, s65, v227
    v_dot2_f32_bf16 v228, v154, s64, v228
    v_dot2_f32_bf16 v229, v154, s65, v229
    v_dot2_f32_bf16 v230, v155, s64, v230
    v_dot2_f32_bf16 v231, v155, s65, v231
    v_dot2_f32_bf16 v232, v156, s64, v232
    v_dot2_f32_bf16 v233, v156, s65, v233
    v_dot2_f32_bf16 v234, v157, s64, v234
    v_dot2_f32_bf16 v235, v157, s65, v235
    v_dot2_f32_bf16 v236, v158, s64, v236
    v_dot2_f32_bf16 v237, v158, s65, v237
    v_dot2_f32_bf16 v238, v159, s64, v238
    v_dot2_f32_bf16 v239, v159, s65, v239
    s_nop 3
    v_mul_f32 v224, 0x40088e99, v224
    v_mul_f32 v225, 0x40088e99, v225
    v_mul_f32 v226, 0x40088e99, v226
    v_mul_f32 v227, 0x40088e99, v227
    v_mul_f32 v228, 0x40088e99, v228
    v_mul_f32 v229, 0x40088e99, v229
    v_mul_f32 v230, 0x40088e99, v230
    v_mul_f32 v231, 0x40088e99, v231
    v_mul_f32 v232, 0x40088e99, v232
    v_mul_f32 v233, 0x40088e99, v233
    v_mul_f32 v234, 0x40088e99, v234
    v_mul_f32 v235, 0x40088e99, v235
    v_mul_f32 v236, 0x40088e99, v236
    v_mul_f32 v237, 0x40088e99, v237
    v_mul_f32 v238, 0x40088e99, v238
    v_mul_f32 v239, 0x40088e99, v239
    v_dot2_f32_bf16 v224, v240, s64, v224
    v_dot2_f32_bf16 v225, v240, s65, v225
    v_dot2_f32_bf16 v226, v241, s64, v226
    v_dot2_f32_bf16 v227, v241, s65, v227
    v_dot2_f32_bf16 v228, v242, s64, v228
    v_dot2_f32_bf16 v229, v242, s65, v229
    v_dot2_f32_bf16 v230, v243, s64, v230
    v_dot2_f32_bf16 v231, v243, s65, v231
    v_dot2_f32_bf16 v232, v244, s64, v232
    v_dot2_f32_bf16 v233, v244, s65, v233
    v_dot2_f32_bf16 v234, v245, s64, v234
    v_dot2_f32_bf16 v235, v245, s65, v235
    v_dot2_f32_bf16 v236, v246, s64, v236
    v_dot2_f32_bf16 v237, v246, s65, v237
    v_dot2_f32_bf16 v238, v247, s64, v238
    v_dot2_f32_bf16 v239, v247, s65, v239
    s_nop 3
T_nc12:
    s_bitcmp1_b32 s46, 0
    s_cbranch_scc0 T_nc0
    ds_read_b64_tr_b16 a[144:145], v8 offset:0
    ds_read_b64_tr_b16 a[146:147], v8 offset:512
    ds_read_b64_tr_b16 a[148:149], v10 offset:0
    ds_read_b64_tr_b16 a[150:151], v10 offset:512
    ds_read_b64_tr_b16 a[152:153], v8 offset:1152
    ds_read_b64_tr_b16 a[154:155], v8 offset:1664
    ds_read_b64_tr_b16 a[156:157], v10 offset:1152
    ds_read_b64_tr_b16 a[158:159], v10 offset:1664
    ds_read_b64_tr_b16 a[160:161], v8 offset:2304
    ds_read_b64_tr_b16 a[162:163], v8 offset:2816
    ds_read_b64_tr_b16 a[164:165], v10 offset:2304
    ds_read_b64_tr_b16 a[166:167], v10 offset:2816
    ds_read_b64_tr_b16 a[168:169], v8 offset:3456
    ds_read_b64_tr_b16 a[170:171], v8 offset:3968
    ds_read_b64_tr_b16 a[172:173], v10 offset:3456
    ds_read_b64_tr_b16 a[174:175], v10 offset:3968
    s_waitcnt lgkmcnt(14)
    v_mfma_f32_32x32x16_bf16 v[16:31], a[144:147], a[0:3], v[16:31]
    s_waitcnt lgkmcnt(12)
    v_mfma_f32_32x32x16_bf16 v[32:47], a[148:151], a[0:3], v[32:47]
    s_waitcnt lgkmcnt(10)
    v_mfma_f32_32x32x16_bf16 v[16:31], a[152:155], a[4:7], v[16:31]
    s_waitcnt lgkmcnt(8)
    v_mfma_f32_32x32x16_bf16 v[32:47], a[156:159], a[4:7], v[32:47]
    s_waitcnt lgkmcnt(6)
    v_mfma_f32_32x32x16_bf16 v[16:31], a[160:163], a[8:11], v[16:31]
    s_waitcnt lgkmcnt(4)
    v_mfma_f32_32x32x16_bf16 v[32:47], a[164:167], a[8:11], v[32:47]
    s_waitcnt lgkmcnt(2)
    v_mfma_f32_32x32x16_bf16 v[16:31], a[168:171], a[12:15], v[16:31]
    s_waitcnt lgkmcnt(0)
    v_mfma_f32_32x32x16_bf16 v[32:47], a[172:175], a[12:15], v[32:47]
T_nc0:
    s_bitcmp1_b32 s46, 1
    s_cbranch_scc0 T_nc1
    ds_read_b64_tr_b16 a[144:145], v8 offset:4608
    ds_read_b64_tr_b16 a[146:147], v8 offset:5120
    ds_read_b64_tr_b16 a[148:149], v10 offset:4608
    ds_read_b64_tr_b16 a[150:151], v10 offset:5120
    ds_read_b64_tr_b16 a[152:153], v8 offset:5760
    ds_read_b64_tr_b16 a[154:155], v8 offset:6272
    ds_read_b64_tr_b16 a[156:157], v10 offset:5760
    ds_read_b64_tr_b16 a[158:159], v10 offset:6272
    ds_read_b64_tr_b16 a[160:161], v8 offset:6912
    ds_read_b64_tr_b16 a[162:163], v8 offset:7424
    ds_read_b64_tr_b16 a[164:165], v10 offset:6912
    ds_read_b64_tr_b16 a[166:167], v10 offset:7424
    ds_read_b64_tr_b16 a[168:169], v8 offset:8064
    ds_read_b64_tr_b16 a[170:171], v8 offset:8576
    ds_read_b64_tr_b16 a[172:173], v10 offset:8064
    ds_read_b64_tr_b16 a[174:175], v10 offset:8576
    s_waitcnt lgkmcnt(14)
    v_mfma_f32_32x32x16_bf16 v[16:31], a[144:147], a[16:19], v[16:31]
    s_waitcnt lgkmcnt(12)
    v_mfma_f32_32x32x16_bf16 v[32:47], a[148:151], a[16:19], v[32:47]
    s_waitcnt lgkmcnt(10)
    v_mfma_f32_32x32x16_bf16 v[16:31], a[152:155], a[20:23], v[16:31]
    s_waitcnt lgkmcnt(8)
    v_mfma_f32_32x32x16_bf16 v[32:47], a[156:159], a[20:23], v[32:47]
    s_waitcnt lgkmcnt(6)
    v_mfma_f32_32x32x16_bf16 v[16:31], a[160:163], a[24:27], v[16:31]
    s_waitcnt lgkmcnt(4)
    v_mfma_f32_32x32x16_bf16 v[32:47], a[164:167], a[24:27], v[32:47]
    s_waitcnt lgkmcnt(2)
    v_mfma_f32_32x32x16_bf16 v[16:31], a[168:171], a[28:31], v[16:31]
    s_waitcnt lgkmcnt(0)
    v_mfma_f32_32x32x16_bf16 v[32:47], a[172:175], a[28:31], v[32:47]
T_nc1:
    s_bitcmp1_b32 s46, 2
    s_cbranch_scc0 T_nc2
    ds_read_b64_tr_b16 a[144:145], v8 offset:9216
    ds_read_b64_tr_b16 a[146:147], v8 offset:9728
    ds_read_b64_tr_b16 a[148:149], v10 offset:9216
    ds_read_b64_tr_b16 a[150:151], v10 offset:9728
    ds_read_b64_tr_b16 a[152:153], v8 offset:10368
    ds_read_b64_tr_b16 a[154:155], v8 offset:10880
    ds_read_b64_tr_b16 a[156:157], v10 offset:10368
    ds_read_b64_tr_b16 a[158:159], v10 offset:10880
    ds_read_b64_tr_b16 a[160:161], v8 offset:11520
    ds_read_b64_tr_b16 a[162:163], v8 offset:12032
    ds_read_b64_tr_b16 a[164:165], v10 offset:11520
    ds_read_b64_tr_b16 a[166:167], v10 offset:12032
    ds_read_b64_tr_b16 a[168:169], v8 offset:12672
    ds_read_b64_tr_b16 a[170:171], v8 offset:13184
    ds_read_b64_tr_b16 a[172:173], v10 offset:12672
    ds_read_b64_tr_b16 a[174:175], v10 offset:13184
    s_waitcnt lgkmcnt(14)
    v_mfma_f32_32x32x16_bf16 v[16:31], a[144:147], a[32:35], v[16:31]
    s_waitcnt lgkmcnt(12)
    v_mfma_f32_32x32x16_bf16 v[32:47], a[148:151], a[32:35], v[32:47]
    s_waitcnt lgkmcnt(10)
    v_mfma_f32_32x32x16_bf16 v[16:31], a[152:155], a[36:39], v[16:31]
    s_waitcnt lgkmcnt(8)
    v_mfma_f32_32x32x16_bf16 v[32:47], a[156:159], a[36:39], v[32:47]
    s_waitcnt lgkmcnt(6)
    v_mfma_f32_32x32x16_bf16 v[16:31], a[160:163], a[40:43], v[16:31]
    s_waitcnt lgkmcnt(4)
    v_mfma_f32_32x32x16_bf16 v[32:47], a[164:167], a[40:43], v[32:47]
    s_waitcnt lgkmcnt(2)
    v_mfma_f32_32x32x16_bf16 v[16:31], a[168:171], a[44:47], v[16:31]
    s_waitcnt lgkmcnt(0)
    v_mfma_f32_32x32x16_bf16 v[32:47], a[172:175], a[44:47], v[32:47]
T_nc2:
    s_bitcmp1_b32 s46, 3
    s_cbranch_scc0 T_nc3
    ds_read_b64_tr_b16 a[144:145], v8 offset:13824
    ds_read_b64_tr_b16 a[146:147], v8 offset:14336
    ds_read_b64_tr_b16 a[148:149], v10 offset:13824
    ds_read_b64_tr_b16 a[150:151], v10 offset:14336
    ds_read_b64_tr_b16 a[152:153], v8 offset:14976
    ds_read_b64_tr_b16 a[154:155], v8 offset:15488
    ds_read_b64_tr_b16 a[156:157], v10 offset:14976
    ds_read_b64_tr_b16 a[158:159], v10 offset:15488
    ds_read_b64_tr_b16 a[160:161], v8 offset:16128
    ds_read_b64_tr_b16 a[162:163], v8 offset:16640
    ds_read_b64_tr_b16 a[164:165], v10 offset:16128
    ds_read_b64_tr_b16 a[166:167], v10 offset:16640
    ds_read_b64_tr_b16 a[168:169], v8 offset:17280
    ds_read_b64_tr_b16 a[170:171], v8 offset:17792
    ds_read_b64_tr_b16 a[172:173], v10 offset:17280
    ds_read_b64_tr_b16 a[174:175], v10 offset:17792
    s_waitcnt lgkmcnt(14)
    v_mfma_f32_32x32x16_bf16 v[16:31], a[144:147], a[48:51], v[16:31]
    s_waitcnt lgkmcnt(12)
    v_mfma_f32_32x32x16_bf16 v[32:47], a[148:151], a[48:51], v[32:47]
    s_waitcnt lgkmcnt(10)
    v_mfma_f32_32x32x16_bf16 v[16:31], a[152:155], a[52:55], v[16:31]
    s_waitcnt lgkmcnt(8)
    v_mfma_f32_32x32x16_bf16 v[32:47], a[156:159], a[52:55], v[32:47]
    s_waitcnt lgkmcnt(6)
    v_mfma_f32_32x32x16_bf16 v[16:31], a[160:163], a[56:59], v[16:31]
    s_waitcnt lgkmcnt(4)
    v_mfma_f32_32x32x16_bf16 v[32:47], a[164:167], a[56:59], v[32:47]
    s_waitcnt lgkmcnt(2)
    v_mfma_f32_32x32x16_bf16 v[16:31], a[168:171], a[60:63], v[16:31]
    s_waitcnt lgkmcnt(0)
    v_mfma_f32_32x32x16_bf16 v[32:47], a[172:175], a[60:63], v[32:47]
T_nc3:
    s_bitcmp1_b32 s46, 4
    s_cbranch_scc0 T_nc4
    ds_read_b64_tr_b16 a[144:145], v8 offset:18432
    ds_read_b64_tr_b16 a[146:147], v8 offset:18944
    ds_read_b64_tr_b16 a[148:149], v10 offset:18432
    ds_read_b64_tr_b16 a[150:151], v10 offset:18944
    ds_read_b64_tr_b16 a[152:153], v8 offset:19584
    ds_read_b64_tr_b16 a[154:155], v8 offset:20096
    ds_read_b64_tr_b16 a[156:157], v10 offset:19584
    ds_read_b64_tr_b16 a[158:159], v10 offset:20096
    ds_read_b64_tr_b16 a[160:161], v8 offset:20736
    ds_read_b64_tr_b16 a[162:163], v8 offset:21248
    ds_read_b64_tr_b16 a[164:165], v10 offset:20736
    ds_read_b64_tr_b16 a[166:167], v10 offset:21248
    ds_read_b64_tr_b16 a[168:169], v8 offset:21888
    ds_read_b64_tr_b16 a[170:171], v8 offset:22400
    ds_read_b64_tr_b16 a[172:173], v10 offset:21888
    ds_read_b64_tr_b16 a[174:175], v10 offset:22400
    s_waitcnt lgkmcnt(14)
    v_mfma_f32_32x32x16_bf16 v[16:31], a[144:147], a[64:67], v[16:31]
    s_waitcnt lgkmcnt(12)
    v_mfma_f32_32x32x16_bf16 v[32:47], a[148:151], a[64:67], v[32:47]
    s_waitcnt lgkmcnt(10)
    v_mfma_f32_32x32x16_bf16 v[16:31], a[152:155], a[68:71], v[16:31]
    s_waitcnt lgkmcnt(8)
    v_mfma_f32_32x32x16_bf16 v[32:47], a[156:159], a[68:71], v[32:47]
    s_waitcnt lgkmcnt(6)
    v_mfma_f32_32x32x16_bf16 v[16:31], a[160:163], a[72:75], v[16:31]
    s_waitcnt lgkmcnt(4)
    v_mfma_f32_32x32x16_bf16 v[32:47], a[164:167], a[72:75], v[32:47]
    s_waitcnt lgkmcnt(2)
    v_mfma_f32_32x32x16_bf16 v[16:31], a[168:171], a[76:79], v[16:31]
    s_waitcnt lgkmcnt(0)
    v_mfma_f32_32x32x16_bf16 v[32:47], a[172:175], a[76:79], v[32:47]
T_nc4:
    s_bitcmp1_b32 s46, 5
    s_cbranch_scc0 T_nc5
    ds_read_b64_tr_b16 a[144:145], v8 offset:23040
    ds_read_b64_tr_b16 a[146:147], v8 offset:23552
    ds_read_b64_tr_b16 a[148:149], v10 offset:23040
    ds_read_b64_tr_b16 a[150:151], v10 offset:23552
    ds_read_b64_tr_b16 a[152:153], v8 offset:24192
    ds_read_b64_tr_b16 a[154:155], v8 offset:24704
    ds_read_b64_tr_b16 a[156:157], v10 offset:24192
    ds_read_b64_tr_b16 a[158:159], v10 offset:24704
    ds_read_b64_tr_b16 a[160:161], v8 offset:25344
    ds_read_b64_tr_b16 a[162:163], v8 offset:25856
    ds_read_b64_tr_b16 a[164:165], v10 offset:25344
    ds_read_b64_tr_b16 a[166:167], v10 offset:25856
    ds_read_b64_tr_b16 a[168:169], v8 offset:26496
    ds_read_b64_tr_b16 a[170:171], v8 offset:27008
    ds_read_b64_tr_b16 a[172:173], v10 offset:26496
    ds_read_b64_tr_b16 a[174:175], v10 offset:27008
    s_waitcnt lgkmcnt(14)
    v_mfma_f32_32x32x16_bf16 v[16:31], a[144:147], a[80:83], v[16:31]
    s_waitcnt lgkmcnt(12)
    v_mfma_f32_32x32x16_bf16 v[32:47], a[148:151], a[80:83], v[32:47]
    s_waitcnt lgkmcnt(10)
    v_mfma_f32_32x32x16_bf16 v[16:31], a[152:155], a[84:87], v[16:31]
    s_waitcnt lgkmcnt(8)
    v_mfma_f32_32x32x16_bf16 v[32:47], a[156:159], a[84:87], v[32:47]
    s_waitcnt lgkmcnt(6)
    v_mfma_f32_32x32x16_bf16 v[16:31], a[160:163], a[88:91], v[16:31]
    s_waitcnt lgkmcnt(4)
    v_mfma_f32_32x32x16_bf16 v[32:47], a[164:167], a[88:91], v[32:47]
    s_waitcnt lgkmcnt(2)
    v_mfma_f32_32x32x16_bf16 v[16:31], a[168:171], a[92:95], v[16:31]
    s_waitcnt lgkmcnt(0)
    v_mfma_f32_32x32x16_bf16 v[32:47], a[172:175], a[92:95], v[32:47]
T_nc5:
    s_bitcmp1_b32 s46, 6
    s_cbranch_scc0 T_nc6
    ds_read_b64_tr_b16 a[144:145], v8 offset:27648
    ds_read_b64_tr_b16 a[146:147], v8 offset:28160
    ds_read_b64_tr_b16 a[148:149], v10 offset:27648
    ds_read_b64_tr_b16 a[150:151], v10 offset:28160
    ds_read_b64_tr_b16 a[152:153], v8 offset:28800
    ds_read_b64_tr_b16 a[154:155], v8 offset:29312
    ds_read_b64_tr_b16 a[156:157], v10 offset:28800
    ds_read_b64_tr_b16 a[158:159], v10 offset:29312
    ds_read_b64_tr_b16 a[160:161], v8 offset:29952
    ds_read_b64_tr_b16 a[162:163], v8 offset:30464
    ds_read_b64_tr_b16 a[164:165], v10 offset:29952
    ds_read_b64_tr_b16 a[166:167], v10 offset:30464
    ds_read_b64_tr_b16 a[168:169], v8 offset:31104
    ds_read_b64_tr_b16 a[170:171], v8 offset:31616
    ds_read_b64_tr_b16 a[172:173], v10 offset:31104
    ds_read_b64_tr_b16 a[174:175], v10 offset:31616
    s_waitcnt lgkmcnt(14)
    v_mfma_f32_32x32x16_bf16 v[16:31], a[144:147], a[96:99], v[16:31]
    s_waitcnt lgkmcnt(12)
    v_mfma_f32_32x32x16_bf16 v[32:47], a[148:151], a[96:99], v[32:47]
    s_waitcnt lgkmcnt(10)
    v_mfma_f32_32x32x16_bf16 v[16:31], a[152:155], a[100:103], v[16:31]
    s_waitcnt lgkmcnt(8)
    v_mfma_f32_32x32x16_bf16 v[32:47], a[156:159], a[100:103], v[32:47]
    s_waitcnt lgkmcnt(6)
    v_mfma_f32_32x32x16_bf16 v[16:31], a[160:163], a[104:107], v[16:31]
    s_waitcnt lgkmcnt(4)
    v_mfma_f32_32x32x16_bf16 v[32:47], a[164:167], a[104:107], v[32:47]
    s_waitcnt lgkmcnt(2)
    v_mfma_f32_32x32x16_bf16 v[16:31], a[168:171], a[108:111], v[16:31]
    s_waitcnt lgkmcnt(0)
    v_mfma_f32_32x32x16_bf16 v[32:47], a[172:175], a[108:111], v[32:47]
T_nc6:
    s_bitcmp1_b32 s46, 7
    s_cbranch_scc0 T_nc7
    ds_read_b64_tr_b16 a[144:145], v8 offset:32256
    ds_read_b64_tr_b16 a[146:147], v8 offset:32768
    ds_read_b64_tr_b16 a[148:149], v10 offset:32256
    ds_read_b64_tr_b16 a[150:151], v10 offset:32768
    ds_read_b64_tr_b16 a[152:153], v8 offset:33408
    ds_read_b64_tr_b16 a[154:155], v8 offset:33920
    ds_read_b64_tr_b16 a[156:157], v10 offset:33408
    ds_read_b64_tr_b16 a[158:159], v10 offset:33920
    ds_read_b64_tr_b16 a[160:161], v8 offset:34560
    ds_read_b64_tr_b16 a[162:163], v8 offset:35072
    ds_read_b64_tr_b16 a[164:165], v10 offset:34560
    ds_read_b64_tr_b16 a[166:167], v10 offset:35072
    ds_read_b64_tr_b16 a[168:169], v8 offset:35712
    ds_read_b64_tr_b16 a[170:171], v8 offset:36224
    ds_read_b64_tr_b16 a[172:173], v10 offset:35712
    ds_read_b64_tr_b16 a[174:175], v10 offset:36224
    s_waitcnt lgkmcnt(14)
    v_mfma_f32_32x32x16_bf16 v[16:31], a[144:147], a[112:115], v[16:31]
    s_waitcnt lgkmcnt(12)
    v_mfma_f32_32x32x16_bf16 v[32:47], a[148:151], a[112:115], v[32:47]
    s_waitcnt lgkmcnt(10)
    v_mfma_f32_32x32x16_bf16 v[16:31], a[152:155], a[116:119], v[16:31]
    s_waitcnt lgkmcnt(8)
    v_mfma_f32_32x32x16_bf16 v[32:47], a[156:159], a[116:119], v[32:47]
    s_waitcnt lgkmcnt(6)
    v_mfma_f32_32x32x16_bf16 v[16:31], a[160:163], a[120:123], v[16:31]
    s_waitcnt lgkmcnt(4)
    v_mfma_f32_32x32x16_bf16 v[32:47], a[164:167], a[120:123], v[32:47]
    s_waitcnt lgkmcnt(2)
    v_mfma_f32_32x32x16_bf16 v[16:31], a[168:171], a[124:127], v[16:31]
    s_waitcnt lgkmcnt(0)
    v_mfma_f32_32x32x16_bf16 v[32:47], a[172:175], a[124:127], v[32:47]
T_nc7:
    s_bitcmp1_b32 s46, 8
    s_cbranch_scc0 T_ncx0
    ds_read_b64_tr_b16 a[144:145], v9 offset:0
    ds_read_b64_tr_b16 a[146:147], v9 offset:2304
    ds_read_b64_tr_b16 a[148:149], v11 offset:0
    ds_read_b64_tr_b16 a[150:151], v11 offset:2304
    s_waitcnt lgkmcnt(2)
    v_mfma_f32_32x32x16_bf16 v[16:31], a[144:147], a[128:131], v[16:31]
    s_waitcnt lgkmcnt(0)
    v_mfma_f32_32x32x16_bf16 v[32:47], a[148:151], a[128:131], v[32:47]
T_ncx0:
    s_bitcmp1_b32 s46, 9
    s_cbranch_scc0 T_ncx1
    ds_read_b64_tr_b16 a[144:145], v9 offset:9216
    ds_read_b64_tr_b16 a[146:147], v9 offset:11520
    ds_read_b64_tr_b16 a[148:149], v11 offset:9216
    ds_read_b64_tr_b16 a[150:151], v11 offset:11520
    s_waitcnt lgkmcnt(2)
    v_mfma_f32_32x32x16_bf16 v[16:31], a[144:147], a[132:135], v[16:31]
    s_waitcnt lgkmcnt(0)
    v_mfma_f32_32x32x16_bf16 v[32:47], a[148:151], a[132:135], v[32:47]
T_ncx1:
    s_bitcmp1_b32 s46, 10
    s_cbranch_scc0 T_ncx2
    ds_read_b64_tr_b16 a[144:145], v9 offset:18432
    ds_read_b64_tr_b16 a[146:147], v9 offset:20736
    ds_read_b64_tr_b16 a[148:149], v11 offset:18432
    ds_read_b64_tr_b16 a[150:151], v11 offset:20736
    s_waitcnt lgkmcnt(2)
    v_mfma_f32_32x32x16_bf16 v[16:31], a[144:147], a[136:139], v[16:31]
    s_waitcnt lgkmcnt(0)
    v_mfma_f32_32x32x16_bf16 v[32:47], a[148:151], a[136:139], v[32:47]
T_ncx2:
    s_bitcmp1_b32 s46, 11
    s_cbranch_scc0 T_ncx3
    ds_read_b64_tr_b16 a[144:145], v9 offset:27648
    ds_read_b64_tr_b16 a[146:147], v9 offset:29952
    ds_read_b64_tr_b16 a[148:149], v11 offset:27648
    ds_read_b64_tr_b16 a[150:151], v11 offset:29952
    s_waitcnt lgkmcnt(2)
    v_mfma_f32_32x32x16_bf16 v[16:31], a[144:147], a[140:143], v[16:31]
    s_waitcnt lgkmcnt(0)
    v_mfma_f32_32x32x16_bf16 v[32:47], a[148:151], a[140:143], v[32:47]
T_ncx3:
    s_cmp_eq_u32 s9, 0x3fff
    s_cbranch_scc1 T_alld
    s_or_b32 s7, s11, s46
    s_cmp_lg_u32 s7, 0
    s_cbranch_scc1 T_round
    s_sleep 3
    s_branch T_round
T_alld:
    s_cmp_lg_u32 s5, s47
    s_cbranch_scc1 T_noE0
    v_add_u32 v8, 73728, v8
    v_add_u32 v9, 73728, v9
    ds_read_b64_tr_b16 a[144:145], v8 offset:0
    ds_read_b64_tr_b16 a[146:147], v8 offset:512
    ds_read_b64_tr_b16 a[148:149], v8 offset:1152
    ds_read_b64_tr_b16 a[150:151], v8 offset:1664
    ds_read_b64_tr_b16 a[152:153], v8 offset:2304
    ds_read_b64_tr_b16 a[154:155], v8 offset:2816
    ds_read_b64_tr_b16 a[156:157], v8 offset:3456
    ds_read_b64_tr_b16 a[158:159], v8 offset:3968
    ds_read_b64_tr_b16 a[160:161], v8 offset:4608
    ds_read_b64_tr_b16 a[162:163], v8 offset:5120
    ds_read_b64_tr_b16 a[164:165], v8 offset:5760
    ds_read_b64_tr_b16 a[166:167], v8 offset:6272
    s_waitcnt lgkmcnt(10)
    v_mfma_f32_32x32x16_bf16 v[96:111], a[144:147], a[0:3], 0
    ds_read_b64_tr_b16 a[168:169], v8 offset:6912
    ds_read_b64_tr_b16 a[170:171], v8 offset:7424
    s_waitcnt lgkmcnt(10)
    v_mfma_f32_32x32x16_bf16 v[96:111], a[148:151], a[4:7], v[96:111]
    ds_read_b64_tr_b16 a[172:173], v8 offset:8064
    ds_read_b64_tr_b16 a[174:175], v8 offset:8576
    s_waitcnt lgkmcnt(10)
    v_mfma_f32_32x32x16_bf16 v[96:111], a[152:155], a[8:11], v[96:111]
    ds_read_b64_tr_b16 a[144:145], v8 offset:9216
    ds_read_b64_tr_b16 a[146:147], v8 offset:9728
    s_waitcnt lgkmcnt(10)
    v_mfma_f32_32x32x16_bf16 v[96:111], a[156:159], a[12:15], v[96:111]
    ds_read_b64_tr_b16 a[148:149], v8 offset:10368
    ds_read_b64_tr_b16 a[150:151], v8 offset:10880
    s_waitcnt lgkmcnt(10)
    v_mfma_f32_32x32x16_bf16 v[96:111], a[160:163], a[16:19], v[96:111]
    ds_read_b64_tr_b16 a[152:153], v8 offset:11520
    ds_read_b64_tr_b16 a[154:155], v8 offset:12032
    s_waitcnt lgkmcnt(10)
    v_mfma_f32_32x32x16_bf16 v[96:111], a[164:167], a[20:23], v[96:111]
    ds_read_b64_tr_b16 a[156:157], v8 offset:12672
    ds_read_b64_tr_b16 a[158:159], v8 offset:13184
    s_waitcnt lgkmcnt(10)
    v_mfma_f32_32x32x16_bf16 v[96:111], a[168:171], a[24:27], v[96:111]
    ds_read_b64_tr_b16 a[160:161], v8 offset:13824
    ds_read_b64_tr_b16 a[162:163], v8 offset:14336
    s_waitcnt lgkmcnt(10)
    v_mfma_f32_32x32x16_bf16 v[96:111], a[172:175], a[28:31], v[96:111]
    ds_read_b64_tr_b16 a[164:165], v8 offset:14976
    ds_read_b64_tr_b16 a[166:167], v8 offset:15488
    s_waitcnt lgkmcnt(10)
    v_mfma_f32_32x32x16_bf16 v[96:111], a[144:147], a[32:35], v[96:111]
    ds_read_b64_tr_b16 a[168:169], v8 offset:16128
    ds_read_b64_tr_b16 a[170:171], v8 offset:16640
    s_waitcnt lgkmcnt(10)
    v_mfma_f32_32x32x16_bf16 v[96:111], a[148:151], a[36:39], v[96:111]
    ds_read_b64_tr_b16 a[172:173], v8 offset:17280
    ds_read_b64_tr_b16 a[174:175], v8 offset:17792
    s_waitcnt lgkmcnt(10)
    v_mfma_f32_32x32x16_bf16 v[96:111], a[152:155], a[40:43], v[96:111]
    ds_read_b64_tr_b16 a[144:145], v8 offset:18432
    ds_read_b64_tr_b16 a[146:147], v8 offset:18944
    s_waitcnt lgkmcnt(10)
    v_mfma_f32_32x32x16_bf16 v[96:111], a[156:159], a[44:47], v[96:111]
    ds_read_b64_tr_b16 a[148:149], v8 offset:19584
    ds_read_b64_tr_b16 a[150:151], v8 offset:20096
    s_waitcnt lgkmcnt(10)
    v_mfma_f32_32x32x16_bf16 v[96:111], a[160:163], a[48:51], v[96:111]
    ds_read_b64_tr_b16 a[152:153], v8 offset:20736
    ds_read_b64_tr_b16 a[154:155], v8 offset:21248
    s_waitcnt lgkmcnt(10)
    v_mfma_f32_32x32x16_bf16 v[96:111], a[164:167], a[52:55], v[96:111]
    ds_read_b64_tr_b16 a[156:157], v8 offset:21888
    ds_read_b64_tr_b16 a[158:159], v8 offset:22400
    s_waitcnt lgkmcnt(10)
    v_mfma_f32_32x32x16_bf16 v[96:111], a[168:171], a[56:59], v[96:111]
    ds_read_b64_tr_b16 a[160:161], v8 offset:23040
    ds_read_b64_tr_b16 a[162:163], v8 offset:23552
    s_waitcnt lgkmcnt(10)
    v_mfma_f32_32x32x16_bf16 v[96:111], a[172:175], a[60:63], v[96:111]
    ds_read_b64_tr_b16 a[164:165], v8 offset:24192
    ds_read_b64_tr_b16 a[166:167], v8 offset:24704
    s_waitcnt lgkmcnt(10)
    v_mfma_f32_32x32x16_bf16 v[96:111], a[144:147], a[64:67], v[96:111]
    ds_read_b64_tr_b16 a[168:169], v8 offset:25344
    ds_read_b64_tr_b16 a[170:171], v8 offset:25856
    s_waitcnt lgkmcnt(10)
    v_mfma_f32_32x32x16_bf16 v[96:111], a[148:151], a[68:71], v[96:111]
    ds_read_b64_tr_b16 a[172:173], v8 offset:26496
    ds_read_b64_tr_b16 a[174:175], v8 offset:27008
    s_waitcnt lgkmcnt(10)
    v_mfma_f32_32x32x16_bf16 v[96:111], a[152:155], a[72:75], v[96:111]
    ds_read_b64_tr_b16 a[144:145], v8 offset:27648
    ds_read_b64_tr_b16 a[146:147], v8 offset:28160
    s_waitcnt lgkmcnt(10)
    v_mfma_f32_32x32x16_bf16 v[96:111], a[156:159], a[76:79], v[96:111]
    ds_read_b64_tr_b16 a[148:149], v8 offset:28800
    ds_read_b64_tr_b16 a[150:151], v8 offset:29312
    s_waitcnt lgkmcnt(10)
    v_mfma_f32_32x32x16_bf16 v[96:111], a[160:163], a[80:83], v[96:111]
    ds_read_b64_tr_b16 a[152:153], v8 offset:29952
    ds_read_b64_tr_b16 a[154:155], v8 offset:30464
    s_waitcnt lgkmcnt(10)
    v_mfma_f32_32x32x16_bf16 v[96:111], a[164:167], a[84:87], v[96:111]
    ds_read_b64_tr_b16 a[156:157], v8 offset:31104
    ds_read_b64_tr_b16 a[158:159], v8 offset:31616
    s_waitcnt lgkmcnt(10)
    v_mfma_f32_32x32x16_bf16 v[96:111], a[168:171], a[88:91], v[96:111]
    ds_read_b64_tr_b16 a[160:161], v8 offset:32256
    ds_read_b64_tr_b16 a[162:163], v8 offset:32768
    s_waitcnt lgkmcnt(10)
    v_mfma_f32_32x32x16_bf16 v[96:111], a[172:175], a[92:95], v[96:111]
    ds_read_b64_tr_b16 a[164:165], v8 offset:33408
    ds_read_b64_tr_b16 a[166:167], v8 offset:33920
    s_waitcnt lgkmcnt(10)
    v_mfma_f32_32x32x16_bf16 v[96:111], a[144:147], a[96:99], v[96:111]
    ds_read_b64_tr_b16 a[168:169], v8 offset:34560
    ds_read_b64_tr_b16 a[170:171], v8 offset:35072
    s_waitcnt lgkmcnt(10)
    v_mfma_f32_32x32x16_bf16 v[96:111], a[148:151], a[100:103], v[96:111]
    ds_read_b64_tr_b16 a[172:173], v8 offset:35712
    ds_read_b64_tr_b16 a[174:175], v8 offset:36224
    s_waitcnt lgkmcnt(10)
    v_mfma_f32_32x32x16_bf16 v[96:111], a[152:155], a[104:107], v[96:111]
    ds_read_b64_tr_b16 a[144:145], v9 offset:0
    ds_read_b64_tr_b16 a[146:147], v9 offset:2304
    s_waitcnt lgkmcnt(10)
    v_mfma_f32_32x32x16_bf16 v[96:111], a[156:159], a[108:111], v[96:111]
    ds_read_b64_tr_b16 a[148:149], v9 offset:9216
    ds_read_b64_tr_b16 a[150:151], v9 offset:11520
    s_waitcnt lgkmcnt(10)
    v_mfma_f32_32x32x16_bf16 v[96:111], a[160:163], a[112:115], v[96:111]
    ds_read_b64_tr_b16 a[152:153], v9 offset:18432
    ds_read_b64_tr_b16 a[154:155], v9 offset:20736
    s_waitcnt lgkmcnt(10)
    v_mfma_f32_32x32x16_bf16 v[96:111], a[164:167], a[116:119], v[96:111]
    ds_read_b64_tr_b16 a[156:157], v9 offset:27648
    ds_read_b64_tr_b16 a[158:159], v9 offset:29952
    s_waitcnt lgkmcnt(10)
    v_mfma_f32_32x32x16_bf16 v[96:111], a[168:171], a[120:123], v[96:111]
    s_waitcnt lgkmcnt(8)
    v_mfma_f32_32x32x16_bf16 v[96:111], a[172:175], a[124:127], v[96:111]
    s_waitcnt lgkmcnt(6)
    v_mfma_f32_32x32x16_bf16 v[96:111], a[144:147], a[128:131], v[96:111]
    s_waitcnt lgkmcnt(4)
    v_mfma_f32_32x32x16_bf16 v[96:111], a[148:151], a[132:135], v[96:111]
    s_waitcnt lgkmcnt(2)
    v_mfma_f32_32x32x16_bf16 v[96:111], a[152:155], a[136:139], v[96:111]
    s_waitcnt lgkmcnt(0)
    v_mfma_f32_32x32x16_bf16 v[96:111], a[156:159], a[140:143], v[96:111]
T_noE0:
    s_nop 7
    s_nop 3
    v_sub_f32 v16, v16, v48
    v_fma_f32 v16, v5, v16, v48
    v_sub_f32 v17, v17, v49
    v_fma_f32 v17, v5, v17, v49
    v_sub_f32 v18, v18, v50
    v_fma_f32 v18, v5, v18, v50
    v_sub_f32 v19, v19, v51
    v_fma_f32 v19, v5, v19, v51
    v_sub_f32 v20, v20, v52
    v_fma_f32 v20, v5, v20, v52
    v_sub_f32 v21, v21, v53
    v_fma_f32 v21, v5, v21, v53
    v_sub_f32 v22, v22, v54
    v_fma_f32 v22, v5, v22, v54
    v_sub_f32 v23, v23, v55
    v_fma_f32 v23, v5, v23, v55
    v_sub_f32 v24, v24, v56
    v_fma_f32 v24, v5, v24, v56
    v_sub_f32 v25, v25, v57
    v_fma_f32 v25, v5, v25, v57
    v_sub_f32 v26, v26, v58
    v_fma_f32 v26, v5, v26, v58
    v_sub_f32 v27, v27, v59
    v_fma_f32 v27, v5, v27, v59
    v_sub_f32 v28, v28, v60
    v_fma_f32 v28, v5, v28, v60
    v_sub_f32 v29, v29, v61
    v_fma_f32 v29, v5, v29, v61
    v_sub_f32 v30, v30, v62
    v_fma_f32 v30, v5, v30, v62
    v_sub_f32 v31, v31, v63
    v_fma_f32 v31, v5, v31, v63
    v_cvt_pk_bf16_f32 v80, v16, v17
    v_cvt_pk_bf16_f32 v81, v18, v19
    v_cvt_pk_bf16_f32 v82, v20, v21
    v_cvt_pk_bf16_f32 v83, v22, v23
    v_cvt_pk_bf16_f32 v84, v24, v25
    v_cvt_pk_bf16_f32 v85, v26, v27
    v_cvt_pk_bf16_f32 v86, v28, v29
    v_cvt_pk_bf16_f32 v87, v30, v31
    s_nop 1
    v_permlane32_swap_b32 v80, v82
    v_permlane32_swap_b32 v81, v83
    v_permlane32_swap_b32 v84, v86
    v_permlane32_swap_b32 v85, v87
    s_nop 1
    buffer_store_dwordx4 v[80:83], v2, s[12:15], s51 offen offset:0 nt
    buffer_store_dwordx4 v[84:87], v2, s[12:15], s51 offen offset:32 nt
    v_sub_f32 v32, v32, v64
    v_fma_f32 v32, v5, v32, v64
    v_sub_f32 v33, v33, v65
    v_fma_f32 v33, v5, v33, v65
    v_sub_f32 v34, v34, v66
    v_fma_f32 v34, v5, v34, v66
    v_sub_f32 v35, v35, v67
    v_fma_f32 v35, v5, v35, v67
    v_sub_f32 v36, v36, v68
    v_fma_f32 v36, v5, v36, v68
    v_sub_f32 v37, v37, v69
    v_fma_f32 v37, v5, v37, v69
    v_sub_f32 v38, v38, v70
    v_fma_f32 v38, v5, v38, v70
    v_sub_f32 v39, v39, v71
    v_fma_f32 v39, v5, v39, v71
    v_sub_f32 v40, v40, v72
    v_fma_f32 v40, v5, v40, v72
    v_sub_f32 v41, v41, v73
    v_fma_f32 v41, v5, v41, v73
    v_sub_f32 v42, v42, v74
    v_fma_f32 v42, v5, v42, v74
    v_sub_f32 v43, v43, v75
    v_fma_f32 v43, v5, v43, v75
    v_sub_f32 v44, v44, v76
    v_fma_f32 v44, v5, v44, v76
    v_sub_f32 v45, v45, v77
    v_fma_f32 v45, v5, v45, v77
    v_sub_f32 v46, v46, v78
    v_fma_f32 v46, v5, v46, v78
    v_sub_f32 v47, v47, v79
    v_fma_f32 v47, v5, v47, v79
    v_cvt_pk_bf16_f32 v88, v32, v33
    v_cvt_pk_bf16_f32 v89, v34, v35
    v_cvt_pk_bf16_f32 v90, v36, v37
    v_cvt_pk_bf16_f32 v91, v38, v39
    v_cvt_pk_bf16_f32 v92, v40, v41
    v_cvt_pk_bf16_f32 v93, v42, v43
    v_cvt_pk_bf16_f32 v94, v44, v45
    v_cvt_pk_bf16_f32 v95, v46, v47
    s_nop 1
    v_permlane32_swap_b32 v88, v90
    v_permlane32_swap_b32 v89, v91
    v_permlane32_swap_b32 v92, v94
    v_permlane32_swap_b32 v93, v95
    s_nop 1
    buffer_store_dwordx4 v[88:91], v2, s[12:15], s51 offen offset:64 nt
    buffer_store_dwordx4 v[92:95], v2, s[12:15], s51 offen offset:96 nt
    s_cmp_lg_u32 s5, s47
    s_cbranch_scc1 T_done
    s_mul_i32 s8, s6, 36864
    s_add_u32 s8, s8, s48
    v_sub_f32 v96, v96, v224
    v_fma_f32 v96, v5, v96, v224
    v_sub_f32 v97, v97, v225
    v_fma_f32 v97, v5, v97, v225
    v_sub_f32 v98, v98, v226
    v_fma_f32 v98, v5, v98, v226
    v_sub_f32 v99, v99, v227
    v_fma_f32 v99, v5, v99, v227
    v_sub_f32 v100, v100, v228
    v_fma_f32 v100, v5, v100, v228
    v_sub_f32 v101, v101, v229
    v_fma_f32 v101, v5, v101, v229
    v_sub_f32 v102, v102, v230
    v_fma_f32 v102, v5, v102, v230
    v_sub_f32 v103, v103, v231
    v_fma_f32 v103, v5, v103, v231
    v_sub_f32 v104, v104, v232
    v_fma_f32 v104, v5, v104, v232
    v_sub_f32 v105, v105, v233
    v_fma_f32 v105, v5, v105, v233
    v_sub_f32 v106, v106, v234
    v_fma_f32 v106, v5, v106, v234
    v_sub_f32 v107, v107, v235
    v_fma_f32 v107, v5, v107, v235
    v_sub_f32 v108, v108, v236
    v_fma_f32 v108, v5, v108, v236
    v_sub_f32 v109, v109, v237
    v_fma_f32 v109, v5, v109, v237
    v_sub_f32 v110, v110, v238
    v_fma_f32 v110, v5, v110, v238
    v_sub_f32 v111, v111, v239
    v_fma_f32 v111, v5, v111, v239
    v_cvt_pk_bf16_f32 v112, v96, v97
    v_cvt_pk_bf16_f32 v113, v98, v99
    v_cvt_pk_bf16_f32 v114, v100, v101
    v_cvt_pk_bf16_f32 v115, v102, v103
    v_cvt_pk_bf16_f32 v116, v104, v105
    v_cvt_pk_bf16_f32 v117, v106, v107
    v_cvt_pk_bf16_f32 v118, v108, v109
    v_cvt_pk_bf16_f32 v119, v110, v111
    s_nop 1
    v_permlane32_swap_b32 v112, v114
    v_permlane32_swap_b32 v113, v115
    v_permlane32_swap_b32 v116, v118
    v_permlane32_swap_b32 v117, v119
    s_nop 1
    buffer_store_dwordx4 v[112:115], v2, s[12:15], s8 offen offset:0 nt
    buffer_store_dwordx4 v[116:119], v2, s[12:15], s8 offen offset:32 nt
T_done:
    s_or_b32 s8, s3, s4
    s_or_b32 s8, s8, s5
    s_cmp_lg_u32 s8, 0
    s_cbranch_scc1 T_end
    s_mov_b64 exec, 1
    v_mov_b32 v13, 0
T_ep:
    buffer_load_dword v14, v13, s[60:63], 0 offen offset:4 sc1
    s_waitcnt vmcnt(0)
    v_readfirstlane_b32 s8, v14
    s_nop 3
    s_cmp_ge_u32 s8, 256
    s_cbranch_scc1 T_epd
    s_sleep 2
    s_branch T_ep
T_epd:
    v_mov_b32 v14, s98
    s_mov_b32 s8, 29368320
    buffer_store_dword v14, v13, s[24:27], s8 offen
    s_mov_b64 exec, -1
T_end:
    s_endpgm
A_start:
    v_lshlrev_b32 v2, 4, v1
    v_and_b32 v3, 31, v1
    v_lshlrev_b32 v4, 2, v3
    v_lshrrev_b32 v5, 5, v1
    s_mov_b32 s9, 5462
    v_add_u32 v131, 0, v1
    v_mul_lo_u32 v132, v131, s9
    v_lshrrev_b32 v132, 16, v132
    v_mul_u32_u24 v133, 12, v132
    v_sub_u32 v131, v131, v133
    v_lshlrev_b32 v131, 4, v131
    v_mul_u32_u24 v132, 1152, v132
    v_add_u32 v134, v131, v132
    v_add_u32 v131, 64, v1
    v_mul_lo_u32 v132, v131, s9
    v_lshrrev_b32 v132, 16, v132
    v_mul_u32_u24 v133, 12, v132
    v_sub_u32 v131, v131, v133
    v_lshlrev_b32 v131, 4, v131
    v_mul_u32_u24 v132, 1152, v132
    v_add_u32 v135, v131, v132
    v_add_u32 v131, 128, v1
    v_mul_lo_u32 v132, v131, s9
    v_lshrrev_b32 v132, 16, v132
    v_mul_u32_u24 v133, 12, v132
    v_sub_u32 v131, v131, v133
    v_lshlrev_b32 v131, 4, v131
    v_mul_u32_u24 v132, 1152, v132
    v_add_u32 v136, v131, v132
    v_and_b32 v131, 31, v1
    v_bfe_u32 v132, v131, 1, 3
    v_mul_u32_u24 v131, 1152, v131
    s_mul_i32 s11, s5, 36864
    v_add_u32 v131, s11, v131
    v_lshrrev_b32 v146, 5, v1
    v_add_u32 v146, 0, v146
    v_xor_b32 v146, v146, v132
    v_lshlrev_b32 v146, 4, v146
    v_add_u32 v146, v131, v146
    v_lshrrev_b32 v147, 5, v1
    v_add_u32 v147, 2, v147
    v_xor_b32 v147, v147, v132
    v_lshlrev_b32 v147, 4, v147
    v_add_u32 v147, v131, v147
    v_lshrrev_b32 v148, 5, v1
    v_add_u32 v148, 4, v148
    v_xor_b32 v148, v148, v132
    v_lshlrev_b32 v148, 4, v148
    v_add_u32 v148, v131, v148
    v_lshrrev_b32 v149, 5, v1
    v_add_u32 v149, 6, v149
    v_xor_b32 v149, v149, v132
    v_lshlrev_b32 v149, 4, v149
    v_add_u32 v149, v131, v149
    v_lshlrev_b32 v131, 3, v5
    v_bfe_u32 v132, v1, 2, 2
    v_add_u32 v131, v131, v132
    v_mul_u32_u24 v137, 192, v131
    v_bfe_u32 v131, v1, 4, 1
    v_lshlrev_b32 v131, 5, v131
    v_add_u32 v137, v137, v131
    v_and_b32 v131, 3, v1
    v_lshlrev_b32 v131, 3, v131
    v_add_u32 v137, v137, v131
    v_add_u32 v138, 55296, v137
    v_lshlrev_b32 v150, 4, v0
    s_cmp_ge_u32 s3, 2
    s_cbranch_scc1 A_nokv0
    s_mov_b32 s9, 58255
    v_lshlrev_b32 v151, 2, v0
    v_add_u32 v151, 0, v151
    v_mul_lo_u32 v152, v151, s9
    v_lshrrev_b32 v152, 19, v152
    v_mul_u32_u24 v153, 9, v152
    v_sub_u32 v151, v151, v153
    v_lshlrev_b32 v152, 6, v152
    v_add_u32 v152, 110592, v152
    v_add_u32 v153, 0, v151
    v_cmp_lt_u32 vcc, 8, v153
    v_lshlrev_b32 v153, 2, v153
    v_add_u32 v232, v152, v153
    v_add_u32 v153, 28, v232
    v_cndmask_b32 v232, v232, v153, vcc
    v_add_u32 v153, 1, v151
    v_cmp_lt_u32 vcc, 8, v153
    v_lshlrev_b32 v153, 2, v153
    v_add_u32 v233, v152, v153
    v_add_u32 v153, 28, v233
    v_cndmask_b32 v233, v233, v153, vcc
    v_add_u32 v153, 2, v151
    v_cmp_lt_u32 vcc, 8, v153
    v_lshlrev_b32 v153, 2, v153
    v_add_u32 v234, v152, v153
    v_add_u32 v153, 28, v234
    v_cndmask_b32 v234, v234, v153, vcc
    v_add_u32 v153, 3, v151
    v_cmp_lt_u32 vcc, 8, v153
    v_lshlrev_b32 v153, 2, v153
    v_add_u32 v235, v152, v153
    v_add_u32 v153, 28, v235
    v_cndmask_b32 v235, v235, v153, vcc
    v_lshlrev_b32 v151, 2, v0
    v_add_u32 v151, 1024, v151
    v_mul_lo_u32 v152, v151, s9
    v_lshrrev_b32 v152, 19, v152
    v_mul_u32_u24 v153, 9, v152
    v_sub_u32 v151, v151, v153
    v_lshlrev_b32 v152, 6, v152
    v_add_u32 v152, 110592, v152
    v_add_u32 v153, 0, v151
    v_cmp_lt_u32 vcc, 8, v153
    v_lshlrev_b32 v153, 2, v153
    v_add_u32 v236, v152, v153
    v_add_u32 v153, 28, v236
    v_cndmask_b32 v236, v236, v153, vcc
    v_add_u32 v153, 1, v151
    v_cmp_lt_u32 vcc, 8, v153
    v_lshlrev_b32 v153, 2, v153
    v_add_u32 v237, v152, v153
    v_add_u32 v153, 28, v237
    v_cndmask_b32 v237, v237, v153, vcc
    v_add_u32 v153, 2, v151
    v_cmp_lt_u32 vcc, 8, v153
    v_lshlrev_b32 v153, 2, v153
    v_add_u32 v238, v152, v153
    v_add_u32 v153, 28, v238
    v_cndmask_b32 v238, v238, v153, vcc
    v_add_u32 v153, 3, v151
    v_cmp_lt_u32 vcc, 8, v153
    v_lshlrev_b32 v153, 2, v153
    v_add_u32 v239, v152, v153
    v_add_u32 v153, 28, v239
    v_cndmask_b32 v239, v239, v153, vcc
    v_lshlrev_b32 v151, 2, v0
    v_add_u32 v151, 2048, v151
    v_mul_lo_u32 v152, v151, s9
    v_lshrrev_b32 v152, 19, v152
    v_mul_u32_u24 v153, 9, v152
    v_sub_u32 v151, v151, v153
    v_lshlrev_b32 v152, 6, v152
    v_add_u32 v152, 110592, v152
    v_add_u32 v153, 0, v151
    v_cmp_lt_u32 vcc, 8, v153
    v_lshlrev_b32 v153, 2, v153
    v_add_u32 v240, v152, v153
    v_add_u32 v153, 28, v240
    v_cndmask_b32 v240, v240, v153, vcc
    v_add_u32 v153, 1, v151
    v_cmp_lt_u32 vcc, 8, v153
    v_lshlrev_b32 v153, 2, v153
    v_add_u32 v241, v152, v153
    v_add_u32 v153, 28, v241
    v_cndmask_b32 v241, v241, v153, vcc
    v_add_u32 v153, 2, v151
    v_cmp_lt_u32 vcc, 8, v153
    v_lshlrev_b32 v153, 2, v153
    v_add_u32 v242, v152, v153
    v_add_u32 v153, 28, v242
    v_cndmask_b32 v242, v242, v153, vcc
    v_add_u32 v153, 3, v151
    v_cmp_lt_u32 vcc, 8, v153
    v_lshlrev_b32 v153, 2, v153
    v_add_u32 v243, v152, v153
    v_add_u32 v153, 28, v243
    v_cndmask_b32 v243, v243, v153, vcc
    v_lshlrev_b32 v151, 2, v0
    v_add_u32 v151, 3072, v151
    v_mul_lo_u32 v152, v151, s9
    v_lshrrev_b32 v152, 19, v152
    v_mul_u32_u24 v153, 9, v152
    v_sub_u32 v151, v151, v153
    v_lshlrev_b32 v152, 6, v152
    v_add_u32 v152, 110592, v152
    v_add_u32 v153, 0, v151
    v_cmp_lt_u32 vcc, 8, v153
    v_lshlrev_b32 v153, 2, v153
    v_add_u32 v244, v152, v153
    v_add_u32 v153, 28, v244
    v_cndmask_b32 v244, v244, v153, vcc
    v_add_u32 v153, 1, v151
    v_cmp_lt_u32 vcc, 8, v153
    v_lshlrev_b32 v153, 2, v153
    v_add_u32 v245, v152, v153
    v_add_u32 v153, 28, v245
    v_cndmask_b32 v245, v245, v153, vcc
    v_add_u32 v153, 2, v151
    v_cmp_lt_u32 vcc, 8, v153
    v_lshlrev_b32 v153, 2, v153
    v_add_u32 v246, v152, v153
    v_add_u32 v153, 28, v246
    v_cndmask_b32 v246, v246, v153, vcc
    v_add_u32 v153, 3, v151
    v_cmp_lt_u32 vcc, 8, v153
    v_lshlrev_b32 v153, 2, v153
    v_add_u32 v247, v152, v153
    v_add_u32 v153, 28, v247
    v_cndmask_b32 v247, v247, v153, vcc
    v_lshlrev_b32 v151, 2, v0
    v_add_u32 v151, 4096, v151
    v_mul_lo_u32 v152, v151, s9
    v_lshrrev_b32 v152, 19, v152
    v_mul_u32_u24 v153, 9, v152
    v_sub_u32 v151, v151, v153
    v_lshlrev_b32 v152, 6, v152
    v_add_u32 v152, 110592, v152
    v_add_u32 v153, 0, v151
    v_cmp_lt_u32 vcc, 8, v153
    v_lshlrev_b32 v153, 2, v153
    v_add_u32 v248, v152, v153
    v_add_u32 v153, 28, v248
    v_cndmask_b32 v248, v248, v153, vcc
    v_add_u32 v153, 1, v151
    v_cmp_lt_u32 vcc, 8, v153
    v_lshlrev_b32 v153, 2, v153
    v_add_u32 v249, v152, v153
    v_add_u32 v153, 28, v249
    v_cndmask_b32 v249, v249, v153, vcc
    v_add_u32 v153, 2, v151
    v_cmp_lt_u32 vcc, 8, v153
    v_lshlrev_b32 v153, 2, v153
    v_add_u32 v250, v152, v153
    v_add_u32 v153, 28, v250
    v_cndmask_b32 v250, v250, v153, vcc
    v_add_u32 v153, 3, v151
    v_cmp_lt_u32 vcc, 8, v153
    v_lshlrev_b32 v153, 2, v153
    v_add_u32 v251, v152, v153
    v_add_u32 v153, 28, v251
    v_cndmask_b32 v251, v251, v153, vcc
    v_lshlrev_b32 v151, 2, v0
    v_add_u32 v151, 5120, v151
    v_mul_lo_u32 v152, v151, s9
    v_lshrrev_b32 v152, 19, v152
    v_mul_u32_u24 v153, 9, v152
    v_sub_u32 v151, v151, v153
    v_lshlrev_b32 v152, 6, v152
    v_add_u32 v152, 110592, v152
    v_add_u32 v153, 0, v151
    v_cmp_lt_u32 vcc, 8, v153
    v_lshlrev_b32 v153, 2, v153
    v_add_u32 v252, v152, v153
    v_add_u32 v153, 28, v252
    v_cndmask_b32 v252, v252, v153, vcc
    v_add_u32 v153, 1, v151
    v_cmp_lt_u32 vcc, 8, v153
    v_lshlrev_b32 v153, 2, v153
    v_add_u32 v253, v152, v153
    v_add_u32 v153, 28, v253
    v_cndmask_b32 v253, v253, v153, vcc
    v_add_u32 v153, 2, v151
    v_cmp_lt_u32 vcc, 8, v153
    v_lshlrev_b32 v153, 2, v153
    v_add_u32 v254, v152, v153
    v_add_u32 v153, 28, v254
    v_cndmask_b32 v254, v254, v153, vcc
    v_add_u32 v153, 3, v151
    v_cmp_lt_u32 vcc, 8, v153
    v_lshlrev_b32 v153, 2, v153
    v_add_u32 v255, v152, v153
    v_add_u32 v153, 28, v255
    v_cndmask_b32 v255, v255, v153, vcc
    v_lshrrev_b32 v152, 5, v1
    v_mul_u32_u24 v154, 512, v152
    v_bfe_u32 v152, v1, 2, 2
    v_lshlrev_b32 v152, 6, v152
    v_add_u32 v154, v154, v152
    v_bfe_u32 v152, v1, 4, 1
    v_lshlrev_b32 v152, 5, v152
    v_add_u32 v154, v154, v152
    v_and_b32 v152, 3, v1
    v_lshlrev_b32 v152, 3, v152
    v_add_u32 v154, v154, v152
    v_add_u32 v154, 110592, v154
A_nokv0:
    s_add_u32 s9, s5, 0
    s_mul_i32 s10, s9, 43691
    s_lshr_b32 s10, s10, 17
    s_mul_i32 s11, s10, 3
    s_sub_u32 s11, s9, s11
    s_cmp_eq_u32 s11, 1
    s_cselect_b64 vcc, -1, 0
    v_cndmask_b32 v140, v134, v135, vcc
    s_cmp_eq_u32 s11, 2
    s_cselect_b64 vcc, -1, 0
    v_cndmask_b32 v140, v140, v136, vcc
    s_add_u32 s9, s5, 4
    s_mul_i32 s10, s9, 43691
    s_lshr_b32 s10, s10, 17
    s_mul_i32 s11, s10, 3
    s_sub_u32 s11, s9, s11
    s_cmp_eq_u32 s11, 1
    s_cselect_b64 vcc, -1, 0
    v_cndmask_b32 v141, v134, v135, vcc
    s_cmp_eq_u32 s11, 2
    s_cselect_b64 vcc, -1, 0
    v_cndmask_b32 v141, v141, v136, vcc
    s_add_u32 s9, s5, 8
    s_mul_i32 s10, s9, 43691
    s_lshr_b32 s10, s10, 17
    s_mul_i32 s11, s10, 3
    s_sub_u32 s11, s9, s11
    s_cmp_eq_u32 s11, 1
    s_cselect_b64 vcc, -1, 0
    v_cndmask_b32 v142, v134, v135, vcc
    s_cmp_eq_u32 s11, 2
    s_cselect_b64 vcc, -1, 0
    v_cndmask_b32 v142, v142, v136, vcc
    s_waitcnt lgkmcnt(0)
    s_mov_b32 s64, s40
    s_and_b32 s65, s41, 0xffff
    s_mov_b32 s66, 2359296
    s_mov_b32 s67, 0x20000
    s_lshr_b32 s7, s2, 3
    s_lshl_b32 s7, s7, 2
    s_add_u32 s7, s7, s5
    s_and_b32 s8, s2, 7
    s_lshr_b32 s9, s8, 1
    v_lshlrev_b32 v118, 7, v1
    s_mul_i32 s10, s7, 4608
    s_mul_i32 s11, s9, 589824
    s_add_u32 s10, s10, s11
    s_mov_b32 exec_hi, 15
    buffer_load_dword v119, v118, s[64:67], s10 offen
    s_mov_b32 exec_hi, -1
    s_mov_b64 s[94:95], s[42:43]
    s_cmp_eq_u32 s3, 0
    s_cselect_b32 s92, s44, s46
    s_cselect_b32 s93, s45, s47
    s_mov_b32 s16, s92
    s_and_b32 s17, s93, 0xffff
    s_mov_b32 s18, 20736
    s_mov_b32 s19, 0x20000
    s_cmp_ge_u32 s3, 2
    s_cbranch_scc1 A_nokv1
    s_mov_b32 s9, 0
    buffer_load_dwordx4 v[208:211], v150, s[16:19], s9 offen
    s_mov_b32 s9, 4096
    buffer_load_dwordx4 v[212:215], v150, s[16:19], s9 offen
    s_mov_b32 s9, 8192
    buffer_load_dwordx4 v[216:219], v150, s[16:19], s9 offen
    s_mov_b32 s9, 12288
    buffer_load_dwordx4 v[220:223], v150, s[16:19], s9 offen
    s_mov_b32 s9, 16384
    buffer_load_dwordx4 v[224:227], v150, s[16:19], s9 offen
    s_mov_b32 s9, 20480
    buffer_load_dwordx4 v[228:231], v150, s[16:19], s9 offen
A_nokv1:
    s_mov_b32 s24, s58
    s_and_b32 s25, s59, 0xffff
    s_mov_b32 s26, 29372416
    s_mov_b32 s27, 0x20000
    v_mov_b32 v130, 0
    s_mov_b32 s9, 29368320
    s_mov_b64 exec, 1
    buffer_load_dword v130, v130, s[24:27], s9 offen sc1
    s_mov_b64 exec, -1
    s_mov_b32 s42, 911
    s_mul_i32 s44, s6, 36864
    s_add_u32 s99, s44, 18432
    s_mul_i32 s45, s5, 36864
    v_mov_b32 v115, v1
    s_mov_b32 s43, 18
XD_1:
    v_mul_lo_u32 v113, v115, s42
    v_lshrrev_b32 v113, 16, v113
    v_mul_u32_u24 v114, 72, v113
    v_sub_u32 v112, v115, v114
    v_bfe_u32 v114, v113, 1, 3
    v_xor_b32 v112, v112, v114
    v_lshlrev_b32 v112, 4, v112
    v_mul_u32_u24 v113, 1152, v113
    s_mov_b32 m0, s45
    v_add_u32 v116, v112, v113
    buffer_load_dwordx4 v116, s[64:67], s44 offen lds
    s_add_u32 m0, s45, 18432
    v_add_u32 v115, 64, v115
    buffer_load_dwordx4 v116, s[64:67], s99 offen lds
    s_add_u32 s45, s45, 1024
    s_sub_u32 s43, s43, 1
    s_cmp_lg_u32 s43, 0
    s_cbranch_scc1 XD_1
    s_mov_b32 s28, s52
    s_and_b32 s29, s53, 0xffff
    s_mov_b32 s30, 5308416
    s_mov_b32 s31, 0x20000
    s_mov_b32 s32, s50
    s_and_b32 s33, s51, 0xffff
    s_mov_b32 s34, 5308416
    s_mov_b32 s35, 0x20000
    s_mov_b32 s36, s54
    s_and_b32 s37, s55, 0xffff
    s_mov_b32 s38, 9216
    s_mov_b32 s39, 0x20000
    s_mov_b32 s60, s56
    s_and_b32 s61, s57, 0xffff
    s_mov_b32 s62, 256
    s_mov_b32 s63, 0x20000
    s_mov_b32 s12, s94
    s_and_b32 s13, s95, 0xffff
    s_mov_b32 s14, 663552
    s_mov_b32 s15, 0x20000
    s_mul_i32 s7, s3, 144
    s_add_u32 s9, s5, 0
    s_mul_i32 s10, s9, 43691
    s_lshr_b32 s10, s10, 17
    s_mul_i32 s10, s10, 18432
    s_add_u32 s50, s10, s7
    s_add_u32 s9, s5, 4
    s_mul_i32 s10, s9, 43691
    s_lshr_b32 s10, s10, 17
    s_mul_i32 s10, s10, 18432
    s_add_u32 s51, s10, s7
    s_add_u32 s9, s5, 8
    s_mul_i32 s10, s9, 43691
    s_lshr_b32 s10, s10, 17
    s_mul_i32 s10, s10, 18432
    s_add_u32 s52, s10, s7
    s_lshl_b32 s53, s5, 10
    s_lshr_b32 s44, s2, 3
    s_lshl_b32 s44, s44, 2
    s_add_u32 s44, s44, s5
    s_and_b32 s45, s2, 1
    v_lshlrev_b32 v120, 7, v1
    s_mul_i32 s49, s44, 5248
    buffer_load_dword v121, v120, s[12:15], s49 offen
    s_mul_i32 s49, s44, 36
    v_add_u32 v122, s49, v1
    v_lshrrev_b32 v123, 3, v122
    v_mul_u32_u24 v123, 9216, v123
    v_bfe_u32 v120, v122, 1, 2
    v_mul_u32_u24 v120, 1152, v120
    v_add_u32 v123, v123, v120
    v_and_b32 v120, 1, v122
    v_lshlrev_b32 v120, 7, v120
    v_add_u32 v123, v123, v120
    s_mul_i32 s49, s45, 4608
    buffer_load_dword v124, v123, s[28:31], s49 offen
    s_waitcnt vmcnt(2)
    ds_read_b128 a[0:3], v146 offset:0
    ds_read_b128 a[4:7], v147 offset:0
    ds_read_b128 a[8:11], v148 offset:0
    ds_read_b128 a[12:15], v149 offset:0
    ds_read_b128 a[16:19], v146 offset:128
    ds_read_b128 a[20:23], v147 offset:128
    ds_read_b128 a[24:27], v148 offset:128
    ds_read_b128 a[28:31], v149 offset:128
    ds_read_b128 a[32:35], v146 offset:256
    ds_read_b128 a[36:39], v147 offset:256
    ds_read_b128 a[40:43], v148 offset:256
    ds_read_b128 a[44:47], v149 offset:256
    ds_read_b128 a[48:51], v146 offset:384
    ds_read_b128 a[52:55], v147 offset:384
    ds_read_b128 a[56:59], v148 offset:384
    ds_read_b128 a[60:63], v149 offset:384
    ds_read_b128 a[64:67], v146 offset:512
    ds_read_b128 a[68:71], v147 offset:512
    ds_read_b128 a[72:75], v148 offset:512
    ds_read_b128 a[76:79], v149 offset:512
    ds_read_b128 a[80:83], v146 offset:640
    ds_read_b128 a[84:87], v147 offset:640
    ds_read_b128 a[88:91], v148 offset:640
    ds_read_b128 a[92:95], v149 offset:640
    ds_read_b128 a[96:99], v146 offset:768
    ds_read_b128 a[100:103], v147 offset:768
    ds_read_b128 a[104:107], v148 offset:768
    ds_read_b128 a[108:111], v149 offset:768
    ds_read_b128 a[112:115], v146 offset:896
    ds_read_b128 a[116:119], v147 offset:896
    ds_read_b128 a[120:123], v148 offset:896
    ds_read_b128 a[124:127], v149 offset:896
    ds_read_b128 a[128:131], v146 offset:1024
    ds_read_b128 a[132:135], v147 offset:1024
    ds_read_b128 a[136:139], v148 offset:1024
    ds_read_b128 a[140:143], v149 offset:1024
    s_waitcnt lgkmcnt(0)
    s_barrier
    v_readfirstlane_b32 s98, v130
    s_nop 3
    s_add_u32 s98, s98, 1
    s_cmp_lt_u32 s3, 2
    s_cbranch_scc1 A_kvjob
    s_add_u32 m0, s53, 0
    s_add_u32 s10, s50, 0
    buffer_load_dwordx4 v140, s[12:15], s10 offen lds
    s_add_u32 m0, s53, 4096
    s_add_u32 s10, s51, 0
    buffer_load_dwordx4 v141, s[12:15], s10 offen lds
    s_add_u32 m0, s53, 8192
    s_add_u32 s10, s52, 0
    buffer_load_dwordx4 v142, s[12:15], s10 offen lds
    s_add_u32 m0, s53, 12288
    s_add_u32 s10, s50, 73728
    buffer_load_dwordx4 v140, s[12:15], s10 offen lds
    s_add_u32 m0, s53, 16384
    s_add_u32 s10, s51, 73728
    buffer_load_dwordx4 v141, s[12:15], s10 offen lds
    s_add_u32 m0, s53, 20480
    s_add_u32 s10, s52, 73728
    buffer_load_dwordx4 v142, s[12:15], s10 offen lds
    s_add_u32 m0, s53, 24576
    s_add_u32 s10, s50, 147456
    buffer_load_dwordx4 v140, s[12:15], s10 offen lds
    s_add_u32 m0, s53, 28672
    s_add_u32 s10, s51, 147456
    buffer_load_dwordx4 v141, s[12:15], s10 offen lds
    s_add_u32 m0, s53, 32768
    s_add_u32 s10, s52, 147456
    buffer_load_dwordx4 v142, s[12:15], s10 offen lds
    s_add_u32 m0, s53, 36864
    s_add_u32 s10, s50, 221184
    buffer_load_dwordx4 v140, s[12:15], s10 offen lds
    s_add_u32 m0, s53, 40960
    s_add_u32 s10, s51, 221184
    buffer_load_dwordx4 v141, s[12:15], s10 offen lds
    s_add_u32 m0, s53, 45056
    s_add_u32 s10, s52, 221184
    buffer_load_dwordx4 v142, s[12:15], s10 offen lds
    s_add_u32 m0, s53, 49152
    s_add_u32 s10, s50, 294912
    buffer_load_dwordx4 v140, s[12:15], s10 offen lds
    s_add_u32 m0, s53, 53248
    s_add_u32 s10, s51, 294912
    buffer_load_dwordx4 v141, s[12:15], s10 offen lds
    s_add_u32 m0, s53, 57344
    s_add_u32 s10, s52, 294912
    buffer_load_dwordx4 v142, s[12:15], s10 offen lds
    s_add_u32 m0, s53, 61440
    s_add_u32 s10, s50, 368640
    buffer_load_dwordx4 v140, s[12:15], s10 offen lds
    s_add_u32 m0, s53, 65536
    s_add_u32 s10, s51, 368640
    buffer_load_dwordx4 v141, s[12:15], s10 offen lds
    s_add_u32 m0, s53, 69632
    s_add_u32 s10, s52, 368640
    buffer_load_dwordx4 v142, s[12:15], s10 offen lds
    s_add_u32 m0, s53, 73728
    s_add_u32 s10, s50, 442368
    buffer_load_dwordx4 v140, s[12:15], s10 offen lds
    s_add_u32 m0, s53, 77824
    s_add_u32 s10, s51, 442368
    buffer_load_dwordx4 v141, s[12:15], s10 offen lds
    s_add_u32 m0, s53, 81920
    s_add_u32 s10, s52, 442368
    buffer_load_dwordx4 v142, s[12:15], s10 offen lds
    s_add_u32 m0, s53, 86016
    s_add_u32 s10, s50, 516096
    buffer_load_dwordx4 v140, s[12:15], s10 offen lds
    s_add_u32 m0, s53, 90112
    s_add_u32 s10, s51, 516096
    buffer_load_dwordx4 v141, s[12:15], s10 offen lds
    s_add_u32 m0, s53, 94208
    s_add_u32 s10, s52, 516096
    buffer_load_dwordx4 v142, s[12:15], s10 offen lds
    s_add_u32 m0, s53, 98304
    s_add_u32 s10, s50, 589824
    buffer_load_dwordx4 v140, s[12:15], s10 offen lds
    s_add_u32 m0, s53, 102400
    s_add_u32 s10, s51, 589824
    buffer_load_dwordx4 v141, s[12:15], s10 offen lds
    s_add_u32 m0, s53, 106496
    s_add_u32 s10, s52, 589824
    buffer_load_dwordx4 v142, s[12:15], s10 offen lds
    s_branch A_nokv2
A_kvjob:
    ds_write_b32 v232, v208
    ds_write_b32 v233, v209
    ds_write_b32 v234, v210
    ds_write_b32 v235, v211
    ds_write_b32 v236, v212
    ds_write_b32 v237, v213
    ds_write_b32 v238, v214
    ds_write_b32 v239, v215
    ds_write_b32 v240, v216
    ds_write_b32 v241, v217
    ds_write_b32 v242, v218
    ds_write_b32 v243, v219
    ds_write_b32 v244, v220
    ds_write_b32 v245, v221
    ds_write_b32 v246, v222
    ds_write_b32 v247, v223
    ds_write_b32 v248, v224
    ds_write_b32 v249, v225
    ds_write_b32 v250, v226
    ds_write_b32 v251, v227
    s_cmp_lg_u32 s5, 0
    s_cbranch_scc1 A_kvw5
    s_mov_b64 exec, 0xffff
    ds_write_b32 v252, v228
    ds_write_b32 v253, v229
    ds_write_b32 v254, v230
    ds_write_b32 v255, v231
    s_mov_b64 exec, -1
A_kvw5:
    s_waitcnt lgkmcnt(0)
    s_barrier
    v_mov_b32 v207, 0
    s_lshr_b32 s49, s6, 4
    s_mul_i32 s49, s49, 39936
    s_add_u32 s49, s49, 4718592
    s_and_b32 s45, s6, 15
    s_cmp_eq_u32 s3, 1
    s_cbranch_scc1 A_V
    ds_read_b64_tr_b16 v[156:157], v154 offset:0
    ds_read_b64_tr_b16 v[158:159], v154 offset:256
    ds_read_b64_tr_b16 v[160:161], v154 offset:1024
    ds_read_b64_tr_b16 v[162:163], v154 offset:1280
    ds_read_b64_tr_b16 v[164:165], v154 offset:2048
    ds_read_b64_tr_b16 v[166:167], v154 offset:2304
    ds_read_b64_tr_b16 v[168:169], v154 offset:3072
    ds_read_b64_tr_b16 v[170:171], v154 offset:3328
    ds_read_b64_tr_b16 v[172:173], v154 offset:4096
    ds_read_b64_tr_b16 v[174:175], v154 offset:4352
    s_waitcnt lgkmcnt(8)
    v_mfma_f32_32x32x16_bf16 v[180:195], v[156:159], a[0:3], 0
    ds_read_b64_tr_b16 v[176:177], v154 offset:5120
    ds_read_b64_tr_b16 v[178:179], v154 offset:5376
    s_add_u32 m0, s53, 0
    s_add_u32 s10, s50, 0
    buffer_load_dwordx4 v140, s[12:15], s10 offen lds
    s_waitcnt lgkmcnt(8)
    v_mfma_f32_32x32x16_bf16 v[180:195], v[160:163], a[4:7], v[180:195]
    ds_read_b64_tr_b16 v[156:157], v154 offset:6144
    ds_read_b64_tr_b16 v[158:159], v154 offset:6400
    s_add_u32 m0, s53, 4096
    s_add_u32 s10, s51, 0
    buffer_load_dwordx4 v141, s[12:15], s10 offen lds
    s_waitcnt lgkmcnt(8)
    v_mfma_f32_32x32x16_bf16 v[180:195], v[164:167], a[8:11], v[180:195]
    ds_read_b64_tr_b16 v[160:161], v154 offset:7168
    ds_read_b64_tr_b16 v[162:163], v154 offset:7424
    s_add_u32 m0, s53, 8192
    s_add_u32 s10, s52, 0
    buffer_load_dwordx4 v142, s[12:15], s10 offen lds
    s_waitcnt lgkmcnt(8)
    v_mfma_f32_32x32x16_bf16 v[180:195], v[168:171], a[12:15], v[180:195]
    ds_read_b64_tr_b16 v[164:165], v154 offset:8192
    ds_read_b64_tr_b16 v[166:167], v154 offset:8448
    s_add_u32 m0, s53, 12288
    s_add_u32 s10, s50, 73728
    buffer_load_dwordx4 v140, s[12:15], s10 offen lds
    s_waitcnt lgkmcnt(8)
    v_mfma_f32_32x32x16_bf16 v[180:195], v[172:175], a[16:19], v[180:195]
    ds_read_b64_tr_b16 v[168:169], v154 offset:9216
    ds_read_b64_tr_b16 v[170:171], v154 offset:9472
    s_add_u32 m0, s53, 16384
    s_add_u32 s10, s51, 73728
    buffer_load_dwordx4 v141, s[12:15], s10 offen lds
    s_waitcnt lgkmcnt(8)
    v_mfma_f32_32x32x16_bf16 v[180:195], v[176:179], a[20:23], v[180:195]
    ds_read_b64_tr_b16 v[172:173], v154 offset:10240
    ds_read_b64_tr_b16 v[174:175], v154 offset:10496
    s_add_u32 m0, s53, 20480
    s_add_u32 s10, s52, 73728
    buffer_load_dwordx4 v142, s[12:15], s10 offen lds
    s_waitcnt lgkmcnt(8)
    v_mfma_f32_32x32x16_bf16 v[180:195], v[156:159], a[24:27], v[180:195]
    ds_read_b64_tr_b16 v[176:177], v154 offset:11264
    ds_read_b64_tr_b16 v[178:179], v154 offset:11520
    s_add_u32 m0, s53, 24576
    s_add_u32 s10, s50, 147456
    buffer_load_dwordx4 v140, s[12:15], s10 offen lds
    s_waitcnt lgkmcnt(8)
    v_mfma_f32_32x32x16_bf16 v[180:195], v[160:163], a[28:31], v[180:195]
    ds_read_b64_tr_b16 v[156:157], v154 offset:12288
    ds_read_b64_tr_b16 v[158:159], v154 offset:12544
    s_add_u32 m0, s53, 28672
    s_add_u32 s10, s51, 147456
    buffer_load_dwordx4 v141, s[12:15], s10 offen lds
    s_waitcnt lgkmcnt(8)
    v_mfma_f32_32x32x16_bf16 v[180:195], v[164:167], a[32:35], v[180:195]
    ds_read_b64_tr_b16 v[160:161], v154 offset:13312
    ds_read_b64_tr_b16 v[162:163], v154 offset:13568
    s_add_u32 m0, s53, 32768
    s_add_u32 s10, s52, 147456
    buffer_load_dwordx4 v142, s[12:15], s10 offen lds
    s_waitcnt lgkmcnt(8)
    v_mfma_f32_32x32x16_bf16 v[180:195], v[168:171], a[36:39], v[180:195]
    ds_read_b64_tr_b16 v[164:165], v154 offset:14336
    ds_read_b64_tr_b16 v[166:167], v154 offset:14592
    s_add_u32 m0, s53, 36864
    s_add_u32 s10, s50, 221184
    buffer_load_dwordx4 v140, s[12:15], s10 offen lds
    s_waitcnt lgkmcnt(8)
    v_mfma_f32_32x32x16_bf16 v[180:195], v[172:175], a[40:43], v[180:195]
    ds_read_b64_tr_b16 v[168:169], v154 offset:15360
    ds_read_b64_tr_b16 v[170:171], v154 offset:15616
    s_add_u32 m0, s53, 40960
    s_add_u32 s10, s51, 221184
    buffer_load_dwordx4 v141, s[12:15], s10 offen lds
    s_waitcnt lgkmcnt(8)
    v_mfma_f32_32x32x16_bf16 v[180:195], v[176:179], a[44:47], v[180:195]
    ds_read_b64_tr_b16 v[172:173], v154 offset:16384
    ds_read_b64_tr_b16 v[174:175], v154 offset:16640
    s_add_u32 m0, s53, 45056
    s_add_u32 s10, s52, 221184
    buffer_load_dwordx4 v142, s[12:15], s10 offen lds
    s_waitcnt lgkmcnt(8)
    v_mfma_f32_32x32x16_bf16 v[180:195], v[156:159], a[48:51], v[180:195]
    ds_read_b64_tr_b16 v[176:177], v154 offset:17408
    ds_read_b64_tr_b16 v[178:179], v154 offset:17664
    s_add_u32 m0, s53, 49152
    s_add_u32 s10, s50, 294912
    buffer_load_dwordx4 v140, s[12:15], s10 offen lds
    s_waitcnt lgkmcnt(8)
    v_mfma_f32_32x32x16_bf16 v[180:195], v[160:163], a[52:55], v[180:195]
    ds_read_b64_tr_b16 v[156:157], v154 offset:18432
    ds_read_b64_tr_b16 v[158:159], v154 offset:18688
    s_add_u32 m0, s53, 53248
    s_add_u32 s10, s51, 294912
    buffer_load_dwordx4 v141, s[12:15], s10 offen lds
    s_waitcnt lgkmcnt(8)
    v_mfma_f32_32x32x16_bf16 v[180:195], v[164:167], a[56:59], v[180:195]
    ds_read_b64_tr_b16 v[160:161], v154 offset:19456
    ds_read_b64_tr_b16 v[162:163], v154 offset:19712
    s_add_u32 m0, s53, 57344
    s_add_u32 s10, s52, 294912
    buffer_load_dwordx4 v142, s[12:15], s10 offen lds
    s_waitcnt lgkmcnt(8)
    v_mfma_f32_32x32x16_bf16 v[180:195], v[168:171], a[60:63], v[180:195]
    ds_read_b64_tr_b16 v[164:165], v154 offset:20480
    ds_read_b64_tr_b16 v[166:167], v154 offset:20736
    s_add_u32 m0, s53, 61440
    s_add_u32 s10, s50, 368640
    buffer_load_dwordx4 v140, s[12:15], s10 offen lds
    s_waitcnt lgkmcnt(8)
    v_mfma_f32_32x32x16_bf16 v[180:195], v[172:175], a[64:67], v[180:195]
    ds_read_b64_tr_b16 v[168:169], v154 offset:21504
    ds_read_b64_tr_b16 v[170:171], v154 offset:21760
    s_add_u32 m0, s53, 65536
    s_add_u32 s10, s51, 368640
    buffer_load_dwordx4 v141, s[12:15], s10 offen lds
    s_waitcnt lgkmcnt(8)
    v_mfma_f32_32x32x16_bf16 v[180:195], v[176:179], a[68:71], v[180:195]
    ds_read_b64_tr_b16 v[172:173], v154 offset:22528
    ds_read_b64_tr_b16 v[174:175], v154 offset:22784
    s_add_u32 m0, s53, 69632
    s_add_u32 s10, s52, 368640
    buffer_load_dwordx4 v142, s[12:15], s10 offen lds
    s_waitcnt lgkmcnt(8)
    v_mfma_f32_32x32x16_bf16 v[180:195], v[156:159], a[72:75], v[180:195]
    ds_read_b64_tr_b16 v[176:177], v154 offset:23552
    ds_read_b64_tr_b16 v[178:179], v154 offset:23808
    s_add_u32 m0, s53, 73728
    s_add_u32 s10, s50, 442368
    buffer_load_dwordx4 v140, s[12:15], s10 offen lds
    s_waitcnt lgkmcnt(8)
    v_mfma_f32_32x32x16_bf16 v[180:195], v[160:163], a[76:79], v[180:195]
    ds_read_b64_tr_b16 v[156:157], v154 offset:24576
    ds_read_b64_tr_b16 v[158:159], v154 offset:24832
    s_add_u32 m0, s53, 77824
    s_add_u32 s10, s51, 442368
    buffer_load_dwordx4 v141, s[12:15], s10 offen lds
    s_waitcnt lgkmcnt(8)
    v_mfma_f32_32x32x16_bf16 v[180:195], v[164:167], a[80:83], v[180:195]
    ds_read_b64_tr_b16 v[160:161], v154 offset:25600
    ds_read_b64_tr_b16 v[162:163], v154 offset:25856
    s_add_u32 m0, s53, 81920
    s_add_u32 s10, s52, 442368
    buffer_load_dwordx4 v142, s[12:15], s10 offen lds
    s_waitcnt lgkmcnt(8)
    v_mfma_f32_32x32x16_bf16 v[180:195], v[168:171], a[84:87], v[180:195]
    ds_read_b64_tr_b16 v[164:165], v154 offset:26624
    ds_read_b64_tr_b16 v[166:167], v154 offset:26880
    s_add_u32 m0, s53, 86016
    s_add_u32 s10, s50, 516096
    buffer_load_dwordx4 v140, s[12:15], s10 offen lds
    s_waitcnt lgkmcnt(8)
    v_mfma_f32_32x32x16_bf16 v[180:195], v[172:175], a[88:91], v[180:195]
    ds_read_b64_tr_b16 v[168:169], v154 offset:27648
    ds_read_b64_tr_b16 v[170:171], v154 offset:27904
    s_add_u32 m0, s53, 90112
    s_add_u32 s10, s51, 516096
    buffer_load_dwordx4 v141, s[12:15], s10 offen lds
    s_waitcnt lgkmcnt(8)
    v_mfma_f32_32x32x16_bf16 v[180:195], v[176:179], a[92:95], v[180:195]
    ds_read_b64_tr_b16 v[172:173], v154 offset:28672
    ds_read_b64_tr_b16 v[174:175], v154 offset:28928
    s_add_u32 m0, s53, 94208
    s_add_u32 s10, s52, 516096
    buffer_load_dwordx4 v142, s[12:15], s10 offen lds
    s_waitcnt lgkmcnt(8)
    v_mfma_f32_32x32x16_bf16 v[180:195], v[156:159], a[96:99], v[180:195]
    ds_read_b64_tr_b16 v[176:177], v154 offset:29696
    ds_read_b64_tr_b16 v[178:179], v154 offset:29952
    s_add_u32 m0, s53, 98304
    s_add_u32 s10, s50, 589824
    buffer_load_dwordx4 v140, s[12:15], s10 offen lds
    s_waitcnt lgkmcnt(8)
    v_mfma_f32_32x32x16_bf16 v[180:195], v[160:163], a[100:103], v[180:195]
    ds_read_b64_tr_b16 v[156:157], v154 offset:30720
    ds_read_b64_tr_b16 v[158:159], v154 offset:30976
    s_add_u32 m0, s53, 102400
    s_add_u32 s10, s51, 589824
    buffer_load_dwordx4 v141, s[12:15], s10 offen lds
    s_waitcnt lgkmcnt(8)
    v_mfma_f32_32x32x16_bf16 v[180:195], v[164:167], a[104:107], v[180:195]
    ds_read_b64_tr_b16 v[160:161], v154 offset:31744
    ds_read_b64_tr_b16 v[162:163], v154 offset:32000
    s_add_u32 m0, s53, 106496
    s_add_u32 s10, s52, 589824
    buffer_load_dwordx4 v142, s[12:15], s10 offen lds
    s_waitcnt lgkmcnt(8)
    v_mfma_f32_32x32x16_bf16 v[180:195], v[168:171], a[108:111], v[180:195]
    ds_read_b64_tr_b16 v[164:165], v154 offset:32768
    ds_read_b64_tr_b16 v[166:167], v154 offset:33024
    s_waitcnt lgkmcnt(8)
    v_mfma_f32_32x32x16_bf16 v[180:195], v[172:175], a[112:115], v[180:195]
    ds_read_b64_tr_b16 v[168:169], v154 offset:33792
    ds_read_b64_tr_b16 v[170:171], v154 offset:34048
    s_waitcnt lgkmcnt(8)
    v_mfma_f32_32x32x16_bf16 v[180:195], v[176:179], a[116:119], v[180:195]
    ds_read_b64_tr_b16 v[172:173], v154 offset:34816
    ds_read_b64_tr_b16 v[174:175], v154 offset:35072
    s_waitcnt lgkmcnt(8)
    v_mfma_f32_32x32x16_bf16 v[180:195], v[156:159], a[120:123], v[180:195]
    ds_read_b64_tr_b16 v[176:177], v154 offset:35840
    ds_read_b64_tr_b16 v[178:179], v154 offset:36096
    s_waitcnt lgkmcnt(8)
    v_mfma_f32_32x32x16_bf16 v[180:195], v[160:163], a[124:127], v[180:195]
    s_waitcnt lgkmcnt(6)
    v_mfma_f32_32x32x16_bf16 v[180:195], v[164:167], a[128:131], v[180:195]
    s_waitcnt lgkmcnt(4)
    v_mfma_f32_32x32x16_bf16 v[180:195], v[168:171], a[132:135], v[180:195]
    s_waitcnt lgkmcnt(2)
    v_mfma_f32_32x32x16_bf16 v[180:195], v[172:175], a[136:139], v[180:195]
    s_waitcnt lgkmcnt(0)
    v_mfma_f32_32x32x16_bf16 v[180:195], v[176:179], a[140:143], v[180:195]
    s_nop 7
    s_nop 3
    v_cvt_pk_bf16_f32 v196, v180, v181
    v_cvt_pk_bf16_f32 v197, v182, v183
    v_cvt_pk_bf16_f32 v198, v184, v185
    v_cvt_pk_bf16_f32 v199, v186, v187
    v_cvt_pk_bf16_f32 v200, v188, v189
    s_lshl_b32 s53, s45, 10
    s_add_u32 s53, s53, s49
    buffer_store_dwordx4 v[196:199], v2, s[24:27], s53 offen sc1
    s_lshl_b32 s53, s45, 7
    s_add_u32 s53, s53, s49
    s_add_u32 s53, s53, 16384
    s_mov_b32 exec_hi, 0
    buffer_store_dword v200, v4, s[24:27], s53 offen sc1
    s_mov_b32 exec_hi, -1
    v_cmp_gt_u32 vcc, 32, v1
    s_nop 1
    v_cndmask_b32 v204, 0, v200, vcc
    v_mov_b32 v205, 0
    v_dot2_f32_bf16 v205, v196, v196, v205
    v_dot2_f32_bf16 v205, v197, v197, v205
    v_dot2_f32_bf16 v205, v198, v198, v205
    v_dot2_f32_bf16 v205, v199, v199, v205
    v_dot2_f32_bf16 v205, v204, v204, v205
    s_nop 3
    v_mov_b32 v206, v205
    s_nop 1
    v_permlane32_swap_b32 v205, v206
    s_nop 1
    v_add_f32 v205, v205, v206
    s_nop 1
    v_max_f32_dpp v205, v205, v205 quad_perm:[1,0,3,2] row_mask:0xf bank_mask:0xf
    s_nop 1
    v_max_f32_dpp v205, v205, v205 quad_perm:[2,3,0,1] row_mask:0xf bank_mask:0xf
    s_nop 1
    v_max_f32_dpp v205, v205, v205 row_half_mirror row_mask:0xf bank_mask:0xf
    s_nop 1
    v_max_f32_dpp v205, v205, v205 row_mirror row_mask:0xf bank_mask:0xf
    ds_swizzle_b32 v206, v205 offset:0x401F
    s_waitcnt lgkmcnt(0)
    v_max_f32 v205, v205, v206
    s_lshl_b32 s53, s6, 2
    s_add_u32 s53, s53, 4882432
    v_mov_b32 v206, 0
    s_mov_b64 exec, 1
    buffer_store_dword v205, v206, s[24:27], s53 offen sc1
    s_mov_b64 exec, -1
    s_branch A_kvpub
A_V:
    ds_read_b64_tr_b16 v[156:157], v154 offset:0
    ds_read_b64_tr_b16 v[158:159], v154 offset:256
    ds_read_b64_tr_b16 v[160:161], v154 offset:1024
    ds_read_b64_tr_b16 v[162:163], v154 offset:1280
    ds_read_b64_tr_b16 v[164:165], v154 offset:2048
    ds_read_b64_tr_b16 v[166:167], v154 offset:2304
    ds_read_b64_tr_b16 v[168:169], v154 offset:3072
    ds_read_b64_tr_b16 v[170:171], v154 offset:3328
    ds_read_b64_tr_b16 v[172:173], v154 offset:4096
    ds_read_b64_tr_b16 v[174:175], v154 offset:4352
    s_waitcnt lgkmcnt(8)
    v_mfma_f32_32x32x16_bf16 v[180:195], a[0:3], v[156:159], 0
    ds_read_b64_tr_b16 v[176:177], v154 offset:5120
    ds_read_b64_tr_b16 v[178:179], v154 offset:5376
    s_add_u32 m0, s53, 0
    s_add_u32 s10, s50, 0
    buffer_load_dwordx4 v140, s[12:15], s10 offen lds
    s_waitcnt lgkmcnt(8)
    v_mfma_f32_32x32x16_bf16 v[180:195], a[4:7], v[160:163], v[180:195]
    ds_read_b64_tr_b16 v[156:157], v154 offset:6144
    ds_read_b64_tr_b16 v[158:159], v154 offset:6400
    s_add_u32 m0, s53, 4096
    s_add_u32 s10, s51, 0
    buffer_load_dwordx4 v141, s[12:15], s10 offen lds
    s_waitcnt lgkmcnt(8)
    v_mfma_f32_32x32x16_bf16 v[180:195], a[8:11], v[164:167], v[180:195]
    ds_read_b64_tr_b16 v[160:161], v154 offset:7168
    ds_read_b64_tr_b16 v[162:163], v154 offset:7424
    s_add_u32 m0, s53, 8192
    s_add_u32 s10, s52, 0
    buffer_load_dwordx4 v142, s[12:15], s10 offen lds
    s_waitcnt lgkmcnt(8)
    v_mfma_f32_32x32x16_bf16 v[180:195], a[12:15], v[168:171], v[180:195]
    ds_read_b64_tr_b16 v[164:165], v154 offset:8192
    ds_read_b64_tr_b16 v[166:167], v154 offset:8448
    s_add_u32 m0, s53, 12288
    s_add_u32 s10, s50, 73728
    buffer_load_dwordx4 v140, s[12:15], s10 offen lds
    s_waitcnt lgkmcnt(8)
    v_mfma_f32_32x32x16_bf16 v[180:195], a[16:19], v[172:175], v[180:195]
    ds_read_b64_tr_b16 v[168:169], v154 offset:9216
    ds_read_b64_tr_b16 v[170:171], v154 offset:9472
    s_add_u32 m0, s53, 16384
    s_add_u32 s10, s51, 73728
    buffer_load_dwordx4 v141, s[12:15], s10 offen lds
    s_waitcnt lgkmcnt(8)
    v_mfma_f32_32x32x16_bf16 v[180:195], a[20:23], v[176:179], v[180:195]
    ds_read_b64_tr_b16 v[172:173], v154 offset:10240
    ds_read_b64_tr_b16 v[174:175], v154 offset:10496
    s_add_u32 m0, s53, 20480
    s_add_u32 s10, s52, 73728
    buffer_load_dwordx4 v142, s[12:15], s10 offen lds
    s_waitcnt lgkmcnt(8)
    v_mfma_f32_32x32x16_bf16 v[180:195], a[24:27], v[156:159], v[180:195]
    ds_read_b64_tr_b16 v[176:177], v154 offset:11264
    ds_read_b64_tr_b16 v[178:179], v154 offset:11520
    s_add_u32 m0, s53, 24576
    s_add_u32 s10, s50, 147456
    buffer_load_dwordx4 v140, s[12:15], s10 offen lds
    s_waitcnt lgkmcnt(8)
    v_mfma_f32_32x32x16_bf16 v[180:195], a[28:31], v[160:163], v[180:195]
    ds_read_b64_tr_b16 v[156:157], v154 offset:12288
    ds_read_b64_tr_b16 v[158:159], v154 offset:12544
    s_add_u32 m0, s53, 28672
    s_add_u32 s10, s51, 147456
    buffer_load_dwordx4 v141, s[12:15], s10 offen lds
    s_waitcnt lgkmcnt(8)
    v_mfma_f32_32x32x16_bf16 v[180:195], a[32:35], v[164:167], v[180:195]
    ds_read_b64_tr_b16 v[160:161], v154 offset:13312
    ds_read_b64_tr_b16 v[162:163], v154 offset:13568
    s_add_u32 m0, s53, 32768
    s_add_u32 s10, s52, 147456
    buffer_load_dwordx4 v142, s[12:15], s10 offen lds
    s_waitcnt lgkmcnt(8)
    v_mfma_f32_32x32x16_bf16 v[180:195], a[36:39], v[168:171], v[180:195]
    ds_read_b64_tr_b16 v[164:165], v154 offset:14336
    ds_read_b64_tr_b16 v[166:167], v154 offset:14592
    s_add_u32 m0, s53, 36864
    s_add_u32 s10, s50, 221184
    buffer_load_dwordx4 v140, s[12:15], s10 offen lds
    s_waitcnt lgkmcnt(8)
    v_mfma_f32_32x32x16_bf16 v[180:195], a[40:43], v[172:175], v[180:195]
    ds_read_b64_tr_b16 v[168:169], v154 offset:15360
    ds_read_b64_tr_b16 v[170:171], v154 offset:15616
    s_add_u32 m0, s53, 40960
    s_add_u32 s10, s51, 221184
    buffer_load_dwordx4 v141, s[12:15], s10 offen lds
    s_waitcnt lgkmcnt(8)
    v_mfma_f32_32x32x16_bf16 v[180:195], a[44:47], v[176:179], v[180:195]
    ds_read_b64_tr_b16 v[172:173], v154 offset:16384
    ds_read_b64_tr_b16 v[174:175], v154 offset:16640
    s_add_u32 m0, s53, 45056
    s_add_u32 s10, s52, 221184
    buffer_load_dwordx4 v142, s[12:15], s10 offen lds
    s_waitcnt lgkmcnt(8)
    v_mfma_f32_32x32x16_bf16 v[180:195], a[48:51], v[156:159], v[180:195]
    ds_read_b64_tr_b16 v[176:177], v154 offset:17408
    ds_read_b64_tr_b16 v[178:179], v154 offset:17664
    s_add_u32 m0, s53, 49152
    s_add_u32 s10, s50, 294912
    buffer_load_dwordx4 v140, s[12:15], s10 offen lds
    s_waitcnt lgkmcnt(8)
    v_mfma_f32_32x32x16_bf16 v[180:195], a[52:55], v[160:163], v[180:195]
    ds_read_b64_tr_b16 v[156:157], v154 offset:18432
    ds_read_b64_tr_b16 v[158:159], v154 offset:18688
    s_add_u32 m0, s53, 53248
    s_add_u32 s10, s51, 294912
    buffer_load_dwordx4 v141, s[12:15], s10 offen lds
    s_waitcnt lgkmcnt(8)
    v_mfma_f32_32x32x16_bf16 v[180:195], a[56:59], v[164:167], v[180:195]
    ds_read_b64_tr_b16 v[160:161], v154 offset:19456
    ds_read_b64_tr_b16 v[162:163], v154 offset:19712
    s_add_u32 m0, s53, 57344
    s_add_u32 s10, s52, 294912
    buffer_load_dwordx4 v142, s[12:15], s10 offen lds
    s_waitcnt lgkmcnt(8)
    v_mfma_f32_32x32x16_bf16 v[180:195], a[60:63], v[168:171], v[180:195]
    ds_read_b64_tr_b16 v[164:165], v154 offset:20480
    ds_read_b64_tr_b16 v[166:167], v154 offset:20736
    s_add_u32 m0, s53, 61440
    s_add_u32 s10, s50, 368640
    buffer_load_dwordx4 v140, s[12:15], s10 offen lds
    s_waitcnt lgkmcnt(8)
    v_mfma_f32_32x32x16_bf16 v[180:195], a[64:67], v[172:175], v[180:195]
    ds_read_b64_tr_b16 v[168:169], v154 offset:21504
    ds_read_b64_tr_b16 v[170:171], v154 offset:21760
    s_add_u32 m0, s53, 65536
    s_add_u32 s10, s51, 368640
    buffer_load_dwordx4 v141, s[12:15], s10 offen lds
    s_waitcnt lgkmcnt(8)
    v_mfma_f32_32x32x16_bf16 v[180:195], a[68:71], v[176:179], v[180:195]
    ds_read_b64_tr_b16 v[172:173], v154 offset:22528
    ds_read_b64_tr_b16 v[174:175], v154 offset:22784
    s_add_u32 m0, s53, 69632
    s_add_u32 s10, s52, 368640
    buffer_load_dwordx4 v142, s[12:15], s10 offen lds
    s_waitcnt lgkmcnt(8)
    v_mfma_f32_32x32x16_bf16 v[180:195], a[72:75], v[156:159], v[180:195]
    ds_read_b64_tr_b16 v[176:177], v154 offset:23552
    ds_read_b64_tr_b16 v[178:179], v154 offset:23808
    s_add_u32 m0, s53, 73728
    s_add_u32 s10, s50, 442368
    buffer_load_dwordx4 v140, s[12:15], s10 offen lds
    s_waitcnt lgkmcnt(8)
    v_mfma_f32_32x32x16_bf16 v[180:195], a[76:79], v[160:163], v[180:195]
    ds_read_b64_tr_b16 v[156:157], v154 offset:24576
    ds_read_b64_tr_b16 v[158:159], v154 offset:24832
    s_add_u32 m0, s53, 77824
    s_add_u32 s10, s51, 442368
    buffer_load_dwordx4 v141, s[12:15], s10 offen lds
    s_waitcnt lgkmcnt(8)
    v_mfma_f32_32x32x16_bf16 v[180:195], a[80:83], v[164:167], v[180:195]
    ds_read_b64_tr_b16 v[160:161], v154 offset:25600
    ds_read_b64_tr_b16 v[162:163], v154 offset:25856
    s_add_u32 m0, s53, 81920
    s_add_u32 s10, s52, 442368
    buffer_load_dwordx4 v142, s[12:15], s10 offen lds
    s_waitcnt lgkmcnt(8)
    v_mfma_f32_32x32x16_bf16 v[180:195], a[84:87], v[168:171], v[180:195]
    ds_read_b64_tr_b16 v[164:165], v154 offset:26624
    ds_read_b64_tr_b16 v[166:167], v154 offset:26880
    s_add_u32 m0, s53, 86016
    s_add_u32 s10, s50, 516096
    buffer_load_dwordx4 v140, s[12:15], s10 offen lds
    s_waitcnt lgkmcnt(8)
    v_mfma_f32_32x32x16_bf16 v[180:195], a[88:91], v[172:175], v[180:195]
    ds_read_b64_tr_b16 v[168:169], v154 offset:27648
    ds_read_b64_tr_b16 v[170:171], v154 offset:27904
    s_add_u32 m0, s53, 90112
    s_add_u32 s10, s51, 516096
    buffer_load_dwordx4 v141, s[12:15], s10 offen lds
    s_waitcnt lgkmcnt(8)
    v_mfma_f32_32x32x16_bf16 v[180:195], a[92:95], v[176:179], v[180:195]
    ds_read_b64_tr_b16 v[172:173], v154 offset:28672
    ds_read_b64_tr_b16 v[174:175], v154 offset:28928
    s_add_u32 m0, s53, 94208
    s_add_u32 s10, s52, 516096
    buffer_load_dwordx4 v142, s[12:15], s10 offen lds
    s_waitcnt lgkmcnt(8)
    v_mfma_f32_32x32x16_bf16 v[180:195], a[96:99], v[156:159], v[180:195]
    ds_read_b64_tr_b16 v[176:177], v154 offset:29696
    ds_read_b64_tr_b16 v[178:179], v154 offset:29952
    s_add_u32 m0, s53, 98304
    s_add_u32 s10, s50, 589824
    buffer_load_dwordx4 v140, s[12:15], s10 offen lds
    s_waitcnt lgkmcnt(8)
    v_mfma_f32_32x32x16_bf16 v[180:195], a[100:103], v[160:163], v[180:195]
    ds_read_b64_tr_b16 v[156:157], v154 offset:30720
    ds_read_b64_tr_b16 v[158:159], v154 offset:30976
    s_add_u32 m0, s53, 102400
    s_add_u32 s10, s51, 589824
    buffer_load_dwordx4 v141, s[12:15], s10 offen lds
    s_waitcnt lgkmcnt(8)
    v_mfma_f32_32x32x16_bf16 v[180:195], a[104:107], v[164:167], v[180:195]
    ds_read_b64_tr_b16 v[160:161], v154 offset:31744
    ds_read_b64_tr_b16 v[162:163], v154 offset:32000
    s_add_u32 m0, s53, 106496
    s_add_u32 s10, s52, 589824
    buffer_load_dwordx4 v142, s[12:15], s10 offen lds
    s_waitcnt lgkmcnt(8)
    v_mfma_f32_32x32x16_bf16 v[180:195], a[108:111], v[168:171], v[180:195]
    ds_read_b64_tr_b16 v[164:165], v154 offset:32768
    ds_read_b64_tr_b16 v[166:167], v154 offset:33024
    s_waitcnt lgkmcnt(8)
    v_mfma_f32_32x32x16_bf16 v[180:195], a[112:115], v[172:175], v[180:195]
    ds_read_b64_tr_b16 v[168:169], v154 offset:33792
    ds_read_b64_tr_b16 v[170:171], v154 offset:34048
    s_waitcnt lgkmcnt(8)
    v_mfma_f32_32x32x16_bf16 v[180:195], a[116:119], v[176:179], v[180:195]
    ds_read_b64_tr_b16 v[172:173], v154 offset:34816
    ds_read_b64_tr_b16 v[174:175], v154 offset:35072
    s_waitcnt lgkmcnt(8)
    v_mfma_f32_32x32x16_bf16 v[180:195], a[120:123], v[156:159], v[180:195]
    ds_read_b64_tr_b16 v[176:177], v154 offset:35840
    ds_read_b64_tr_b16 v[178:179], v154 offset:36096
    s_waitcnt lgkmcnt(8)
    v_mfma_f32_32x32x16_bf16 v[180:195], a[124:127], v[160:163], v[180:195]
    s_waitcnt lgkmcnt(6)
    v_mfma_f32_32x32x16_bf16 v[180:195], a[128:131], v[164:167], v[180:195]
    s_waitcnt lgkmcnt(4)
    v_mfma_f32_32x32x16_bf16 v[180:195], a[132:135], v[168:171], v[180:195]
    s_waitcnt lgkmcnt(2)
    v_mfma_f32_32x32x16_bf16 v[180:195], a[136:139], v[172:175], v[180:195]
    s_waitcnt lgkmcnt(0)
    v_mfma_f32_32x32x16_bf16 v[180:195], a[140:143], v[176:179], v[180:195]
    s_nop 7
    s_nop 3
    v_cvt_pk_bf16_f32 v196, v180, v181
    v_cvt_pk_bf16_f32 v197, v182, v183
    v_cvt_pk_bf16_f32 v198, v184, v185
    v_cvt_pk_bf16_f32 v199, v186, v187
    v_cvt_pk_bf16_f32 v200, v188, v189
    v_cvt_pk_bf16_f32 v201, v190, v191
    v_cvt_pk_bf16_f32 v202, v192, v193
    v_cvt_pk_bf16_f32 v203, v194, v195
    v_cmp_eq_u32 vcc, 18, v3
    v_mov_b32 v204, 0x3f803f80
    s_nop 0
    v_cndmask_b32 v196, v196, v204, vcc
    v_cndmask_b32 v197, v197, v204, vcc
    v_cndmask_b32 v198, v198, v204, vcc
    v_cndmask_b32 v199, v199, v204, vcc
    v_cndmask_b32 v200, v200, v204, vcc
    v_cndmask_b32 v201, v201, v204, vcc
    v_cndmask_b32 v202, v202, v204, vcc
    v_cndmask_b32 v203, v203, v204, vcc
    v_cmp_eq_u32 vcc, 19, v3
    s_nop 1
    v_cndmask_b32 v196, v196, v207, vcc
    v_cndmask_b32 v197, v197, v207, vcc
    v_cndmask_b32 v198, v198, v207, vcc
    v_cndmask_b32 v199, v199, v207, vcc
    v_cndmask_b32 v200, v200, v207, vcc
    v_cndmask_b32 v201, v201, v207, vcc
    v_cndmask_b32 v202, v202, v207, vcc
    v_cndmask_b32 v203, v203, v207, vcc
    v_mul_u32_u24 v205, 1040, v3
    v_lshlrev_b32 v206, 4, v5
    v_add_u32 v205, v205, v206
    s_lshl_b32 s53, s45, 6
    s_add_u32 s53, s53, s49
    s_add_u32 s53, s53, 18432
    v_cmp_gt_u32 vcc, 20, v3
    s_and_saveexec_b64 s[54:55], vcc
    buffer_store_dwordx4 v[196:199], v205, s[24:27], s53 offen sc1
    buffer_store_dwordx4 v[200:203], v205, s[24:27], s53 offen offset:32 sc1
    s_mov_b64 exec, s[54:55]
A_kvpub:
    s_waitcnt vmcnt(0)
    s_barrier
    s_cmp_lg_u32 s5, 0
    s_cbranch_scc1 A_nokv2
    s_lshl_b32 s9, s4, 1
    s_add_u32 s9, s9, s3
    s_lshl_b32 s9, s9, 2
    s_add_u32 s9, s9, 29364224
    v_mbcnt_lo_u32_b32 v204, -1, 0
    v_lshlrev_b32 v204, 7, v204
    v_mov_b32 v205, s98
    s_mov_b64 exec, 0xff
    buffer_store_dword v205, v204, s[24:27], s9 offen sc1
    s_mov_b64 exec, -1
A_nokv2:
    s_waitcnt vmcnt(18)
    s_barrier
    ds_read_b64_tr_b16 a[144:145], v137 offset:0
    ds_read_b64_tr_b16 a[146:147], v137 offset:768
    ds_read_b64_tr_b16 a[148:149], v137 offset:32
    ds_read_b64_tr_b16 a[150:151], v137 offset:800
    ds_read_b64_tr_b16 a[152:153], v137 offset:72
    ds_read_b64_tr_b16 a[154:155], v137 offset:840
    ds_read_b64_tr_b16 a[156:157], v137 offset:104
    ds_read_b64_tr_b16 a[158:159], v137 offset:872
    ds_read_b64_tr_b16 a[160:161], v137 offset:3072
    ds_read_b64_tr_b16 a[162:163], v137 offset:3840
    ds_read_b64_tr_b16 a[164:165], v137 offset:3104
    ds_read_b64_tr_b16 a[166:167], v137 offset:3872
    s_waitcnt lgkmcnt(8)
    v_mfma_f32_32x32x16_bf16 v[48:63], a[144:147], a[0:3], 0
    ds_read_b64_tr_b16 a[168:169], v137 offset:3144
    ds_read_b64_tr_b16 a[170:171], v137 offset:3912
    v_mfma_f32_32x32x16_bf16 v[64:79], a[148:151], a[0:3], 0
    ds_read_b64_tr_b16 a[172:173], v137 offset:3176
    ds_read_b64_tr_b16 a[174:175], v137 offset:3944
    s_waitcnt lgkmcnt(8)
    v_mfma_f32_32x32x16_bf16 v[80:95], a[152:155], a[0:3], 0
    ds_read_b64_tr_b16 a[144:145], v137 offset:6144
    ds_read_b64_tr_b16 a[146:147], v137 offset:6912
    v_mfma_f32_32x32x16_bf16 v[96:111], a[156:159], a[0:3], 0
    ds_read_b64_tr_b16 a[148:149], v137 offset:6176
    ds_read_b64_tr_b16 a[150:151], v137 offset:6944
    s_waitcnt lgkmcnt(8)
    v_mfma_f32_32x32x16_bf16 v[48:63], a[160:163], a[4:7], v[48:63]
    ds_read_b64_tr_b16 a[152:153], v137 offset:6216
    ds_read_b64_tr_b16 a[154:155], v137 offset:6984
    v_mfma_f32_32x32x16_bf16 v[64:79], a[164:167], a[4:7], v[64:79]
    ds_read_b64_tr_b16 a[156:157], v137 offset:6248
    ds_read_b64_tr_b16 a[158:159], v137 offset:7016
    s_waitcnt lgkmcnt(8)
    v_mfma_f32_32x32x16_bf16 v[80:95], a[168:171], a[4:7], v[80:95]
    ds_read_b64_tr_b16 a[160:161], v137 offset:9216
    ds_read_b64_tr_b16 a[162:163], v137 offset:9984
    v_mfma_f32_32x32x16_bf16 v[96:111], a[172:175], a[4:7], v[96:111]
    ds_read_b64_tr_b16 a[164:165], v137 offset:9248
    ds_read_b64_tr_b16 a[166:167], v137 offset:10016
    s_waitcnt lgkmcnt(8)
    v_mfma_f32_32x32x16_bf16 v[48:63], a[144:147], a[8:11], v[48:63]
    ds_read_b64_tr_b16 a[168:169], v137 offset:9288
    ds_read_b64_tr_b16 a[170:171], v137 offset:10056
    v_mfma_f32_32x32x16_bf16 v[64:79], a[148:151], a[8:11], v[64:79]
    ds_read_b64_tr_b16 a[172:173], v137 offset:9320
    ds_read_b64_tr_b16 a[174:175], v137 offset:10088
    s_waitcnt lgkmcnt(8)
    v_mfma_f32_32x32x16_bf16 v[80:95], a[152:155], a[8:11], v[80:95]
    ds_read_b64_tr_b16 a[144:145], v137 offset:12288
    ds_read_b64_tr_b16 a[146:147], v137 offset:13056
    v_mfma_f32_32x32x16_bf16 v[96:111], a[156:159], a[8:11], v[96:111]
    ds_read_b64_tr_b16 a[148:149], v137 offset:12320
    ds_read_b64_tr_b16 a[150:151], v137 offset:13088
    s_waitcnt lgkmcnt(8)
    v_mfma_f32_32x32x16_bf16 v[48:63], a[160:163], a[12:15], v[48:63]
    ds_read_b64_tr_b16 a[152:153], v137 offset:12360
    ds_read_b64_tr_b16 a[154:155], v137 offset:13128
    v_mfma_f32_32x32x16_bf16 v[64:79], a[164:167], a[12:15], v[64:79]
    ds_read_b64_tr_b16 a[156:157], v137 offset:12392
    ds_read_b64_tr_b16 a[158:159], v137 offset:13160
    s_waitcnt lgkmcnt(8)
    v_mfma_f32_32x32x16_bf16 v[80:95], a[168:171], a[12:15], v[80:95]
    ds_read_b64_tr_b16 a[160:161], v137 offset:15360
    ds_read_b64_tr_b16 a[162:163], v137 offset:16128
    v_mfma_f32_32x32x16_bf16 v[96:111], a[172:175], a[12:15], v[96:111]
    ds_read_b64_tr_b16 a[164:165], v137 offset:15392
    ds_read_b64_tr_b16 a[166:167], v137 offset:16160
    s_waitcnt lgkmcnt(8)
    v_mfma_f32_32x32x16_bf16 v[48:63], a[144:147], a[16:19], v[48:63]
    ds_read_b64_tr_b16 a[168:169], v137 offset:15432
    ds_read_b64_tr_b16 a[170:171], v137 offset:16200
    v_mfma_f32_32x32x16_bf16 v[64:79], a[148:151], a[16:19], v[64:79]
    ds_read_b64_tr_b16 a[172:173], v137 offset:15464
    ds_read_b64_tr_b16 a[174:175], v137 offset:16232
    s_waitcnt lgkmcnt(8)
    v_mfma_f32_32x32x16_bf16 v[80:95], a[152:155], a[16:19], v[80:95]
    ds_read_b64_tr_b16 a[144:145], v137 offset:18432
    ds_read_b64_tr_b16 a[146:147], v137 offset:19200
    v_mfma_f32_32x32x16_bf16 v[96:111], a[156:159], a[16:19], v[96:111]
    ds_read_b64_tr_b16 a[148:149], v137 offset:18464
    ds_read_b64_tr_b16 a[150:151], v137 offset:19232
    s_waitcnt lgkmcnt(8)
    v_mfma_f32_32x32x16_bf16 v[48:63], a[160:163], a[20:23], v[48:63]
    ds_read_b64_tr_b16 a[152:153], v137 offset:18504
    ds_read_b64_tr_b16 a[154:155], v137 offset:19272
    v_mfma_f32_32x32x16_bf16 v[64:79], a[164:167], a[20:23], v[64:79]
    ds_read_b64_tr_b16 a[156:157], v137 offset:18536
    ds_read_b64_tr_b16 a[158:159], v137 offset:19304
    s_waitcnt lgkmcnt(8)
    v_mfma_f32_32x32x16_bf16 v[80:95], a[168:171], a[20:23], v[80:95]
    ds_read_b64_tr_b16 a[160:161], v137 offset:21504
    ds_read_b64_tr_b16 a[162:163], v137 offset:22272
    v_mfma_f32_32x32x16_bf16 v[96:111], a[172:175], a[20:23], v[96:111]
    ds_read_b64_tr_b16 a[164:165], v137 offset:21536
    ds_read_b64_tr_b16 a[166:167], v137 offset:22304
    s_waitcnt lgkmcnt(8)
    v_mfma_f32_32x32x16_bf16 v[48:63], a[144:147], a[24:27], v[48:63]
    ds_read_b64_tr_b16 a[168:169], v137 offset:21576
    ds_read_b64_tr_b16 a[170:171], v137 offset:22344
    v_mfma_f32_32x32x16_bf16 v[64:79], a[148:151], a[24:27], v[64:79]
    ds_read_b64_tr_b16 a[172:173], v137 offset:21608
    ds_read_b64_tr_b16 a[174:175], v137 offset:22376
    s_waitcnt lgkmcnt(8)
    v_mfma_f32_32x32x16_bf16 v[80:95], a[152:155], a[24:27], v[80:95]
    ds_read_b64_tr_b16 a[144:145], v137 offset:24576
    ds_read_b64_tr_b16 a[146:147], v137 offset:25344
    v_mfma_f32_32x32x16_bf16 v[96:111], a[156:159], a[24:27], v[96:111]
    ds_read_b64_tr_b16 a[148:149], v137 offset:24608
    ds_read_b64_tr_b16 a[150:151], v137 offset:25376
    s_waitcnt lgkmcnt(8)
    v_mfma_f32_32x32x16_bf16 v[48:63], a[160:163], a[28:31], v[48:63]
    ds_read_b64_tr_b16 a[152:153], v137 offset:24648
    ds_read_b64_tr_b16 a[154:155], v137 offset:25416
    v_mfma_f32_32x32x16_bf16 v[64:79], a[164:167], a[28:31], v[64:79]
    ds_read_b64_tr_b16 a[156:157], v137 offset:24680
    ds_read_b64_tr_b16 a[158:159], v137 offset:25448
    s_waitcnt lgkmcnt(8)
    v_mfma_f32_32x32x16_bf16 v[80:95], a[168:171], a[28:31], v[80:95]
    ds_read_b64_tr_b16 a[160:161], v137 offset:27648
    ds_read_b64_tr_b16 a[162:163], v137 offset:28416
    v_mfma_f32_32x32x16_bf16 v[96:111], a[172:175], a[28:31], v[96:111]
    ds_read_b64_tr_b16 a[164:165], v137 offset:27680
    ds_read_b64_tr_b16 a[166:167], v137 offset:28448
    s_waitcnt lgkmcnt(8)
    v_mfma_f32_32x32x16_bf16 v[48:63], a[144:147], a[32:35], v[48:63]
    ds_read_b64_tr_b16 a[168:169], v137 offset:27720
    ds_read_b64_tr_b16 a[170:171], v137 offset:28488
    v_mfma_f32_32x32x16_bf16 v[64:79], a[148:151], a[32:35], v[64:79]
    ds_read_b64_tr_b16 a[172:173], v137 offset:27752
    ds_read_b64_tr_b16 a[174:175], v137 offset:28520
    s_waitcnt lgkmcnt(8)
    v_mfma_f32_32x32x16_bf16 v[80:95], a[152:155], a[32:35], v[80:95]
    ds_read_b64_tr_b16 a[144:145], v137 offset:30720
    ds_read_b64_tr_b16 a[146:147], v137 offset:31488
    v_mfma_f32_32x32x16_bf16 v[96:111], a[156:159], a[32:35], v[96:111]
    ds_read_b64_tr_b16 a[148:149], v137 offset:30752
    ds_read_b64_tr_b16 a[150:151], v137 offset:31520
    s_waitcnt lgkmcnt(8)
    v_mfma_f32_32x32x16_bf16 v[48:63], a[160:163], a[36:39], v[48:63]
    ds_read_b64_tr_b16 a[152:153], v137 offset:30792
    ds_read_b64_tr_b16 a[154:155], v137 offset:31560
    v_mfma_f32_32x32x16_bf16 v[64:79], a[164:167], a[36:39], v[64:79]
    ds_read_b64_tr_b16 a[156:157], v137 offset:30824
    ds_read_b64_tr_b16 a[158:159], v137 offset:31592
    s_waitcnt lgkmcnt(8)
    v_mfma_f32_32x32x16_bf16 v[80:95], a[168:171], a[36:39], v[80:95]
    ds_read_b64_tr_b16 a[160:161], v137 offset:33792
    ds_read_b64_tr_b16 a[162:163], v137 offset:34560
    v_mfma_f32_32x32x16_bf16 v[96:111], a[172:175], a[36:39], v[96:111]
    ds_read_b64_tr_b16 a[164:165], v137 offset:33824
    ds_read_b64_tr_b16 a[166:167], v137 offset:34592
    s_waitcnt lgkmcnt(8)
    v_mfma_f32_32x32x16_bf16 v[48:63], a[144:147], a[40:43], v[48:63]
    ds_read_b64_tr_b16 a[168:169], v137 offset:33864
    ds_read_b64_tr_b16 a[170:171], v137 offset:34632
    v_mfma_f32_32x32x16_bf16 v[64:79], a[148:151], a[40:43], v[64:79]
    ds_read_b64_tr_b16 a[172:173], v137 offset:33896
    ds_read_b64_tr_b16 a[174:175], v137 offset:34664
    s_waitcnt lgkmcnt(8)
    v_mfma_f32_32x32x16_bf16 v[80:95], a[152:155], a[40:43], v[80:95]
    s_waitcnt vmcnt(9)
    s_barrier
    ds_read_b64_tr_b16 a[144:145], v137 offset:36864
    ds_read_b64_tr_b16 a[146:147], v137 offset:37632
    v_mfma_f32_32x32x16_bf16 v[96:111], a[156:159], a[40:43], v[96:111]
    ds_read_b64_tr_b16 a[148:149], v137 offset:36896
    ds_read_b64_tr_b16 a[150:151], v137 offset:37664
    s_waitcnt lgkmcnt(8)
    v_mfma_f32_32x32x16_bf16 v[48:63], a[160:163], a[44:47], v[48:63]
    ds_read_b64_tr_b16 a[152:153], v137 offset:36936
    ds_read_b64_tr_b16 a[154:155], v137 offset:37704
    v_mfma_f32_32x32x16_bf16 v[64:79], a[164:167], a[44:47], v[64:79]
    ds_read_b64_tr_b16 a[156:157], v137 offset:36968
    ds_read_b64_tr_b16 a[158:159], v137 offset:37736
    s_waitcnt lgkmcnt(8)
    v_mfma_f32_32x32x16_bf16 v[80:95], a[168:171], a[44:47], v[80:95]
    ds_read_b64_tr_b16 a[160:161], v137 offset:39936
    ds_read_b64_tr_b16 a[162:163], v137 offset:40704
    v_mfma_f32_32x32x16_bf16 v[96:111], a[172:175], a[44:47], v[96:111]
    ds_read_b64_tr_b16 a[164:165], v137 offset:39968
    ds_read_b64_tr_b16 a[166:167], v137 offset:40736
    s_waitcnt lgkmcnt(8)
    v_mfma_f32_32x32x16_bf16 v[48:63], a[144:147], a[48:51], v[48:63]
    ds_read_b64_tr_b16 a[168:169], v137 offset:40008
    ds_read_b64_tr_b16 a[170:171], v137 offset:40776
    v_mfma_f32_32x32x16_bf16 v[64:79], a[148:151], a[48:51], v[64:79]
    ds_read_b64_tr_b16 a[172:173], v137 offset:40040
    ds_read_b64_tr_b16 a[174:175], v137 offset:40808
    s_waitcnt lgkmcnt(8)
    v_mfma_f32_32x32x16_bf16 v[80:95], a[152:155], a[48:51], v[80:95]
    ds_read_b64_tr_b16 a[144:145], v137 offset:43008
    ds_read_b64_tr_b16 a[146:147], v137 offset:43776
    v_mfma_f32_32x32x16_bf16 v[96:111], a[156:159], a[48:51], v[96:111]
    ds_read_b64_tr_b16 a[148:149], v137 offset:43040
    ds_read_b64_tr_b16 a[150:151], v137 offset:43808
    s_waitcnt lgkmcnt(8)
    v_mfma_f32_32x32x16_bf16 v[48:63], a[160:163], a[52:55], v[48:63]
    ds_read_b64_tr_b16 a[152:153], v137 offset:43080
    ds_read_b64_tr_b16 a[154:155], v137 offset:43848
    v_mfma_f32_32x32x16_bf16 v[64:79], a[164:167], a[52:55], v[64:79]
    ds_read_b64_tr_b16 a[156:157], v137 offset:43112
    ds_read_b64_tr_b16 a[158:159], v137 offset:43880
    s_waitcnt lgkmcnt(8)
    v_mfma_f32_32x32x16_bf16 v[80:95], a[168:171], a[52:55], v[80:95]
    ds_read_b64_tr_b16 a[160:161], v137 offset:46080
    ds_read_b64_tr_b16 a[162:163], v137 offset:46848
    v_mfma_f32_32x32x16_bf16 v[96:111], a[172:175], a[52:55], v[96:111]
    ds_read_b64_tr_b16 a[164:165], v137 offset:46112
    ds_read_b64_tr_b16 a[166:167], v137 offset:46880
    s_waitcnt lgkmcnt(8)
    v_mfma_f32_32x32x16_bf16 v[48:63], a[144:147], a[56:59], v[48:63]
    ds_read_b64_tr_b16 a[168:169], v137 offset:46152
    ds_read_b64_tr_b16 a[170:171], v137 offset:46920
    v_mfma_f32_32x32x16_bf16 v[64:79], a[148:151], a[56:59], v[64:79]
    ds_read_b64_tr_b16 a[172:173], v137 offset:46184
    ds_read_b64_tr_b16 a[174:175], v137 offset:46952
    s_waitcnt lgkmcnt(8)
    v_mfma_f32_32x32x16_bf16 v[80:95], a[152:155], a[56:59], v[80:95]
    ds_read_b64_tr_b16 a[144:145], v137 offset:49152
    ds_read_b64_tr_b16 a[146:147], v137 offset:49920
    v_mfma_f32_32x32x16_bf16 v[96:111], a[156:159], a[56:59], v[96:111]
    ds_read_b64_tr_b16 a[148:149], v137 offset:49184
    ds_read_b64_tr_b16 a[150:151], v137 offset:49952
    s_waitcnt lgkmcnt(8)
    v_mfma_f32_32x32x16_bf16 v[48:63], a[160:163], a[60:63], v[48:63]
    ds_read_b64_tr_b16 a[152:153], v137 offset:49224
    ds_read_b64_tr_b16 a[154:155], v137 offset:49992
    v_mfma_f32_32x32x16_bf16 v[64:79], a[164:167], a[60:63], v[64:79]
    ds_read_b64_tr_b16 a[156:157], v137 offset:49256
    ds_read_b64_tr_b16 a[158:159], v137 offset:50024
    s_waitcnt lgkmcnt(8)
    v_mfma_f32_32x32x16_bf16 v[80:95], a[168:171], a[60:63], v[80:95]
    ds_read_b64_tr_b16 a[160:161], v137 offset:52224
    ds_read_b64_tr_b16 a[162:163], v137 offset:52992
    v_mfma_f32_32x32x16_bf16 v[96:111], a[172:175], a[60:63], v[96:111]
    ds_read_b64_tr_b16 a[164:165], v137 offset:52256
    ds_read_b64_tr_b16 a[166:167], v137 offset:53024
    s_waitcnt lgkmcnt(8)
    v_mfma_f32_32x32x16_bf16 v[48:63], a[144:147], a[64:67], v[48:63]
    ds_read_b64_tr_b16 a[168:169], v137 offset:52296
    ds_read_b64_tr_b16 a[170:171], v137 offset:53064
    v_mfma_f32_32x32x16_bf16 v[64:79], a[148:151], a[64:67], v[64:79]
    ds_read_b64_tr_b16 a[172:173], v137 offset:52328
    ds_read_b64_tr_b16 a[174:175], v137 offset:53096
    s_waitcnt lgkmcnt(8)
    v_mfma_f32_32x32x16_bf16 v[80:95], a[152:155], a[64:67], v[80:95]
    ds_read_b64_tr_b16 a[144:145], v138 offset:0
    ds_read_b64_tr_b16 a[146:147], v138 offset:768
    v_mfma_f32_32x32x16_bf16 v[96:111], a[156:159], a[64:67], v[96:111]
    ds_read_b64_tr_b16 a[148:149], v138 offset:32
    ds_read_b64_tr_b16 a[150:151], v138 offset:800
    s_waitcnt lgkmcnt(8)
    v_mfma_f32_32x32x16_bf16 v[48:63], a[160:163], a[68:71], v[48:63]
    ds_read_b64_tr_b16 a[152:153], v138 offset:72
    ds_read_b64_tr_b16 a[154:155], v138 offset:840
    v_mfma_f32_32x32x16_bf16 v[64:79], a[164:167], a[68:71], v[64:79]
    ds_read_b64_tr_b16 a[156:157], v138 offset:104
    ds_read_b64_tr_b16 a[158:159], v138 offset:872
    s_waitcnt lgkmcnt(8)
    v_mfma_f32_32x32x16_bf16 v[80:95], a[168:171], a[68:71], v[80:95]
    ds_read_b64_tr_b16 a[160:161], v138 offset:3072
    ds_read_b64_tr_b16 a[162:163], v138 offset:3840
    v_mfma_f32_32x32x16_bf16 v[96:111], a[172:175], a[68:71], v[96:111]
    ds_read_b64_tr_b16 a[164:165], v138 offset:3104
    ds_read_b64_tr_b16 a[166:167], v138 offset:3872
    s_waitcnt lgkmcnt(8)
    v_mfma_f32_32x32x16_bf16 v[48:63], a[144:147], a[72:75], v[48:63]
    ds_read_b64_tr_b16 a[168:169], v138 offset:3144
    ds_read_b64_tr_b16 a[170:171], v138 offset:3912
    v_mfma_f32_32x32x16_bf16 v[64:79], a[148:151], a[72:75], v[64:79]
    ds_read_b64_tr_b16 a[172:173], v138 offset:3176
    ds_read_b64_tr_b16 a[174:175], v138 offset:3944
    s_waitcnt lgkmcnt(8)
    v_mfma_f32_32x32x16_bf16 v[80:95], a[152:155], a[72:75], v[80:95]
    ds_read_b64_tr_b16 a[144:145], v138 offset:6144
    ds_read_b64_tr_b16 a[146:147], v138 offset:6912
    v_mfma_f32_32x32x16_bf16 v[96:111], a[156:159], a[72:75], v[96:111]
    ds_read_b64_tr_b16 a[148:149], v138 offset:6176
    ds_read_b64_tr_b16 a[150:151], v138 offset:6944
    s_waitcnt lgkmcnt(8)
    v_mfma_f32_32x32x16_bf16 v[48:63], a[160:163], a[76:79], v[48:63]
    ds_read_b64_tr_b16 a[152:153], v138 offset:6216
    ds_read_b64_tr_b16 a[154:155], v138 offset:6984
    v_mfma_f32_32x32x16_bf16 v[64:79], a[164:167], a[76:79], v[64:79]
    ds_read_b64_tr_b16 a[156:157], v138 offset:6248
    ds_read_b64_tr_b16 a[158:159], v138 offset:7016
    s_waitcnt lgkmcnt(8)
    v_mfma_f32_32x32x16_bf16 v[80:95], a[168:171], a[76:79], v[80:95]
    ds_read_b64_tr_b16 a[160:161], v138 offset:9216
    ds_read_b64_tr_b16 a[162:163], v138 offset:9984
    v_mfma_f32_32x32x16_bf16 v[96:111], a[172:175], a[76:79], v[96:111]
    ds_read_b64_tr_b16 a[164:165], v138 offset:9248
    ds_read_b64_tr_b16 a[166:167], v138 offset:10016
    s_waitcnt lgkmcnt(8)
    v_mfma_f32_32x32x16_bf16 v[48:63], a[144:147], a[80:83], v[48:63]
    ds_read_b64_tr_b16 a[168:169], v138 offset:9288
    ds_read_b64_tr_b16 a[170:171], v138 offset:10056
    v_mfma_f32_32x32x16_bf16 v[64:79], a[148:151], a[80:83], v[64:79]
    ds_read_b64_tr_b16 a[172:173], v138 offset:9320
    ds_read_b64_tr_b16 a[174:175], v138 offset:10088
    s_waitcnt lgkmcnt(8)
    v_mfma_f32_32x32x16_bf16 v[80:95], a[152:155], a[80:83], v[80:95]
    ds_read_b64_tr_b16 a[144:145], v138 offset:12288
    ds_read_b64_tr_b16 a[146:147], v138 offset:13056
    v_mfma_f32_32x32x16_bf16 v[96:111], a[156:159], a[80:83], v[96:111]
    ds_read_b64_tr_b16 a[148:149], v138 offset:12320
    ds_read_b64_tr_b16 a[150:151], v138 offset:13088
    s_waitcnt lgkmcnt(8)
    v_mfma_f32_32x32x16_bf16 v[48:63], a[160:163], a[84:87], v[48:63]
    ds_read_b64_tr_b16 a[152:153], v138 offset:12360
    ds_read_b64_tr_b16 a[154:155], v138 offset:13128
    v_mfma_f32_32x32x16_bf16 v[64:79], a[164:167], a[84:87], v[64:79]
    ds_read_b64_tr_b16 a[156:157], v138 offset:12392
    ds_read_b64_tr_b16 a[158:159], v138 offset:13160
    s_waitcnt lgkmcnt(8)
    v_mfma_f32_32x32x16_bf16 v[80:95], a[168:171], a[84:87], v[80:95]
    ds_read_b64_tr_b16 a[160:161], v138 offset:15360
    ds_read_b64_tr_b16 a[162:163], v138 offset:16128
    v_mfma_f32_32x32x16_bf16 v[96:111], a[172:175], a[84:87], v[96:111]
    ds_read_b64_tr_b16 a[164:165], v138 offset:15392
    ds_read_b64_tr_b16 a[166:167], v138 offset:16160
    s_waitcnt lgkmcnt(8)
    v_mfma_f32_32x32x16_bf16 v[48:63], a[144:147], a[88:91], v[48:63]
    ds_read_b64_tr_b16 a[168:169], v138 offset:15432
    ds_read_b64_tr_b16 a[170:171], v138 offset:16200
    v_mfma_f32_32x32x16_bf16 v[64:79], a[148:151], a[88:91], v[64:79]
    ds_read_b64_tr_b16 a[172:173], v138 offset:15464
    ds_read_b64_tr_b16 a[174:175], v138 offset:16232
    s_waitcnt lgkmcnt(8)
    v_mfma_f32_32x32x16_bf16 v[80:95], a[152:155], a[88:91], v[80:95]
    s_waitcnt vmcnt(0)
    s_barrier
    ds_read_b64_tr_b16 a[144:145], v138 offset:18432
    ds_read_b64_tr_b16 a[146:147], v138 offset:19200
    v_mfma_f32_32x32x16_bf16 v[96:111], a[156:159], a[88:91], v[96:111]
    ds_read_b64_tr_b16 a[148:149], v138 offset:18464
    ds_read_b64_tr_b16 a[150:151], v138 offset:19232
    s_waitcnt lgkmcnt(8)
    v_mfma_f32_32x32x16_bf16 v[48:63], a[160:163], a[92:95], v[48:63]
    ds_read_b64_tr_b16 a[152:153], v138 offset:18504
    ds_read_b64_tr_b16 a[154:155], v138 offset:19272
    v_mfma_f32_32x32x16_bf16 v[64:79], a[164:167], a[92:95], v[64:79]
    ds_read_b64_tr_b16 a[156:157], v138 offset:18536
    ds_read_b64_tr_b16 a[158:159], v138 offset:19304
    s_waitcnt lgkmcnt(8)
    v_mfma_f32_32x32x16_bf16 v[80:95], a[168:171], a[92:95], v[80:95]
    ds_read_b64_tr_b16 a[160:161], v138 offset:21504
    ds_read_b64_tr_b16 a[162:163], v138 offset:22272
    v_mfma_f32_32x32x16_bf16 v[96:111], a[172:175], a[92:95], v[96:111]
    ds_read_b64_tr_b16 a[164:165], v138 offset:21536
    ds_read_b64_tr_b16 a[166:167], v138 offset:22304
    s_waitcnt lgkmcnt(8)
    v_mfma_f32_32x32x16_bf16 v[48:63], a[144:147], a[96:99], v[48:63]
    ds_read_b64_tr_b16 a[168:169], v138 offset:21576
    ds_read_b64_tr_b16 a[170:171], v138 offset:22344
    v_mfma_f32_32x32x16_bf16 v[64:79], a[148:151], a[96:99], v[64:79]
    ds_read_b64_tr_b16 a[172:173], v138 offset:21608
    ds_read_b64_tr_b16 a[174:175], v138 offset:22376
    s_waitcnt lgkmcnt(8)
    v_mfma_f32_32x32x16_bf16 v[80:95], a[152:155], a[96:99], v[80:95]
    ds_read_b64_tr_b16 a[144:145], v138 offset:24576
    ds_read_b64_tr_b16 a[146:147], v138 offset:25344
    v_mfma_f32_32x32x16_bf16 v[96:111], a[156:159], a[96:99], v[96:111]
    ds_read_b64_tr_b16 a[148:149], v138 offset:24608
    ds_read_b64_tr_b16 a[150:151], v138 offset:25376
    s_waitcnt lgkmcnt(8)
    v_mfma_f32_32x32x16_bf16 v[48:63], a[160:163], a[100:103], v[48:63]
    ds_read_b64_tr_b16 a[152:153], v138 offset:24648
    ds_read_b64_tr_b16 a[154:155], v138 offset:25416
    v_mfma_f32_32x32x16_bf16 v[64:79], a[164:167], a[100:103], v[64:79]
    ds_read_b64_tr_b16 a[156:157], v138 offset:24680
    ds_read_b64_tr_b16 a[158:159], v138 offset:25448
    s_waitcnt lgkmcnt(8)
    v_mfma_f32_32x32x16_bf16 v[80:95], a[168:171], a[100:103], v[80:95]
    ds_read_b64_tr_b16 a[160:161], v138 offset:27648
    ds_read_b64_tr_b16 a[162:163], v138 offset:28416
    v_mfma_f32_32x32x16_bf16 v[96:111], a[172:175], a[100:103], v[96:111]
    ds_read_b64_tr_b16 a[164:165], v138 offset:27680
    ds_read_b64_tr_b16 a[166:167], v138 offset:28448
    s_waitcnt lgkmcnt(8)
    v_mfma_f32_32x32x16_bf16 v[48:63], a[144:147], a[104:107], v[48:63]
    ds_read_b64_tr_b16 a[168:169], v138 offset:27720
    ds_read_b64_tr_b16 a[170:171], v138 offset:28488
    v_mfma_f32_32x32x16_bf16 v[64:79], a[148:151], a[104:107], v[64:79]
    ds_read_b64_tr_b16 a[172:173], v138 offset:27752
    ds_read_b64_tr_b16 a[174:175], v138 offset:28520
    s_waitcnt lgkmcnt(8)
    v_mfma_f32_32x32x16_bf16 v[80:95], a[152:155], a[104:107], v[80:95]
    ds_read_b64_tr_b16 a[144:145], v138 offset:30720
    ds_read_b64_tr_b16 a[146:147], v138 offset:31488
    v_mfma_f32_32x32x16_bf16 v[96:111], a[156:159], a[104:107], v[96:111]
    ds_read_b64_tr_b16 a[148:149], v138 offset:30752
    ds_read_b64_tr_b16 a[150:151], v138 offset:31520
    s_waitcnt lgkmcnt(8)
    v_mfma_f32_32x32x16_bf16 v[48:63], a[160:163], a[108:111], v[48:63]
    ds_read_b64_tr_b16 a[152:153], v138 offset:30792
    ds_read_b64_tr_b16 a[154:155], v138 offset:31560
    v_mfma_f32_32x32x16_bf16 v[64:79], a[164:167], a[108:111], v[64:79]
    ds_read_b64_tr_b16 a[156:157], v138 offset:30824
    ds_read_b64_tr_b16 a[158:159], v138 offset:31592
    s_waitcnt lgkmcnt(8)
    v_mfma_f32_32x32x16_bf16 v[80:95], a[168:171], a[108:111], v[80:95]
    ds_read_b64_tr_b16 a[160:161], v138 offset:33792
    ds_read_b64_tr_b16 a[162:163], v138 offset:34560
    v_mfma_f32_32x32x16_bf16 v[96:111], a[172:175], a[108:111], v[96:111]
    ds_read_b64_tr_b16 a[164:165], v138 offset:33824
    ds_read_b64_tr_b16 a[166:167], v138 offset:34592
    s_waitcnt lgkmcnt(8)
    v_mfma_f32_32x32x16_bf16 v[48:63], a[144:147], a[112:115], v[48:63]
    ds_read_b64_tr_b16 a[168:169], v138 offset:33864
    ds_read_b64_tr_b16 a[170:171], v138 offset:34632
    v_mfma_f32_32x32x16_bf16 v[64:79], a[148:151], a[112:115], v[64:79]
    ds_read_b64_tr_b16 a[172:173], v138 offset:33896
    ds_read_b64_tr_b16 a[174:175], v138 offset:34664
    s_waitcnt lgkmcnt(8)
    v_mfma_f32_32x32x16_bf16 v[80:95], a[152:155], a[112:115], v[80:95]
    ds_read_b64_tr_b16 a[144:145], v138 offset:36864
    ds_read_b64_tr_b16 a[146:147], v138 offset:37632
    v_mfma_f32_32x32x16_bf16 v[96:111], a[156:159], a[112:115], v[96:111]
    ds_read_b64_tr_b16 a[148:149], v138 offset:36896
    ds_read_b64_tr_b16 a[150:151], v138 offset:37664
    s_waitcnt lgkmcnt(8)
    v_mfma_f32_32x32x16_bf16 v[48:63], a[160:163], a[116:119], v[48:63]
    ds_read_b64_tr_b16 a[152:153], v138 offset:36936
    ds_read_b64_tr_b16 a[154:155], v138 offset:37704
    v_mfma_f32_32x32x16_bf16 v[64:79], a[164:167], a[116:119], v[64:79]
    ds_read_b64_tr_b16 a[156:157], v138 offset:36968
    ds_read_b64_tr_b16 a[158:159], v138 offset:37736
    s_waitcnt lgkmcnt(8)
    v_mfma_f32_32x32x16_bf16 v[80:95], a[168:171], a[116:119], v[80:95]
    ds_read_b64_tr_b16 a[160:161], v138 offset:39936
    ds_read_b64_tr_b16 a[162:163], v138 offset:40704
    v_mfma_f32_32x32x16_bf16 v[96:111], a[172:175], a[116:119], v[96:111]
    ds_read_b64_tr_b16 a[164:165], v138 offset:39968
    ds_read_b64_tr_b16 a[166:167], v138 offset:40736
    s_waitcnt lgkmcnt(8)
    v_mfma_f32_32x32x16_bf16 v[48:63], a[144:147], a[120:123], v[48:63]
    ds_read_b64_tr_b16 a[168:169], v138 offset:40008
    ds_read_b64_tr_b16 a[170:171], v138 offset:40776
    v_mfma_f32_32x32x16_bf16 v[64:79], a[148:151], a[120:123], v[64:79]
    ds_read_b64_tr_b16 a[172:173], v138 offset:40040
    ds_read_b64_tr_b16 a[174:175], v138 offset:40808
    s_waitcnt lgkmcnt(8)
    v_mfma_f32_32x32x16_bf16 v[80:95], a[152:155], a[120:123], v[80:95]
    ds_read_b64_tr_b16 a[144:145], v138 offset:43008
    ds_read_b64_tr_b16 a[146:147], v138 offset:43776
    v_mfma_f32_32x32x16_bf16 v[96:111], a[156:159], a[120:123], v[96:111]
    ds_read_b64_tr_b16 a[148:149], v138 offset:43040
    ds_read_b64_tr_b16 a[150:151], v138 offset:43808
    s_and_b32 s57, s2, 7
    s_lshl_b32 s57, s57, 7
    s_add_u32 s57, s57, 29364224
    s_cmp_lg_u32 s5, 0
    s_cbranch_scc1 A_kv_w
    v_mbcnt_lo_u32_b32 v120, -1, 0
    v_lshlrev_b32 v120, 2, v120
    s_mov_b32 exec_lo, 0xffffffff
    s_mov_b32 exec_hi, 0
A_kv_p:
    buffer_load_dword v121, v120, s[24:27], s57 offen sc1
    s_waitcnt vmcnt(0)
    v_cmp_ne_u32 vcc, s98, v121
    s_nop 7
    s_cbranch_vccz A_kv_d
    s_sleep 4
    s_branch A_kv_p
A_kv_d:
    s_mov_b64 exec, -1
    buffer_inv sc1
    s_waitcnt vmcnt(0)
A_kv_w:
    s_barrier
    v_lshlrev_b32 v6, 2, v1
    s_mov_b32 s11, 4882432
    buffer_load_dword v7, v6, s[24:27], s11 offen
    s_lshl_b32 s18, s5, 10
    s_add_u32 m0, s18, 119808
    s_add_u32 s7, s18, 4718592
    buffer_load_dwordx4 v2, s[24:27], s7 offen lds
    s_add_u32 m0, s18, 123904
    s_add_u32 s7, s18, 4722688
    buffer_load_dwordx4 v2, s[24:27], s7 offen lds
    s_add_u32 m0, s18, 128000
    s_add_u32 s7, s18, 4726784
    buffer_load_dwordx4 v2, s[24:27], s7 offen lds
    s_add_u32 m0, s18, 132096
    s_add_u32 s7, s18, 4730880
    buffer_load_dwordx4 v2, s[24:27], s7 offen lds
    s_add_u32 m0, s18, 136192
    s_add_u32 s7, s18, 4734976
    buffer_load_dwordx4 v2, s[24:27], s7 offen lds
    s_add_u32 m0, s18, 140288
    s_add_u32 s7, s18, 4739072
    buffer_load_dwordx4 v2, s[24:27], s7 offen lds
    s_add_u32 m0, s18, 144384
    s_add_u32 s7, s18, 4743168
    buffer_load_dwordx4 v2, s[24:27], s7 offen lds
    s_add_u32 m0, s18, 148480
    s_add_u32 s7, s18, 4747264
    buffer_load_dwordx4 v2, s[24:27], s7 offen lds
    s_add_u32 m0, s18, 152576
    s_add_u32 s7, s18, 4751360
    buffer_load_dwordx4 v2, s[24:27], s7 offen lds
    s_add_u32 m0, s18, 156672
    s_add_u32 s7, s18, 4755456
    buffer_load_dwordx4 v2, s[24:27], s7 offen lds
    s_waitcnt lgkmcnt(8)
    v_mfma_f32_32x32x16_bf16 v[48:63], a[160:163], a[124:127], v[48:63]
    ds_read_b64_tr_b16 a[152:153], v138 offset:43080
    ds_read_b64_tr_b16 a[154:155], v138 offset:43848
    v_mfma_f32_32x32x16_bf16 v[64:79], a[164:167], a[124:127], v[64:79]
    ds_read_b64_tr_b16 a[156:157], v138 offset:43112
    ds_read_b64_tr_b16 a[158:159], v138 offset:43880
    s_waitcnt lgkmcnt(8)
    v_mfma_f32_32x32x16_bf16 v[80:95], a[168:171], a[124:127], v[80:95]
    ds_read_b64_tr_b16 a[160:161], v138 offset:46080
    ds_read_b64_tr_b16 a[162:163], v138 offset:46848
    v_mfma_f32_32x32x16_bf16 v[96:111], a[172:175], a[124:127], v[96:111]
    ds_read_b64_tr_b16 a[164:165], v138 offset:46112
    ds_read_b64_tr_b16 a[166:167], v138 offset:46880
    s_waitcnt lgkmcnt(8)
    v_mfma_f32_32x32x16_bf16 v[48:63], a[144:147], a[128:131], v[48:63]
    ds_read_b64_tr_b16 a[168:169], v138 offset:46152
    ds_read_b64_tr_b16 a[170:171], v138 offset:46920
    v_mfma_f32_32x32x16_bf16 v[64:79], a[148:151], a[128:131], v[64:79]
    ds_read_b64_tr_b16 a[172:173], v138 offset:46184
    ds_read_b64_tr_b16 a[174:175], v138 offset:46952
    s_waitcnt lgkmcnt(8)
    v_mfma_f32_32x32x16_bf16 v[80:95], a[152:155], a[128:131], v[80:95]
    ds_read_b64_tr_b16 a[144:145], v138 offset:49152
    ds_read_b64_tr_b16 a[146:147], v138 offset:49920
    v_mfma_f32_32x32x16_bf16 v[96:111], a[156:159], a[128:131], v[96:111]
    ds_read_b64_tr_b16 a[148:149], v138 offset:49184
    ds_read_b64_tr_b16 a[150:151], v138 offset:49952
    s_waitcnt lgkmcnt(8)
    v_mfma_f32_32x32x16_bf16 v[48:63], a[160:163], a[132:135], v[48:63]
    ds_read_b64_tr_b16 a[152:153], v138 offset:49224
    ds_read_b64_tr_b16 a[154:155], v138 offset:49992
    v_mfma_f32_32x32x16_bf16 v[64:79], a[164:167], a[132:135], v[64:79]
    ds_read_b64_tr_b16 a[156:157], v138 offset:49256
    ds_read_b64_tr_b16 a[158:159], v138 offset:50024
    s_waitcnt lgkmcnt(8)
    v_mfma_f32_32x32x16_bf16 v[80:95], a[168:171], a[132:135], v[80:95]
    ds_read_b64_tr_b16 a[160:161], v138 offset:52224
    ds_read_b64_tr_b16 a[162:163], v138 offset:52992
    v_mfma_f32_32x32x16_bf16 v[96:111], a[172:175], a[132:135], v[96:111]
    ds_read_b64_tr_b16 a[164:165], v138 offset:52256
    ds_read_b64_tr_b16 a[166:167], v138 offset:53024
    s_waitcnt lgkmcnt(8)
    v_mfma_f32_32x32x16_bf16 v[48:63], a[144:147], a[136:139], v[48:63]
    ds_read_b64_tr_b16 a[168:169], v138 offset:52296
    ds_read_b64_tr_b16 a[170:171], v138 offset:53064
    v_mfma_f32_32x32x16_bf16 v[64:79], a[148:151], a[136:139], v[64:79]
    ds_read_b64_tr_b16 a[172:173], v138 offset:52328
    ds_read_b64_tr_b16 a[174:175], v138 offset:53096
    s_waitcnt lgkmcnt(8)
    v_mfma_f32_32x32x16_bf16 v[80:95], a[152:155], a[136:139], v[80:95]
    v_mfma_f32_32x32x16_bf16 v[96:111], a[156:159], a[136:139], v[96:111]
    s_waitcnt lgkmcnt(4)
    v_mfma_f32_32x32x16_bf16 v[48:63], a[160:163], a[140:143], v[48:63]
    v_mfma_f32_32x32x16_bf16 v[64:79], a[164:167], a[140:143], v[64:79]
    s_waitcnt lgkmcnt(0)
    v_mfma_f32_32x32x16_bf16 v[80:95], a[168:171], a[140:143], v[80:95]
    v_mfma_f32_32x32x16_bf16 v[96:111], a[172:175], a[140:143], v[96:111]
    s_nop 7
    s_nop 3
    v_cmp_gt_u32 vcc, 32, v1
    s_nop 1
    s_mov_b64 s[12:13], vcc
    s_mov_b32 s9, 0x3eae1a93
    v_mul_f32 v48, s9, v48
    v_mul_f32 v49, s9, v49
    v_mul_f32 v50, s9, v50
    v_mul_f32 v51, s9, v51
    v_mul_f32 v52, s9, v52
    v_mul_f32 v53, s9, v53
    v_mul_f32 v54, s9, v54
    v_mul_f32 v55, s9, v55
    v_mul_f32 v56, s9, v56
    v_mul_f32 v57, s9, v57
    v_cvt_pk_bf16_f32 v112, v48, v49
    v_cvt_pk_bf16_f32 v113, v50, v51
    v_cvt_pk_bf16_f32 v114, v52, v53
    v_cvt_pk_bf16_f32 v115, v54, v55
    v_cvt_pk_bf16_f32 v116, v56, v57
    v_mov_b32 v16, v112
    v_mov_b32 v17, v113
    v_mov_b32 v18, v114
    v_mov_b32 v19, v115
    v_mov_b32 v20, v116
    v_mul_f32 v64, s9, v64
    v_mul_f32 v65, s9, v65
    v_mul_f32 v66, s9, v66
    v_mul_f32 v67, s9, v67
    v_mul_f32 v68, s9, v68
    v_mul_f32 v69, s9, v69
    v_mul_f32 v70, s9, v70
    v_mul_f32 v71, s9, v71
    v_mul_f32 v72, s9, v72
    v_mul_f32 v73, s9, v73
    v_mul_f32 v74, s9, v74
    v_mul_f32 v75, s9, v75
    v_cvt_pk_bf16_f32 v112, v64, v65
    v_cvt_pk_bf16_f32 v113, v66, v67
    v_cvt_pk_bf16_f32 v114, v68, v69
    v_cvt_pk_bf16_f32 v115, v70, v71
    v_cvt_pk_bf16_f32 v116, v72, v73
    v_cvt_pk_bf16_f32 v117, v74, v75
    v_mov_b32 v24, v113
    v_mov_b32 v26, v115
    v_mov_b32 v28, v117
    v_mov_b32 v120, v112
    v_mov_b32 v121, v114
    s_nop 1
    v_permlane32_swap_b32 v120, v121
    s_nop 1
    v_cndmask_b32 v25, v120, v121, s[12:13]
    v_mov_b32 v120, v114
    v_mov_b32 v121, v116
    s_nop 1
    v_permlane32_swap_b32 v120, v121
    s_nop 1
    v_cndmask_b32 v27, v120, v121, s[12:13]
    v_mul_f32 v80, s9, v80
    v_mul_f32 v81, s9, v81
    v_mul_f32 v82, s9, v82
    v_mul_f32 v83, s9, v83
    v_mul_f32 v84, s9, v84
    v_mul_f32 v85, s9, v85
    v_mul_f32 v86, s9, v86
    v_mul_f32 v87, s9, v87
    v_mul_f32 v88, s9, v88
    v_mul_f32 v89, s9, v89
    v_cvt_pk_bf16_f32 v112, v80, v81
    v_cvt_pk_bf16_f32 v113, v82, v83
    v_cvt_pk_bf16_f32 v114, v84, v85
    v_cvt_pk_bf16_f32 v115, v86, v87
    v_cvt_pk_bf16_f32 v116, v88, v89
    v_mov_b32 v32, v112
    v_mov_b32 v33, v113
    v_mov_b32 v34, v114
    v_mov_b32 v35, v115
    v_mov_b32 v36, v116
    v_mul_f32 v96, s9, v96
    v_mul_f32 v97, s9, v97
    v_mul_f32 v98, s9, v98
    v_mul_f32 v99, s9, v99
    v_mul_f32 v100, s9, v100
    v_mul_f32 v101, s9, v101
    v_mul_f32 v102, s9, v102
    v_mul_f32 v103, s9, v103
    v_mul_f32 v104, s9, v104
    v_mul_f32 v105, s9, v105
    v_mul_f32 v106, s9, v106
    v_mul_f32 v107, s9, v107
    v_cvt_pk_bf16_f32 v112, v96, v97
    v_cvt_pk_bf16_f32 v113, v98, v99
    v_cvt_pk_bf16_f32 v114, v100, v101
    v_cvt_pk_bf16_f32 v115, v102, v103
    v_cvt_pk_bf16_f32 v116, v104, v105
    v_cvt_pk_bf16_f32 v117, v106, v107
    v_mov_b32 v40, v113
    v_mov_b32 v42, v115
    v_mov_b32 v44, v117
    v_mov_b32 v120, v112
    v_mov_b32 v121, v114
    s_nop 1
    v_permlane32_swap_b32 v120, v121
    s_nop 1
    v_cndmask_b32 v41, v120, v121, s[12:13]
    v_mov_b32 v120, v114
    v_mov_b32 v121, v116
    s_nop 1
    v_permlane32_swap_b32 v120, v121
    s_nop 1
    v_cndmask_b32 v43, v120, v121, s[12:13]
    s_barrier
    v_mov_b32 v157, 0x3f803f80
    v_mov_b32 v158, 0
    v_mov_b32 v159, 0
    v_mov_b32 v173, 0x3f803f80
    v_mov_b32 v174, 0
    v_mov_b32 v175, 0
    s_waitcnt vmcnt(10)
    s_nop 1
    v_max_f32_dpp v7, v7, v7 quad_perm:[1,0,3,2] row_mask:0xf bank_mask:0xf
    s_nop 1
    v_max_f32_dpp v7, v7, v7 quad_perm:[2,3,0,1] row_mask:0xf bank_mask:0xf
    s_nop 1
    v_max_f32_dpp v7, v7, v7 row_half_mirror row_mask:0xf bank_mask:0xf
    s_nop 1
    v_max_f32_dpp v7, v7, v7 row_mirror row_mask:0xf bank_mask:0xf
    ds_swizzle_b32 v8, v7 offset:0x401F
    s_waitcnt lgkmcnt(0)
    v_max_f32 v7, v7, v8
    v_mov_b32 v8, v7
    s_nop 1
    v_permlane32_swap_b32 v7, v8
    s_nop 1
    v_max_f32 v7, v7, v8
    v_cmp_gt_u32 vcc, 32, v1
    s_mov_b64 s[12:13], vcc
    v_cndmask_b32 v20, 0, v20, s[12:13]
    v_mov_b32 v8, 0
    v_dot2_f32_bf16 v8, v16, v16, v8
    v_dot2_f32_bf16 v8, v17, v17, v8
    v_dot2_f32_bf16 v8, v18, v18, v8
    v_dot2_f32_bf16 v8, v19, v19, v8
    v_dot2_f32_bf16 v8, v20, v20, v8
    s_nop 3
    v_mov_b32 v9, v8
    s_nop 1
    v_permlane32_swap_b32 v8, v9
    s_nop 1
    v_add_f32 v8, v8, v9
    v_mul_f32 v8, v8, v7
    v_sqrt_f32 v8, v8
    s_nop 0
    v_mul_f32 v8, 0xbf8020c5, v8
    v_cvt_pk_bf16_f32 v9, v8, v8
    v_lshlrev_b32 v9, 16, v9
    v_sub_f32 v9, v8, v9
    v_cvt_pk_bf16_f32 v9, v8, v9
    v_cndmask_b32 v21, 0, v9, s[12:13]
    v_mov_b32 v22, 0
    v_mov_b32 v23, 0
    v_cndmask_b32 v28, 0, v28, s[12:13]
    v_mov_b32 v8, 0
    v_dot2_f32_bf16 v8, v24, v24, v8
    v_dot2_f32_bf16 v8, v25, v25, v8
    v_dot2_f32_bf16 v8, v26, v26, v8
    v_dot2_f32_bf16 v8, v27, v27, v8
    v_dot2_f32_bf16 v8, v28, v28, v8
    s_nop 3
    v_mov_b32 v9, v8
    s_nop 1
    v_permlane32_swap_b32 v8, v9
    s_nop 1
    v_add_f32 v8, v8, v9
    v_mul_f32 v8, v8, v7
    v_sqrt_f32 v8, v8
    s_nop 0
    v_mul_f32 v8, 0xbf8020c5, v8
    v_cvt_pk_bf16_f32 v9, v8, v8
    v_lshlrev_b32 v9, 16, v9
    v_sub_f32 v9, v8, v9
    v_cvt_pk_bf16_f32 v9, v8, v9
    v_cndmask_b32 v29, 0, v9, s[12:13]
    v_mov_b32 v30, 0
    v_mov_b32 v31, 0
    v_cndmask_b32 v36, 0, v36, s[12:13]
    v_mov_b32 v8, 0
    v_dot2_f32_bf16 v8, v32, v32, v8
    v_dot2_f32_bf16 v8, v33, v33, v8
    v_dot2_f32_bf16 v8, v34, v34, v8
    v_dot2_f32_bf16 v8, v35, v35, v8
    v_dot2_f32_bf16 v8, v36, v36, v8
    s_nop 3
    v_mov_b32 v9, v8
    s_nop 1
    v_permlane32_swap_b32 v8, v9
    s_nop 1
    v_add_f32 v8, v8, v9
    v_mul_f32 v8, v8, v7
    v_sqrt_f32 v8, v8
    s_nop 0
    v_mul_f32 v8, 0xbf8020c5, v8
    v_cvt_pk_bf16_f32 v9, v8, v8
    v_lshlrev_b32 v9, 16, v9
    v_sub_f32 v9, v8, v9
    v_cvt_pk_bf16_f32 v9, v8, v9
    v_cndmask_b32 v37, 0, v9, s[12:13]
    v_mov_b32 v38, 0
    v_mov_b32 v39, 0
    v_cndmask_b32 v44, 0, v44, s[12:13]
    v_mov_b32 v8, 0
    v_dot2_f32_bf16 v8, v40, v40, v8
    v_dot2_f32_bf16 v8, v41, v41, v8
    v_dot2_f32_bf16 v8, v42, v42, v8
    v_dot2_f32_bf16 v8, v43, v43, v8
    v_dot2_f32_bf16 v8, v44, v44, v8
    s_nop 3
    v_mov_b32 v9, v8
    s_nop 1
    v_permlane32_swap_b32 v8, v9
    s_nop 1
    v_add_f32 v8, v8, v9
    v_mul_f32 v8, v8, v7
    v_sqrt_f32 v8, v8
    s_nop 0
    v_mul_f32 v8, 0xbf8020c5, v8
    v_cvt_pk_bf16_f32 v9, v8, v8
    v_lshlrev_b32 v9, 16, v9
    v_sub_f32 v9, v8, v9
    v_cvt_pk_bf16_f32 v9, v8, v9
    v_cndmask_b32 v45, 0, v9, s[12:13]
    v_mov_b32 v46, 0
    v_mov_b32 v47, 0
    s_mov_b32 s14, 0
    s_waitcnt vmcnt(0) lgkmcnt(0)
    s_barrier
A_run:
    v_add_u32 v184, 119808, v2
    v_add_u32 v185, 136192, v4
    v_min_u32 v8, 19, v3
    v_mul_u32_u24 v8, 1040, v8
    v_lshlrev_b32 v9, 4, v5
    v_add_u32 v8, v8, v9
    v_add_u32 v186, 138240, v8
    ds_read_b128 v[152:155], v184 offset:0
    ds_read_b32 v156, v185 offset:0
    ds_read_b128 v[160:163], v186 offset:0
    ds_read_b128 v[164:167], v186 offset:32
    s_lshl_b32 s18, s5, 10
    s_lshl_b32 s16, s4, 3
    s_add_u32 s16, s16, s3
    s_lshl_b32 s16, s16, 2
    s_add_u32 s16, s16, s5
    v_lshlrev_b32 v201, 7, v1
    s_lshl_b32 s17, s16, 13
    s_add_u32 s16, s17, 4194304
    s_load_dwordx2 s[8:9], s[0:1], 32
    s_waitcnt lgkmcnt(0)
    s_and_b32 s9, s9, 0xffff
    s_mov_b32 s10, 663552
    s_mov_b32 s11, 0x20000
    buffer_load_dword v203, v201, s[8:11], s17 offen
    v_mfma_f32_32x32x16_bf16 v[112:127], v[152:155], v[16:19], 0
    v_mfma_f32_32x32x16_bf16 v[112:127], v[156:159], v[20:23], v[112:127]
    s_nop 7
    s_nop 3
    s_mov_b32 s15, 16
    s_cmp_eq_u32 s14, 0
    s_cselect_b32 s20, -1, 0
    v_mfma_f32_32x32x16_bf16 v[128:143], v[152:155], v[24:27], 0
    s_mov_b32 s21, 4096
    v_exp_f32 v112, v112
    v_exp_f32 v113, v113
    v_exp_f32 v114, v114
    v_exp_f32 v115, v115
    v_mfma_f32_32x32x16_bf16 v[128:143], v[156:159], v[28:31], v[128:143]
    s_mov_b32 s22, 512
    v_exp_f32 v116, v116
    v_exp_f32 v117, v117
    v_exp_f32 v118, v118
    v_exp_f32 v119, v119
    v_cvt_pk_bf16_f32 v144, v112, v113
    v_cvt_pk_bf16_f32 v145, v114, v115
    v_exp_f32 v120, v120
    v_exp_f32 v121, v121
    v_exp_f32 v122, v122
    v_exp_f32 v123, v123
    v_cvt_pk_bf16_f32 v146, v116, v117
    v_cvt_pk_bf16_f32 v147, v118, v119
    v_exp_f32 v124, v124
    v_exp_f32 v125, v125
    v_mfma_f32_32x32x16_bf16 v[48:63], v[160:163], v[144:147], 0
    s_mov_b32 s23, 256
    v_exp_f32 v126, v126
    v_exp_f32 v127, v127
    v_cvt_pk_bf16_f32 v148, v120, v121
    v_cvt_pk_bf16_f32 v149, v122, v123
    v_cvt_pk_bf16_f32 v150, v124, v125
    v_cvt_pk_bf16_f32 v151, v126, v127
    v_mfma_f32_32x32x16_bf16 v[112:127], v[152:155], v[32:35], 0
    s_add_u32 m0, s18, 0
    s_add_u32 s7, s18, 4758528
    buffer_load_dwordx4 v2, s[24:27], s7 offen lds
    v_exp_f32 v128, v128
    v_exp_f32 v129, v129
    v_exp_f32 v130, v130
    v_exp_f32 v131, v131
    v_mfma_f32_32x32x16_bf16 v[112:127], v[156:159], v[36:39], v[112:127]
    s_add_u32 m0, s18, 4096
    s_add_u32 s7, s18, 4762624
    buffer_load_dwordx4 v2, s[24:27], s7 offen lds
    v_exp_f32 v132, v132
    v_exp_f32 v133, v133
    v_exp_f32 v134, v134
    v_exp_f32 v135, v135
    v_cvt_pk_bf16_f32 v144, v128, v129
    v_cvt_pk_bf16_f32 v145, v130, v131
    v_mfma_f32_32x32x16_bf16 v[48:63], v[164:167], v[148:151], v[48:63]
    ds_read_b128 v[168:171], v184 offset:1024
    v_exp_f32 v136, v136
    v_exp_f32 v137, v137
    v_exp_f32 v138, v138
    v_exp_f32 v139, v139
    v_cvt_pk_bf16_f32 v146, v132, v133
    v_cvt_pk_bf16_f32 v147, v134, v135
    v_exp_f32 v140, v140
    v_exp_f32 v141, v141
    v_mfma_f32_32x32x16_bf16 v[64:79], v[160:163], v[144:147], 0
    ds_read_b32 v172, v185 offset:128
    v_exp_f32 v142, v142
    v_exp_f32 v143, v143
    v_cvt_pk_bf16_f32 v148, v136, v137
    v_cvt_pk_bf16_f32 v149, v138, v139
    v_cvt_pk_bf16_f32 v150, v140, v141
    v_cvt_pk_bf16_f32 v151, v142, v143
    v_mfma_f32_32x32x16_bf16 v[128:143], v[152:155], v[40:43], 0
    ds_read_b128 v[176:179], v186 offset:64
    v_exp_f32 v112, v112
    v_exp_f32 v113, v113
    v_exp_f32 v114, v114
    v_exp_f32 v115, v115
    v_mfma_f32_32x32x16_bf16 v[128:143], v[156:159], v[44:47], v[128:143]
    ds_read_b128 v[180:183], v186 offset:96
    v_exp_f32 v116, v116
    v_exp_f32 v117, v117
    v_exp_f32 v118, v118
    v_exp_f32 v119, v119
    v_cvt_pk_bf16_f32 v144, v112, v113
    v_cvt_pk_bf16_f32 v145, v114, v115
    v_mfma_f32_32x32x16_bf16 v[64:79], v[164:167], v[148:151], v[64:79]
    s_add_u32 m0, s18, 8192
    s_add_u32 s7, s18, 4766720
    buffer_load_dwordx4 v2, s[24:27], s7 offen lds
    v_exp_f32 v120, v120
    v_exp_f32 v121, v121
    v_exp_f32 v122, v122
    v_exp_f32 v123, v123
    v_cvt_pk_bf16_f32 v146, v116, v117
    v_cvt_pk_bf16_f32 v147, v118, v119
    v_exp_f32 v124, v124
    v_exp_f32 v125, v125
    v_mfma_f32_32x32x16_bf16 v[80:95], v[160:163], v[144:147], 0
    s_waitcnt lgkmcnt(2)
    v_exp_f32 v126, v126
    v_exp_f32 v127, v127
    v_cvt_pk_bf16_f32 v148, v120, v121
    v_cvt_pk_bf16_f32 v149, v122, v123
    v_cvt_pk_bf16_f32 v150, v124, v125
    v_cvt_pk_bf16_f32 v151, v126, v127
    v_mfma_f32_32x32x16_bf16 v[112:127], v[168:171], v[16:19], 0
    s_add_u32 m0, s18, 12288
    s_add_u32 s7, s18, 4770816
    buffer_load_dwordx4 v2, s[24:27], s7 offen lds
    v_exp_f32 v128, v128
    v_exp_f32 v129, v129
    v_exp_f32 v130, v130
    v_exp_f32 v131, v131
    v_mfma_f32_32x32x16_bf16 v[112:127], v[172:175], v[20:23], v[112:127]
    s_add_u32 m0, s18, 16384
    s_add_u32 s7, s18, 4774912
    buffer_load_dwordx4 v2, s[24:27], s7 offen lds
    v_exp_f32 v132, v132
    v_exp_f32 v133, v133
    v_exp_f32 v134, v134
    v_exp_f32 v135, v135
    v_cvt_pk_bf16_f32 v144, v128, v129
    v_cvt_pk_bf16_f32 v145, v130, v131
    v_mfma_f32_32x32x16_bf16 v[80:95], v[164:167], v[148:151], v[80:95]
    s_add_u32 m0, s18, 20480
    s_add_u32 s7, s18, 4779008
    buffer_load_dwordx4 v2, s[24:27], s7 offen lds
    v_exp_f32 v136, v136
    v_exp_f32 v137, v137
    v_exp_f32 v138, v138
    v_exp_f32 v139, v139
    v_cvt_pk_bf16_f32 v146, v132, v133
    v_cvt_pk_bf16_f32 v147, v134, v135
    v_exp_f32 v140, v140
    v_exp_f32 v141, v141
    v_mfma_f32_32x32x16_bf16 v[96:111], v[160:163], v[144:147], 0
    s_waitcnt lgkmcnt(0)
    v_exp_f32 v142, v142
    v_exp_f32 v143, v143
    v_cvt_pk_bf16_f32 v148, v136, v137
    v_cvt_pk_bf16_f32 v149, v138, v139
    v_cvt_pk_bf16_f32 v150, v140, v141
    v_cvt_pk_bf16_f32 v151, v142, v143
    v_mfma_f32_32x32x16_bf16 v[128:143], v[168:171], v[24:27], 0
    s_add_u32 m0, s18, 24576
    s_add_u32 s7, s18, 4783104
    buffer_load_dwordx4 v2, s[24:27], s7 offen lds
    v_exp_f32 v112, v112
    v_exp_f32 v113, v113
    v_exp_f32 v114, v114
    v_exp_f32 v115, v115
    v_mfma_f32_32x32x16_bf16 v[128:143], v[172:175], v[28:31], v[128:143]
    s_add_u32 m0, s18, 28672
    s_add_u32 s7, s18, 4787200
    buffer_load_dwordx4 v2, s[24:27], s7 offen lds
    v_exp_f32 v116, v116
    v_exp_f32 v117, v117
    v_exp_f32 v118, v118
    v_exp_f32 v119, v119
    v_cvt_pk_bf16_f32 v144, v112, v113
    v_cvt_pk_bf16_f32 v145, v114, v115
    v_mfma_f32_32x32x16_bf16 v[96:111], v[164:167], v[148:151], v[96:111]
    s_add_u32 m0, s18, 32768
    s_add_u32 s7, s18, 4791296
    buffer_load_dwordx4 v2, s[24:27], s7 offen lds
    v_exp_f32 v120, v120
    v_exp_f32 v121, v121
    v_exp_f32 v122, v122
    v_exp_f32 v123, v123
    v_cvt_pk_bf16_f32 v146, v116, v117
    v_cvt_pk_bf16_f32 v147, v118, v119
    v_exp_f32 v124, v124
    v_exp_f32 v125, v125
    v_mfma_f32_32x32x16_bf16 v[48:63], v[176:179], v[144:147], v[48:63]
    s_add_u32 m0, s18, 36864
    s_add_u32 s7, s18, 4795392
    buffer_load_dwordx4 v2, s[24:27], s7 offen lds
    v_exp_f32 v126, v126
    v_exp_f32 v127, v127
    v_cvt_pk_bf16_f32 v148, v120, v121
    v_cvt_pk_bf16_f32 v149, v122, v123
    v_cvt_pk_bf16_f32 v150, v124, v125
    v_cvt_pk_bf16_f32 v151, v126, v127
    v_mfma_f32_32x32x16_bf16 v[112:127], v[168:171], v[32:35], 0
    s_add_u32 m0, s18, 40960
    s_add_u32 s7, s18, 4799488
    buffer_load_dwordx4 v2, s[24:27], s7 offen lds
    v_exp_f32 v128, v128
    v_exp_f32 v129, v129
    v_exp_f32 v130, v130
    v_exp_f32 v131, v131
    v_mfma_f32_32x32x16_bf16 v[112:127], v[172:175], v[36:39], v[112:127]
    s_add_u32 m0, s18, 45056
    s_add_u32 s7, s18, 4803584
    buffer_load_dwordx4 v2, s[24:27], s7 offen lds
    v_exp_f32 v132, v132
    v_exp_f32 v133, v133
    v_exp_f32 v134, v134
    v_exp_f32 v135, v135
    v_cvt_pk_bf16_f32 v144, v128, v129
    v_cvt_pk_bf16_f32 v145, v130, v131
    v_mfma_f32_32x32x16_bf16 v[48:63], v[180:183], v[148:151], v[48:63]
    ds_read_b128 v[152:155], v184 offset:2048
    v_exp_f32 v136, v136
    v_exp_f32 v137, v137
    v_exp_f32 v138, v138
    v_exp_f32 v139, v139
    v_cvt_pk_bf16_f32 v146, v132, v133
    v_cvt_pk_bf16_f32 v147, v134, v135
    v_exp_f32 v140, v140
    v_exp_f32 v141, v141
    v_mfma_f32_32x32x16_bf16 v[64:79], v[176:179], v[144:147], v[64:79]
    ds_read_b32 v156, v185 offset:256
    v_exp_f32 v142, v142
    v_exp_f32 v143, v143
    v_cvt_pk_bf16_f32 v148, v136, v137
    v_cvt_pk_bf16_f32 v149, v138, v139
    v_cvt_pk_bf16_f32 v150, v140, v141
    v_cvt_pk_bf16_f32 v151, v142, v143
    v_mfma_f32_32x32x16_bf16 v[128:143], v[168:171], v[40:43], 0
    ds_read_b128 v[160:163], v186 offset:128
    v_exp_f32 v112, v112
    v_exp_f32 v113, v113
    v_exp_f32 v114, v114
    v_exp_f32 v115, v115
    v_mfma_f32_32x32x16_bf16 v[128:143], v[172:175], v[44:47], v[128:143]
    ds_read_b128 v[164:167], v186 offset:160
    v_exp_f32 v116, v116
    v_exp_f32 v117, v117
    v_exp_f32 v118, v118
    v_exp_f32 v119, v119
    v_cvt_pk_bf16_f32 v144, v112, v113
    v_cvt_pk_bf16_f32 v145, v114, v115
    v_mfma_f32_32x32x16_bf16 v[64:79], v[180:183], v[148:151], v[64:79]
    s_add_u32 m0, s18, 49152
    s_add_u32 s7, s18, 4807680
    buffer_load_dwordx4 v2, s[24:27], s7 offen lds
    v_exp_f32 v120, v120
    v_exp_f32 v121, v121
    v_exp_f32 v122, v122
    v_exp_f32 v123, v123
    v_cvt_pk_bf16_f32 v146, v116, v117
    v_cvt_pk_bf16_f32 v147, v118, v119
    v_exp_f32 v124, v124
    v_exp_f32 v125, v125
    v_mfma_f32_32x32x16_bf16 v[80:95], v[176:179], v[144:147], v[80:95]
    s_waitcnt lgkmcnt(2)
    v_exp_f32 v126, v126
    v_exp_f32 v127, v127
    v_cvt_pk_bf16_f32 v148, v120, v121
    v_cvt_pk_bf16_f32 v149, v122, v123
    v_cvt_pk_bf16_f32 v150, v124, v125
    v_cvt_pk_bf16_f32 v151, v126, v127
    v_mfma_f32_32x32x16_bf16 v[112:127], v[152:155], v[16:19], 0
    s_add_u32 m0, s18, 53248
    s_add_u32 s7, s18, 4811776
    buffer_load_dwordx4 v2, s[24:27], s7 offen lds
    v_exp_f32 v128, v128
    v_exp_f32 v129, v129
    v_exp_f32 v130, v130
    v_exp_f32 v131, v131
    v_mfma_f32_32x32x16_bf16 v[112:127], v[156:159], v[20:23], v[112:127]
    s_add_u32 m0, s18, 57344
    s_add_u32 s7, s18, 4815872
    buffer_load_dwordx4 v2, s[24:27], s7 offen lds
    v_exp_f32 v132, v132
    v_exp_f32 v133, v133
    v_exp_f32 v134, v134
    v_exp_f32 v135, v135
    v_cvt_pk_bf16_f32 v144, v128, v129
    v_cvt_pk_bf16_f32 v145, v130, v131
    v_mfma_f32_32x32x16_bf16 v[80:95], v[180:183], v[148:151], v[80:95]
    s_add_u32 m0, s18, 61440
    s_add_u32 s7, s18, 4819968
    buffer_load_dwordx4 v2, s[24:27], s7 offen lds
    v_exp_f32 v136, v136
    v_exp_f32 v137, v137
    v_exp_f32 v138, v138
    v_exp_f32 v139, v139
    v_cvt_pk_bf16_f32 v146, v132, v133
    v_cvt_pk_bf16_f32 v147, v134, v135
    v_exp_f32 v140, v140
    v_exp_f32 v141, v141
    v_mfma_f32_32x32x16_bf16 v[96:111], v[176:179], v[144:147], v[96:111]
    s_waitcnt lgkmcnt(0)
    v_exp_f32 v142, v142
    v_exp_f32 v143, v143
    v_cvt_pk_bf16_f32 v148, v136, v137
    v_cvt_pk_bf16_f32 v149, v138, v139
    v_cvt_pk_bf16_f32 v150, v140, v141
    v_cvt_pk_bf16_f32 v151, v142, v143
    v_mfma_f32_32x32x16_bf16 v[128:143], v[152:155], v[24:27], 0
    s_add_u32 m0, s18, 65536
    s_add_u32 s7, s18, 4824064
    buffer_load_dwordx4 v2, s[24:27], s7 offen lds
    v_exp_f32 v112, v112
    v_exp_f32 v113, v113
    v_exp_f32 v114, v114
    v_exp_f32 v115, v115
    v_mfma_f32_32x32x16_bf16 v[128:143], v[156:159], v[28:31], v[128:143]
    s_add_u32 m0, s18, 69632
    s_add_u32 s7, s18, 4828160
    buffer_load_dwordx4 v2, s[24:27], s7 offen lds
    v_exp_f32 v116, v116
    v_exp_f32 v117, v117
    v_exp_f32 v118, v118
    v_exp_f32 v119, v119
    v_cvt_pk_bf16_f32 v144, v112, v113
    v_cvt_pk_bf16_f32 v145, v114, v115
    v_mfma_f32_32x32x16_bf16 v[96:111], v[180:183], v[148:151], v[96:111]
    s_add_u32 m0, s18, 73728
    s_add_u32 s7, s18, 4832256
    buffer_load_dwordx4 v2, s[24:27], s7 offen lds
    v_exp_f32 v120, v120
    v_exp_f32 v121, v121
    v_exp_f32 v122, v122
    v_exp_f32 v123, v123
    v_cvt_pk_bf16_f32 v146, v116, v117
    v_cvt_pk_bf16_f32 v147, v118, v119
    v_exp_f32 v124, v124
    v_exp_f32 v125, v125
    v_mfma_f32_32x32x16_bf16 v[48:63], v[160:163], v[144:147], v[48:63]
    s_add_u32 m0, s18, 77824
    s_add_u32 s7, s18, 4836352
    buffer_load_dwordx4 v2, s[24:27], s7 offen lds
    v_exp_f32 v126, v126
    v_exp_f32 v127, v127
    v_cvt_pk_bf16_f32 v148, v120, v121
    v_cvt_pk_bf16_f32 v149, v122, v123
    v_cvt_pk_bf16_f32 v150, v124, v125
    v_cvt_pk_bf16_f32 v151, v126, v127
    v_mfma_f32_32x32x16_bf16 v[112:127], v[152:155], v[32:35], 0
    s_add_u32 m0, s18, 81920
    s_add_u32 s7, s18, 4840448
    buffer_load_dwordx4 v2, s[24:27], s7 offen lds
    v_exp_f32 v128, v128
    v_exp_f32 v129, v129
    v_exp_f32 v130, v130
    v_exp_f32 v131, v131
    v_mfma_f32_32x32x16_bf16 v[112:127], v[156:159], v[36:39], v[112:127]
    s_add_u32 m0, s18, 86016
    s_add_u32 s7, s18, 4844544
    buffer_load_dwordx4 v2, s[24:27], s7 offen lds
    v_exp_f32 v132, v132
    v_exp_f32 v133, v133
    v_exp_f32 v134, v134
    v_exp_f32 v135, v135
    v_cvt_pk_bf16_f32 v144, v128, v129
    v_cvt_pk_bf16_f32 v145, v130, v131
    v_mfma_f32_32x32x16_bf16 v[48:63], v[164:167], v[148:151], v[48:63]
    ds_read_b128 v[168:171], v184 offset:3072
    v_exp_f32 v136, v136
    v_exp_f32 v137, v137
    v_exp_f32 v138, v138
    v_exp_f32 v139, v139
    v_cvt_pk_bf16_f32 v146, v132, v133
    v_cvt_pk_bf16_f32 v147, v134, v135
    v_exp_f32 v140, v140
    v_exp_f32 v141, v141
    v_mfma_f32_32x32x16_bf16 v[64:79], v[160:163], v[144:147], v[64:79]
    ds_read_b32 v172, v185 offset:384
    v_exp_f32 v142, v142
    v_exp_f32 v143, v143
    v_cvt_pk_bf16_f32 v148, v136, v137
    v_cvt_pk_bf16_f32 v149, v138, v139
    v_cvt_pk_bf16_f32 v150, v140, v141
    v_cvt_pk_bf16_f32 v151, v142, v143
    v_mfma_f32_32x32x16_bf16 v[128:143], v[152:155], v[40:43], 0
    ds_read_b128 v[176:179], v186 offset:192
    v_exp_f32 v112, v112
    v_exp_f32 v113, v113
    v_exp_f32 v114, v114
    v_exp_f32 v115, v115
    v_mfma_f32_32x32x16_bf16 v[128:143], v[156:159], v[44:47], v[128:143]
    ds_read_b128 v[180:183], v186 offset:224
    v_exp_f32 v116, v116
    v_exp_f32 v117, v117
    v_exp_f32 v118, v118
    v_exp_f32 v119, v119
    v_cvt_pk_bf16_f32 v144, v112, v113
    v_cvt_pk_bf16_f32 v145, v114, v115
    v_mfma_f32_32x32x16_bf16 v[64:79], v[164:167], v[148:151], v[64:79]
    s_add_u32 m0, s18, 90112
    s_add_u32 s7, s18, 4848640
    buffer_load_dwordx4 v2, s[24:27], s7 offen lds
    v_exp_f32 v120, v120
    v_exp_f32 v121, v121
    v_exp_f32 v122, v122
    v_exp_f32 v123, v123
    v_cvt_pk_bf16_f32 v146, v116, v117
    v_cvt_pk_bf16_f32 v147, v118, v119
    v_exp_f32 v124, v124
    v_exp_f32 v125, v125
    v_mfma_f32_32x32x16_bf16 v[80:95], v[160:163], v[144:147], v[80:95]
    s_waitcnt lgkmcnt(2)
    v_exp_f32 v126, v126
    v_exp_f32 v127, v127
    v_cvt_pk_bf16_f32 v148, v120, v121
    v_cvt_pk_bf16_f32 v149, v122, v123
    v_cvt_pk_bf16_f32 v150, v124, v125
    v_cvt_pk_bf16_f32 v151, v126, v127
    v_mfma_f32_32x32x16_bf16 v[112:127], v[168:171], v[16:19], 0
    s_add_u32 m0, s18, 94208
    s_add_u32 s7, s18, 4852736
    buffer_load_dwordx4 v2, s[24:27], s7 offen lds
    v_exp_f32 v128, v128
    v_exp_f32 v129, v129
    v_exp_f32 v130, v130
    v_exp_f32 v131, v131
    v_mfma_f32_32x32x16_bf16 v[112:127], v[172:175], v[20:23], v[112:127]
    s_add_u32 m0, s18, 98304
    s_add_u32 s7, s18, 4856832
    buffer_load_dwordx4 v2, s[24:27], s7 offen lds
    v_exp_f32 v132, v132
    v_exp_f32 v133, v133
    v_exp_f32 v134, v134
    v_exp_f32 v135, v135
    v_cvt_pk_bf16_f32 v144, v128, v129
    v_cvt_pk_bf16_f32 v145, v130, v131
    v_mfma_f32_32x32x16_bf16 v[80:95], v[164:167], v[148:151], v[80:95]
    s_add_u32 m0, s18, 102400
    s_add_u32 s7, s18, 4860928
    buffer_load_dwordx4 v2, s[24:27], s7 offen lds
    v_exp_f32 v136, v136
    v_exp_f32 v137, v137
    v_exp_f32 v138, v138
    v_exp_f32 v139, v139
    v_cvt_pk_bf16_f32 v146, v132, v133
    v_cvt_pk_bf16_f32 v147, v134, v135
    v_exp_f32 v140, v140
    v_exp_f32 v141, v141
    v_mfma_f32_32x32x16_bf16 v[96:111], v[160:163], v[144:147], v[96:111]
    s_waitcnt lgkmcnt(0)
    v_exp_f32 v142, v142
    v_exp_f32 v143, v143
    v_cvt_pk_bf16_f32 v148, v136, v137
    v_cvt_pk_bf16_f32 v149, v138, v139
    v_cvt_pk_bf16_f32 v150, v140, v141
    v_cvt_pk_bf16_f32 v151, v142, v143
    v_mfma_f32_32x32x16_bf16 v[128:143], v[168:171], v[24:27], 0
    s_add_u32 m0, s18, 106496
    s_add_u32 s7, s18, 4865024
    buffer_load_dwordx4 v2, s[24:27], s7 offen lds
    v_exp_f32 v112, v112
    v_exp_f32 v113, v113
    v_exp_f32 v114, v114
    v_exp_f32 v115, v115
    v_mfma_f32_32x32x16_bf16 v[128:143], v[172:175], v[28:31], v[128:143]
    s_add_u32 m0, s18, 110592
    s_add_u32 s7, s18, 4869120
    buffer_load_dwordx4 v2, s[24:27], s7 offen lds
    v_exp_f32 v116, v116
    v_exp_f32 v117, v117
    v_exp_f32 v118, v118
    v_exp_f32 v119, v119
    v_cvt_pk_bf16_f32 v144, v112, v113
    v_cvt_pk_bf16_f32 v145, v114, v115
    v_mfma_f32_32x32x16_bf16 v[96:111], v[164:167], v[148:151], v[96:111]
    s_add_u32 m0, s18, 114688
    s_add_u32 s7, s18, 4873216
    buffer_load_dwordx4 v2, s[24:27], s7 offen lds
    v_exp_f32 v120, v120
    v_exp_f32 v121, v121
    v_exp_f32 v122, v122
    v_exp_f32 v123, v123
    v_cvt_pk_bf16_f32 v146, v116, v117
    v_cvt_pk_bf16_f32 v147, v118, v119
    v_exp_f32 v124, v124
    v_exp_f32 v125, v125
    v_mfma_f32_32x32x16_bf16 v[48:63], v[176:179], v[144:147], v[48:63]
    s_cmp_eq_u32 s5, 0
    s_cselect_b32 s19, 4096, 0
    s_add_u32 s19, s19, 114688
    s_add_u32 m0, s18, s19
    s_add_u32 s7, s18, 4758528
    s_add_u32 s7, s7, s19
    buffer_load_dwordx4 v2, s[24:27], s7 offen lds
    v_exp_f32 v126, v126
    v_exp_f32 v127, v127
    v_cvt_pk_bf16_f32 v148, v120, v121
    v_cvt_pk_bf16_f32 v149, v122, v123
    v_cvt_pk_bf16_f32 v150, v124, v125
    v_cvt_pk_bf16_f32 v151, v126, v127
    v_mfma_f32_32x32x16_bf16 v[112:127], v[168:171], v[32:35], 0
    buffer_load_dword v204, v201, s[28:31], s17 offen
    v_exp_f32 v128, v128
    v_exp_f32 v129, v129
    v_exp_f32 v130, v130
    v_exp_f32 v131, v131
    v_mfma_f32_32x32x16_bf16 v[112:127], v[172:175], v[36:39], v[112:127]
    buffer_load_dword v205, v201, s[28:31], s16 offen
    v_add_u32 v184, s21, v184
    v_add_u32 v185, s22, v185
    v_exp_f32 v132, v132
    v_exp_f32 v133, v133
    v_exp_f32 v134, v134
    v_exp_f32 v135, v135
    v_cvt_pk_bf16_f32 v144, v128, v129
    v_cvt_pk_bf16_f32 v145, v130, v131
    v_mfma_f32_32x32x16_bf16 v[48:63], v[180:183], v[148:151], v[48:63]
    ds_read_b128 v[152:155], v184 offset:0
    v_exp_f32 v136, v136
    v_exp_f32 v137, v137
    v_exp_f32 v138, v138
    v_exp_f32 v139, v139
    v_cvt_pk_bf16_f32 v146, v132, v133
    v_cvt_pk_bf16_f32 v147, v134, v135
    v_exp_f32 v140, v140
    v_exp_f32 v141, v141
    v_mfma_f32_32x32x16_bf16 v[64:79], v[176:179], v[144:147], v[64:79]
    ds_read_b32 v156, v185 offset:0
    v_exp_f32 v142, v142
    v_exp_f32 v143, v143
    v_cvt_pk_bf16_f32 v148, v136, v137
    v_cvt_pk_bf16_f32 v149, v138, v139
    v_cvt_pk_bf16_f32 v150, v140, v141
    v_cvt_pk_bf16_f32 v151, v142, v143
    v_mfma_f32_32x32x16_bf16 v[128:143], v[168:171], v[40:43], 0
    v_add_u32 v186, s23, v186
    ds_read_b128 v[160:163], v186 offset:0
    v_exp_f32 v112, v112
    v_exp_f32 v113, v113
    v_exp_f32 v114, v114
    v_exp_f32 v115, v115
    v_mfma_f32_32x32x16_bf16 v[128:143], v[172:175], v[44:47], v[128:143]
    ds_read_b128 v[164:167], v186 offset:32
    v_exp_f32 v116, v116
    v_exp_f32 v117, v117
    v_exp_f32 v118, v118
    v_exp_f32 v119, v119
    v_cvt_pk_bf16_f32 v144, v112, v113
    v_cvt_pk_bf16_f32 v145, v114, v115
    v_mfma_f32_32x32x16_bf16 v[64:79], v[180:183], v[148:151], v[64:79]
    buffer_load_dword v206, v201, s[32:35], s17 offen
    v_exp_f32 v120, v120
    v_exp_f32 v121, v121
    v_exp_f32 v122, v122
    v_exp_f32 v123, v123
    v_cvt_pk_bf16_f32 v146, v116, v117
    v_cvt_pk_bf16_f32 v147, v118, v119
    v_exp_f32 v124, v124
    v_exp_f32 v125, v125
    v_mfma_f32_32x32x16_bf16 v[80:95], v[176:179], v[144:147], v[80:95]
    s_waitcnt lgkmcnt(2)
    v_exp_f32 v126, v126
    v_exp_f32 v127, v127
    v_cvt_pk_bf16_f32 v148, v120, v121
    v_cvt_pk_bf16_f32 v149, v122, v123
    v_cvt_pk_bf16_f32 v150, v124, v125
    v_cvt_pk_bf16_f32 v151, v126, v127
    v_mfma_f32_32x32x16_bf16 v[112:127], v[152:155], v[16:19], 0
    buffer_load_dword v207, v201, s[32:35], s16 offen
    v_exp_f32 v128, v128
    v_exp_f32 v129, v129
    v_exp_f32 v130, v130
    v_exp_f32 v131, v131
    v_mfma_f32_32x32x16_bf16 v[112:127], v[156:159], v[20:23], v[112:127]
    s_sub_u32 s15, s15, 1
    v_exp_f32 v132, v132
    v_exp_f32 v133, v133
    v_exp_f32 v134, v134
    v_exp_f32 v135, v135
    v_cvt_pk_bf16_f32 v144, v128, v129
    v_cvt_pk_bf16_f32 v145, v130, v131
    v_mfma_f32_32x32x16_bf16 v[80:95], v[180:183], v[148:151], v[80:95]
    v_exp_f32 v136, v136
    v_exp_f32 v137, v137
    v_exp_f32 v138, v138
    v_exp_f32 v139, v139
    v_cvt_pk_bf16_f32 v146, v132, v133
    v_cvt_pk_bf16_f32 v147, v134, v135
    v_exp_f32 v140, v140
    v_exp_f32 v141, v141
    v_mfma_f32_32x32x16_bf16 v[96:111], v[176:179], v[144:147], v[96:111]
    s_waitcnt lgkmcnt(0)
    v_exp_f32 v142, v142
    v_exp_f32 v143, v143
    v_cvt_pk_bf16_f32 v148, v136, v137
    v_cvt_pk_bf16_f32 v149, v138, v139
    v_cvt_pk_bf16_f32 v150, v140, v141
    v_cvt_pk_bf16_f32 v151, v142, v143
A_loop:
    v_mfma_f32_32x32x16_bf16 v[128:143], v[152:155], v[24:27], 0
    s_and_b32 s19, s15, s20
    v_exp_f32 v112, v112
    v_exp_f32 v113, v113
    v_exp_f32 v114, v114
    v_exp_f32 v115, v115
    v_mfma_f32_32x32x16_bf16 v[128:143], v[156:159], v[28:31], v[128:143]
    s_mov_b32 s9, 39936
    v_exp_f32 v116, v116
    v_exp_f32 v117, v117
    v_exp_f32 v118, v118
    v_exp_f32 v119, v119
    v_cvt_pk_bf16_f32 v144, v112, v113
    v_cvt_pk_bf16_f32 v145, v114, v115
    v_mfma_f32_32x32x16_bf16 v[96:111], v[180:183], v[148:151], v[96:111]
    v_exp_f32 v120, v120
    v_exp_f32 v121, v121
    v_exp_f32 v122, v122
    v_exp_f32 v123, v123
    v_cvt_pk_bf16_f32 v146, v116, v117
    v_cvt_pk_bf16_f32 v147, v118, v119
    v_exp_f32 v124, v124
    v_exp_f32 v125, v125
    v_mfma_f32_32x32x16_bf16 v[48:63], v[160:163], v[144:147], v[48:63]
    s_cmp_eq_u32 s15, 13
    v_exp_f32 v126, v126
    v_exp_f32 v127, v127
    v_cvt_pk_bf16_f32 v148, v120, v121
    v_cvt_pk_bf16_f32 v149, v122, v123
    v_cvt_pk_bf16_f32 v150, v124, v125
    v_cvt_pk_bf16_f32 v151, v126, v127
    v_mfma_f32_32x32x16_bf16 v[112:127], v[152:155], v[32:35], 0
    v_exp_f32 v128, v128
    v_exp_f32 v129, v129
    v_exp_f32 v130, v130
    v_exp_f32 v131, v131
    v_mfma_f32_32x32x16_bf16 v[112:127], v[156:159], v[36:39], v[112:127]
    v_exp_f32 v132, v132
    v_exp_f32 v133, v133
    v_exp_f32 v134, v134
    v_exp_f32 v135, v135
    v_cvt_pk_bf16_f32 v144, v128, v129
    v_cvt_pk_bf16_f32 v145, v130, v131
    v_mfma_f32_32x32x16_bf16 v[48:63], v[164:167], v[148:151], v[48:63]
    ds_read_b128 v[168:171], v184 offset:1024
    v_exp_f32 v136, v136
    v_exp_f32 v137, v137
    v_exp_f32 v138, v138
    v_exp_f32 v139, v139
    v_cvt_pk_bf16_f32 v146, v132, v133
    v_cvt_pk_bf16_f32 v147, v134, v135
    v_exp_f32 v140, v140
    v_exp_f32 v141, v141
    v_mfma_f32_32x32x16_bf16 v[64:79], v[160:163], v[144:147], v[64:79]
    ds_read_b32 v172, v185 offset:128
    v_exp_f32 v142, v142
    v_exp_f32 v143, v143
    v_cvt_pk_bf16_f32 v148, v136, v137
    v_cvt_pk_bf16_f32 v149, v138, v139
    v_cvt_pk_bf16_f32 v150, v140, v141
    v_cvt_pk_bf16_f32 v151, v142, v143
    v_mfma_f32_32x32x16_bf16 v[128:143], v[152:155], v[40:43], 0
    ds_read_b128 v[176:179], v186 offset:64
    v_exp_f32 v112, v112
    v_exp_f32 v113, v113
    v_exp_f32 v114, v114
    v_exp_f32 v115, v115
    v_mfma_f32_32x32x16_bf16 v[128:143], v[156:159], v[44:47], v[128:143]
    ds_read_b128 v[180:183], v186 offset:96
    v_exp_f32 v116, v116
    v_exp_f32 v117, v117
    v_exp_f32 v118, v118
    v_exp_f32 v119, v119
    v_cvt_pk_bf16_f32 v144, v112, v113
    v_cvt_pk_bf16_f32 v145, v114, v115
    v_mfma_f32_32x32x16_bf16 v[64:79], v[164:167], v[148:151], v[64:79]
    v_exp_f32 v120, v120
    v_exp_f32 v121, v121
    v_exp_f32 v122, v122
    v_exp_f32 v123, v123
    v_cvt_pk_bf16_f32 v146, v116, v117
    v_cvt_pk_bf16_f32 v147, v118, v119
    v_exp_f32 v124, v124
    v_exp_f32 v125, v125
    v_mfma_f32_32x32x16_bf16 v[80:95], v[160:163], v[144:147], v[80:95]
    s_waitcnt lgkmcnt(2)
    v_exp_f32 v126, v126
    v_exp_f32 v127, v127
    v_cvt_pk_bf16_f32 v148, v120, v121
    v_cvt_pk_bf16_f32 v149, v122, v123
    v_cvt_pk_bf16_f32 v150, v124, v125
    v_cvt_pk_bf16_f32 v151, v126, v127
    v_mfma_f32_32x32x16_bf16 v[112:127], v[168:171], v[16:19], 0
    s_cselect_b32 s9, 4294847488, s9
    v_exp_f32 v128, v128
    v_exp_f32 v129, v129
    v_exp_f32 v130, v130
    v_exp_f32 v131, v131
    v_mfma_f32_32x32x16_bf16 v[112:127], v[172:175], v[20:23], v[112:127]
    s_sub_u32 s21, s9, 12288
    v_exp_f32 v132, v132
    v_exp_f32 v133, v133
    v_exp_f32 v134, v134
    v_exp_f32 v135, v135
    v_cvt_pk_bf16_f32 v144, v128, v129
    v_cvt_pk_bf16_f32 v145, v130, v131
    v_mfma_f32_32x32x16_bf16 v[80:95], v[164:167], v[148:151], v[80:95]
    s_sub_u32 s22, s9, 1536
    v_exp_f32 v136, v136
    v_exp_f32 v137, v137
    v_exp_f32 v138, v138
    v_exp_f32 v139, v139
    v_cvt_pk_bf16_f32 v146, v132, v133
    v_cvt_pk_bf16_f32 v147, v134, v135
    v_exp_f32 v140, v140
    v_exp_f32 v141, v141
    v_mfma_f32_32x32x16_bf16 v[96:111], v[160:163], v[144:147], v[96:111]
    s_sub_u32 s23, s9, 768
    s_waitcnt lgkmcnt(0)
    v_exp_f32 v142, v142
    v_exp_f32 v143, v143
    v_cvt_pk_bf16_f32 v148, v136, v137
    v_cvt_pk_bf16_f32 v149, v138, v139
    v_cvt_pk_bf16_f32 v150, v140, v141
    v_cvt_pk_bf16_f32 v151, v142, v143
    v_mfma_f32_32x32x16_bf16 v[128:143], v[168:171], v[24:27], 0
    s_and_b32 s9, s15, 3
    v_exp_f32 v112, v112
    v_exp_f32 v113, v113
    v_exp_f32 v114, v114
    v_exp_f32 v115, v115
    v_mfma_f32_32x32x16_bf16 v[128:143], v[172:175], v[28:31], v[128:143]
    s_cmp_eq_u32 s9, 1
    v_exp_f32 v116, v116
    v_exp_f32 v117, v117
    v_exp_f32 v118, v118
    v_exp_f32 v119, v119
    v_cvt_pk_bf16_f32 v144, v112, v113
    v_cvt_pk_bf16_f32 v145, v114, v115
    v_mfma_f32_32x32x16_bf16 v[96:111], v[164:167], v[148:151], v[96:111]
    v_exp_f32 v120, v120
    v_exp_f32 v121, v121
    v_exp_f32 v122, v122
    v_exp_f32 v123, v123
    v_cvt_pk_bf16_f32 v146, v116, v117
    v_cvt_pk_bf16_f32 v147, v118, v119
    v_exp_f32 v124, v124
    v_exp_f32 v125, v125
    v_mfma_f32_32x32x16_bf16 v[48:63], v[176:179], v[144:147], v[48:63]
    s_cselect_b32 s21, s21, 4096
    v_exp_f32 v126, v126
    v_exp_f32 v127, v127
    v_cvt_pk_bf16_f32 v148, v120, v121
    v_cvt_pk_bf16_f32 v149, v122, v123
    v_cvt_pk_bf16_f32 v150, v124, v125
    v_cvt_pk_bf16_f32 v151, v126, v127
    v_mfma_f32_32x32x16_bf16 v[112:127], v[168:171], v[32:35], 0
    v_exp_f32 v128, v128
    v_exp_f32 v129, v129
    v_exp_f32 v130, v130
    v_exp_f32 v131, v131
    v_mfma_f32_32x32x16_bf16 v[112:127], v[172:175], v[36:39], v[112:127]
    v_exp_f32 v132, v132
    v_exp_f32 v133, v133
    v_exp_f32 v134, v134
    v_exp_f32 v135, v135
    v_cvt_pk_bf16_f32 v144, v128, v129
    v_cvt_pk_bf16_f32 v145, v130, v131
    v_mfma_f32_32x32x16_bf16 v[48:63], v[180:183], v[148:151], v[48:63]
    ds_read_b128 v[152:155], v184 offset:2048
    v_exp_f32 v136, v136
    v_exp_f32 v137, v137
    v_exp_f32 v138, v138
    v_exp_f32 v139, v139
    v_cvt_pk_bf16_f32 v146, v132, v133
    v_cvt_pk_bf16_f32 v147, v134, v135
    v_exp_f32 v140, v140
    v_exp_f32 v141, v141
    v_mfma_f32_32x32x16_bf16 v[64:79], v[176:179], v[144:147], v[64:79]
    ds_read_b32 v156, v185 offset:256
    v_exp_f32 v142, v142
    v_exp_f32 v143, v143
    v_cvt_pk_bf16_f32 v148, v136, v137
    v_cvt_pk_bf16_f32 v149, v138, v139
    v_cvt_pk_bf16_f32 v150, v140, v141
    v_cvt_pk_bf16_f32 v151, v142, v143
    v_mfma_f32_32x32x16_bf16 v[128:143], v[168:171], v[40:43], 0
    ds_read_b128 v[160:163], v186 offset:128
    v_exp_f32 v112, v112
    v_exp_f32 v113, v113
    v_exp_f32 v114, v114
    v_exp_f32 v115, v115
    v_mfma_f32_32x32x16_bf16 v[128:143], v[172:175], v[44:47], v[128:143]
    ds_read_b128 v[164:167], v186 offset:160
    v_exp_f32 v116, v116
    v_exp_f32 v117, v117
    v_exp_f32 v118, v118
    v_exp_f32 v119, v119
    v_cvt_pk_bf16_f32 v144, v112, v113
    v_cvt_pk_bf16_f32 v145, v114, v115
    v_mfma_f32_32x32x16_bf16 v[64:79], v[180:183], v[148:151], v[64:79]
    v_exp_f32 v120, v120
    v_exp_f32 v121, v121
    v_exp_f32 v122, v122
    v_exp_f32 v123, v123
    v_cvt_pk_bf16_f32 v146, v116, v117
    v_cvt_pk_bf16_f32 v147, v118, v119
    v_exp_f32 v124, v124
    v_exp_f32 v125, v125
    v_mfma_f32_32x32x16_bf16 v[80:95], v[176:179], v[144:147], v[80:95]
    s_waitcnt lgkmcnt(2)
    v_exp_f32 v126, v126
    v_exp_f32 v127, v127
    v_cvt_pk_bf16_f32 v148, v120, v121
    v_cvt_pk_bf16_f32 v149, v122, v123
    v_cvt_pk_bf16_f32 v150, v124, v125
    v_cvt_pk_bf16_f32 v151, v126, v127
    v_mfma_f32_32x32x16_bf16 v[112:127], v[152:155], v[16:19], 0
    s_cselect_b32 s22, s22, 512
    v_exp_f32 v128, v128
    v_exp_f32 v129, v129
    v_exp_f32 v130, v130
    v_exp_f32 v131, v131
    v_mfma_f32_32x32x16_bf16 v[112:127], v[156:159], v[20:23], v[112:127]
    s_cselect_b32 s23, s23, 256
    v_exp_f32 v132, v132
    v_exp_f32 v133, v133
    v_exp_f32 v134, v134
    v_exp_f32 v135, v135
    v_cvt_pk_bf16_f32 v144, v128, v129
    v_cvt_pk_bf16_f32 v145, v130, v131
    v_mfma_f32_32x32x16_bf16 v[80:95], v[180:183], v[148:151], v[80:95]
    v_exp_f32 v136, v136
    v_exp_f32 v137, v137
    v_exp_f32 v138, v138
    v_exp_f32 v139, v139
    v_cvt_pk_bf16_f32 v146, v132, v133
    v_cvt_pk_bf16_f32 v147, v134, v135
    v_exp_f32 v140, v140
    v_exp_f32 v141, v141
    v_mfma_f32_32x32x16_bf16 v[96:111], v[176:179], v[144:147], v[96:111]
    s_waitcnt lgkmcnt(0)
    v_exp_f32 v142, v142
    v_exp_f32 v143, v143
    v_cvt_pk_bf16_f32 v148, v136, v137
    v_cvt_pk_bf16_f32 v149, v138, v139
    v_cvt_pk_bf16_f32 v150, v140, v141
    v_cvt_pk_bf16_f32 v151, v142, v143
    v_mfma_f32_32x32x16_bf16 v[128:143], v[152:155], v[24:27], 0
    v_exp_f32 v112, v112
    v_exp_f32 v113, v113
    v_exp_f32 v114, v114
    v_exp_f32 v115, v115
    v_mfma_f32_32x32x16_bf16 v[128:143], v[156:159], v[28:31], v[128:143]
    v_exp_f32 v116, v116
    v_exp_f32 v117, v117
    v_exp_f32 v118, v118
    v_exp_f32 v119, v119
    v_cvt_pk_bf16_f32 v144, v112, v113
    v_cvt_pk_bf16_f32 v145, v114, v115
    v_mfma_f32_32x32x16_bf16 v[96:111], v[180:183], v[148:151], v[96:111]
    v_exp_f32 v120, v120
    v_exp_f32 v121, v121
    v_exp_f32 v122, v122
    v_exp_f32 v123, v123
    v_cvt_pk_bf16_f32 v146, v116, v117
    v_cvt_pk_bf16_f32 v147, v118, v119
    v_exp_f32 v124, v124
    v_exp_f32 v125, v125
    v_mfma_f32_32x32x16_bf16 v[48:63], v[160:163], v[144:147], v[48:63]
    v_exp_f32 v126, v126
    v_exp_f32 v127, v127
    v_cvt_pk_bf16_f32 v148, v120, v121
    v_cvt_pk_bf16_f32 v149, v122, v123
    v_cvt_pk_bf16_f32 v150, v124, v125
    v_cvt_pk_bf16_f32 v151, v126, v127
    v_mfma_f32_32x32x16_bf16 v[112:127], v[152:155], v[32:35], 0
    v_exp_f32 v128, v128
    v_exp_f32 v129, v129
    v_exp_f32 v130, v130
    v_exp_f32 v131, v131
    v_mfma_f32_32x32x16_bf16 v[112:127], v[156:159], v[36:39], v[112:127]
    v_exp_f32 v132, v132
    v_exp_f32 v133, v133
    v_exp_f32 v134, v134
    v_exp_f32 v135, v135
    v_cvt_pk_bf16_f32 v144, v128, v129
    v_cvt_pk_bf16_f32 v145, v130, v131
    v_mfma_f32_32x32x16_bf16 v[48:63], v[164:167], v[148:151], v[48:63]
    ds_read_b128 v[168:171], v184 offset:3072
    v_exp_f32 v136, v136
    v_exp_f32 v137, v137
    v_exp_f32 v138, v138
    v_exp_f32 v139, v139
    v_cvt_pk_bf16_f32 v146, v132, v133
    v_cvt_pk_bf16_f32 v147, v134, v135
    v_exp_f32 v140, v140
    v_exp_f32 v141, v141
    v_mfma_f32_32x32x16_bf16 v[64:79], v[160:163], v[144:147], v[64:79]
    ds_read_b32 v172, v185 offset:384
    v_exp_f32 v142, v142
    v_exp_f32 v143, v143
    v_cvt_pk_bf16_f32 v148, v136, v137
    v_cvt_pk_bf16_f32 v149, v138, v139
    v_cvt_pk_bf16_f32 v150, v140, v141
    v_cvt_pk_bf16_f32 v151, v142, v143
    v_mfma_f32_32x32x16_bf16 v[128:143], v[152:155], v[40:43], 0
    ds_read_b128 v[176:179], v186 offset:192
    v_exp_f32 v112, v112
    v_exp_f32 v113, v113
    v_exp_f32 v114, v114
    v_exp_f32 v115, v115
    v_mfma_f32_32x32x16_bf16 v[128:143], v[156:159], v[44:47], v[128:143]
    ds_read_b128 v[180:183], v186 offset:224
    v_exp_f32 v116, v116
    v_exp_f32 v117, v117
    v_exp_f32 v118, v118
    v_exp_f32 v119, v119
    v_cvt_pk_bf16_f32 v144, v112, v113
    v_cvt_pk_bf16_f32 v145, v114, v115
    v_mfma_f32_32x32x16_bf16 v[64:79], v[164:167], v[148:151], v[64:79]
    v_exp_f32 v120, v120
    v_exp_f32 v121, v121
    v_exp_f32 v122, v122
    v_exp_f32 v123, v123
    v_cvt_pk_bf16_f32 v146, v116, v117
    v_cvt_pk_bf16_f32 v147, v118, v119
    v_exp_f32 v124, v124
    v_exp_f32 v125, v125
    v_mfma_f32_32x32x16_bf16 v[80:95], v[160:163], v[144:147], v[80:95]
    s_waitcnt lgkmcnt(2)
    v_exp_f32 v126, v126
    v_exp_f32 v127, v127
    v_cvt_pk_bf16_f32 v148, v120, v121
    v_cvt_pk_bf16_f32 v149, v122, v123
    v_cvt_pk_bf16_f32 v150, v124, v125
    v_cvt_pk_bf16_f32 v151, v126, v127
    v_mfma_f32_32x32x16_bf16 v[112:127], v[168:171], v[16:19], 0
    v_exp_f32 v128, v128
    v_exp_f32 v129, v129
    v_exp_f32 v130, v130
    v_exp_f32 v131, v131
    v_mfma_f32_32x32x16_bf16 v[112:127], v[172:175], v[20:23], v[112:127]
    v_exp_f32 v132, v132
    v_exp_f32 v133, v133
    v_exp_f32 v134, v134
    v_exp_f32 v135, v135
    v_cvt_pk_bf16_f32 v144, v128, v129
    v_cvt_pk_bf16_f32 v145, v130, v131
    v_mfma_f32_32x32x16_bf16 v[80:95], v[164:167], v[148:151], v[80:95]
    v_exp_f32 v136, v136
    v_exp_f32 v137, v137
    v_exp_f32 v138, v138
    v_exp_f32 v139, v139
    v_cvt_pk_bf16_f32 v146, v132, v133
    v_cvt_pk_bf16_f32 v147, v134, v135
    v_exp_f32 v140, v140
    v_exp_f32 v141, v141
    v_mfma_f32_32x32x16_bf16 v[96:111], v[160:163], v[144:147], v[96:111]
    s_waitcnt lgkmcnt(0)
    v_exp_f32 v142, v142
    v_exp_f32 v143, v143
    v_cvt_pk_bf16_f32 v148, v136, v137
    v_cvt_pk_bf16_f32 v149, v138, v139
    v_cvt_pk_bf16_f32 v150, v140, v141
    v_cvt_pk_bf16_f32 v151, v142, v143
    v_mfma_f32_32x32x16_bf16 v[128:143], v[168:171], v[24:27], 0
    v_exp_f32 v112, v112
    v_exp_f32 v113, v113
    v_exp_f32 v114, v114
    v_exp_f32 v115, v115
    v_mfma_f32_32x32x16_bf16 v[128:143], v[172:175], v[28:31], v[128:143]
    v_exp_f32 v116, v116
    v_exp_f32 v117, v117
    v_exp_f32 v118, v118
    v_exp_f32 v119, v119
    v_cvt_pk_bf16_f32 v144, v112, v113
    v_cvt_pk_bf16_f32 v145, v114, v115
    v_mfma_f32_32x32x16_bf16 v[96:111], v[164:167], v[148:151], v[96:111]
    v_exp_f32 v120, v120
    v_exp_f32 v121, v121
    v_exp_f32 v122, v122
    v_exp_f32 v123, v123
    v_cvt_pk_bf16_f32 v146, v116, v117
    v_cvt_pk_bf16_f32 v147, v118, v119
    v_exp_f32 v124, v124
    v_exp_f32 v125, v125
    v_mfma_f32_32x32x16_bf16 v[48:63], v[176:179], v[144:147], v[48:63]
    v_exp_f32 v126, v126
    v_exp_f32 v127, v127
    v_cvt_pk_bf16_f32 v148, v120, v121
    v_cvt_pk_bf16_f32 v149, v122, v123
    v_cvt_pk_bf16_f32 v150, v124, v125
    v_cvt_pk_bf16_f32 v151, v126, v127
    v_mfma_f32_32x32x16_bf16 v[112:127], v[168:171], v[32:35], 0
    s_cmp_lg_u32 s19, 13
    v_exp_f32 v128, v128
    v_exp_f32 v129, v129
    v_exp_f32 v130, v130
    v_exp_f32 v131, v131
    v_mfma_f32_32x32x16_bf16 v[112:127], v[172:175], v[36:39], v[112:127]
    s_cbranch_scc1 A_nost
    s_waitcnt vmcnt(0)
    s_barrier
A_nost:
    v_add_u32 v184, s21, v184
    v_add_u32 v185, s22, v185
    v_exp_f32 v132, v132
    v_exp_f32 v133, v133
    v_exp_f32 v134, v134
    v_exp_f32 v135, v135
    v_cvt_pk_bf16_f32 v144, v128, v129
    v_cvt_pk_bf16_f32 v145, v130, v131
    v_mfma_f32_32x32x16_bf16 v[48:63], v[180:183], v[148:151], v[48:63]
    ds_read_b128 v[152:155], v184 offset:0
    v_exp_f32 v136, v136
    v_exp_f32 v137, v137
    v_exp_f32 v138, v138
    v_exp_f32 v139, v139
    v_cvt_pk_bf16_f32 v146, v132, v133
    v_cvt_pk_bf16_f32 v147, v134, v135
    v_exp_f32 v140, v140
    v_exp_f32 v141, v141
    v_mfma_f32_32x32x16_bf16 v[64:79], v[176:179], v[144:147], v[64:79]
    ds_read_b32 v156, v185 offset:0
    v_exp_f32 v142, v142
    v_exp_f32 v143, v143
    v_cvt_pk_bf16_f32 v148, v136, v137
    v_cvt_pk_bf16_f32 v149, v138, v139
    v_cvt_pk_bf16_f32 v150, v140, v141
    v_cvt_pk_bf16_f32 v151, v142, v143
    v_mfma_f32_32x32x16_bf16 v[128:143], v[168:171], v[40:43], 0
    v_add_u32 v186, s23, v186
    ds_read_b128 v[160:163], v186 offset:0
    v_exp_f32 v112, v112
    v_exp_f32 v113, v113
    v_exp_f32 v114, v114
    v_exp_f32 v115, v115
    v_mfma_f32_32x32x16_bf16 v[128:143], v[172:175], v[44:47], v[128:143]
    ds_read_b128 v[164:167], v186 offset:32
    v_exp_f32 v116, v116
    v_exp_f32 v117, v117
    v_exp_f32 v118, v118
    v_exp_f32 v119, v119
    v_cvt_pk_bf16_f32 v144, v112, v113
    v_cvt_pk_bf16_f32 v145, v114, v115
    v_mfma_f32_32x32x16_bf16 v[64:79], v[180:183], v[148:151], v[64:79]
    v_exp_f32 v120, v120
    v_exp_f32 v121, v121
    v_exp_f32 v122, v122
    v_exp_f32 v123, v123
    v_cvt_pk_bf16_f32 v146, v116, v117
    v_cvt_pk_bf16_f32 v147, v118, v119
    v_exp_f32 v124, v124
    v_exp_f32 v125, v125
    v_mfma_f32_32x32x16_bf16 v[80:95], v[176:179], v[144:147], v[80:95]
    s_waitcnt lgkmcnt(2)
    v_exp_f32 v126, v126
    v_exp_f32 v127, v127
    v_cvt_pk_bf16_f32 v148, v120, v121
    v_cvt_pk_bf16_f32 v149, v122, v123
    v_cvt_pk_bf16_f32 v150, v124, v125
    v_cvt_pk_bf16_f32 v151, v126, v127
    v_mfma_f32_32x32x16_bf16 v[112:127], v[152:155], v[16:19], 0
    v_exp_f32 v128, v128
    v_exp_f32 v129, v129
    v_exp_f32 v130, v130
    v_exp_f32 v131, v131
    v_mfma_f32_32x32x16_bf16 v[112:127], v[156:159], v[20:23], v[112:127]
    s_sub_u32 s15, s15, 1
    v_exp_f32 v132, v132
    v_exp_f32 v133, v133
    v_exp_f32 v134, v134
    v_exp_f32 v135, v135
    v_cvt_pk_bf16_f32 v144, v128, v129
    v_cvt_pk_bf16_f32 v145, v130, v131
    v_mfma_f32_32x32x16_bf16 v[80:95], v[180:183], v[148:151], v[80:95]
    s_cmp_lg_u32 s15, 0
    v_exp_f32 v136, v136
    v_exp_f32 v137, v137
    v_exp_f32 v138, v138
    v_exp_f32 v139, v139
    v_cvt_pk_bf16_f32 v146, v132, v133
    v_cvt_pk_bf16_f32 v147, v134, v135
    v_exp_f32 v140, v140
    v_exp_f32 v141, v141
    v_mfma_f32_32x32x16_bf16 v[96:111], v[176:179], v[144:147], v[96:111]
    s_waitcnt lgkmcnt(0)
    v_exp_f32 v142, v142
    v_exp_f32 v143, v143
    v_cvt_pk_bf16_f32 v148, v136, v137
    v_cvt_pk_bf16_f32 v149, v138, v139
    v_cvt_pk_bf16_f32 v150, v140, v141
    v_cvt_pk_bf16_f32 v151, v142, v143
    s_cbranch_scc1 A_loop
    s_nop 1
    v_mfma_f32_32x32x16_bf16 v[96:111], v[180:183], v[148:151], v[96:111]
    s_nop 7
    s_nop 3
    s_cmp_lg_u32 s14, 0
    s_cbranch_scc1 A_fin
    v_mov_b32 v10, 0x2b800000
    s_mov_b64 s[16:17], 0
    v_cmp_nge_f32 vcc, v58, v10
    s_nop 1
    s_or_b64 s[16:17], s[16:17], vcc
    v_cmp_nge_f32 vcc, v74, v10
    s_nop 1
    s_or_b64 s[16:17], s[16:17], vcc
    v_cmp_nge_f32 vcc, v90, v10
    s_nop 1
    s_or_b64 s[16:17], s[16:17], vcc
    v_cmp_nge_f32 vcc, v106, v10
    s_nop 1
    s_or_b64 s[16:17], s[16:17], vcc
    s_and_b32 s16, s16, -1
    s_cbranch_scc0 A_fin
    s_mov_b32 s14, 1
    v_mov_b32 v21, 0
    v_mov_b32 v48, 0xff800000
    v_mov_b32 v29, 0
    v_mov_b32 v64, 0xff800000
    v_mov_b32 v37, 0
    v_mov_b32 v80, 0xff800000
    v_mov_b32 v45, 0
    v_mov_b32 v96, 0xff800000
    s_mov_b32 s15, 0
A_max:
    s_lshr_b32 s9, s15, 4
    s_mul_i32 s9, s9, 39936
    s_and_b32 s10, s15, 15
    s_lshl_b32 s11, s10, 10
    s_add_u32 s11, s11, s9
    v_add_u32 v184, s11, v2
    s_lshl_b32 s11, s10, 7
    s_add_u32 s11, s11, s9
    s_add_u32 s11, s11, 16384
    v_add_u32 v185, s11, v4
    ds_read_b128 v[152:155], v184 offset:0
    ds_read_b32 v156, v185 offset:0
    s_waitcnt lgkmcnt(0)
    v_mfma_f32_32x32x16_bf16 v[112:127], v[152:155], v[16:19], 0
    v_mfma_f32_32x32x16_bf16 v[112:127], v[156:159], v[20:23], v[112:127]
    s_nop 7
    s_nop 3
    v_max3_f32 v48, v112, v113, v48
    v_max3_f32 v48, v114, v115, v48
    v_max3_f32 v48, v116, v117, v48
    v_max3_f32 v48, v118, v119, v48
    v_max3_f32 v48, v120, v121, v48
    v_max3_f32 v48, v122, v123, v48
    v_max3_f32 v48, v124, v125, v48
    v_max3_f32 v48, v126, v127, v48
    v_mfma_f32_32x32x16_bf16 v[112:127], v[152:155], v[24:27], 0
    v_mfma_f32_32x32x16_bf16 v[112:127], v[156:159], v[28:31], v[112:127]
    s_nop 7
    s_nop 3
    v_max3_f32 v64, v112, v113, v64
    v_max3_f32 v64, v114, v115, v64
    v_max3_f32 v64, v116, v117, v64
    v_max3_f32 v64, v118, v119, v64
    v_max3_f32 v64, v120, v121, v64
    v_max3_f32 v64, v122, v123, v64
    v_max3_f32 v64, v124, v125, v64
    v_max3_f32 v64, v126, v127, v64
    v_mfma_f32_32x32x16_bf16 v[112:127], v[152:155], v[32:35], 0
    v_mfma_f32_32x32x16_bf16 v[112:127], v[156:159], v[36:39], v[112:127]
    s_nop 7
    s_nop 3
    v_max3_f32 v80, v112, v113, v80
    v_max3_f32 v80, v114, v115, v80
    v_max3_f32 v80, v116, v117, v80
    v_max3_f32 v80, v118, v119, v80
    v_max3_f32 v80, v120, v121, v80
    v_max3_f32 v80, v122, v123, v80
    v_max3_f32 v80, v124, v125, v80
    v_max3_f32 v80, v126, v127, v80
    v_mfma_f32_32x32x16_bf16 v[112:127], v[152:155], v[40:43], 0
    v_mfma_f32_32x32x16_bf16 v[112:127], v[156:159], v[44:47], v[112:127]
    s_nop 7
    s_nop 3
    v_max3_f32 v96, v112, v113, v96
    v_max3_f32 v96, v114, v115, v96
    v_max3_f32 v96, v116, v117, v96
    v_max3_f32 v96, v118, v119, v96
    v_max3_f32 v96, v120, v121, v96
    v_max3_f32 v96, v122, v123, v96
    v_max3_f32 v96, v124, v125, v96
    v_max3_f32 v96, v126, v127, v96
    s_add_u32 s15, s15, 1
    s_cmp_lg_u32 s15, 64
    s_cbranch_scc1 A_max
    v_mov_b32 v8, v48
    v_mov_b32 v9, v48
    s_nop 1
    v_permlane32_swap_b32 v8, v9
    s_nop 1
    v_max_f32 v8, v8, v9
    v_sub_f32 v8, 0, v8
    v_cvt_pk_bf16_f32 v9, v8, v8
    v_lshlrev_b32 v9, 16, v9
    v_sub_f32 v9, v8, v9
    v_cvt_pk_bf16_f32 v9, v8, v9
    v_cndmask_b32 v21, 0, v9, s[12:13]
    v_mov_b32 v8, v64
    v_mov_b32 v9, v64
    s_nop 1
    v_permlane32_swap_b32 v8, v9
    s_nop 1
    v_max_f32 v8, v8, v9
    v_sub_f32 v8, 0, v8
    v_cvt_pk_bf16_f32 v9, v8, v8
    v_lshlrev_b32 v9, 16, v9
    v_sub_f32 v9, v8, v9
    v_cvt_pk_bf16_f32 v9, v8, v9
    v_cndmask_b32 v29, 0, v9, s[12:13]
    v_mov_b32 v8, v80
    v_mov_b32 v9, v80
    s_nop 1
    v_permlane32_swap_b32 v8, v9
    s_nop 1
    v_max_f32 v8, v8, v9
    v_sub_f32 v8, 0, v8
    v_cvt_pk_bf16_f32 v9, v8, v8
    v_lshlrev_b32 v9, 16, v9
    v_sub_f32 v9, v8, v9
    v_cvt_pk_bf16_f32 v9, v8, v9
    v_cndmask_b32 v37, 0, v9, s[12:13]
    v_mov_b32 v8, v96
    v_mov_b32 v9, v96
    s_nop 1
    v_permlane32_swap_b32 v8, v9
    s_nop 1
    v_max_f32 v8, v8, v9
    v_sub_f32 v8, 0, v8
    v_cvt_pk_bf16_f32 v9, v8, v8
    v_lshlrev_b32 v9, 16, v9
    v_sub_f32 v9, v8, v9
    v_cvt_pk_bf16_f32 v9, v8, v9
    v_cndmask_b32 v45, 0, v9, s[12:13]
    s_branch A_run
A_fin:
    s_lshl_b32 s8, s6, 5
    s_lshl_b32 s9, s3, 2
    s_add_u32 s8, s8, s9
    s_lshl_b32 s8, s8, 10
    s_add_u32 s8, s8, 4894720
    s_lshl_b32 s9, s6, 12
    s_lshr_b32 s10, s3, 1
    s_lshl_b32 s10, s10, 10
    s_add_u32 s9, s9, s10
    s_and_b32 s10, s3, 1
    s_lshl_b32 s10, s10, 9
    s_add_u32 s9, s9, s10
    s_add_u32 s9, s9, 6991872
    v_lshlrev_b32 v10, 4, v3
    v_mov_b32 v8, v58
    v_mov_b32 v9, v58
    s_nop 1
    v_permlane32_swap_b32 v8, v9
    s_nop 1
    v_rcp_f32 v8, v8
    s_nop 0
    v_mul_f32 v48, v8, v48
    v_mul_f32 v49, v8, v49
    v_mul_f32 v50, v8, v50
    v_mul_f32 v51, v8, v51
    v_mul_f32 v52, v8, v52
    v_mul_f32 v53, v8, v53
    v_mul_f32 v54, v8, v54
    v_mul_f32 v55, v8, v55
    v_mul_f32 v56, v8, v56
    v_mul_f32 v57, v8, v57
    v_cvt_pk_bf16_f32 v188, v48, v49
    v_cvt_pk_bf16_f32 v189, v50, v51
    v_cvt_pk_bf16_f32 v190, v52, v53
    v_cvt_pk_bf16_f32 v191, v54, v55
    v_cvt_pk_bf16_f32 v192, v56, v57
    buffer_store_dwordx4 v[188:191], v2, s[24:27], s8 offen offset:0 sc1
    s_mov_b32 exec_hi, 0
    buffer_store_dword v192, v10, s[24:27], s9 offen offset:0 sc1
    s_mov_b32 exec_hi, -1
    s_nop 1
    v_mov_b32 v8, v74
    v_mov_b32 v9, v74
    s_nop 1
    v_permlane32_swap_b32 v8, v9
    s_nop 1
    v_rcp_f32 v8, v8
    s_nop 0
    v_mul_f32 v64, v8, v64
    v_mul_f32 v65, v8, v65
    v_mul_f32 v66, v8, v66
    v_mul_f32 v67, v8, v67
    v_mul_f32 v68, v8, v68
    v_mul_f32 v69, v8, v69
    v_mul_f32 v70, v8, v70
    v_mul_f32 v71, v8, v71
    v_mul_f32 v72, v8, v72
    v_mul_f32 v73, v8, v73
    v_cvt_pk_bf16_f32 v188, v64, v65
    v_cvt_pk_bf16_f32 v189, v66, v67
    v_cvt_pk_bf16_f32 v190, v68, v69
    v_cvt_pk_bf16_f32 v191, v70, v71
    v_cvt_pk_bf16_f32 v192, v72, v73
    buffer_store_dwordx4 v[188:191], v2, s[24:27], s8 offen offset:1024 sc1
    s_mov_b32 exec_hi, 0
    buffer_store_dword v192, v10, s[24:27], s9 offen offset:4 sc1
    s_mov_b32 exec_hi, -1
    s_nop 1
    v_mov_b32 v8, v90
    v_mov_b32 v9, v90
    s_nop 1
    v_permlane32_swap_b32 v8, v9
    s_nop 1
    v_rcp_f32 v8, v8
    s_nop 0
    v_mul_f32 v80, v8, v80
    v_mul_f32 v81, v8, v81
    v_mul_f32 v82, v8, v82
    v_mul_f32 v83, v8, v83
    v_mul_f32 v84, v8, v84
    v_mul_f32 v85, v8, v85
    v_mul_f32 v86, v8, v86
    v_mul_f32 v87, v8, v87
    v_mul_f32 v88, v8, v88
    v_mul_f32 v89, v8, v89
    v_cvt_pk_bf16_f32 v188, v80, v81
    v_cvt_pk_bf16_f32 v189, v82, v83
    v_cvt_pk_bf16_f32 v190, v84, v85
    v_cvt_pk_bf16_f32 v191, v86, v87
    v_cvt_pk_bf16_f32 v192, v88, v89
    buffer_store_dwordx4 v[188:191], v2, s[24:27], s8 offen offset:2048 sc1
    s_mov_b32 exec_hi, 0
    buffer_store_dword v192, v10, s[24:27], s9 offen offset:8 sc1
    s_mov_b32 exec_hi, -1
    s_nop 1
    v_mov_b32 v8, v106
    v_mov_b32 v9, v106
    s_nop 1
    v_permlane32_swap_b32 v8, v9
    s_nop 1
    v_rcp_f32 v8, v8
    s_nop 0
    v_mul_f32 v96, v8, v96
    v_mul_f32 v97, v8, v97
    v_mul_f32 v98, v8, v98
    v_mul_f32 v99, v8, v99
    v_mul_f32 v100, v8, v100
    v_mul_f32 v101, v8, v101
    v_mul_f32 v102, v8, v102
    v_mul_f32 v103, v8, v103
    v_mul_f32 v104, v8, v104
    v_mul_f32 v105, v8, v105
    v_cvt_pk_bf16_f32 v188, v96, v97
    v_cvt_pk_bf16_f32 v189, v98, v99
    v_cvt_pk_bf16_f32 v190, v100, v101
    v_cvt_pk_bf16_f32 v191, v102, v103
    v_cvt_pk_bf16_f32 v192, v104, v105
    buffer_store_dwordx4 v[188:191], v2, s[24:27], s8 offen offset:3072 sc1
    s_mov_b32 exec_hi, 0
    buffer_store_dword v192, v10, s[24:27], s9 offen offset:12 sc1
    s_mov_b32 exec_hi, -1
    s_nop 1
    s_waitcnt vmcnt(0)
    s_barrier
    s_cmp_lg_u32 s5, 0
    s_cbranch_scc1 A_nf
    s_lshl_b32 s9, s4, 7
    s_lshl_b32 s10, s3, 2
    s_add_u32 s9, s9, s10
    s_add_u32 s9, s9, 29360192
    s_mov_b64 exec, 1
    v_mov_b32 v8, 0
    v_mov_b32 v9, s98
    buffer_store_dword v9, v8, s[24:27], s9 offen sc1
    s_mov_b64 exec, -1
A_nf:
    s_mov_b64 s[94:95], exec
    s_cmp_eq_u32 s5, 0
    s_cselect_b64 exec, 1, 0
    v_mov_b32 v8, 0
    v_mov_b32 v9, 1
    s_cbranch_execz L_arr1
    buffer_atomic_add v9, v8, s[60:63], 0 offen offset:4
L_arr1:
    s_mov_b64 exec, s[94:95]
    s_endpgm
MK_end:
    s_endpgm
MK_codeend:
.section .rodata,"a"
.p2align 6
.amdhsa_kernel gated_mix__grouped_kv_mqa__mixer_channel_mlp__prompt_kernel
  .amdhsa_next_free_vgpr 512
  .amdhsa_next_free_sgpr 100
  .amdhsa_accum_offset 256
  .amdhsa_group_segment_fixed_size 0
  .amdhsa_kernarg_size 112
  .amdhsa_user_sgpr_count 2
  .amdhsa_user_sgpr_kernarg_segment_ptr 1
  .amdhsa_system_sgpr_workgroup_id_x 1
.end_amdhsa_kernel
```
